```python
import torch

def _softmax(x, axis=-1):
    return torch.softmax(x, dim=axis)
def _gelu(x):
    return torch.nn.functional.gelu(x, approximate="tanh")
def _silu(x):
    return torch.nn.functional.silu(x)
def _sigmoid(x):
    return torch.sigmoid(x)
def _layernorm(x, axis=-1, eps=1e-5):
    m = x.mean(dim=axis, keepdim=True)
    v = x.var(dim=axis, keepdim=True, unbiased=False)
    return (x - m) / torch.sqrt(v + eps)
def _scatter_add(tgt, idx, src, axis=0):
    return tgt.clone().index_add_(axis, idx, src)
def _segment_sum(src, seg, n):
    out = torch.zeros((n,) + src.shape[1:], dtype=src.dtype)
    return out.index_add_(0, seg, src)
def _pad(x, pw):
    flat = tuple(v for pair in reversed(pw) for v in pair)
    return torch.nn.functional.pad(x, flat)

kernel_name = 'parallel_sum__ssm_conv_h3__dense_activation_mish__prompt'

def setup_inputs():

    _w = (lambda a: (lambda t: t.to(torch.bfloat16) if t.is_floating_point() else t)(torch.as_tensor(a)))
    def _A_setup():
        B, S, D = 1, 2048, 576
        ks = 4
        return {
            "q": _w((lambda *s: torch.randn(*s, dtype=torch.bfloat16) * 0.05)(B, S, D)),
            "k": _w((lambda *s: torch.randn(*s, dtype=torch.bfloat16) * 0.2)(B, S, D)),
            "v": _w((lambda *s: torch.randn(*s, dtype=torch.bfloat16) * 0.2)(B, S, D)),
            "shift_k": _w((lambda *s: torch.randn(*s, dtype=torch.bfloat16) * 0.2)(D, ks) * 0.5),
            "ssm_k": _w((lambda *s: torch.randn(*s, dtype=torch.bfloat16) * 0.8)(D, S) * (1.0 / S ** 0.5)),
            "ssm_D": _w((lambda *s: torch.randn(*s, dtype=torch.bfloat16) * 0.2)(D)),
        }
    _A_in = _A_setup()

    def _B_setup():
        B, S, D, F = 1, 2048, 576, 4608
        return {
            "x": _w((lambda *s: torch.randn(*s, dtype=torch.bfloat16) * 0.05)(B, S, D)),
            "w1": _w((lambda *s: torch.randn(*s, dtype=torch.bfloat16) * 0.8)(D, F) * (D ** -0.5)),
            "b1": _w((lambda *s: torch.randn(*s, dtype=torch.bfloat16) * 0.2)(F)),
            "w2": _w((lambda *s: torch.randn(*s, dtype=torch.bfloat16) * 0.1)(F, D) * (F ** -0.5)),
        }
    _B_in = _B_setup()

    return {
        "A_q": _A_in["q"],
        "A_k": _A_in["k"],
        "A_v": _A_in["v"],
        "A_shift_k": _A_in["shift_k"],
        "A_ssm_k": _A_in["ssm_k"],
        "A_ssm_D": _A_in["ssm_D"],
        "B_x": _B_in["x"],
        "B_w1": _B_in["w1"],
        "B_b1": _B_in["b1"],
        "B_w2": _B_in["w2"],
    }

def reference(A_q, A_k, A_v, A_shift_k, A_ssm_k, A_ssm_D, B_x, B_w1, B_b1, B_w2):
    def _A_ref(q, k, v, shift_k, ssm_k, ssm_D):
        B, S, D = q.shape
        ks = shift_k.shape[-1]
        k_pad = _pad(k, ((0, 0), (ks - 1, 0), (0, 0)))
        k_shift = torch.zeros_like(k)
        for t in range(ks):
            k_shift = k_shift + k_pad[:, t:t + S, :] * shift_k[:, ks - 1 - t][None, None, :]
        kv = k_shift * v
        L = 2 * S
        kv_pad = _pad(kv, ((0, 0), (0, S), (0, 0)))
        kf_pad = _pad(ssm_k, ((0, 0), (0, S)))
        kv_f = (lambda x, axes=(-2,-1): torch.fft.rfft2(x.float(), dim=axes))(kv_pad[:, None, :, :], axes=(1, 2))
        kf_f = (lambda x, axes=(-2,-1): torch.fft.rfft2(x.float(), dim=axes))(kf_pad[:, None, :], axes=(1, 2))
        kf_f = (lambda x, *d: x.permute(*d))(kf_f, 1, 2, 0)
        y_f = kv_f * kf_f[None, :, :, :]
        y = (lambda x, s, axes=(-2,-1): torch.fft.irfft2(x, s=s, dim=axes).to(torch.bfloat16))(y_f, (1, L), axes=(1, 2))[:, 0, :S, :]
        y = y + kv * ssm_D[None, None, :]
        return q * y

    def _B_ref(x, w1, b1, w2):
        h = torch.einsum("bsd,df->bsf", x, w1) + b1
        sp = torch.log1p(torch.exp(-torch.abs(h))) + torch.where(h > 0, h, torch.zeros_like(h))
        act = h * torch.tanh(sp)
        return torch.einsum("bsf,fd->bsd", act, w2)

    x = A_q
    xn = _layernorm(x, axis=-1)
    return x + _A_ref(xn, A_k, A_v, A_shift_k, A_ssm_k, A_ssm_D) + _B_ref(xn, B_w1, B_b1, B_w2)
```

```asm
; @launch grid=(256,1,1) block=(512,1,1) lds=163840
.amdgcn_target "amdgcn-amd-amdhsa--gfx950"
.text
.globl parallel_sum__ssm_conv_h3__dense_activation_mish__prompt_kernel
.p2align 8
.type parallel_sum__ssm_conv_h3__dense_activation_mish__prompt_kernel,@function
parallel_sum__ssm_conv_h3__dense_activation_mish__prompt_kernel:
    s_cmp_ge_u32 s2, 256
    s_cbranch_scc1 Lend_1
    s_mov_b32 s5, 0x80000
    s_cmp_ge_u32 s2, 192
    s_cbranch_scc1 Lhelp_2
    s_load_dwordx2 s[8:9], s[0:1], 0
    s_load_dwordx2 s[12:13], s[0:1], 56
    s_load_dwordx2 s[24:25], s[0:1], 64
    s_load_dwordx2 s[16:17], s[0:1], 72
    s_load_dwordx2 s[20:21], s[0:1], 96
    s_load_dwordx2 s[52:53], s[0:1], 88
    v_lshrrev_b32 v240, 6, v0
    v_and_b32 v241, 63, v0
    v_readfirstlane_b32 s30, v240
    s_lshr_b32 s56, s2, 3
    s_mul_i32 s57, s56, 11
    s_lshr_b32 s57, s57, 5
    s_mul_i32 s58, s57, 3
    s_sub_u32 s56, s56, s58
    s_and_b32 s58, s2, 3
    s_mul_i32 s58, s58, 3
    s_add_u32 s29, s56, s58
    s_bfe_u32 s56, s2, 0x10002
    s_lshl_b32 s56, s56, 3
    s_add_u32 s28, s56, s57
    s_and_b32 s31, s30, 3
    s_lshr_b32 s32, s30, 2
    v_lshrrev_b32 v242, 3, v241
    v_and_b32 v243, 7, v241
    s_lshl_b32 s57, s31, 5
    s_lshl_b32 s58, s32, 3
    s_add_u32 s57, s57, s58
    s_lshl_b32 s56, s28, 7
    s_add_u32 s56, s56, s57
    v_add_u32 v245, s56, v242
    v_mul_u32_u24 v245, 1152, v245
    v_lshl_add_u32 v245, v243, 4, v245
    s_and_b32 s4, s29, 1
    s_mul_i32 s36, s4, 18432
    s_sub_u32 s3, 18432, s36
    s_waitcnt lgkmcnt(0)
    s_and_b32 s9, s9, 0xffff
    s_mov_b32 s10, 2359296
    s_mov_b32 s11, 0x00020000
    buffer_load_dwordx4 v[144:147], v245, s[8:11], s36 offen offset:0
    buffer_load_dwordx4 v[148:151], v245, s[8:11], s36 offen offset:128
    buffer_load_dwordx4 v[152:155], v245, s[8:11], s36 offen offset:256
    buffer_load_dwordx4 v[156:159], v245, s[8:11], s36 offen offset:384
    buffer_load_dwordx4 v[160:163], v245, s[8:11], s36 offen offset:512
    buffer_load_dwordx4 v[164:167], v245, s[8:11], s36 offen offset:640
    buffer_load_dwordx4 v[168:171], v245, s[8:11], s36 offen offset:768
    buffer_load_dwordx4 v[172:175], v245, s[8:11], s36 offen offset:896
    buffer_load_dwordx4 v[176:179], v245, s[8:11], s36 offen offset:1024
    s_and_b32 s13, s13, 0xffff
    s_mov_b32 s14, 5308416
    s_mov_b32 s15, 0x00020000
    s_and_b32 s25, s25, 0xffff
    s_mov_b32 s26, 9216
    s_mov_b32 s27, 0x00020000
    s_and_b32 s17, s17, 0xffff
    s_mov_b32 s18, 5308416
    s_mov_b32 s19, 0x00020000
    s_and_b32 s21, s21, 0xffff
    s_mov_b32 s22, 49049600
    s_mov_b32 s23, 0x00020000
    s_and_b32 s53, s53, 0xffff
    s_mov_b32 s54, 256
    s_mov_b32 s55, 0x00020000
    s_mul_i32 s33, s29, 768
    s_mul_i32 s34, s29, 442368
    s_lshl_b32 s64, s31, 10
    s_mov_b32 s63, 0x3f803f80
    v_lshlrev_b32 v239, 4, v241
    s_lshl_b32 s56, s31, 3
    v_add_u32 v249, s56, v242
    v_mul_u32_u24 v232, 9216, v249
    v_bfe_u32 v248, v242, 1, 1
    s_and_b32 s56, s30, 1
    s_lshl_b32 s56, s56, 1
    v_or_b32 v248, s56, v248
    v_lshlrev_b32 v248, 1, v248
    v_xor_b32 v248, v248, v243
    v_lshl_add_u32 v232, v248, 4, v232
    v_mul_u32_u24 v233, 1152, v249
    v_and_b32 v248, 6, v242
    v_xor_b32 v248, v248, v243
    v_lshl_add_u32 v233, v248, 4, v233
    v_lshlrev_b32 v246, 1, v0
    v_lshrrev_b32 v250, 4, v241
    v_bfe_u32 v251, v241, 2, 2
    v_and_b32 v252, 3, v241
    v_lshrrev_b32 v248, 1, v251
    v_and_b32 v249, 1, v250
    v_lshl_or_b32 v253, v249, 1, v248
    s_lshl_b32 s56, s32, 1
    v_xor_b32 v248, s56, v253
    v_lshlrev_b32 v248, 5, v248
    v_lshl_add_u32 v248, v250, 10, v248
    v_lshl_add_u32 v248, v251, 7, v248
    v_lshl_add_u32 v228, v252, 3, v248
    v_xor_b32 v229, 32, v228
    v_add_u32 v231, 0x8000, v229
    v_add_u32 v230, 0x8000, v228
    s_lshr_b32 s56, s30, 1
    v_xor_b32 v248, s56, v253
    v_lshlrev_b32 v248, 5, v248
    v_lshl_add_u32 v248, v250, 9, v248
    v_lshl_add_u32 v248, v251, 7, v248
    v_lshl_add_u32 v238, v252, 3, v248
    s_lshl_b32 s56, s32, 7
    s_add_u32 s56, s56, 155648
    v_lshl_add_u32 v236, v250, 4, s56
    s_lshl_b32 s56, s31, 11
    s_add_u32 s56, s56, 73728
    v_add_u32 v235, s56, v239
    s_mul_i32 s56, s31, 18432
    s_add_u32 s56, s56, 73728
    s_lshl_b32 s57, s32, 3
    v_add_u32 v248, s57, v242
    v_xor_b32 v248, v248, v243
    v_lshlrev_b32 v248, 4, v248
    v_lshl_add_u32 v248, v243, 8, v248
    v_add_u32 v254, s56, v248
    v_and_b32 v249, 15, v241
    v_xor_b32 v249, v249, v250
    v_lshlrev_b32 v249, 4, v249
    v_lshl_add_u32 v249, v250, 8, v249
    v_add_u32 v255, s56, v249
    v_xor_b32 v248, 64, v255
    s_mul_i32 s58, s29, 36864
    s_lshl_b32 s56, s28, 2
    s_and_b32 s57, s30, 1
    s_lshl_b32 s57, s57, 1
    s_add_u32 s56, s56, s57
    s_mul_i32 s56, s56, 479232
    s_add_u32 s58, s58, s56
    s_lshr_b32 s56, s30, 1
    s_lshl_b32 s56, s56, 10
    s_add_u32 s58, s58, s56
    s_lshl_b32 s56, s4, 8
    v_xor_b32 v237, s56, v239
    v_add_u32 v237, s58, v237
    s_lshl_b32 s56, s28, 9
    s_lshl_b32 s57, s29, 3
    s_add_u32 s56, s56, s57
    s_add_u32 s56, s56, 44847104
    s_cmp_eq_u32 s30, 4
    s_cselect_b32 s35, s56, 0x7ffffff0
    s_cmp_lg_u32 s32, 0
    s_cbranch_scc1 Lph1_3
    v_mov_b32 v216, 0
    v_mov_b32 v217, 0
    v_mov_b32 v218, 0
    v_mov_b32 v219, 0
    s_waitcnt vmcnt(8)
    v_dot2c_f32_bf16 v216, s63, v144
    v_dot2c_f32_bf16 v218, v144, v144
    v_dot2c_f32_bf16 v217, s63, v145
    v_dot2c_f32_bf16 v219, v145, v145
    v_dot2c_f32_bf16 v216, s63, v146
    v_dot2c_f32_bf16 v218, v146, v146
    v_dot2c_f32_bf16 v217, s63, v147
    v_dot2c_f32_bf16 v219, v147, v147
    s_waitcnt vmcnt(7)
    v_dot2c_f32_bf16 v216, s63, v148
    v_dot2c_f32_bf16 v218, v148, v148
    v_dot2c_f32_bf16 v217, s63, v149
    v_dot2c_f32_bf16 v219, v149, v149
    v_dot2c_f32_bf16 v216, s63, v150
    v_dot2c_f32_bf16 v218, v150, v150
    v_dot2c_f32_bf16 v217, s63, v151
    v_dot2c_f32_bf16 v219, v151, v151
    s_waitcnt vmcnt(6)
    v_dot2c_f32_bf16 v216, s63, v152
    v_dot2c_f32_bf16 v218, v152, v152
    v_dot2c_f32_bf16 v217, s63, v153
    v_dot2c_f32_bf16 v219, v153, v153
    v_dot2c_f32_bf16 v216, s63, v154
    v_dot2c_f32_bf16 v218, v154, v154
    v_dot2c_f32_bf16 v217, s63, v155
    v_dot2c_f32_bf16 v219, v155, v155
    buffer_load_dwordx4 v[180:183], v245, s[8:11], s3 offen offset:0
    s_waitcnt vmcnt(6)
    v_dot2c_f32_bf16 v216, s63, v156
    v_dot2c_f32_bf16 v218, v156, v156
    v_dot2c_f32_bf16 v217, s63, v157
    v_dot2c_f32_bf16 v219, v157, v157
    v_dot2c_f32_bf16 v216, s63, v158
    v_dot2c_f32_bf16 v218, v158, v158
    v_dot2c_f32_bf16 v217, s63, v159
    v_dot2c_f32_bf16 v219, v159, v159
    s_waitcnt vmcnt(5)
    v_dot2c_f32_bf16 v216, s63, v160
    v_dot2c_f32_bf16 v218, v160, v160
    v_dot2c_f32_bf16 v217, s63, v161
    v_dot2c_f32_bf16 v219, v161, v161
    v_dot2c_f32_bf16 v216, s63, v162
    v_dot2c_f32_bf16 v218, v162, v162
    v_dot2c_f32_bf16 v217, s63, v163
    v_dot2c_f32_bf16 v219, v163, v163
    buffer_load_dwordx4 v[184:187], v245, s[8:11], s3 offen offset:128
    s_waitcnt vmcnt(5)
    v_dot2c_f32_bf16 v216, s63, v164
    v_dot2c_f32_bf16 v218, v164, v164
    v_dot2c_f32_bf16 v217, s63, v165
    v_dot2c_f32_bf16 v219, v165, v165
    v_dot2c_f32_bf16 v216, s63, v166
    v_dot2c_f32_bf16 v218, v166, v166
    v_dot2c_f32_bf16 v217, s63, v167
    v_dot2c_f32_bf16 v219, v167, v167
    s_waitcnt vmcnt(4)
    v_dot2c_f32_bf16 v216, s63, v168
    v_dot2c_f32_bf16 v218, v168, v168
    v_dot2c_f32_bf16 v217, s63, v169
    v_dot2c_f32_bf16 v219, v169, v169
    v_dot2c_f32_bf16 v216, s63, v170
    v_dot2c_f32_bf16 v218, v170, v170
    v_dot2c_f32_bf16 v217, s63, v171
    v_dot2c_f32_bf16 v219, v171, v171
    buffer_load_dwordx4 v[188:191], v245, s[8:11], s3 offen offset:256
    s_waitcnt vmcnt(4)
    v_dot2c_f32_bf16 v216, s63, v172
    v_dot2c_f32_bf16 v218, v172, v172
    v_dot2c_f32_bf16 v217, s63, v173
    v_dot2c_f32_bf16 v219, v173, v173
    v_dot2c_f32_bf16 v216, s63, v174
    v_dot2c_f32_bf16 v218, v174, v174
    v_dot2c_f32_bf16 v217, s63, v175
    v_dot2c_f32_bf16 v219, v175, v175
    s_waitcnt vmcnt(3)
    v_dot2c_f32_bf16 v216, s63, v176
    v_dot2c_f32_bf16 v218, v176, v176
    v_dot2c_f32_bf16 v217, s63, v177
    v_dot2c_f32_bf16 v219, v177, v177
    v_dot2c_f32_bf16 v216, s63, v178
    v_dot2c_f32_bf16 v218, v178, v178
    v_dot2c_f32_bf16 v217, s63, v179
    v_dot2c_f32_bf16 v219, v179, v179
    buffer_load_dwordx4 v[192:195], v245, s[8:11], s3 offen offset:384
    s_nop 2
    v_add_f32 v216, v216, v217
    v_add_f32 v218, v218, v219
    s_nop 0
    v_add_f32_dpp v217, v216, v216 quad_perm:[1,0,3,2] row_mask:0xf bank_mask:0xf
    v_add_f32_dpp v219, v218, v218 quad_perm:[1,0,3,2] row_mask:0xf bank_mask:0xf
    s_nop 0
    v_add_f32_dpp v216, v217, v217 quad_perm:[2,3,0,1] row_mask:0xf bank_mask:0xf
    v_add_f32_dpp v218, v219, v219 quad_perm:[2,3,0,1] row_mask:0xf bank_mask:0xf
    s_nop 0
    v_add_f32_dpp v217, v216, v216 row_half_mirror row_mask:0xf bank_mask:0xf
    v_add_f32_dpp v219, v218, v218 row_half_mirror row_mask:0xf bank_mask:0xf
    s_nop 0
    v_mul_f32 v220, 0x3ae38e39, v217
    v_mul_f32 v221, 0x3ae38e39, v219
    v_fma_f32 v221, -v220, v220, v221
    buffer_load_dwordx4 v[196:199], v245, s[8:11], s3 offen offset:512
    v_max_f32 v221, 0, v221
    v_cvt_pk_bf16_f32 v222, v220, v221
    v_and_b32 v221, 0xffff0000, v222
    v_lshlrev_b32 v222, 16, v222
    v_add_f32 v221, 0x3727c5ac, v221
    v_cvt_pk_bf16_f32 v221, v221, v221
    v_lshlrev_b32 v221, 16, v221
    v_sqrt_f32 v221, v221
    s_nop 0
    v_cvt_pk_bf16_f32 v221, v221, v221
    v_lshlrev_b32 v221, 16, v221
    v_rcp_f32 v223, v221
    s_nop 0
    v_mul_f32 v224, 0x3fb8aa3b, v223
    v_mul_f32 v226, v222, v224
    buffer_load_dwordx4 v[200:203], v245, s[8:11], s3 offen offset:640
    v_lshlrev_b32 v250, 16, v144
    v_and_b32 v251, 0xffff0000, v144
    v_lshlrev_b32 v252, 16, v145
    v_and_b32 v253, 0xffff0000, v145
    v_pk_fma_f32 v[250:251], v[250:251], v[224:225], v[226:227] op_sel_hi:[1,0,0] neg_lo:[0,0,1] neg_hi:[0,0,1]
    v_pk_fma_f32 v[252:253], v[252:253], v[224:225], v[226:227] op_sel_hi:[1,0,0] neg_lo:[0,0,1] neg_hi:[0,0,1]
    v_cvt_pk_bf16_f32 v144, v250, v251
    v_cvt_pk_bf16_f32 v145, v252, v253
    v_lshlrev_b32 v250, 16, v146
    v_and_b32 v251, 0xffff0000, v146
    v_lshlrev_b32 v252, 16, v147
    v_and_b32 v253, 0xffff0000, v147
    v_pk_fma_f32 v[250:251], v[250:251], v[224:225], v[226:227] op_sel_hi:[1,0,0] neg_lo:[0,0,1] neg_hi:[0,0,1]
    v_pk_fma_f32 v[252:253], v[252:253], v[224:225], v[226:227] op_sel_hi:[1,0,0] neg_lo:[0,0,1] neg_hi:[0,0,1]
    v_cvt_pk_bf16_f32 v146, v250, v251
    v_cvt_pk_bf16_f32 v147, v252, v253
    ds_write_b128 v254, v[144:147] offset:0
    v_lshlrev_b32 v250, 16, v148
    v_and_b32 v251, 0xffff0000, v148
    v_lshlrev_b32 v252, 16, v149
    v_and_b32 v253, 0xffff0000, v149
    buffer_load_dwordx4 v[204:207], v245, s[8:11], s3 offen offset:768
    v_pk_fma_f32 v[250:251], v[250:251], v[224:225], v[226:227] op_sel_hi:[1,0,0] neg_lo:[0,0,1] neg_hi:[0,0,1]
    v_pk_fma_f32 v[252:253], v[252:253], v[224:225], v[226:227] op_sel_hi:[1,0,0] neg_lo:[0,0,1] neg_hi:[0,0,1]
    v_cvt_pk_bf16_f32 v148, v250, v251
    v_cvt_pk_bf16_f32 v149, v252, v253
    v_lshlrev_b32 v250, 16, v150
    v_and_b32 v251, 0xffff0000, v150
    v_lshlrev_b32 v252, 16, v151
    v_and_b32 v253, 0xffff0000, v151
    v_pk_fma_f32 v[250:251], v[250:251], v[224:225], v[226:227] op_sel_hi:[1,0,0] neg_lo:[0,0,1] neg_hi:[0,0,1]
    v_pk_fma_f32 v[252:253], v[252:253], v[224:225], v[226:227] op_sel_hi:[1,0,0] neg_lo:[0,0,1] neg_hi:[0,0,1]
    v_cvt_pk_bf16_f32 v150, v250, v251
    v_cvt_pk_bf16_f32 v151, v252, v253
    ds_write_b128 v254, v[148:151] offset:2048
    v_lshlrev_b32 v250, 16, v152
    v_and_b32 v251, 0xffff0000, v152
    v_lshlrev_b32 v252, 16, v153
    v_and_b32 v253, 0xffff0000, v153
    v_pk_fma_f32 v[250:251], v[250:251], v[224:225], v[226:227] op_sel_hi:[1,0,0] neg_lo:[0,0,1] neg_hi:[0,0,1]
    v_pk_fma_f32 v[252:253], v[252:253], v[224:225], v[226:227] op_sel_hi:[1,0,0] neg_lo:[0,0,1] neg_hi:[0,0,1]
    v_cvt_pk_bf16_f32 v152, v250, v251
    buffer_load_dwordx4 v[208:211], v245, s[8:11], s3 offen offset:896
    v_cvt_pk_bf16_f32 v153, v252, v253
    v_lshlrev_b32 v250, 16, v154
    v_and_b32 v251, 0xffff0000, v154
    v_lshlrev_b32 v252, 16, v155
    v_and_b32 v253, 0xffff0000, v155
    v_pk_fma_f32 v[250:251], v[250:251], v[224:225], v[226:227] op_sel_hi:[1,0,0] neg_lo:[0,0,1] neg_hi:[0,0,1]
    v_pk_fma_f32 v[252:253], v[252:253], v[224:225], v[226:227] op_sel_hi:[1,0,0] neg_lo:[0,0,1] neg_hi:[0,0,1]
    v_cvt_pk_bf16_f32 v154, v250, v251
    v_cvt_pk_bf16_f32 v155, v252, v253
    ds_write_b128 v254, v[152:155] offset:4096
    v_lshlrev_b32 v250, 16, v156
    v_and_b32 v251, 0xffff0000, v156
    v_lshlrev_b32 v252, 16, v157
    v_and_b32 v253, 0xffff0000, v157
    v_pk_fma_f32 v[250:251], v[250:251], v[224:225], v[226:227] op_sel_hi:[1,0,0] neg_lo:[0,0,1] neg_hi:[0,0,1]
    v_pk_fma_f32 v[252:253], v[252:253], v[224:225], v[226:227] op_sel_hi:[1,0,0] neg_lo:[0,0,1] neg_hi:[0,0,1]
    v_cvt_pk_bf16_f32 v156, v250, v251
    v_cvt_pk_bf16_f32 v157, v252, v253
    v_lshlrev_b32 v250, 16, v158
    v_and_b32 v251, 0xffff0000, v158
    buffer_load_dwordx4 v[212:215], v245, s[8:11], s3 offen offset:1024
    v_lshlrev_b32 v252, 16, v159
    v_and_b32 v253, 0xffff0000, v159
    v_pk_fma_f32 v[250:251], v[250:251], v[224:225], v[226:227] op_sel_hi:[1,0,0] neg_lo:[0,0,1] neg_hi:[0,0,1]
    v_pk_fma_f32 v[252:253], v[252:253], v[224:225], v[226:227] op_sel_hi:[1,0,0] neg_lo:[0,0,1] neg_hi:[0,0,1]
    v_cvt_pk_bf16_f32 v158, v250, v251
    v_cvt_pk_bf16_f32 v159, v252, v253
    ds_write_b128 v254, v[156:159] offset:6144
    v_lshlrev_b32 v250, 16, v160
    v_and_b32 v251, 0xffff0000, v160
    v_lshlrev_b32 v252, 16, v161
    v_and_b32 v253, 0xffff0000, v161
    v_pk_fma_f32 v[250:251], v[250:251], v[224:225], v[226:227] op_sel_hi:[1,0,0] neg_lo:[0,0,1] neg_hi:[0,0,1]
    v_pk_fma_f32 v[252:253], v[252:253], v[224:225], v[226:227] op_sel_hi:[1,0,0] neg_lo:[0,0,1] neg_hi:[0,0,1]
    v_cvt_pk_bf16_f32 v160, v250, v251
    v_cvt_pk_bf16_f32 v161, v252, v253
    v_lshlrev_b32 v250, 16, v162
    v_and_b32 v251, 0xffff0000, v162
    v_lshlrev_b32 v252, 16, v163
    v_and_b32 v253, 0xffff0000, v163
    v_pk_fma_f32 v[250:251], v[250:251], v[224:225], v[226:227] op_sel_hi:[1,0,0] neg_lo:[0,0,1] neg_hi:[0,0,1]
    v_pk_fma_f32 v[252:253], v[252:253], v[224:225], v[226:227] op_sel_hi:[1,0,0] neg_lo:[0,0,1] neg_hi:[0,0,1]
    v_cvt_pk_bf16_f32 v162, v250, v251
    v_cvt_pk_bf16_f32 v163, v252, v253
    ds_write_b128 v254, v[160:163] offset:8192
    v_lshlrev_b32 v250, 16, v164
    v_and_b32 v251, 0xffff0000, v164
    v_lshlrev_b32 v252, 16, v165
    v_and_b32 v253, 0xffff0000, v165
    v_pk_fma_f32 v[250:251], v[250:251], v[224:225], v[226:227] op_sel_hi:[1,0,0] neg_lo:[0,0,1] neg_hi:[0,0,1]
    v_pk_fma_f32 v[252:253], v[252:253], v[224:225], v[226:227] op_sel_hi:[1,0,0] neg_lo:[0,0,1] neg_hi:[0,0,1]
    v_cvt_pk_bf16_f32 v164, v250, v251
    v_cvt_pk_bf16_f32 v165, v252, v253
    v_lshlrev_b32 v250, 16, v166
    v_and_b32 v251, 0xffff0000, v166
    v_lshlrev_b32 v252, 16, v167
    v_and_b32 v253, 0xffff0000, v167
    v_pk_fma_f32 v[250:251], v[250:251], v[224:225], v[226:227] op_sel_hi:[1,0,0] neg_lo:[0,0,1] neg_hi:[0,0,1]
    v_pk_fma_f32 v[252:253], v[252:253], v[224:225], v[226:227] op_sel_hi:[1,0,0] neg_lo:[0,0,1] neg_hi:[0,0,1]
    v_cvt_pk_bf16_f32 v166, v250, v251
    v_cvt_pk_bf16_f32 v167, v252, v253
    ds_write_b128 v254, v[164:167] offset:10240
    v_lshlrev_b32 v250, 16, v168
    v_and_b32 v251, 0xffff0000, v168
    v_lshlrev_b32 v252, 16, v169
    v_and_b32 v253, 0xffff0000, v169
    v_pk_fma_f32 v[250:251], v[250:251], v[224:225], v[226:227] op_sel_hi:[1,0,0] neg_lo:[0,0,1] neg_hi:[0,0,1]
    v_pk_fma_f32 v[252:253], v[252:253], v[224:225], v[226:227] op_sel_hi:[1,0,0] neg_lo:[0,0,1] neg_hi:[0,0,1]
    v_cvt_pk_bf16_f32 v168, v250, v251
    v_cvt_pk_bf16_f32 v169, v252, v253
    v_lshlrev_b32 v250, 16, v170
    v_and_b32 v251, 0xffff0000, v170
    v_lshlrev_b32 v252, 16, v171
    v_and_b32 v253, 0xffff0000, v171
    v_pk_fma_f32 v[250:251], v[250:251], v[224:225], v[226:227] op_sel_hi:[1,0,0] neg_lo:[0,0,1] neg_hi:[0,0,1]
    v_pk_fma_f32 v[252:253], v[252:253], v[224:225], v[226:227] op_sel_hi:[1,0,0] neg_lo:[0,0,1] neg_hi:[0,0,1]
    v_cvt_pk_bf16_f32 v170, v250, v251
    v_cvt_pk_bf16_f32 v171, v252, v253
    ds_write_b128 v254, v[168:171] offset:12288
    v_lshlrev_b32 v250, 16, v172
    v_and_b32 v251, 0xffff0000, v172
    v_lshlrev_b32 v252, 16, v173
    v_and_b32 v253, 0xffff0000, v173
    v_pk_fma_f32 v[250:251], v[250:251], v[224:225], v[226:227] op_sel_hi:[1,0,0] neg_lo:[0,0,1] neg_hi:[0,0,1]
    v_pk_fma_f32 v[252:253], v[252:253], v[224:225], v[226:227] op_sel_hi:[1,0,0] neg_lo:[0,0,1] neg_hi:[0,0,1]
    v_cvt_pk_bf16_f32 v172, v250, v251
    v_cvt_pk_bf16_f32 v173, v252, v253
    v_lshlrev_b32 v250, 16, v174
    v_and_b32 v251, 0xffff0000, v174
    v_lshlrev_b32 v252, 16, v175
    v_and_b32 v253, 0xffff0000, v175
    v_pk_fma_f32 v[250:251], v[250:251], v[224:225], v[226:227] op_sel_hi:[1,0,0] neg_lo:[0,0,1] neg_hi:[0,0,1]
    v_pk_fma_f32 v[252:253], v[252:253], v[224:225], v[226:227] op_sel_hi:[1,0,0] neg_lo:[0,0,1] neg_hi:[0,0,1]
    v_cvt_pk_bf16_f32 v174, v250, v251
    v_cvt_pk_bf16_f32 v175, v252, v253
    ds_write_b128 v254, v[172:175] offset:14336
    v_lshlrev_b32 v250, 16, v176
    v_and_b32 v251, 0xffff0000, v176
    v_lshlrev_b32 v252, 16, v177
    v_and_b32 v253, 0xffff0000, v177
    v_pk_fma_f32 v[250:251], v[250:251], v[224:225], v[226:227] op_sel_hi:[1,0,0] neg_lo:[0,0,1] neg_hi:[0,0,1]
    v_pk_fma_f32 v[252:253], v[252:253], v[224:225], v[226:227] op_sel_hi:[1,0,0] neg_lo:[0,0,1] neg_hi:[0,0,1]
    v_cvt_pk_bf16_f32 v176, v250, v251
    v_cvt_pk_bf16_f32 v177, v252, v253
    v_lshlrev_b32 v250, 16, v178
    v_and_b32 v251, 0xffff0000, v178
    v_lshlrev_b32 v252, 16, v179
    v_and_b32 v253, 0xffff0000, v179
    v_pk_fma_f32 v[250:251], v[250:251], v[224:225], v[226:227] op_sel_hi:[1,0,0] neg_lo:[0,0,1] neg_hi:[0,0,1]
    v_pk_fma_f32 v[252:253], v[252:253], v[224:225], v[226:227] op_sel_hi:[1,0,0] neg_lo:[0,0,1] neg_hi:[0,0,1]
    v_cvt_pk_bf16_f32 v178, v250, v251
    v_cvt_pk_bf16_f32 v179, v252, v253
    ds_write_b128 v254, v[176:179] offset:16384
    buffer_load_ushort v247, v246, s[24:27], s33 offen
    v_lshlrev_b32 v246, 2, v0
    v_add_u32 v246, 155648, v246
    v_mov_b32 v216, 0
    v_mov_b32 v217, 0
    v_mov_b32 v218, 0
    v_mov_b32 v219, 0
    s_waitcnt vmcnt(9)
    v_dot2c_f32_bf16 v216, s63, v180
    v_dot2c_f32_bf16 v218, v180, v180
    v_dot2c_f32_bf16 v217, s63, v181
    v_dot2c_f32_bf16 v219, v181, v181
    v_dot2c_f32_bf16 v216, s63, v182
    v_dot2c_f32_bf16 v218, v182, v182
    v_dot2c_f32_bf16 v217, s63, v183
    v_dot2c_f32_bf16 v219, v183, v183
    s_waitcnt vmcnt(8)
    v_dot2c_f32_bf16 v216, s63, v184
    v_dot2c_f32_bf16 v218, v184, v184
    v_dot2c_f32_bf16 v217, s63, v185
    v_dot2c_f32_bf16 v219, v185, v185
    v_dot2c_f32_bf16 v216, s63, v186
    v_dot2c_f32_bf16 v218, v186, v186
    v_dot2c_f32_bf16 v217, s63, v187
    v_dot2c_f32_bf16 v219, v187, v187
    s_waitcnt vmcnt(7)
    v_dot2c_f32_bf16 v216, s63, v188
    v_dot2c_f32_bf16 v218, v188, v188
    v_dot2c_f32_bf16 v217, s63, v189
    v_dot2c_f32_bf16 v219, v189, v189
    v_dot2c_f32_bf16 v216, s63, v190
    v_dot2c_f32_bf16 v218, v190, v190
    v_dot2c_f32_bf16 v217, s63, v191
    v_dot2c_f32_bf16 v219, v191, v191
    s_waitcnt vmcnt(6)
    v_dot2c_f32_bf16 v216, s63, v192
    v_dot2c_f32_bf16 v218, v192, v192
    v_dot2c_f32_bf16 v217, s63, v193
    v_dot2c_f32_bf16 v219, v193, v193
    v_dot2c_f32_bf16 v216, s63, v194
    v_dot2c_f32_bf16 v218, v194, v194
    v_dot2c_f32_bf16 v217, s63, v195
    v_dot2c_f32_bf16 v219, v195, v195
    s_waitcnt vmcnt(5)
    v_dot2c_f32_bf16 v216, s63, v196
    v_dot2c_f32_bf16 v218, v196, v196
    v_dot2c_f32_bf16 v217, s63, v197
    v_dot2c_f32_bf16 v219, v197, v197
    v_dot2c_f32_bf16 v216, s63, v198
    v_dot2c_f32_bf16 v218, v198, v198
    v_dot2c_f32_bf16 v217, s63, v199
    v_dot2c_f32_bf16 v219, v199, v199
    s_waitcnt vmcnt(4)
    v_dot2c_f32_bf16 v216, s63, v200
    v_dot2c_f32_bf16 v218, v200, v200
    v_dot2c_f32_bf16 v217, s63, v201
    v_dot2c_f32_bf16 v219, v201, v201
    v_dot2c_f32_bf16 v216, s63, v202
    v_dot2c_f32_bf16 v218, v202, v202
    v_dot2c_f32_bf16 v217, s63, v203
    v_dot2c_f32_bf16 v219, v203, v203
    s_waitcnt vmcnt(3)
    v_dot2c_f32_bf16 v216, s63, v204
    v_dot2c_f32_bf16 v218, v204, v204
    v_dot2c_f32_bf16 v217, s63, v205
    v_dot2c_f32_bf16 v219, v205, v205
    v_dot2c_f32_bf16 v216, s63, v206
    v_dot2c_f32_bf16 v218, v206, v206
    v_dot2c_f32_bf16 v217, s63, v207
    v_dot2c_f32_bf16 v219, v207, v207
    s_waitcnt vmcnt(2)
    v_dot2c_f32_bf16 v216, s63, v208
    v_dot2c_f32_bf16 v218, v208, v208
    v_dot2c_f32_bf16 v217, s63, v209
    v_dot2c_f32_bf16 v219, v209, v209
    v_dot2c_f32_bf16 v216, s63, v210
    v_dot2c_f32_bf16 v218, v210, v210
    v_dot2c_f32_bf16 v217, s63, v211
    v_dot2c_f32_bf16 v219, v211, v211
    s_waitcnt vmcnt(1)
    v_dot2c_f32_bf16 v216, s63, v212
    v_dot2c_f32_bf16 v218, v212, v212
    v_dot2c_f32_bf16 v217, s63, v213
    v_dot2c_f32_bf16 v219, v213, v213
    v_dot2c_f32_bf16 v216, s63, v214
    v_dot2c_f32_bf16 v218, v214, v214
    v_dot2c_f32_bf16 v217, s63, v215
    v_dot2c_f32_bf16 v219, v215, v215
    s_nop 2
    v_add_f32 v216, v216, v217
    v_add_f32 v218, v218, v219
    s_nop 0
    v_add_f32_dpp v217, v216, v216 quad_perm:[1,0,3,2] row_mask:0xf bank_mask:0xf
    v_add_f32_dpp v219, v218, v218 quad_perm:[1,0,3,2] row_mask:0xf bank_mask:0xf
    s_nop 0
    v_add_f32_dpp v216, v217, v217 quad_perm:[2,3,0,1] row_mask:0xf bank_mask:0xf
    v_add_f32_dpp v218, v219, v219 quad_perm:[2,3,0,1] row_mask:0xf bank_mask:0xf
    s_nop 0
    v_add_f32_dpp v217, v216, v216 row_half_mirror row_mask:0xf bank_mask:0xf
    v_add_f32_dpp v219, v218, v218 row_half_mirror row_mask:0xf bank_mask:0xf
    s_nop 0
    v_mul_f32 v220, 0x3ae38e39, v217
    v_mul_f32 v221, 0x3ae38e39, v219
    v_fma_f32 v221, -v220, v220, v221
    v_max_f32 v221, 0, v221
    v_cvt_pk_bf16_f32 v222, v220, v221
    v_and_b32 v221, 0xffff0000, v222
    v_lshlrev_b32 v222, 16, v222
    v_add_f32 v221, 0x3727c5ac, v221
    v_cvt_pk_bf16_f32 v221, v221, v221
    v_lshlrev_b32 v221, 16, v221
    v_sqrt_f32 v221, v221
    s_nop 0
    v_cvt_pk_bf16_f32 v221, v221, v221
    v_lshlrev_b32 v221, 16, v221
    v_rcp_f32 v223, v221
    s_nop 0
    v_mul_f32 v224, 0x3fb8aa3b, v223
    v_mul_f32 v226, v222, v224
    s_waitcnt vmcnt(0)
    v_lshlrev_b32 v247, 16, v247
    v_mul_f32 v247, 0x3fb8aa3b, v247
    ds_write_b32 v246, v247
    s_waitcnt lgkmcnt(0)
    s_barrier
    s_setprio 0
    v_lshlrev_b32 v250, 16, v180
    v_and_b32 v251, 0xffff0000, v180
    v_lshlrev_b32 v252, 16, v181
    ds_read_b128 v[0:3], v255 offset:0
    v_and_b32 v253, 0xffff0000, v181
    v_pk_fma_f32 v[250:251], v[250:251], v[224:225], v[226:227] op_sel_hi:[1,0,0] neg_lo:[0,0,1] neg_hi:[0,0,1]
    v_pk_fma_f32 v[252:253], v[252:253], v[224:225], v[226:227] op_sel_hi:[1,0,0] neg_lo:[0,0,1] neg_hi:[0,0,1]
    ds_read_b128 v[4:7], v248 offset:1024
    v_cvt_pk_bf16_f32 v180, v250, v251
    v_cvt_pk_bf16_f32 v181, v252, v253
    ds_read_b128 v[8:11], v255 offset:2048
    v_lshlrev_b32 v250, 16, v182
    v_and_b32 v251, 0xffff0000, v182
    v_lshlrev_b32 v252, 16, v183
    ds_read_b128 v[12:15], v248 offset:3072
    v_and_b32 v253, 0xffff0000, v183
    v_pk_fma_f32 v[250:251], v[250:251], v[224:225], v[226:227] op_sel_hi:[1,0,0] neg_lo:[0,0,1] neg_hi:[0,0,1]
    v_pk_fma_f32 v[252:253], v[252:253], v[224:225], v[226:227] op_sel_hi:[1,0,0] neg_lo:[0,0,1] neg_hi:[0,0,1]
    ds_read_b128 v[16:19], v255 offset:4096
    v_cvt_pk_bf16_f32 v182, v250, v251
    v_cvt_pk_bf16_f32 v183, v252, v253
    ds_read_b128 v[20:23], v248 offset:5120
    v_lshlrev_b32 v250, 16, v184
    v_and_b32 v251, 0xffff0000, v184
    v_lshlrev_b32 v252, 16, v185
    ds_read_b128 v[24:27], v255 offset:6144
    v_and_b32 v253, 0xffff0000, v185
    v_pk_fma_f32 v[250:251], v[250:251], v[224:225], v[226:227] op_sel_hi:[1,0,0] neg_lo:[0,0,1] neg_hi:[0,0,1]
    v_pk_fma_f32 v[252:253], v[252:253], v[224:225], v[226:227] op_sel_hi:[1,0,0] neg_lo:[0,0,1] neg_hi:[0,0,1]
    ds_read_b128 v[28:31], v248 offset:7168
    v_cvt_pk_bf16_f32 v184, v250, v251
    v_cvt_pk_bf16_f32 v185, v252, v253
    ds_read_b128 v[32:35], v255 offset:8192
    v_lshlrev_b32 v250, 16, v186
    v_and_b32 v251, 0xffff0000, v186
    v_lshlrev_b32 v252, 16, v187
    ds_read_b128 v[36:39], v248 offset:9216
    v_and_b32 v253, 0xffff0000, v187
    v_pk_fma_f32 v[250:251], v[250:251], v[224:225], v[226:227] op_sel_hi:[1,0,0] neg_lo:[0,0,1] neg_hi:[0,0,1]
    v_pk_fma_f32 v[252:253], v[252:253], v[224:225], v[226:227] op_sel_hi:[1,0,0] neg_lo:[0,0,1] neg_hi:[0,0,1]
    ds_read_b128 v[40:43], v255 offset:10240
    v_cvt_pk_bf16_f32 v186, v250, v251
    v_cvt_pk_bf16_f32 v187, v252, v253
    ds_read_b128 v[44:47], v248 offset:11264
    v_lshlrev_b32 v250, 16, v188
    v_and_b32 v251, 0xffff0000, v188
    v_lshlrev_b32 v252, 16, v189
    ds_read_b128 v[48:51], v255 offset:12288
    v_and_b32 v253, 0xffff0000, v189
    v_pk_fma_f32 v[250:251], v[250:251], v[224:225], v[226:227] op_sel_hi:[1,0,0] neg_lo:[0,0,1] neg_hi:[0,0,1]
    v_pk_fma_f32 v[252:253], v[252:253], v[224:225], v[226:227] op_sel_hi:[1,0,0] neg_lo:[0,0,1] neg_hi:[0,0,1]
    ds_read_b128 v[52:55], v248 offset:13312
    v_cvt_pk_bf16_f32 v188, v250, v251
    v_cvt_pk_bf16_f32 v189, v252, v253
    ds_read_b128 v[56:59], v255 offset:14336
    v_lshlrev_b32 v250, 16, v190
    v_and_b32 v251, 0xffff0000, v190
    v_lshlrev_b32 v252, 16, v191
    s_waitcnt lgkmcnt(14)
    ds_read_b128 v[60:63], v248 offset:15360
    v_and_b32 v253, 0xffff0000, v191
    v_pk_fma_f32 v[250:251], v[250:251], v[224:225], v[226:227] op_sel_hi:[1,0,0] neg_lo:[0,0,1] neg_hi:[0,0,1]
    v_pk_fma_f32 v[252:253], v[252:253], v[224:225], v[226:227] op_sel_hi:[1,0,0] neg_lo:[0,0,1] neg_hi:[0,0,1]
    s_waitcnt lgkmcnt(14)
    ds_read_b128 v[64:67], v255 offset:16384
    v_cvt_pk_bf16_f32 v190, v250, v251
    v_cvt_pk_bf16_f32 v191, v252, v253
    s_waitcnt lgkmcnt(14)
    ds_read_b128 v[68:71], v248 offset:17408
    v_lshlrev_b32 v250, 16, v192
    v_and_b32 v251, 0xffff0000, v192
    v_lshlrev_b32 v252, 16, v193
    v_and_b32 v253, 0xffff0000, v193
    v_pk_fma_f32 v[250:251], v[250:251], v[224:225], v[226:227] op_sel_hi:[1,0,0] neg_lo:[0,0,1] neg_hi:[0,0,1]
    v_pk_fma_f32 v[252:253], v[252:253], v[224:225], v[226:227] op_sel_hi:[1,0,0] neg_lo:[0,0,1] neg_hi:[0,0,1]
    v_cvt_pk_bf16_f32 v192, v250, v251
    v_cvt_pk_bf16_f32 v193, v252, v253
    v_lshlrev_b32 v250, 16, v194
    v_and_b32 v251, 0xffff0000, v194
    v_lshlrev_b32 v252, 16, v195
    v_and_b32 v253, 0xffff0000, v195
    v_pk_fma_f32 v[250:251], v[250:251], v[224:225], v[226:227] op_sel_hi:[1,0,0] neg_lo:[0,0,1] neg_hi:[0,0,1]
    v_pk_fma_f32 v[252:253], v[252:253], v[224:225], v[226:227] op_sel_hi:[1,0,0] neg_lo:[0,0,1] neg_hi:[0,0,1]
    v_cvt_pk_bf16_f32 v194, v250, v251
    v_cvt_pk_bf16_f32 v195, v252, v253
    s_waitcnt lgkmcnt(0)
    s_barrier
    v_lshlrev_b32 v250, 16, v196
    v_and_b32 v251, 0xffff0000, v196
    v_lshlrev_b32 v252, 16, v197
    v_and_b32 v253, 0xffff0000, v197
    v_pk_fma_f32 v[250:251], v[250:251], v[224:225], v[226:227] op_sel_hi:[1,0,0] neg_lo:[0,0,1] neg_hi:[0,0,1]
    v_pk_fma_f32 v[252:253], v[252:253], v[224:225], v[226:227] op_sel_hi:[1,0,0] neg_lo:[0,0,1] neg_hi:[0,0,1]
    v_cvt_pk_bf16_f32 v196, v250, v251
    v_cvt_pk_bf16_f32 v197, v252, v253
    v_lshlrev_b32 v250, 16, v198
    v_and_b32 v251, 0xffff0000, v198
    v_lshlrev_b32 v252, 16, v199
    v_and_b32 v253, 0xffff0000, v199
    v_pk_fma_f32 v[250:251], v[250:251], v[224:225], v[226:227] op_sel_hi:[1,0,0] neg_lo:[0,0,1] neg_hi:[0,0,1]
    v_pk_fma_f32 v[252:253], v[252:253], v[224:225], v[226:227] op_sel_hi:[1,0,0] neg_lo:[0,0,1] neg_hi:[0,0,1]
    v_cvt_pk_bf16_f32 v198, v250, v251
    v_cvt_pk_bf16_f32 v199, v252, v253
    ds_write_b128 v254, v[196:199] offset:8192
    v_lshlrev_b32 v250, 16, v200
    v_and_b32 v251, 0xffff0000, v200
    v_lshlrev_b32 v252, 16, v201
    v_and_b32 v253, 0xffff0000, v201
    v_pk_fma_f32 v[250:251], v[250:251], v[224:225], v[226:227] op_sel_hi:[1,0,0] neg_lo:[0,0,1] neg_hi:[0,0,1]
    ds_write_b128 v254, v[180:183] offset:0
    v_pk_fma_f32 v[252:253], v[252:253], v[224:225], v[226:227] op_sel_hi:[1,0,0] neg_lo:[0,0,1] neg_hi:[0,0,1]
    v_cvt_pk_bf16_f32 v200, v250, v251
    v_cvt_pk_bf16_f32 v201, v252, v253
    v_lshlrev_b32 v250, 16, v202
    v_and_b32 v251, 0xffff0000, v202
    v_lshlrev_b32 v252, 16, v203
    v_and_b32 v253, 0xffff0000, v203
    v_pk_fma_f32 v[250:251], v[250:251], v[224:225], v[226:227] op_sel_hi:[1,0,0] neg_lo:[0,0,1] neg_hi:[0,0,1]
    v_pk_fma_f32 v[252:253], v[252:253], v[224:225], v[226:227] op_sel_hi:[1,0,0] neg_lo:[0,0,1] neg_hi:[0,0,1]
    v_cvt_pk_bf16_f32 v202, v250, v251
    v_cvt_pk_bf16_f32 v203, v252, v253
    ds_write_b128 v254, v[200:203] offset:10240
    v_lshlrev_b32 v250, 16, v204
    v_and_b32 v251, 0xffff0000, v204
    v_lshlrev_b32 v252, 16, v205
    v_and_b32 v253, 0xffff0000, v205
    v_pk_fma_f32 v[250:251], v[250:251], v[224:225], v[226:227] op_sel_hi:[1,0,0] neg_lo:[0,0,1] neg_hi:[0,0,1]
    v_pk_fma_f32 v[252:253], v[252:253], v[224:225], v[226:227] op_sel_hi:[1,0,0] neg_lo:[0,0,1] neg_hi:[0,0,1]
    v_cvt_pk_bf16_f32 v204, v250, v251
    v_cvt_pk_bf16_f32 v205, v252, v253
    v_lshlrev_b32 v250, 16, v206
    ds_write_b128 v254, v[184:187] offset:2048
    v_and_b32 v251, 0xffff0000, v206
    v_lshlrev_b32 v252, 16, v207
    v_and_b32 v253, 0xffff0000, v207
    v_pk_fma_f32 v[250:251], v[250:251], v[224:225], v[226:227] op_sel_hi:[1,0,0] neg_lo:[0,0,1] neg_hi:[0,0,1]
    v_pk_fma_f32 v[252:253], v[252:253], v[224:225], v[226:227] op_sel_hi:[1,0,0] neg_lo:[0,0,1] neg_hi:[0,0,1]
    v_cvt_pk_bf16_f32 v206, v250, v251
    v_cvt_pk_bf16_f32 v207, v252, v253
    ds_write_b128 v254, v[204:207] offset:12288
    v_lshlrev_b32 v250, 16, v208
    v_and_b32 v251, 0xffff0000, v208
    v_lshlrev_b32 v252, 16, v209
    v_and_b32 v253, 0xffff0000, v209
    v_pk_fma_f32 v[250:251], v[250:251], v[224:225], v[226:227] op_sel_hi:[1,0,0] neg_lo:[0,0,1] neg_hi:[0,0,1]
    v_pk_fma_f32 v[252:253], v[252:253], v[224:225], v[226:227] op_sel_hi:[1,0,0] neg_lo:[0,0,1] neg_hi:[0,0,1]
    v_cvt_pk_bf16_f32 v208, v250, v251
    v_cvt_pk_bf16_f32 v209, v252, v253
    v_lshlrev_b32 v250, 16, v210
    v_and_b32 v251, 0xffff0000, v210
    v_lshlrev_b32 v252, 16, v211
    v_and_b32 v253, 0xffff0000, v211
    v_pk_fma_f32 v[250:251], v[250:251], v[224:225], v[226:227] op_sel_hi:[1,0,0] neg_lo:[0,0,1] neg_hi:[0,0,1]
    ds_write_b128 v254, v[188:191] offset:4096
    v_pk_fma_f32 v[252:253], v[252:253], v[224:225], v[226:227] op_sel_hi:[1,0,0] neg_lo:[0,0,1] neg_hi:[0,0,1]
    v_cvt_pk_bf16_f32 v210, v250, v251
    v_cvt_pk_bf16_f32 v211, v252, v253
    ds_write_b128 v254, v[208:211] offset:14336
    v_lshlrev_b32 v250, 16, v212
    v_and_b32 v251, 0xffff0000, v212
    v_lshlrev_b32 v252, 16, v213
    v_and_b32 v253, 0xffff0000, v213
    v_pk_fma_f32 v[250:251], v[250:251], v[224:225], v[226:227] op_sel_hi:[1,0,0] neg_lo:[0,0,1] neg_hi:[0,0,1]
    v_pk_fma_f32 v[252:253], v[252:253], v[224:225], v[226:227] op_sel_hi:[1,0,0] neg_lo:[0,0,1] neg_hi:[0,0,1]
    v_cvt_pk_bf16_f32 v212, v250, v251
    v_cvt_pk_bf16_f32 v213, v252, v253
    v_lshlrev_b32 v250, 16, v214
    v_and_b32 v251, 0xffff0000, v214
    v_lshlrev_b32 v252, 16, v215
    v_and_b32 v253, 0xffff0000, v215
    v_pk_fma_f32 v[250:251], v[250:251], v[224:225], v[226:227] op_sel_hi:[1,0,0] neg_lo:[0,0,1] neg_hi:[0,0,1]
    v_pk_fma_f32 v[252:253], v[252:253], v[224:225], v[226:227] op_sel_hi:[1,0,0] neg_lo:[0,0,1] neg_hi:[0,0,1]
    v_cvt_pk_bf16_f32 v214, v250, v251
    v_cvt_pk_bf16_f32 v215, v252, v253
    ds_write_b128 v254, v[212:215] offset:16384
    ds_write_b128 v254, v[192:195] offset:6144
    v_add_u32 v243, 0x8000, v235
    s_and_b32 s56, s30, 1
    s_lshl_b32 s56, s56, 12
    s_add_u32 s56, s56, 73728
    v_add_u32 v240, s56, v239
    v_add_u32 v241, 0x8000, v240
    s_waitcnt lgkmcnt(0)
    s_barrier
    ds_read_b128 v[72:75], v255 offset:0
    ds_read_b128 v[76:79], v248 offset:1024
    ds_read_b128 v[80:83], v255 offset:2048
    ds_read_b128 v[208:211], v236 offset:0
    ds_read_b128 v[212:215], v236 offset:64
    ds_read_b64_tr_b16 v[176:177], v228 offset:0
    ds_read_b64_tr_b16 v[178:179], v228 offset:512
    ds_read_b64_tr_b16 v[180:181], v229 offset:0
    ds_read_b64_tr_b16 v[182:183], v229 offset:512
    ds_read_b64_tr_b16 v[184:185], v228 offset:4096
    ds_read_b64_tr_b16 v[186:187], v228 offset:4608
    ds_read_b64_tr_b16 v[188:189], v229 offset:4096
    ds_read_b64_tr_b16 v[190:191], v229 offset:4608
    s_setprio 0
    s_waitcnt lgkmcnt(4)
    v_mfma_f32_16x16x32_bf16 v[144:147], v[176:179], v[0:3], v[208:211]
    ds_read_b128 v[84:87], v248 offset:3072
    v_mfma_f32_16x16x32_bf16 v[148:151], v[176:179], v[72:75], v[208:211]
    s_waitcnt lgkmcnt(1)
    s_barrier
    ds_read_b64_tr_b16 v[192:193], v228 offset:8192
    ds_read_b64_tr_b16 v[194:195], v228 offset:8704
    ds_read_b128 v[88:91], v255 offset:4096
    v_mfma_f32_16x16x32_bf16 v[152:155], v[180:183], v[0:3], v[212:215]
    ds_read_b64_tr_b16 v[196:197], v229 offset:8192
    ds_read_b128 v[92:95], v248 offset:5120
    v_mfma_f32_16x16x32_bf16 v[156:159], v[180:183], v[72:75], v[212:215]
    ds_read_b64_tr_b16 v[198:199], v229 offset:8704
    ds_read_b128 v[96:99], v255 offset:6144
    v_mfma_f32_16x16x32_bf16 v[144:147], v[184:187], v[4:7], v[144:147]
    ds_read_b64_tr_b16 v[200:201], v228 offset:12288
    ds_read_b128 v[100:103], v248 offset:7168
    v_mfma_f32_16x16x32_bf16 v[148:151], v[184:187], v[76:79], v[148:151]
    ds_read_b64_tr_b16 v[202:203], v228 offset:12800
    ds_read_b128 v[104:107], v255 offset:8192
    v_mfma_f32_16x16x32_bf16 v[152:155], v[188:191], v[4:7], v[152:155]
    ds_read_b64_tr_b16 v[204:205], v229 offset:12288
    ds_read_b128 v[108:111], v248 offset:9216
    v_mfma_f32_16x16x32_bf16 v[156:159], v[188:191], v[76:79], v[156:159]
    ds_read_b64_tr_b16 v[206:207], v229 offset:12800
    s_waitcnt lgkmcnt(14)
    ds_read_b128 v[112:115], v255 offset:10240
    s_waitcnt lgkmcnt(9)
    v_mfma_f32_16x16x32_bf16 v[144:147], v[192:195], v[8:11], v[144:147]
    ds_read_b64_tr_b16 v[176:177], v228 offset:16384
    ds_read_b128 v[116:119], v248 offset:11264
    v_mfma_f32_16x16x32_bf16 v[148:151], v[192:195], v[80:83], v[148:151]
    ds_read_b64_tr_b16 v[178:179], v228 offset:16896
    ds_read_b128 v[120:123], v255 offset:12288
    v_mfma_f32_16x16x32_bf16 v[152:155], v[196:199], v[8:11], v[152:155]
    ds_read_b64_tr_b16 v[180:181], v229 offset:16384
    ds_read_b128 v[124:127], v248 offset:13312
    v_mfma_f32_16x16x32_bf16 v[156:159], v[196:199], v[80:83], v[156:159]
    s_waitcnt lgkmcnt(14)
    ds_read_b64_tr_b16 v[182:183], v229 offset:16896
    s_waitcnt lgkmcnt(14)
    ds_read_b128 v[128:131], v255 offset:14336
    s_waitcnt lgkmcnt(9)
    v_mfma_f32_16x16x32_bf16 v[144:147], v[200:203], v[12:15], v[144:147]
    ds_read_b64_tr_b16 v[184:185], v228 offset:20480
    ds_read_b128 v[132:135], v248 offset:15360
    v_mfma_f32_16x16x32_bf16 v[148:151], v[200:203], v[84:87], v[148:151]
    ds_read_b64_tr_b16 v[186:187], v228 offset:20992
    ds_read_b128 v[136:139], v255 offset:16384
    v_mfma_f32_16x16x32_bf16 v[152:155], v[204:207], v[12:15], v[152:155]
    ds_read_b64_tr_b16 v[188:189], v229 offset:20480
    ds_read_b128 v[140:143], v248 offset:17408
    v_mfma_f32_16x16x32_bf16 v[156:159], v[204:207], v[84:87], v[156:159]
    s_waitcnt lgkmcnt(14)
    ds_read_b64_tr_b16 v[190:191], v229 offset:20992
    s_waitcnt lgkmcnt(8)
    v_mfma_f32_16x16x32_bf16 v[144:147], v[176:179], v[16:19], v[144:147]
    ds_read_b64_tr_b16 v[192:193], v228 offset:24576
    v_mfma_f32_16x16x32_bf16 v[148:151], v[176:179], v[88:91], v[148:151]
    ds_read_b64_tr_b16 v[194:195], v228 offset:25088
    v_mfma_f32_16x16x32_bf16 v[152:155], v[180:183], v[16:19], v[152:155]
    ds_read_b64_tr_b16 v[196:197], v229 offset:24576
    v_mfma_f32_16x16x32_bf16 v[156:159], v[180:183], v[88:91], v[156:159]
    ds_read_b64_tr_b16 v[198:199], v229 offset:25088
    s_waitcnt lgkmcnt(4)
    v_mfma_f32_16x16x32_bf16 v[144:147], v[184:187], v[20:23], v[144:147]
    ds_read_b64_tr_b16 v[200:201], v228 offset:28672
    v_mfma_f32_16x16x32_bf16 v[148:151], v[184:187], v[92:95], v[148:151]
    ds_read_b64_tr_b16 v[202:203], v228 offset:29184
    v_mfma_f32_16x16x32_bf16 v[152:155], v[188:191], v[20:23], v[152:155]
    ds_read_b64_tr_b16 v[204:205], v229 offset:28672
    v_mfma_f32_16x16x32_bf16 v[156:159], v[188:191], v[92:95], v[156:159]
    ds_read_b64_tr_b16 v[206:207], v229 offset:29184
    s_setprio 2
    s_add_u32 m0, s64, 0
    s_add_u32 s62, s33, 128
    buffer_load_dwordx4 v232, s[12:15], s62 offen lds
    s_setprio 0
    s_waitcnt lgkmcnt(4)
    v_mfma_f32_16x16x32_bf16 v[144:147], v[192:195], v[24:27], v[144:147]
    v_mfma_f32_16x16x32_bf16 v[148:151], v[192:195], v[96:99], v[148:151]
    s_waitcnt lgkmcnt(0)
    s_barrier
    ds_read_b64_tr_b16 v[176:177], v230 offset:0
    ds_read_b64_tr_b16 v[178:179], v230 offset:512
    v_mfma_f32_16x16x32_bf16 v[152:155], v[196:199], v[24:27], v[152:155]
    ds_read_b64_tr_b16 v[180:181], v231 offset:0
    v_mfma_f32_16x16x32_bf16 v[156:159], v[196:199], v[96:99], v[156:159]
    ds_read_b64_tr_b16 v[182:183], v231 offset:512
    v_mfma_f32_16x16x32_bf16 v[144:147], v[200:203], v[28:31], v[144:147]
    ds_read_b64_tr_b16 v[184:185], v230 offset:4096
    v_mfma_f32_16x16x32_bf16 v[148:151], v[200:203], v[100:103], v[148:151]
    ds_read_b64_tr_b16 v[186:187], v230 offset:4608
    v_mfma_f32_16x16x32_bf16 v[152:155], v[204:207], v[28:31], v[152:155]
    ds_read_b64_tr_b16 v[188:189], v231 offset:4096
    v_mfma_f32_16x16x32_bf16 v[156:159], v[204:207], v[100:103], v[156:159]
    ds_read_b64_tr_b16 v[190:191], v231 offset:4608
    s_waitcnt lgkmcnt(4)
    v_mfma_f32_16x16x32_bf16 v[144:147], v[176:179], v[32:35], v[144:147]
    ds_read_b64_tr_b16 v[192:193], v230 offset:8192
    v_mfma_f32_16x16x32_bf16 v[148:151], v[176:179], v[104:107], v[148:151]
    ds_read_b64_tr_b16 v[194:195], v230 offset:8704
    v_mfma_f32_16x16x32_bf16 v[152:155], v[180:183], v[32:35], v[152:155]
    ds_read_b64_tr_b16 v[196:197], v231 offset:8192
    v_mfma_f32_16x16x32_bf16 v[156:159], v[180:183], v[104:107], v[156:159]
    ds_read_b64_tr_b16 v[198:199], v231 offset:8704
    s_waitcnt lgkmcnt(4)
    v_mfma_f32_16x16x32_bf16 v[144:147], v[184:187], v[36:39], v[144:147]
    ds_read_b64_tr_b16 v[200:201], v230 offset:12288
    v_mfma_f32_16x16x32_bf16 v[148:151], v[184:187], v[108:111], v[148:151]
    ds_read_b64_tr_b16 v[202:203], v230 offset:12800
    v_mfma_f32_16x16x32_bf16 v[152:155], v[188:191], v[36:39], v[152:155]
    ds_read_b64_tr_b16 v[204:205], v231 offset:12288
    v_mfma_f32_16x16x32_bf16 v[156:159], v[188:191], v[108:111], v[156:159]
    ds_read_b64_tr_b16 v[206:207], v231 offset:12800
    s_waitcnt lgkmcnt(4)
    v_mfma_f32_16x16x32_bf16 v[144:147], v[192:195], v[40:43], v[144:147]
    ds_read_b64_tr_b16 v[176:177], v230 offset:16384
    v_mfma_f32_16x16x32_bf16 v[148:151], v[192:195], v[112:115], v[148:151]
    ds_read_b64_tr_b16 v[178:179], v230 offset:16896
    v_mfma_f32_16x16x32_bf16 v[152:155], v[196:199], v[40:43], v[152:155]
    ds_read_b64_tr_b16 v[180:181], v231 offset:16384
    v_mfma_f32_16x16x32_bf16 v[156:159], v[196:199], v[112:115], v[156:159]
    ds_read_b64_tr_b16 v[182:183], v231 offset:16896
    s_waitcnt lgkmcnt(4)
    v_mfma_f32_16x16x32_bf16 v[144:147], v[200:203], v[44:47], v[144:147]
    ds_read_b64_tr_b16 v[184:185], v230 offset:20480
    v_mfma_f32_16x16x32_bf16 v[148:151], v[200:203], v[116:119], v[148:151]
    ds_read_b64_tr_b16 v[186:187], v230 offset:20992
    v_mfma_f32_16x16x32_bf16 v[152:155], v[204:207], v[44:47], v[152:155]
    ds_read_b64_tr_b16 v[188:189], v231 offset:20480
    v_mfma_f32_16x16x32_bf16 v[156:159], v[204:207], v[116:119], v[156:159]
    ds_read_b64_tr_b16 v[190:191], v231 offset:20992
    s_setprio 2
    s_add_u32 m0, s64, 8192
    s_add_u32 s62, s33, 589952
    buffer_load_dwordx4 v232, s[12:15], s62 offen lds
    s_add_u32 m0, s64, 16384
    s_add_u32 s62, s33, 1179776
    buffer_load_dwordx4 v232, s[12:15], s62 offen lds
    s_add_u32 m0, s64, 24576
    s_add_u32 s62, s33, 1769600
    buffer_load_dwordx4 v232, s[12:15], s62 offen lds
    ds_read_b128 v[208:211], v236 offset:256
    ds_read_b128 v[212:215], v236 offset:320
    s_setprio 0
    s_waitcnt lgkmcnt(6)
    v_mfma_f32_16x16x32_bf16 v[144:147], v[176:179], v[48:51], v[144:147]
    v_mfma_f32_16x16x32_bf16 v[148:151], v[176:179], v[120:123], v[148:151]
    s_waitcnt vmcnt(3) lgkmcnt(2)
    s_barrier
    ds_read_b64_tr_b16 v[192:193], v230 offset:24576
    ds_read_b64_tr_b16 v[194:195], v230 offset:25088
    v_mfma_f32_16x16x32_bf16 v[152:155], v[180:183], v[48:51], v[152:155]
    ds_read_b64_tr_b16 v[196:197], v231 offset:24576
    v_mfma_f32_16x16x32_bf16 v[156:159], v[180:183], v[120:123], v[156:159]
    ds_read_b64_tr_b16 v[198:199], v231 offset:25088
    v_mfma_f32_16x16x32_bf16 v[144:147], v[184:187], v[52:55], v[144:147]
    ds_read_b64_tr_b16 v[200:201], v230 offset:28672
    v_mfma_f32_16x16x32_bf16 v[148:151], v[184:187], v[124:127], v[148:151]
    ds_read_b64_tr_b16 v[202:203], v230 offset:29184
    v_mfma_f32_16x16x32_bf16 v[152:155], v[188:191], v[52:55], v[152:155]
    ds_read_b64_tr_b16 v[204:205], v231 offset:28672
    v_mfma_f32_16x16x32_bf16 v[156:159], v[188:191], v[124:127], v[156:159]
    ds_read_b64_tr_b16 v[206:207], v231 offset:29184
    s_waitcnt lgkmcnt(4)
    v_mfma_f32_16x16x32_bf16 v[144:147], v[192:195], v[56:59], v[144:147]
    ds_read_b64_tr_b16 v[176:177], v230 offset:32768
    v_mfma_f32_16x16x32_bf16 v[148:151], v[192:195], v[128:131], v[148:151]
    ds_read_b64_tr_b16 v[178:179], v230 offset:33280
    v_mfma_f32_16x16x32_bf16 v[152:155], v[196:199], v[56:59], v[152:155]
    ds_read_b64_tr_b16 v[180:181], v231 offset:32768
    v_mfma_f32_16x16x32_bf16 v[156:159], v[196:199], v[128:131], v[156:159]
    ds_read_b64_tr_b16 v[182:183], v231 offset:33280
    s_waitcnt lgkmcnt(4)
    v_mfma_f32_16x16x32_bf16 v[144:147], v[200:203], v[60:63], v[144:147]
    ds_read_b64_tr_b16 v[184:185], v230 offset:36864
    v_mfma_f32_16x16x32_bf16 v[148:151], v[200:203], v[132:135], v[148:151]
    ds_read_b64_tr_b16 v[186:187], v230 offset:37376
    v_mfma_f32_16x16x32_bf16 v[152:155], v[204:207], v[60:63], v[152:155]
    ds_read_b64_tr_b16 v[188:189], v231 offset:36864
    v_mfma_f32_16x16x32_bf16 v[156:159], v[204:207], v[132:135], v[156:159]
    ds_read_b64_tr_b16 v[190:191], v231 offset:37376
    s_waitcnt lgkmcnt(4)
    v_mfma_f32_16x16x32_bf16 v[144:147], v[176:179], v[64:67], v[144:147]
    ds_read_b64_tr_b16 v[192:193], v228 offset:0
    v_mfma_f32_16x16x32_bf16 v[148:151], v[176:179], v[136:139], v[148:151]
    ds_read_b64_tr_b16 v[194:195], v228 offset:512
    v_mfma_f32_16x16x32_bf16 v[152:155], v[180:183], v[64:67], v[152:155]
    ds_read_b64_tr_b16 v[196:197], v229 offset:0
    v_mfma_f32_16x16x32_bf16 v[156:159], v[180:183], v[136:139], v[156:159]
    ds_read_b64_tr_b16 v[198:199], v229 offset:512
    s_waitcnt lgkmcnt(4)
    v_mfma_f32_16x16x32_bf16 v[160:163], v[184:187], v[68:71], v[144:147]
    ds_read_b64_tr_b16 v[200:201], v228 offset:4096
    v_mfma_f32_16x16x32_bf16 v[164:167], v[184:187], v[140:143], v[148:151]
    ds_read_b64_tr_b16 v[202:203], v228 offset:4608
    v_mfma_f32_16x16x32_bf16 v[168:171], v[188:191], v[68:71], v[152:155]
    ds_read_b64_tr_b16 v[204:205], v229 offset:4096
    v_mfma_f32_16x16x32_bf16 v[172:175], v[188:191], v[140:143], v[156:159]
    ds_read_b64_tr_b16 v[206:207], v229 offset:4608
    s_setprio 2
    s_add_u32 m0, s64, 32768
    s_add_u32 s62, s33, 2359424
    buffer_load_dwordx4 v232, s[12:15], s62 offen lds
    s_add_u32 m0, s64, 40960
    s_add_u32 s62, s33, 2949248
    buffer_load_dwordx4 v232, s[12:15], s62 offen lds
    s_nop 1
    v_exp_f32 v216, v160
    v_exp_f32 v217, v161
    v_exp_f32 v218, v162
    v_exp_f32 v219, v163
    v_fma_f32 v220, v216, 0.5, 1.0
    v_fma_f32 v221, v217, 0.5, 1.0
    v_fma_f32 v222, v218, 0.5, 1.0
    v_fma_f32 v223, v219, 0.5, 1.0
    v_fma_f32 v220, v216, v220, 1.0
    v_fma_f32 v221, v217, v221, 1.0
    v_fma_f32 v222, v218, v222, 1.0
    v_fma_f32 v223, v219, v223, 1.0
    v_rcp_f32 v220, v220
    v_rcp_f32 v221, v221
    v_rcp_f32 v222, v222
    v_rcp_f32 v223, v223
    v_fma_f32 v216, -v160, v220, v160
    v_fma_f32 v217, -v161, v221, v161
    v_fma_f32 v218, -v162, v222, v162
    v_fma_f32 v219, -v163, v223, v163
    v_cvt_pk_bf16_f32 v244, v216, v217
    v_cvt_pk_bf16_f32 v245, v218, v219
    v_exp_f32 v216, v168
    v_exp_f32 v217, v169
    v_exp_f32 v218, v170
    v_exp_f32 v219, v171
    v_fma_f32 v220, v216, 0.5, 1.0
    v_fma_f32 v221, v217, 0.5, 1.0
    s_add_u32 m0, s64, 49152
    s_add_u32 s62, s33, 3539072
    buffer_load_dwordx4 v232, s[12:15], s62 offen lds
    s_setprio 0
    s_waitcnt lgkmcnt(4)
    v_mfma_f32_16x16x32_bf16 v[144:147], v[192:195], v[0:3], v[208:211]
    v_mfma_f32_16x16x32_bf16 v[148:151], v[192:195], v[72:75], v[208:211]
    s_waitcnt vmcnt(3) lgkmcnt(0)
    s_barrier
    ds_read_b64_tr_b16 v[176:177], v228 offset:8192
    ds_read_b64_tr_b16 v[178:179], v228 offset:8704
    v_mfma_f32_16x16x32_bf16 v[152:155], v[196:199], v[0:3], v[212:215]
    ds_read_b64_tr_b16 v[180:181], v229 offset:8192
    v_mfma_f32_16x16x32_bf16 v[156:159], v[196:199], v[72:75], v[212:215]
    ds_read_b64_tr_b16 v[182:183], v229 offset:8704
    v_mfma_f32_16x16x32_bf16 v[144:147], v[200:203], v[4:7], v[144:147]
    ds_read_b64_tr_b16 v[184:185], v228 offset:12288
    v_mfma_f32_16x16x32_bf16 v[148:151], v[200:203], v[76:79], v[148:151]
    ds_read_b64_tr_b16 v[186:187], v228 offset:12800
    v_mfma_f32_16x16x32_bf16 v[152:155], v[204:207], v[4:7], v[152:155]
    ds_read_b64_tr_b16 v[188:189], v229 offset:12288
    v_mfma_f32_16x16x32_bf16 v[156:159], v[204:207], v[76:79], v[156:159]
    ds_read_b64_tr_b16 v[190:191], v229 offset:12800
    s_waitcnt lgkmcnt(4)
    v_mfma_f32_16x16x32_bf16 v[144:147], v[176:179], v[8:11], v[144:147]
    ds_read_b64_tr_b16 v[192:193], v228 offset:16384
    v_mfma_f32_16x16x32_bf16 v[148:151], v[176:179], v[80:83], v[148:151]
    ds_read_b64_tr_b16 v[194:195], v228 offset:16896
    v_mfma_f32_16x16x32_bf16 v[152:155], v[180:183], v[8:11], v[152:155]
    ds_read_b64_tr_b16 v[196:197], v229 offset:16384
    v_mfma_f32_16x16x32_bf16 v[156:159], v[180:183], v[80:83], v[156:159]
    ds_read_b64_tr_b16 v[198:199], v229 offset:16896
    s_waitcnt lgkmcnt(4)
    v_mfma_f32_16x16x32_bf16 v[144:147], v[184:187], v[12:15], v[144:147]
    ds_read_b64_tr_b16 v[200:201], v228 offset:20480
    v_mfma_f32_16x16x32_bf16 v[148:151], v[184:187], v[84:87], v[148:151]
    ds_read_b64_tr_b16 v[202:203], v228 offset:20992
    v_mfma_f32_16x16x32_bf16 v[152:155], v[188:191], v[12:15], v[152:155]
    ds_read_b64_tr_b16 v[204:205], v229 offset:20480
    v_mfma_f32_16x16x32_bf16 v[156:159], v[188:191], v[84:87], v[156:159]
    ds_read_b64_tr_b16 v[206:207], v229 offset:20992
    s_waitcnt lgkmcnt(4)
    v_mfma_f32_16x16x32_bf16 v[144:147], v[192:195], v[16:19], v[144:147]
    ds_read_b64_tr_b16 v[176:177], v228 offset:24576
    v_mfma_f32_16x16x32_bf16 v[148:151], v[192:195], v[88:91], v[148:151]
    ds_read_b64_tr_b16 v[178:179], v228 offset:25088
    v_mfma_f32_16x16x32_bf16 v[152:155], v[196:199], v[16:19], v[152:155]
    ds_read_b64_tr_b16 v[180:181], v229 offset:24576
    v_mfma_f32_16x16x32_bf16 v[156:159], v[196:199], v[88:91], v[156:159]
    ds_read_b64_tr_b16 v[182:183], v229 offset:25088
    s_waitcnt lgkmcnt(4)
    v_mfma_f32_16x16x32_bf16 v[144:147], v[200:203], v[20:23], v[144:147]
    ds_read_b64_tr_b16 v[184:185], v228 offset:28672
    v_mfma_f32_16x16x32_bf16 v[148:151], v[200:203], v[92:95], v[148:151]
    ds_read_b64_tr_b16 v[186:187], v228 offset:29184
    v_mfma_f32_16x16x32_bf16 v[152:155], v[204:207], v[20:23], v[152:155]
    ds_read_b64_tr_b16 v[188:189], v229 offset:28672
    v_mfma_f32_16x16x32_bf16 v[156:159], v[204:207], v[92:95], v[156:159]
    ds_read_b64_tr_b16 v[190:191], v229 offset:29184
    s_setprio 2
    v_fma_f32 v222, v218, 0.5, 1.0
    v_fma_f32 v223, v219, 0.5, 1.0
    v_fma_f32 v220, v216, v220, 1.0
    v_fma_f32 v221, v217, v221, 1.0
    v_fma_f32 v222, v218, v222, 1.0
    v_fma_f32 v223, v219, v223, 1.0
    v_rcp_f32 v220, v220
    v_rcp_f32 v221, v221
    v_rcp_f32 v222, v222
    v_rcp_f32 v223, v223
    v_fma_f32 v216, -v168, v220, v168
    s_add_u32 m0, s64, 57344
    s_add_u32 s62, s33, 4128896
    buffer_load_dwordx4 v232, s[12:15], s62 offen lds
    v_fma_f32 v217, -v169, v221, v169
    v_fma_f32 v218, -v170, v222, v170
    v_fma_f32 v219, -v171, v223, v171
    v_cvt_pk_bf16_f32 v246, v216, v217
    v_cvt_pk_bf16_f32 v247, v218, v219
    ds_write_b128 v243, v[244:247] offset:24576
    v_exp_f32 v216, v164
    v_exp_f32 v217, v165
    v_exp_f32 v218, v166
    v_exp_f32 v219, v167
    s_add_u32 m0, s64, 65536
    s_add_u32 s62, s33, 4718720
    buffer_load_dwordx4 v232, s[12:15], s62 offen lds
    v_fma_f32 v220, v216, 0.5, 1.0
    v_fma_f32 v221, v217, 0.5, 1.0
    v_fma_f32 v222, v218, 0.5, 1.0
    v_fma_f32 v223, v219, 0.5, 1.0
    v_fma_f32 v220, v216, v220, 1.0
    v_fma_f32 v221, v217, v221, 1.0
    v_fma_f32 v222, v218, v222, 1.0
    v_fma_f32 v223, v219, v223, 1.0
    v_rcp_f32 v220, v220
    v_rcp_f32 v221, v221
    s_add_u32 m0, s64, 0
    s_add_u32 s62, s33, 256
    buffer_load_dwordx4 v232, s[12:15], s62 offen lds
    s_setprio 0
    s_waitcnt lgkmcnt(5)
    v_mfma_f32_16x16x32_bf16 v[144:147], v[176:179], v[24:27], v[144:147]
    v_mfma_f32_16x16x32_bf16 v[148:151], v[176:179], v[96:99], v[148:151]
    s_waitcnt vmcnt(3) lgkmcnt(1)
    s_barrier
    ds_read_b64_tr_b16 v[192:193], v230 offset:0
    ds_read_b64_tr_b16 v[194:195], v230 offset:512
    v_mfma_f32_16x16x32_bf16 v[152:155], v[180:183], v[24:27], v[152:155]
    ds_read_b64_tr_b16 v[196:197], v231 offset:0
    v_mfma_f32_16x16x32_bf16 v[156:159], v[180:183], v[96:99], v[156:159]
    ds_read_b64_tr_b16 v[198:199], v231 offset:512
    v_mfma_f32_16x16x32_bf16 v[144:147], v[184:187], v[28:31], v[144:147]
    ds_read_b64_tr_b16 v[200:201], v230 offset:4096
    v_mfma_f32_16x16x32_bf16 v[148:151], v[184:187], v[100:103], v[148:151]
    ds_read_b64_tr_b16 v[202:203], v230 offset:4608
    v_mfma_f32_16x16x32_bf16 v[152:155], v[188:191], v[28:31], v[152:155]
    ds_read_b64_tr_b16 v[204:205], v231 offset:4096
    v_mfma_f32_16x16x32_bf16 v[156:159], v[188:191], v[100:103], v[156:159]
    ds_read_b64_tr_b16 v[206:207], v231 offset:4608
    s_waitcnt lgkmcnt(4)
    v_mfma_f32_16x16x32_bf16 v[144:147], v[192:195], v[32:35], v[144:147]
    ds_read_b64_tr_b16 v[176:177], v230 offset:8192
    v_mfma_f32_16x16x32_bf16 v[148:151], v[192:195], v[104:107], v[148:151]
    ds_read_b64_tr_b16 v[178:179], v230 offset:8704
    v_mfma_f32_16x16x32_bf16 v[152:155], v[196:199], v[32:35], v[152:155]
    ds_read_b64_tr_b16 v[180:181], v231 offset:8192
    v_mfma_f32_16x16x32_bf16 v[156:159], v[196:199], v[104:107], v[156:159]
    ds_read_b64_tr_b16 v[182:183], v231 offset:8704
    s_waitcnt lgkmcnt(4)
    v_mfma_f32_16x16x32_bf16 v[144:147], v[200:203], v[36:39], v[144:147]
    ds_read_b64_tr_b16 v[184:185], v230 offset:12288
    v_mfma_f32_16x16x32_bf16 v[148:151], v[200:203], v[108:111], v[148:151]
    ds_read_b64_tr_b16 v[186:187], v230 offset:12800
    v_mfma_f32_16x16x32_bf16 v[152:155], v[204:207], v[36:39], v[152:155]
    ds_read_b64_tr_b16 v[188:189], v231 offset:12288
    v_mfma_f32_16x16x32_bf16 v[156:159], v[204:207], v[108:111], v[156:159]
    ds_read_b64_tr_b16 v[190:191], v231 offset:12800
    s_waitcnt lgkmcnt(4)
    v_mfma_f32_16x16x32_bf16 v[144:147], v[176:179], v[40:43], v[144:147]
    ds_read_b64_tr_b16 v[192:193], v230 offset:16384
    v_mfma_f32_16x16x32_bf16 v[148:151], v[176:179], v[112:115], v[148:151]
    ds_read_b64_tr_b16 v[194:195], v230 offset:16896
    v_mfma_f32_16x16x32_bf16 v[152:155], v[180:183], v[40:43], v[152:155]
    ds_read_b64_tr_b16 v[196:197], v231 offset:16384
    v_mfma_f32_16x16x32_bf16 v[156:159], v[180:183], v[112:115], v[156:159]
    ds_read_b64_tr_b16 v[198:199], v231 offset:16896
    s_waitcnt lgkmcnt(4)
    v_mfma_f32_16x16x32_bf16 v[144:147], v[184:187], v[44:47], v[144:147]
    ds_read_b64_tr_b16 v[200:201], v230 offset:20480
    v_mfma_f32_16x16x32_bf16 v[148:151], v[184:187], v[116:119], v[148:151]
    ds_read_b64_tr_b16 v[202:203], v230 offset:20992
    v_mfma_f32_16x16x32_bf16 v[152:155], v[188:191], v[44:47], v[152:155]
    ds_read_b64_tr_b16 v[204:205], v231 offset:20480
    v_mfma_f32_16x16x32_bf16 v[156:159], v[188:191], v[116:119], v[156:159]
    ds_read_b64_tr_b16 v[206:207], v231 offset:20992
    s_setprio 2
    v_rcp_f32 v222, v222
    v_rcp_f32 v223, v223
    v_fma_f32 v216, -v164, v220, v164
    v_fma_f32 v217, -v165, v221, v165
    v_fma_f32 v218, -v166, v222, v166
    v_fma_f32 v219, -v167, v223, v167
    v_cvt_pk_bf16_f32 v248, v216, v217
    s_add_u32 m0, s64, 8192
    s_add_u32 s62, s33, 590080
    buffer_load_dwordx4 v232, s[12:15], s62 offen lds
    v_cvt_pk_bf16_f32 v249, v218, v219
    v_exp_f32 v216, v172
    v_exp_f32 v217, v173
    v_exp_f32 v218, v174
    v_exp_f32 v219, v175
    v_fma_f32 v220, v216, 0.5, 1.0
    s_add_u32 m0, s64, 16384
    s_add_u32 s62, s33, 1179904
    buffer_load_dwordx4 v232, s[12:15], s62 offen lds
    v_fma_f32 v221, v217, 0.5, 1.0
    v_fma_f32 v222, v218, 0.5, 1.0
    v_fma_f32 v223, v219, 0.5, 1.0
    v_fma_f32 v220, v216, v220, 1.0
    v_fma_f32 v221, v217, v221, 1.0
    v_fma_f32 v222, v218, v222, 1.0
    s_add_u32 m0, s64, 24576
    s_add_u32 s62, s33, 1769728
    buffer_load_dwordx4 v232, s[12:15], s62 offen lds
    v_fma_f32 v223, v219, v223, 1.0
    v_rcp_f32 v220, v220
    v_rcp_f32 v221, v221
    v_rcp_f32 v222, v222
    v_rcp_f32 v223, v223
    v_fma_f32 v216, -v172, v220, v172
    ds_read_b128 v[208:211], v236 offset:512
    v_fma_f32 v217, -v173, v221, v173
    v_fma_f32 v218, -v174, v222, v174
    v_fma_f32 v219, -v175, v223, v175
    v_cvt_pk_bf16_f32 v250, v216, v217
    v_cvt_pk_bf16_f32 v251, v218, v219
    ds_write_b128 v243, v[248:251] offset:25600
    ds_read_b128 v[212:215], v236 offset:576
    s_setprio 0
    s_waitcnt lgkmcnt(7)
    v_mfma_f32_16x16x32_bf16 v[144:147], v[192:195], v[48:51], v[144:147]
    v_mfma_f32_16x16x32_bf16 v[148:151], v[192:195], v[120:123], v[148:151]
    s_waitcnt vmcnt(3) lgkmcnt(3)
    s_barrier
    ds_read_b64_tr_b16 v[176:177], v230 offset:24576
    ds_read_b64_tr_b16 v[178:179], v230 offset:25088
    v_mfma_f32_16x16x32_bf16 v[152:155], v[196:199], v[48:51], v[152:155]
    ds_read_b64_tr_b16 v[180:181], v231 offset:24576
    v_mfma_f32_16x16x32_bf16 v[156:159], v[196:199], v[120:123], v[156:159]
    ds_read_b64_tr_b16 v[182:183], v231 offset:25088
    v_mfma_f32_16x16x32_bf16 v[144:147], v[200:203], v[52:55], v[144:147]
    ds_read_b64_tr_b16 v[184:185], v230 offset:28672
    v_mfma_f32_16x16x32_bf16 v[148:151], v[200:203], v[124:127], v[148:151]
    ds_read_b64_tr_b16 v[186:187], v230 offset:29184
    v_mfma_f32_16x16x32_bf16 v[152:155], v[204:207], v[52:55], v[152:155]
    ds_read_b64_tr_b16 v[188:189], v231 offset:28672
    v_mfma_f32_16x16x32_bf16 v[156:159], v[204:207], v[124:127], v[156:159]
    ds_read_b64_tr_b16 v[190:191], v231 offset:29184
    s_waitcnt lgkmcnt(4)
    v_mfma_f32_16x16x32_bf16 v[144:147], v[176:179], v[56:59], v[144:147]
    ds_read_b64_tr_b16 v[192:193], v230 offset:32768
    v_mfma_f32_16x16x32_bf16 v[148:151], v[176:179], v[128:131], v[148:151]
    ds_read_b64_tr_b16 v[194:195], v230 offset:33280
    v_mfma_f32_16x16x32_bf16 v[152:155], v[180:183], v[56:59], v[152:155]
    ds_read_b64_tr_b16 v[196:197], v231 offset:32768
    v_mfma_f32_16x16x32_bf16 v[156:159], v[180:183], v[128:131], v[156:159]
    ds_read_b64_tr_b16 v[198:199], v231 offset:33280
    s_waitcnt lgkmcnt(4)
    v_mfma_f32_16x16x32_bf16 v[144:147], v[184:187], v[60:63], v[144:147]
    ds_read_b64_tr_b16 v[200:201], v230 offset:36864
    v_mfma_f32_16x16x32_bf16 v[148:151], v[184:187], v[132:135], v[148:151]
    ds_read_b64_tr_b16 v[202:203], v230 offset:37376
    v_mfma_f32_16x16x32_bf16 v[152:155], v[188:191], v[60:63], v[152:155]
    ds_read_b64_tr_b16 v[204:205], v231 offset:36864
    v_mfma_f32_16x16x32_bf16 v[156:159], v[188:191], v[132:135], v[156:159]
    ds_read_b64_tr_b16 v[206:207], v231 offset:37376
    s_waitcnt lgkmcnt(4)
    v_mfma_f32_16x16x32_bf16 v[144:147], v[192:195], v[64:67], v[144:147]
    ds_read_b64_tr_b16 v[176:177], v228 offset:0
    v_mfma_f32_16x16x32_bf16 v[148:151], v[192:195], v[136:139], v[148:151]
    ds_read_b64_tr_b16 v[178:179], v228 offset:512
    v_mfma_f32_16x16x32_bf16 v[152:155], v[196:199], v[64:67], v[152:155]
    ds_read_b64_tr_b16 v[180:181], v229 offset:0
    v_mfma_f32_16x16x32_bf16 v[156:159], v[196:199], v[136:139], v[156:159]
    ds_read_b64_tr_b16 v[182:183], v229 offset:512
    s_waitcnt lgkmcnt(4)
    v_mfma_f32_16x16x32_bf16 v[160:163], v[200:203], v[68:71], v[144:147]
    ds_read_b64_tr_b16 v[184:185], v228 offset:4096
    v_mfma_f32_16x16x32_bf16 v[164:167], v[200:203], v[140:143], v[148:151]
    ds_read_b64_tr_b16 v[186:187], v228 offset:4608
    v_mfma_f32_16x16x32_bf16 v[168:171], v[204:207], v[68:71], v[152:155]
    ds_read_b64_tr_b16 v[188:189], v229 offset:4096
    v_mfma_f32_16x16x32_bf16 v[172:175], v[204:207], v[140:143], v[156:159]
    ds_read_b64_tr_b16 v[190:191], v229 offset:4608
    s_setprio 2
    s_add_u32 m0, s64, 32768
    s_add_u32 s62, s33, 2359552
    buffer_load_dwordx4 v232, s[12:15], s62 offen lds
    s_add_u32 m0, s64, 40960
    s_add_u32 s62, s33, 2949376
    buffer_load_dwordx4 v232, s[12:15], s62 offen lds
    s_nop 1
    v_exp_f32 v216, v160
    v_exp_f32 v217, v161
    v_exp_f32 v218, v162
    v_exp_f32 v219, v163
    v_fma_f32 v220, v216, 0.5, 1.0
    v_fma_f32 v221, v217, 0.5, 1.0
    v_fma_f32 v222, v218, 0.5, 1.0
    v_fma_f32 v223, v219, 0.5, 1.0
    v_fma_f32 v220, v216, v220, 1.0
    v_fma_f32 v221, v217, v221, 1.0
    v_fma_f32 v222, v218, v222, 1.0
    v_fma_f32 v223, v219, v223, 1.0
    v_rcp_f32 v220, v220
    v_rcp_f32 v221, v221
    v_rcp_f32 v222, v222
    v_rcp_f32 v223, v223
    v_fma_f32 v216, -v160, v220, v160
    v_fma_f32 v217, -v161, v221, v161
    v_fma_f32 v218, -v162, v222, v162
    v_fma_f32 v219, -v163, v223, v163
    v_cvt_pk_bf16_f32 v244, v216, v217
    v_cvt_pk_bf16_f32 v245, v218, v219
    v_exp_f32 v216, v168
    v_exp_f32 v217, v169
    v_exp_f32 v218, v170
    v_exp_f32 v219, v171
    v_fma_f32 v220, v216, 0.5, 1.0
    v_fma_f32 v221, v217, 0.5, 1.0
    s_add_u32 m0, s64, 49152
    s_add_u32 s62, s33, 3539200
    buffer_load_dwordx4 v232, s[12:15], s62 offen lds
    s_setprio 0
    s_waitcnt lgkmcnt(4)
    v_mfma_f32_16x16x32_bf16 v[144:147], v[176:179], v[0:3], v[208:211]
    v_mfma_f32_16x16x32_bf16 v[148:151], v[176:179], v[72:75], v[208:211]
    s_waitcnt vmcnt(3) lgkmcnt(0)
    s_barrier
    ds_read_b64_tr_b16 v[192:193], v228 offset:8192
    ds_read_b64_tr_b16 v[194:195], v228 offset:8704
    v_mfma_f32_16x16x32_bf16 v[152:155], v[180:183], v[0:3], v[212:215]
    ds_read_b64_tr_b16 v[196:197], v229 offset:8192
    v_mfma_f32_16x16x32_bf16 v[156:159], v[180:183], v[72:75], v[212:215]
    ds_read_b64_tr_b16 v[198:199], v229 offset:8704
    v_mfma_f32_16x16x32_bf16 v[144:147], v[184:187], v[4:7], v[144:147]
    ds_read_b64_tr_b16 v[200:201], v228 offset:12288
    v_mfma_f32_16x16x32_bf16 v[148:151], v[184:187], v[76:79], v[148:151]
    ds_read_b64_tr_b16 v[202:203], v228 offset:12800
    v_mfma_f32_16x16x32_bf16 v[152:155], v[188:191], v[4:7], v[152:155]
    ds_read_b64_tr_b16 v[204:205], v229 offset:12288
    v_mfma_f32_16x16x32_bf16 v[156:159], v[188:191], v[76:79], v[156:159]
    ds_read_b64_tr_b16 v[206:207], v229 offset:12800
    s_waitcnt lgkmcnt(4)
    v_mfma_f32_16x16x32_bf16 v[144:147], v[192:195], v[8:11], v[144:147]
    ds_read_b64_tr_b16 v[176:177], v228 offset:16384
    v_mfma_f32_16x16x32_bf16 v[148:151], v[192:195], v[80:83], v[148:151]
    ds_read_b64_tr_b16 v[178:179], v228 offset:16896
    v_mfma_f32_16x16x32_bf16 v[152:155], v[196:199], v[8:11], v[152:155]
    ds_read_b64_tr_b16 v[180:181], v229 offset:16384
    v_mfma_f32_16x16x32_bf16 v[156:159], v[196:199], v[80:83], v[156:159]
    ds_read_b64_tr_b16 v[182:183], v229 offset:16896
    s_waitcnt lgkmcnt(4)
    v_mfma_f32_16x16x32_bf16 v[144:147], v[200:203], v[12:15], v[144:147]
    ds_read_b64_tr_b16 v[184:185], v228 offset:20480
    v_mfma_f32_16x16x32_bf16 v[148:151], v[200:203], v[84:87], v[148:151]
    ds_read_b64_tr_b16 v[186:187], v228 offset:20992
    v_mfma_f32_16x16x32_bf16 v[152:155], v[204:207], v[12:15], v[152:155]
    ds_read_b64_tr_b16 v[188:189], v229 offset:20480
    v_mfma_f32_16x16x32_bf16 v[156:159], v[204:207], v[84:87], v[156:159]
    ds_read_b64_tr_b16 v[190:191], v229 offset:20992
    s_waitcnt lgkmcnt(4)
    v_mfma_f32_16x16x32_bf16 v[144:147], v[176:179], v[16:19], v[144:147]
    ds_read_b64_tr_b16 v[192:193], v228 offset:24576
    v_mfma_f32_16x16x32_bf16 v[148:151], v[176:179], v[88:91], v[148:151]
    ds_read_b64_tr_b16 v[194:195], v228 offset:25088
    v_mfma_f32_16x16x32_bf16 v[152:155], v[180:183], v[16:19], v[152:155]
    ds_read_b64_tr_b16 v[196:197], v229 offset:24576
    v_mfma_f32_16x16x32_bf16 v[156:159], v[180:183], v[88:91], v[156:159]
    ds_read_b64_tr_b16 v[198:199], v229 offset:25088
    s_waitcnt lgkmcnt(4)
    v_mfma_f32_16x16x32_bf16 v[144:147], v[184:187], v[20:23], v[144:147]
    ds_read_b64_tr_b16 v[200:201], v228 offset:28672
    v_mfma_f32_16x16x32_bf16 v[148:151], v[184:187], v[92:95], v[148:151]
    ds_read_b64_tr_b16 v[202:203], v228 offset:29184
    v_mfma_f32_16x16x32_bf16 v[152:155], v[188:191], v[20:23], v[152:155]
    ds_read_b64_tr_b16 v[204:205], v229 offset:28672
    v_mfma_f32_16x16x32_bf16 v[156:159], v[188:191], v[92:95], v[156:159]
    ds_read_b64_tr_b16 v[206:207], v229 offset:29184
    s_setprio 2
    v_fma_f32 v222, v218, 0.5, 1.0
    v_fma_f32 v223, v219, 0.5, 1.0
    v_fma_f32 v220, v216, v220, 1.0
    v_fma_f32 v221, v217, v221, 1.0
    v_fma_f32 v222, v218, v222, 1.0
    v_fma_f32 v223, v219, v223, 1.0
    v_rcp_f32 v220, v220
    v_rcp_f32 v221, v221
    v_rcp_f32 v222, v222
    v_rcp_f32 v223, v223
    v_fma_f32 v216, -v168, v220, v168
    s_add_u32 m0, s64, 57344
    s_add_u32 s62, s33, 4129024
    buffer_load_dwordx4 v232, s[12:15], s62 offen lds
    v_fma_f32 v217, -v169, v221, v169
    v_fma_f32 v218, -v170, v222, v170
    v_fma_f32 v219, -v171, v223, v171
    v_cvt_pk_bf16_f32 v246, v216, v217
    v_cvt_pk_bf16_f32 v247, v218, v219
    ds_write_b128 v235, v[244:247] offset:0
    v_exp_f32 v216, v164
    v_exp_f32 v217, v165
    v_exp_f32 v218, v166
    v_exp_f32 v219, v167
    s_add_u32 m0, s64, 65536
    s_add_u32 s62, s33, 4718848
    buffer_load_dwordx4 v232, s[12:15], s62 offen lds
    v_fma_f32 v220, v216, 0.5, 1.0
    v_fma_f32 v221, v217, 0.5, 1.0
    v_fma_f32 v222, v218, 0.5, 1.0
    v_fma_f32 v223, v219, 0.5, 1.0
    v_fma_f32 v220, v216, v220, 1.0
    v_fma_f32 v221, v217, v221, 1.0
    v_fma_f32 v222, v218, v222, 1.0
    v_fma_f32 v223, v219, v223, 1.0
    v_rcp_f32 v220, v220
    v_rcp_f32 v221, v221
    s_add_u32 m0, s64, 0
    s_add_u32 s62, s33, 384
    buffer_load_dwordx4 v232, s[12:15], s62 offen lds
    s_setprio 0
    s_waitcnt lgkmcnt(5)
    v_mfma_f32_16x16x32_bf16 v[144:147], v[192:195], v[24:27], v[144:147]
    v_mfma_f32_16x16x32_bf16 v[148:151], v[192:195], v[96:99], v[148:151]
    s_waitcnt vmcnt(3) lgkmcnt(1)
    s_barrier
    ds_read_b64_tr_b16 v[176:177], v230 offset:0
    ds_read_b64_tr_b16 v[178:179], v230 offset:512
    v_mfma_f32_16x16x32_bf16 v[152:155], v[196:199], v[24:27], v[152:155]
    ds_read_b64_tr_b16 v[180:181], v231 offset:0
    v_mfma_f32_16x16x32_bf16 v[156:159], v[196:199], v[96:99], v[156:159]
    ds_read_b64_tr_b16 v[182:183], v231 offset:512
    v_mfma_f32_16x16x32_bf16 v[144:147], v[200:203], v[28:31], v[144:147]
    ds_read_b64_tr_b16 v[184:185], v230 offset:4096
    v_mfma_f32_16x16x32_bf16 v[148:151], v[200:203], v[100:103], v[148:151]
    ds_read_b64_tr_b16 v[186:187], v230 offset:4608
    v_mfma_f32_16x16x32_bf16 v[152:155], v[204:207], v[28:31], v[152:155]
    ds_read_b64_tr_b16 v[188:189], v231 offset:4096
    v_mfma_f32_16x16x32_bf16 v[156:159], v[204:207], v[100:103], v[156:159]
    ds_read_b64_tr_b16 v[190:191], v231 offset:4608
    s_waitcnt lgkmcnt(4)
    v_mfma_f32_16x16x32_bf16 v[144:147], v[176:179], v[32:35], v[144:147]
    ds_read_b64_tr_b16 v[192:193], v230 offset:8192
    v_mfma_f32_16x16x32_bf16 v[148:151], v[176:179], v[104:107], v[148:151]
    ds_read_b64_tr_b16 v[194:195], v230 offset:8704
    v_mfma_f32_16x16x32_bf16 v[152:155], v[180:183], v[32:35], v[152:155]
    ds_read_b64_tr_b16 v[196:197], v231 offset:8192
    v_mfma_f32_16x16x32_bf16 v[156:159], v[180:183], v[104:107], v[156:159]
    ds_read_b64_tr_b16 v[198:199], v231 offset:8704
    s_waitcnt lgkmcnt(4)
    v_mfma_f32_16x16x32_bf16 v[144:147], v[184:187], v[36:39], v[144:147]
    ds_read_b64_tr_b16 v[200:201], v230 offset:12288
    v_mfma_f32_16x16x32_bf16 v[148:151], v[184:187], v[108:111], v[148:151]
    ds_read_b64_tr_b16 v[202:203], v230 offset:12800
    v_mfma_f32_16x16x32_bf16 v[152:155], v[188:191], v[36:39], v[152:155]
    ds_read_b64_tr_b16 v[204:205], v231 offset:12288
    v_mfma_f32_16x16x32_bf16 v[156:159], v[188:191], v[108:111], v[156:159]
    ds_read_b64_tr_b16 v[206:207], v231 offset:12800
    s_waitcnt lgkmcnt(4)
    v_mfma_f32_16x16x32_bf16 v[144:147], v[192:195], v[40:43], v[144:147]
    ds_read_b64_tr_b16 v[176:177], v230 offset:16384
    v_mfma_f32_16x16x32_bf16 v[148:151], v[192:195], v[112:115], v[148:151]
    ds_read_b64_tr_b16 v[178:179], v230 offset:16896
    v_mfma_f32_16x16x32_bf16 v[152:155], v[196:199], v[40:43], v[152:155]
    ds_read_b64_tr_b16 v[180:181], v231 offset:16384
    v_mfma_f32_16x16x32_bf16 v[156:159], v[196:199], v[112:115], v[156:159]
    ds_read_b64_tr_b16 v[182:183], v231 offset:16896
    s_waitcnt lgkmcnt(4)
    v_mfma_f32_16x16x32_bf16 v[144:147], v[200:203], v[44:47], v[144:147]
    ds_read_b64_tr_b16 v[184:185], v230 offset:20480
    v_mfma_f32_16x16x32_bf16 v[148:151], v[200:203], v[116:119], v[148:151]
    ds_read_b64_tr_b16 v[186:187], v230 offset:20992
    v_mfma_f32_16x16x32_bf16 v[152:155], v[204:207], v[44:47], v[152:155]
    ds_read_b64_tr_b16 v[188:189], v231 offset:20480
    v_mfma_f32_16x16x32_bf16 v[156:159], v[204:207], v[116:119], v[156:159]
    ds_read_b64_tr_b16 v[190:191], v231 offset:20992
    s_setprio 2
    v_rcp_f32 v222, v222
    v_rcp_f32 v223, v223
    v_fma_f32 v216, -v164, v220, v164
    v_fma_f32 v217, -v165, v221, v165
    v_fma_f32 v218, -v166, v222, v166
    v_fma_f32 v219, -v167, v223, v167
    v_cvt_pk_bf16_f32 v248, v216, v217
    s_add_u32 m0, s64, 8192
    s_add_u32 s62, s33, 590208
    buffer_load_dwordx4 v232, s[12:15], s62 offen lds
    v_cvt_pk_bf16_f32 v249, v218, v219
    v_exp_f32 v216, v172
    v_exp_f32 v217, v173
    v_exp_f32 v218, v174
    v_exp_f32 v219, v175
    v_fma_f32 v220, v216, 0.5, 1.0
    s_add_u32 m0, s64, 16384
    s_add_u32 s62, s33, 1180032
    buffer_load_dwordx4 v232, s[12:15], s62 offen lds
    v_fma_f32 v221, v217, 0.5, 1.0
    v_fma_f32 v222, v218, 0.5, 1.0
    v_fma_f32 v223, v219, 0.5, 1.0
    v_fma_f32 v220, v216, v220, 1.0
    v_fma_f32 v221, v217, v221, 1.0
    v_fma_f32 v222, v218, v222, 1.0
    s_add_u32 m0, s64, 24576
    s_add_u32 s62, s33, 1769856
    buffer_load_dwordx4 v232, s[12:15], s62 offen lds
    v_fma_f32 v223, v219, v223, 1.0
    v_rcp_f32 v220, v220
    v_rcp_f32 v221, v221
    v_rcp_f32 v222, v222
    v_rcp_f32 v223, v223
    v_fma_f32 v216, -v172, v220, v172
    ds_read_b128 v[208:211], v236 offset:768
    v_fma_f32 v217, -v173, v221, v173
    v_fma_f32 v218, -v174, v222, v174
    v_fma_f32 v219, -v175, v223, v175
    v_cvt_pk_bf16_f32 v250, v216, v217
    v_cvt_pk_bf16_f32 v251, v218, v219
    ds_write_b128 v235, v[248:251] offset:1024
    ds_read_b128 v[212:215], v236 offset:832
    s_setprio 0
    s_waitcnt lgkmcnt(7)
    v_mfma_f32_16x16x32_bf16 v[144:147], v[176:179], v[48:51], v[144:147]
    v_mfma_f32_16x16x32_bf16 v[148:151], v[176:179], v[120:123], v[148:151]
    s_waitcnt vmcnt(3) lgkmcnt(3)
    s_barrier
    ds_read_b64_tr_b16 v[192:193], v230 offset:24576
    ds_read_b64_tr_b16 v[194:195], v230 offset:25088
    v_mfma_f32_16x16x32_bf16 v[152:155], v[180:183], v[48:51], v[152:155]
    ds_read_b64_tr_b16 v[196:197], v231 offset:24576
    v_mfma_f32_16x16x32_bf16 v[156:159], v[180:183], v[120:123], v[156:159]
    ds_read_b64_tr_b16 v[198:199], v231 offset:25088
    v_mfma_f32_16x16x32_bf16 v[144:147], v[184:187], v[52:55], v[144:147]
    ds_read_b64_tr_b16 v[200:201], v230 offset:28672
    v_mfma_f32_16x16x32_bf16 v[148:151], v[184:187], v[124:127], v[148:151]
    ds_read_b64_tr_b16 v[202:203], v230 offset:29184
    v_mfma_f32_16x16x32_bf16 v[152:155], v[188:191], v[52:55], v[152:155]
    ds_read_b64_tr_b16 v[204:205], v231 offset:28672
    v_mfma_f32_16x16x32_bf16 v[156:159], v[188:191], v[124:127], v[156:159]
    ds_read_b64_tr_b16 v[206:207], v231 offset:29184
    s_waitcnt lgkmcnt(4)
    v_mfma_f32_16x16x32_bf16 v[144:147], v[192:195], v[56:59], v[144:147]
    ds_read_b64_tr_b16 v[176:177], v230 offset:32768
    v_mfma_f32_16x16x32_bf16 v[148:151], v[192:195], v[128:131], v[148:151]
    ds_read_b64_tr_b16 v[178:179], v230 offset:33280
    v_mfma_f32_16x16x32_bf16 v[152:155], v[196:199], v[56:59], v[152:155]
    ds_read_b64_tr_b16 v[180:181], v231 offset:32768
    v_mfma_f32_16x16x32_bf16 v[156:159], v[196:199], v[128:131], v[156:159]
    ds_read_b64_tr_b16 v[182:183], v231 offset:33280
    s_waitcnt lgkmcnt(4)
    v_mfma_f32_16x16x32_bf16 v[144:147], v[200:203], v[60:63], v[144:147]
    ds_read_b64_tr_b16 v[184:185], v230 offset:36864
    v_mfma_f32_16x16x32_bf16 v[148:151], v[200:203], v[132:135], v[148:151]
    ds_read_b64_tr_b16 v[186:187], v230 offset:37376
    v_mfma_f32_16x16x32_bf16 v[152:155], v[204:207], v[60:63], v[152:155]
    ds_read_b64_tr_b16 v[188:189], v231 offset:36864
    v_mfma_f32_16x16x32_bf16 v[156:159], v[204:207], v[132:135], v[156:159]
    ds_read_b64_tr_b16 v[190:191], v231 offset:37376
    s_waitcnt lgkmcnt(4)
    v_mfma_f32_16x16x32_bf16 v[144:147], v[176:179], v[64:67], v[144:147]
    ds_read_b64_tr_b16 v[192:193], v228 offset:0
    v_mfma_f32_16x16x32_bf16 v[148:151], v[176:179], v[136:139], v[148:151]
    ds_read_b64_tr_b16 v[194:195], v228 offset:512
    v_mfma_f32_16x16x32_bf16 v[152:155], v[180:183], v[64:67], v[152:155]
    ds_read_b64_tr_b16 v[196:197], v229 offset:0
    v_mfma_f32_16x16x32_bf16 v[156:159], v[180:183], v[136:139], v[156:159]
    ds_read_b64_tr_b16 v[198:199], v229 offset:512
    s_waitcnt lgkmcnt(4)
    v_mfma_f32_16x16x32_bf16 v[160:163], v[184:187], v[68:71], v[144:147]
    ds_read_b64_tr_b16 v[200:201], v228 offset:4096
    v_mfma_f32_16x16x32_bf16 v[164:167], v[184:187], v[140:143], v[148:151]
    ds_read_b64_tr_b16 v[202:203], v228 offset:4608
    v_mfma_f32_16x16x32_bf16 v[168:171], v[188:191], v[68:71], v[152:155]
    ds_read_b64_tr_b16 v[204:205], v229 offset:4096
    v_mfma_f32_16x16x32_bf16 v[172:175], v[188:191], v[140:143], v[156:159]
    ds_read_b64_tr_b16 v[206:207], v229 offset:4608
    s_setprio 2
    s_add_u32 m0, s64, 32768
    s_add_u32 s62, s33, 2359680
    buffer_load_dwordx4 v232, s[12:15], s62 offen lds
    s_add_u32 m0, s64, 40960
    s_add_u32 s62, s33, 2949504
    buffer_load_dwordx4 v232, s[12:15], s62 offen lds
    s_nop 1
    v_exp_f32 v216, v160
    v_exp_f32 v217, v161
    v_exp_f32 v218, v162
    v_exp_f32 v219, v163
    v_fma_f32 v220, v216, 0.5, 1.0
    v_fma_f32 v221, v217, 0.5, 1.0
    v_fma_f32 v222, v218, 0.5, 1.0
    v_fma_f32 v223, v219, 0.5, 1.0
    v_fma_f32 v220, v216, v220, 1.0
    v_fma_f32 v221, v217, v221, 1.0
    v_fma_f32 v222, v218, v222, 1.0
    v_fma_f32 v223, v219, v223, 1.0
    v_rcp_f32 v220, v220
    v_rcp_f32 v221, v221
    v_rcp_f32 v222, v222
    v_rcp_f32 v223, v223
    v_fma_f32 v216, -v160, v220, v160
    v_fma_f32 v217, -v161, v221, v161
    v_fma_f32 v218, -v162, v222, v162
    v_fma_f32 v219, -v163, v223, v163
    v_cvt_pk_bf16_f32 v244, v216, v217
    v_cvt_pk_bf16_f32 v245, v218, v219
    v_exp_f32 v216, v168
    v_exp_f32 v217, v169
    v_exp_f32 v218, v170
    v_exp_f32 v219, v171
    v_fma_f32 v220, v216, 0.5, 1.0
    v_fma_f32 v221, v217, 0.5, 1.0
    s_add_u32 m0, s64, 49152
    s_add_u32 s62, s33, 3539328
    buffer_load_dwordx4 v232, s[12:15], s62 offen lds
    s_setprio 0
    s_waitcnt lgkmcnt(4)
    v_mfma_f32_16x16x32_bf16 v[144:147], v[192:195], v[0:3], v[208:211]
    v_mfma_f32_16x16x32_bf16 v[148:151], v[192:195], v[72:75], v[208:211]
    s_waitcnt vmcnt(3) lgkmcnt(0)
    s_barrier
    ds_read_b64_tr_b16 v[176:177], v228 offset:8192
    ds_read_b64_tr_b16 v[178:179], v228 offset:8704
    v_mfma_f32_16x16x32_bf16 v[152:155], v[196:199], v[0:3], v[212:215]
    ds_read_b64_tr_b16 v[180:181], v229 offset:8192
    v_mfma_f32_16x16x32_bf16 v[156:159], v[196:199], v[72:75], v[212:215]
    ds_read_b64_tr_b16 v[182:183], v229 offset:8704
    v_mfma_f32_16x16x32_bf16 v[144:147], v[200:203], v[4:7], v[144:147]
    ds_read_b64_tr_b16 v[184:185], v228 offset:12288
    v_mfma_f32_16x16x32_bf16 v[148:151], v[200:203], v[76:79], v[148:151]
    ds_read_b64_tr_b16 v[186:187], v228 offset:12800
    v_mfma_f32_16x16x32_bf16 v[152:155], v[204:207], v[4:7], v[152:155]
    ds_read_b64_tr_b16 v[188:189], v229 offset:12288
    v_mfma_f32_16x16x32_bf16 v[156:159], v[204:207], v[76:79], v[156:159]
    ds_read_b64_tr_b16 v[190:191], v229 offset:12800
    s_waitcnt lgkmcnt(4)
    v_mfma_f32_16x16x32_bf16 v[144:147], v[176:179], v[8:11], v[144:147]
    ds_read_b64_tr_b16 v[192:193], v228 offset:16384
    v_mfma_f32_16x16x32_bf16 v[148:151], v[176:179], v[80:83], v[148:151]
    ds_read_b64_tr_b16 v[194:195], v228 offset:16896
    v_mfma_f32_16x16x32_bf16 v[152:155], v[180:183], v[8:11], v[152:155]
    ds_read_b64_tr_b16 v[196:197], v229 offset:16384
    v_mfma_f32_16x16x32_bf16 v[156:159], v[180:183], v[80:83], v[156:159]
    ds_read_b64_tr_b16 v[198:199], v229 offset:16896
    s_waitcnt lgkmcnt(4)
    v_mfma_f32_16x16x32_bf16 v[144:147], v[184:187], v[12:15], v[144:147]
    ds_read_b64_tr_b16 v[200:201], v228 offset:20480
    v_mfma_f32_16x16x32_bf16 v[148:151], v[184:187], v[84:87], v[148:151]
    ds_read_b64_tr_b16 v[202:203], v228 offset:20992
    v_mfma_f32_16x16x32_bf16 v[152:155], v[188:191], v[12:15], v[152:155]
    ds_read_b64_tr_b16 v[204:205], v229 offset:20480
    v_mfma_f32_16x16x32_bf16 v[156:159], v[188:191], v[84:87], v[156:159]
    ds_read_b64_tr_b16 v[206:207], v229 offset:20992
    s_waitcnt lgkmcnt(4)
    v_mfma_f32_16x16x32_bf16 v[144:147], v[192:195], v[16:19], v[144:147]
    ds_read_b64_tr_b16 v[176:177], v228 offset:24576
    v_mfma_f32_16x16x32_bf16 v[148:151], v[192:195], v[88:91], v[148:151]
    ds_read_b64_tr_b16 v[178:179], v228 offset:25088
    v_mfma_f32_16x16x32_bf16 v[152:155], v[196:199], v[16:19], v[152:155]
    ds_read_b64_tr_b16 v[180:181], v229 offset:24576
    v_mfma_f32_16x16x32_bf16 v[156:159], v[196:199], v[88:91], v[156:159]
    ds_read_b64_tr_b16 v[182:183], v229 offset:25088
    s_waitcnt lgkmcnt(4)
    v_mfma_f32_16x16x32_bf16 v[144:147], v[200:203], v[20:23], v[144:147]
    ds_read_b64_tr_b16 v[184:185], v228 offset:28672
    v_mfma_f32_16x16x32_bf16 v[148:151], v[200:203], v[92:95], v[148:151]
    ds_read_b64_tr_b16 v[186:187], v228 offset:29184
    v_mfma_f32_16x16x32_bf16 v[152:155], v[204:207], v[20:23], v[152:155]
    ds_read_b64_tr_b16 v[188:189], v229 offset:28672
    v_mfma_f32_16x16x32_bf16 v[156:159], v[204:207], v[92:95], v[156:159]
    ds_read_b64_tr_b16 v[190:191], v229 offset:29184
    s_setprio 2
    v_fma_f32 v222, v218, 0.5, 1.0
    v_fma_f32 v223, v219, 0.5, 1.0
    v_fma_f32 v220, v216, v220, 1.0
    v_fma_f32 v221, v217, v221, 1.0
    v_fma_f32 v222, v218, v222, 1.0
    v_fma_f32 v223, v219, v223, 1.0
    v_rcp_f32 v220, v220
    v_rcp_f32 v221, v221
    v_rcp_f32 v222, v222
    v_rcp_f32 v223, v223
    v_fma_f32 v216, -v168, v220, v168
    s_add_u32 m0, s64, 57344
    s_add_u32 s62, s33, 4129152
    buffer_load_dwordx4 v232, s[12:15], s62 offen lds
    v_fma_f32 v217, -v169, v221, v169
    v_fma_f32 v218, -v170, v222, v170
    v_fma_f32 v219, -v171, v223, v171
    v_cvt_pk_bf16_f32 v246, v216, v217
    v_cvt_pk_bf16_f32 v247, v218, v219
    ds_write_b128 v235, v[244:247] offset:16384
    v_exp_f32 v216, v164
    v_exp_f32 v217, v165
    v_exp_f32 v218, v166
    v_exp_f32 v219, v167
    s_add_u32 m0, s64, 65536
    s_add_u32 s62, s33, 4718976
    buffer_load_dwordx4 v232, s[12:15], s62 offen lds
    v_fma_f32 v220, v216, 0.5, 1.0
    v_fma_f32 v221, v217, 0.5, 1.0
    v_fma_f32 v222, v218, 0.5, 1.0
    v_fma_f32 v223, v219, 0.5, 1.0
    v_fma_f32 v220, v216, v220, 1.0
    v_fma_f32 v221, v217, v221, 1.0
    v_fma_f32 v222, v218, v222, 1.0
    v_fma_f32 v223, v219, v223, 1.0
    v_rcp_f32 v220, v220
    v_rcp_f32 v221, v221
    s_add_u32 m0, s64, 0
    s_add_u32 s62, s33, 512
    buffer_load_dwordx4 v232, s[12:15], s62 offen lds
    s_setprio 0
    s_waitcnt lgkmcnt(5)
    v_mfma_f32_16x16x32_bf16 v[144:147], v[176:179], v[24:27], v[144:147]
    v_mfma_f32_16x16x32_bf16 v[148:151], v[176:179], v[96:99], v[148:151]
    s_waitcnt vmcnt(3) lgkmcnt(1)
    s_barrier
    ds_read_b64_tr_b16 v[192:193], v230 offset:0
    ds_read_b64_tr_b16 v[194:195], v230 offset:512
    v_mfma_f32_16x16x32_bf16 v[152:155], v[180:183], v[24:27], v[152:155]
    ds_read_b64_tr_b16 v[196:197], v231 offset:0
    v_mfma_f32_16x16x32_bf16 v[156:159], v[180:183], v[96:99], v[156:159]
    ds_read_b64_tr_b16 v[198:199], v231 offset:512
    v_mfma_f32_16x16x32_bf16 v[144:147], v[184:187], v[28:31], v[144:147]
    ds_read_b64_tr_b16 v[200:201], v230 offset:4096
    v_mfma_f32_16x16x32_bf16 v[148:151], v[184:187], v[100:103], v[148:151]
    ds_read_b64_tr_b16 v[202:203], v230 offset:4608
    v_mfma_f32_16x16x32_bf16 v[152:155], v[188:191], v[28:31], v[152:155]
    ds_read_b64_tr_b16 v[204:205], v231 offset:4096
    v_mfma_f32_16x16x32_bf16 v[156:159], v[188:191], v[100:103], v[156:159]
    ds_read_b64_tr_b16 v[206:207], v231 offset:4608
    s_waitcnt lgkmcnt(4)
    v_mfma_f32_16x16x32_bf16 v[144:147], v[192:195], v[32:35], v[144:147]
    ds_read_b64_tr_b16 v[176:177], v230 offset:8192
    v_mfma_f32_16x16x32_bf16 v[148:151], v[192:195], v[104:107], v[148:151]
    ds_read_b64_tr_b16 v[178:179], v230 offset:8704
    v_mfma_f32_16x16x32_bf16 v[152:155], v[196:199], v[32:35], v[152:155]
    ds_read_b64_tr_b16 v[180:181], v231 offset:8192
    v_mfma_f32_16x16x32_bf16 v[156:159], v[196:199], v[104:107], v[156:159]
    ds_read_b64_tr_b16 v[182:183], v231 offset:8704
    s_waitcnt lgkmcnt(4)
    v_mfma_f32_16x16x32_bf16 v[144:147], v[200:203], v[36:39], v[144:147]
    ds_read_b64_tr_b16 v[184:185], v230 offset:12288
    v_mfma_f32_16x16x32_bf16 v[148:151], v[200:203], v[108:111], v[148:151]
    ds_read_b64_tr_b16 v[186:187], v230 offset:12800
    v_mfma_f32_16x16x32_bf16 v[152:155], v[204:207], v[36:39], v[152:155]
    ds_read_b64_tr_b16 v[188:189], v231 offset:12288
    v_mfma_f32_16x16x32_bf16 v[156:159], v[204:207], v[108:111], v[156:159]
    ds_read_b64_tr_b16 v[190:191], v231 offset:12800
    s_waitcnt lgkmcnt(4)
    v_mfma_f32_16x16x32_bf16 v[144:147], v[176:179], v[40:43], v[144:147]
    ds_read_b64_tr_b16 v[192:193], v230 offset:16384
    v_mfma_f32_16x16x32_bf16 v[148:151], v[176:179], v[112:115], v[148:151]
    ds_read_b64_tr_b16 v[194:195], v230 offset:16896
    v_mfma_f32_16x16x32_bf16 v[152:155], v[180:183], v[40:43], v[152:155]
    ds_read_b64_tr_b16 v[196:197], v231 offset:16384
    v_mfma_f32_16x16x32_bf16 v[156:159], v[180:183], v[112:115], v[156:159]
    ds_read_b64_tr_b16 v[198:199], v231 offset:16896
    s_waitcnt lgkmcnt(4)
    v_mfma_f32_16x16x32_bf16 v[144:147], v[184:187], v[44:47], v[144:147]
    ds_read_b64_tr_b16 v[200:201], v230 offset:20480
    v_mfma_f32_16x16x32_bf16 v[148:151], v[184:187], v[116:119], v[148:151]
    ds_read_b64_tr_b16 v[202:203], v230 offset:20992
    v_mfma_f32_16x16x32_bf16 v[152:155], v[188:191], v[44:47], v[152:155]
    ds_read_b64_tr_b16 v[204:205], v231 offset:20480
    v_mfma_f32_16x16x32_bf16 v[156:159], v[188:191], v[116:119], v[156:159]
    ds_read_b64_tr_b16 v[206:207], v231 offset:20992
    s_setprio 2
    v_rcp_f32 v222, v222
    v_rcp_f32 v223, v223
    v_fma_f32 v216, -v164, v220, v164
    v_fma_f32 v217, -v165, v221, v165
    v_fma_f32 v218, -v166, v222, v166
    v_fma_f32 v219, -v167, v223, v167
    v_cvt_pk_bf16_f32 v248, v216, v217
    s_add_u32 m0, s64, 8192
    s_add_u32 s62, s33, 590336
    buffer_load_dwordx4 v232, s[12:15], s62 offen lds
    v_cvt_pk_bf16_f32 v249, v218, v219
    v_exp_f32 v216, v172
    v_exp_f32 v217, v173
    v_exp_f32 v218, v174
    v_exp_f32 v219, v175
    v_fma_f32 v220, v216, 0.5, 1.0
    s_add_u32 m0, s64, 16384
    s_add_u32 s62, s33, 1180160
    buffer_load_dwordx4 v232, s[12:15], s62 offen lds
    v_fma_f32 v221, v217, 0.5, 1.0
    v_fma_f32 v222, v218, 0.5, 1.0
    v_fma_f32 v223, v219, 0.5, 1.0
    v_fma_f32 v220, v216, v220, 1.0
    v_fma_f32 v221, v217, v221, 1.0
    v_fma_f32 v222, v218, v222, 1.0
    s_add_u32 m0, s64, 24576
    s_add_u32 s62, s33, 1769984
    buffer_load_dwordx4 v232, s[12:15], s62 offen lds
    v_fma_f32 v223, v219, v223, 1.0
    v_rcp_f32 v220, v220
    v_rcp_f32 v221, v221
    v_rcp_f32 v222, v222
    v_rcp_f32 v223, v223
    v_fma_f32 v216, -v172, v220, v172
    ds_read_b128 v[208:211], v236 offset:1024
    v_fma_f32 v217, -v173, v221, v173
    v_fma_f32 v218, -v174, v222, v174
    v_fma_f32 v219, -v175, v223, v175
    v_cvt_pk_bf16_f32 v250, v216, v217
    v_cvt_pk_bf16_f32 v251, v218, v219
    ds_write_b128 v235, v[248:251] offset:17408
    ds_read_b128 v[212:215], v236 offset:1088
    s_setprio 0
    s_waitcnt lgkmcnt(7)
    v_mfma_f32_16x16x32_bf16 v[144:147], v[192:195], v[48:51], v[144:147]
    v_mfma_f32_16x16x32_bf16 v[148:151], v[192:195], v[120:123], v[148:151]
    s_waitcnt vmcnt(3) lgkmcnt(3)
    s_barrier
    ds_read_b64_tr_b16 v[176:177], v230 offset:24576
    ds_read_b64_tr_b16 v[178:179], v230 offset:25088
    v_mfma_f32_16x16x32_bf16 v[152:155], v[196:199], v[48:51], v[152:155]
    ds_read_b64_tr_b16 v[180:181], v231 offset:24576
    v_mfma_f32_16x16x32_bf16 v[156:159], v[196:199], v[120:123], v[156:159]
    ds_read_b64_tr_b16 v[182:183], v231 offset:25088
    v_mfma_f32_16x16x32_bf16 v[144:147], v[200:203], v[52:55], v[144:147]
    ds_read_b64_tr_b16 v[184:185], v230 offset:28672
    v_mfma_f32_16x16x32_bf16 v[148:151], v[200:203], v[124:127], v[148:151]
    ds_read_b64_tr_b16 v[186:187], v230 offset:29184
    v_mfma_f32_16x16x32_bf16 v[152:155], v[204:207], v[52:55], v[152:155]
    ds_read_b64_tr_b16 v[188:189], v231 offset:28672
    v_mfma_f32_16x16x32_bf16 v[156:159], v[204:207], v[124:127], v[156:159]
    ds_read_b64_tr_b16 v[190:191], v231 offset:29184
    s_waitcnt lgkmcnt(4)
    v_mfma_f32_16x16x32_bf16 v[144:147], v[176:179], v[56:59], v[144:147]
    ds_read_b64_tr_b16 v[192:193], v230 offset:32768
    v_mfma_f32_16x16x32_bf16 v[148:151], v[176:179], v[128:131], v[148:151]
    ds_read_b64_tr_b16 v[194:195], v230 offset:33280
    v_mfma_f32_16x16x32_bf16 v[152:155], v[180:183], v[56:59], v[152:155]
    ds_read_b64_tr_b16 v[196:197], v231 offset:32768
    v_mfma_f32_16x16x32_bf16 v[156:159], v[180:183], v[128:131], v[156:159]
    ds_read_b64_tr_b16 v[198:199], v231 offset:33280
    s_waitcnt lgkmcnt(4)
    v_mfma_f32_16x16x32_bf16 v[144:147], v[184:187], v[60:63], v[144:147]
    ds_read_b64_tr_b16 v[200:201], v230 offset:36864
    v_mfma_f32_16x16x32_bf16 v[148:151], v[184:187], v[132:135], v[148:151]
    ds_read_b64_tr_b16 v[202:203], v230 offset:37376
    v_mfma_f32_16x16x32_bf16 v[152:155], v[188:191], v[60:63], v[152:155]
    ds_read_b64_tr_b16 v[204:205], v231 offset:36864
    v_mfma_f32_16x16x32_bf16 v[156:159], v[188:191], v[132:135], v[156:159]
    ds_read_b64_tr_b16 v[206:207], v231 offset:37376
    s_waitcnt lgkmcnt(4)
    v_mfma_f32_16x16x32_bf16 v[144:147], v[192:195], v[64:67], v[144:147]
    ds_read_b64_tr_b16 v[176:177], v228 offset:0
    v_mfma_f32_16x16x32_bf16 v[148:151], v[192:195], v[136:139], v[148:151]
    ds_read_b64_tr_b16 v[178:179], v228 offset:512
    v_mfma_f32_16x16x32_bf16 v[152:155], v[196:199], v[64:67], v[152:155]
    ds_read_b64_tr_b16 v[180:181], v229 offset:0
    v_mfma_f32_16x16x32_bf16 v[156:159], v[196:199], v[136:139], v[156:159]
    ds_read_b64_tr_b16 v[182:183], v229 offset:512
    s_waitcnt lgkmcnt(4)
    v_mfma_f32_16x16x32_bf16 v[160:163], v[200:203], v[68:71], v[144:147]
    ds_read_b64_tr_b16 v[184:185], v228 offset:4096
    v_mfma_f32_16x16x32_bf16 v[164:167], v[200:203], v[140:143], v[148:151]
    ds_read_b64_tr_b16 v[186:187], v228 offset:4608
    v_mfma_f32_16x16x32_bf16 v[168:171], v[204:207], v[68:71], v[152:155]
    ds_read_b64_tr_b16 v[188:189], v229 offset:4096
    v_mfma_f32_16x16x32_bf16 v[172:175], v[204:207], v[140:143], v[156:159]
    ds_read_b64_tr_b16 v[190:191], v229 offset:4608
    s_setprio 2
    s_add_u32 m0, s64, 32768
    s_add_u32 s62, s33, 2359808
    buffer_load_dwordx4 v232, s[12:15], s62 offen lds
    s_add_u32 m0, s64, 40960
    s_add_u32 s62, s33, 2949632
    buffer_load_dwordx4 v232, s[12:15], s62 offen lds
    s_nop 1
    v_exp_f32 v216, v160
    v_exp_f32 v217, v161
    v_exp_f32 v218, v162
    v_exp_f32 v219, v163
    v_fma_f32 v220, v216, 0.5, 1.0
    v_fma_f32 v221, v217, 0.5, 1.0
    v_fma_f32 v222, v218, 0.5, 1.0
    v_fma_f32 v223, v219, 0.5, 1.0
    v_fma_f32 v220, v216, v220, 1.0
    v_fma_f32 v221, v217, v221, 1.0
    v_fma_f32 v222, v218, v222, 1.0
    v_fma_f32 v223, v219, v223, 1.0
    v_rcp_f32 v220, v220
    v_rcp_f32 v221, v221
    v_rcp_f32 v222, v222
    v_rcp_f32 v223, v223
    v_fma_f32 v216, -v160, v220, v160
    v_fma_f32 v217, -v161, v221, v161
    v_fma_f32 v218, -v162, v222, v162
    v_fma_f32 v219, -v163, v223, v163
    v_cvt_pk_bf16_f32 v244, v216, v217
    v_cvt_pk_bf16_f32 v245, v218, v219
    v_exp_f32 v216, v168
    v_exp_f32 v217, v169
    v_exp_f32 v218, v170
    v_exp_f32 v219, v171
    v_fma_f32 v220, v216, 0.5, 1.0
    v_fma_f32 v221, v217, 0.5, 1.0
    s_add_u32 m0, s64, 49152
    s_add_u32 s62, s33, 3539456
    buffer_load_dwordx4 v232, s[12:15], s62 offen lds
    s_setprio 0
    s_waitcnt lgkmcnt(4)
    v_mfma_f32_16x16x32_bf16 v[144:147], v[176:179], v[0:3], v[208:211]
    v_mfma_f32_16x16x32_bf16 v[148:151], v[176:179], v[72:75], v[208:211]
    s_waitcnt vmcnt(3) lgkmcnt(0)
    s_barrier
    ds_read_b64_tr_b16 v[192:193], v228 offset:8192
    ds_read_b64_tr_b16 v[194:195], v228 offset:8704
    v_mfma_f32_16x16x32_bf16 v[152:155], v[180:183], v[0:3], v[212:215]
    ds_read_b64_tr_b16 v[196:197], v229 offset:8192
    v_mfma_f32_16x16x32_bf16 v[156:159], v[180:183], v[72:75], v[212:215]
    ds_read_b64_tr_b16 v[198:199], v229 offset:8704
    v_mfma_f32_16x16x32_bf16 v[144:147], v[184:187], v[4:7], v[144:147]
    ds_read_b64_tr_b16 v[200:201], v228 offset:12288
    v_mfma_f32_16x16x32_bf16 v[148:151], v[184:187], v[76:79], v[148:151]
    ds_read_b64_tr_b16 v[202:203], v228 offset:12800
    v_mfma_f32_16x16x32_bf16 v[152:155], v[188:191], v[4:7], v[152:155]
    ds_read_b64_tr_b16 v[204:205], v229 offset:12288
    v_mfma_f32_16x16x32_bf16 v[156:159], v[188:191], v[76:79], v[156:159]
    ds_read_b64_tr_b16 v[206:207], v229 offset:12800
    s_waitcnt lgkmcnt(4)
    v_mfma_f32_16x16x32_bf16 v[144:147], v[192:195], v[8:11], v[144:147]
    ds_read_b64_tr_b16 v[176:177], v228 offset:16384
    v_mfma_f32_16x16x32_bf16 v[148:151], v[192:195], v[80:83], v[148:151]
    ds_read_b64_tr_b16 v[178:179], v228 offset:16896
    v_mfma_f32_16x16x32_bf16 v[152:155], v[196:199], v[8:11], v[152:155]
    ds_read_b64_tr_b16 v[180:181], v229 offset:16384
    v_mfma_f32_16x16x32_bf16 v[156:159], v[196:199], v[80:83], v[156:159]
    ds_read_b64_tr_b16 v[182:183], v229 offset:16896
    s_waitcnt lgkmcnt(4)
    v_mfma_f32_16x16x32_bf16 v[144:147], v[200:203], v[12:15], v[144:147]
    ds_read_b64_tr_b16 v[184:185], v228 offset:20480
    v_mfma_f32_16x16x32_bf16 v[148:151], v[200:203], v[84:87], v[148:151]
    ds_read_b64_tr_b16 v[186:187], v228 offset:20992
    v_mfma_f32_16x16x32_bf16 v[152:155], v[204:207], v[12:15], v[152:155]
    ds_read_b64_tr_b16 v[188:189], v229 offset:20480
    v_mfma_f32_16x16x32_bf16 v[156:159], v[204:207], v[84:87], v[156:159]
    ds_read_b64_tr_b16 v[190:191], v229 offset:20992
    s_waitcnt lgkmcnt(4)
    v_mfma_f32_16x16x32_bf16 v[144:147], v[176:179], v[16:19], v[144:147]
    ds_read_b64_tr_b16 v[192:193], v228 offset:24576
    v_mfma_f32_16x16x32_bf16 v[148:151], v[176:179], v[88:91], v[148:151]
    ds_read_b64_tr_b16 v[194:195], v228 offset:25088
    v_mfma_f32_16x16x32_bf16 v[152:155], v[180:183], v[16:19], v[152:155]
    ds_read_b64_tr_b16 v[196:197], v229 offset:24576
    v_mfma_f32_16x16x32_bf16 v[156:159], v[180:183], v[88:91], v[156:159]
    ds_read_b64_tr_b16 v[198:199], v229 offset:25088
    s_waitcnt lgkmcnt(4)
    v_mfma_f32_16x16x32_bf16 v[144:147], v[184:187], v[20:23], v[144:147]
    ds_read_b64_tr_b16 v[200:201], v228 offset:28672
    v_mfma_f32_16x16x32_bf16 v[148:151], v[184:187], v[92:95], v[148:151]
    ds_read_b64_tr_b16 v[202:203], v228 offset:29184
    v_mfma_f32_16x16x32_bf16 v[152:155], v[188:191], v[20:23], v[152:155]
    ds_read_b64_tr_b16 v[204:205], v229 offset:28672
    v_mfma_f32_16x16x32_bf16 v[156:159], v[188:191], v[92:95], v[156:159]
    ds_read_b64_tr_b16 v[206:207], v229 offset:29184
    s_setprio 2
    v_fma_f32 v222, v218, 0.5, 1.0
    v_fma_f32 v223, v219, 0.5, 1.0
    v_fma_f32 v220, v216, v220, 1.0
    v_fma_f32 v221, v217, v221, 1.0
    v_fma_f32 v222, v218, v222, 1.0
    v_fma_f32 v223, v219, v223, 1.0
    v_rcp_f32 v220, v220
    v_rcp_f32 v221, v221
    v_rcp_f32 v222, v222
    v_rcp_f32 v223, v223
    v_fma_f32 v216, -v168, v220, v168
    s_add_u32 m0, s64, 57344
    s_add_u32 s62, s33, 4129280
    buffer_load_dwordx4 v232, s[12:15], s62 offen lds
    v_fma_f32 v217, -v169, v221, v169
    v_fma_f32 v218, -v170, v222, v170
    v_fma_f32 v219, -v171, v223, v171
    v_cvt_pk_bf16_f32 v246, v216, v217
    v_cvt_pk_bf16_f32 v247, v218, v219
    ds_write_b128 v243, v[244:247] offset:0
    v_exp_f32 v216, v164
    v_exp_f32 v217, v165
    v_exp_f32 v218, v166
    v_exp_f32 v219, v167
    s_add_u32 m0, s64, 65536
    s_add_u32 s62, s33, 4719104
    buffer_load_dwordx4 v232, s[12:15], s62 offen lds
    v_fma_f32 v220, v216, 0.5, 1.0
    v_fma_f32 v221, v217, 0.5, 1.0
    v_fma_f32 v222, v218, 0.5, 1.0
    v_fma_f32 v223, v219, 0.5, 1.0
    v_fma_f32 v220, v216, v220, 1.0
    v_fma_f32 v221, v217, v221, 1.0
    v_fma_f32 v222, v218, v222, 1.0
    v_fma_f32 v223, v219, v223, 1.0
    v_rcp_f32 v220, v220
    v_rcp_f32 v221, v221
    s_add_u32 m0, s64, 0
    s_add_u32 s62, s33, 640
    buffer_load_dwordx4 v232, s[12:15], s62 offen lds
    s_setprio 0
    s_waitcnt lgkmcnt(5)
    v_mfma_f32_16x16x32_bf16 v[144:147], v[192:195], v[24:27], v[144:147]
    v_mfma_f32_16x16x32_bf16 v[148:151], v[192:195], v[96:99], v[148:151]
    s_waitcnt vmcnt(3) lgkmcnt(1)
    s_barrier
    ds_read_b64_tr_b16 v[176:177], v230 offset:0
    ds_read_b64_tr_b16 v[178:179], v230 offset:512
    v_mfma_f32_16x16x32_bf16 v[152:155], v[196:199], v[24:27], v[152:155]
    ds_read_b64_tr_b16 v[180:181], v231 offset:0
    v_mfma_f32_16x16x32_bf16 v[156:159], v[196:199], v[96:99], v[156:159]
    ds_read_b64_tr_b16 v[182:183], v231 offset:512
    v_mfma_f32_16x16x32_bf16 v[144:147], v[200:203], v[28:31], v[144:147]
    ds_read_b64_tr_b16 v[184:185], v230 offset:4096
    v_mfma_f32_16x16x32_bf16 v[148:151], v[200:203], v[100:103], v[148:151]
    ds_read_b64_tr_b16 v[186:187], v230 offset:4608
    v_mfma_f32_16x16x32_bf16 v[152:155], v[204:207], v[28:31], v[152:155]
    ds_read_b64_tr_b16 v[188:189], v231 offset:4096
    v_mfma_f32_16x16x32_bf16 v[156:159], v[204:207], v[100:103], v[156:159]
    ds_read_b64_tr_b16 v[190:191], v231 offset:4608
    s_waitcnt lgkmcnt(4)
    v_mfma_f32_16x16x32_bf16 v[144:147], v[176:179], v[32:35], v[144:147]
    ds_read_b64_tr_b16 v[192:193], v230 offset:8192
    v_mfma_f32_16x16x32_bf16 v[148:151], v[176:179], v[104:107], v[148:151]
    ds_read_b64_tr_b16 v[194:195], v230 offset:8704
    v_mfma_f32_16x16x32_bf16 v[152:155], v[180:183], v[32:35], v[152:155]
    ds_read_b64_tr_b16 v[196:197], v231 offset:8192
    v_mfma_f32_16x16x32_bf16 v[156:159], v[180:183], v[104:107], v[156:159]
    ds_read_b64_tr_b16 v[198:199], v231 offset:8704
    s_waitcnt lgkmcnt(4)
    v_mfma_f32_16x16x32_bf16 v[144:147], v[184:187], v[36:39], v[144:147]
    ds_read_b64_tr_b16 v[200:201], v230 offset:12288
    v_mfma_f32_16x16x32_bf16 v[148:151], v[184:187], v[108:111], v[148:151]
    ds_read_b64_tr_b16 v[202:203], v230 offset:12800
    v_mfma_f32_16x16x32_bf16 v[152:155], v[188:191], v[36:39], v[152:155]
    ds_read_b64_tr_b16 v[204:205], v231 offset:12288
    v_mfma_f32_16x16x32_bf16 v[156:159], v[188:191], v[108:111], v[156:159]
    ds_read_b64_tr_b16 v[206:207], v231 offset:12800
    s_waitcnt lgkmcnt(4)
    v_mfma_f32_16x16x32_bf16 v[144:147], v[192:195], v[40:43], v[144:147]
    ds_read_b64_tr_b16 v[176:177], v230 offset:16384
    v_mfma_f32_16x16x32_bf16 v[148:151], v[192:195], v[112:115], v[148:151]
    ds_read_b64_tr_b16 v[178:179], v230 offset:16896
    v_mfma_f32_16x16x32_bf16 v[152:155], v[196:199], v[40:43], v[152:155]
    ds_read_b64_tr_b16 v[180:181], v231 offset:16384
    v_mfma_f32_16x16x32_bf16 v[156:159], v[196:199], v[112:115], v[156:159]
    ds_read_b64_tr_b16 v[182:183], v231 offset:16896
    s_waitcnt lgkmcnt(4)
    v_mfma_f32_16x16x32_bf16 v[144:147], v[200:203], v[44:47], v[144:147]
    ds_read_b64_tr_b16 v[184:185], v230 offset:20480
    v_mfma_f32_16x16x32_bf16 v[148:151], v[200:203], v[116:119], v[148:151]
    ds_read_b64_tr_b16 v[186:187], v230 offset:20992
    v_mfma_f32_16x16x32_bf16 v[152:155], v[204:207], v[44:47], v[152:155]
    ds_read_b64_tr_b16 v[188:189], v231 offset:20480
    v_mfma_f32_16x16x32_bf16 v[156:159], v[204:207], v[116:119], v[156:159]
    ds_read_b64_tr_b16 v[190:191], v231 offset:20992
    s_setprio 2
    v_rcp_f32 v222, v222
    v_rcp_f32 v223, v223
    v_fma_f32 v216, -v164, v220, v164
    v_fma_f32 v217, -v165, v221, v165
    v_fma_f32 v218, -v166, v222, v166
    v_fma_f32 v219, -v167, v223, v167
    v_cvt_pk_bf16_f32 v248, v216, v217
    s_add_u32 m0, s64, 8192
    s_add_u32 s62, s33, 590464
    buffer_load_dwordx4 v232, s[12:15], s62 offen lds
    v_cvt_pk_bf16_f32 v249, v218, v219
    v_exp_f32 v216, v172
    v_exp_f32 v217, v173
    v_exp_f32 v218, v174
    v_exp_f32 v219, v175
    v_fma_f32 v220, v216, 0.5, 1.0
    s_add_u32 m0, s64, 16384
    s_add_u32 s62, s33, 1180288
    buffer_load_dwordx4 v232, s[12:15], s62 offen lds
    v_fma_f32 v221, v217, 0.5, 1.0
    v_fma_f32 v222, v218, 0.5, 1.0
    v_fma_f32 v223, v219, 0.5, 1.0
    v_fma_f32 v220, v216, v220, 1.0
    v_fma_f32 v221, v217, v221, 1.0
    v_fma_f32 v222, v218, v222, 1.0
    s_add_u32 m0, s64, 24576
    s_add_u32 s62, s33, 1770112
    buffer_load_dwordx4 v232, s[12:15], s62 offen lds
    v_fma_f32 v223, v219, v223, 1.0
    v_rcp_f32 v220, v220
    v_rcp_f32 v221, v221
    v_rcp_f32 v222, v222
    v_rcp_f32 v223, v223
    v_fma_f32 v216, -v172, v220, v172
    ds_read_b128 v[208:211], v236 offset:1280
    v_fma_f32 v217, -v173, v221, v173
    v_fma_f32 v218, -v174, v222, v174
    v_fma_f32 v219, -v175, v223, v175
    v_cvt_pk_bf16_f32 v250, v216, v217
    v_cvt_pk_bf16_f32 v251, v218, v219
    ds_write_b128 v243, v[248:251] offset:1024
    ds_read_b128 v[212:215], v236 offset:1344
    s_setprio 0
    s_waitcnt lgkmcnt(7)
    v_mfma_f32_16x16x32_bf16 v[144:147], v[176:179], v[48:51], v[144:147]
    v_mfma_f32_16x16x32_bf16 v[148:151], v[176:179], v[120:123], v[148:151]
    s_waitcnt vmcnt(3) lgkmcnt(3)
    s_barrier
    ds_read_b64_tr_b16 v[192:193], v230 offset:24576
    ds_read_b64_tr_b16 v[194:195], v230 offset:25088
    v_mfma_f32_16x16x32_bf16 v[152:155], v[180:183], v[48:51], v[152:155]
    ds_read_b64_tr_b16 v[196:197], v231 offset:24576
    v_mfma_f32_16x16x32_bf16 v[156:159], v[180:183], v[120:123], v[156:159]
    ds_read_b64_tr_b16 v[198:199], v231 offset:25088
    v_mfma_f32_16x16x32_bf16 v[144:147], v[184:187], v[52:55], v[144:147]
    ds_read_b64_tr_b16 v[200:201], v230 offset:28672
    v_mfma_f32_16x16x32_bf16 v[148:151], v[184:187], v[124:127], v[148:151]
    ds_read_b64_tr_b16 v[202:203], v230 offset:29184
    v_mfma_f32_16x16x32_bf16 v[152:155], v[188:191], v[52:55], v[152:155]
    ds_read_b64_tr_b16 v[204:205], v231 offset:28672
    v_mfma_f32_16x16x32_bf16 v[156:159], v[188:191], v[124:127], v[156:159]
    ds_read_b64_tr_b16 v[206:207], v231 offset:29184
    s_waitcnt lgkmcnt(4)
    v_mfma_f32_16x16x32_bf16 v[144:147], v[192:195], v[56:59], v[144:147]
    ds_read_b64_tr_b16 v[176:177], v230 offset:32768
    v_mfma_f32_16x16x32_bf16 v[148:151], v[192:195], v[128:131], v[148:151]
    ds_read_b64_tr_b16 v[178:179], v230 offset:33280
    v_mfma_f32_16x16x32_bf16 v[152:155], v[196:199], v[56:59], v[152:155]
    ds_read_b64_tr_b16 v[180:181], v231 offset:32768
    v_mfma_f32_16x16x32_bf16 v[156:159], v[196:199], v[128:131], v[156:159]
    ds_read_b64_tr_b16 v[182:183], v231 offset:33280
    s_waitcnt lgkmcnt(4)
    v_mfma_f32_16x16x32_bf16 v[144:147], v[200:203], v[60:63], v[144:147]
    ds_read_b64_tr_b16 v[184:185], v230 offset:36864
    v_mfma_f32_16x16x32_bf16 v[148:151], v[200:203], v[132:135], v[148:151]
    ds_read_b64_tr_b16 v[186:187], v230 offset:37376
    v_mfma_f32_16x16x32_bf16 v[152:155], v[204:207], v[60:63], v[152:155]
    ds_read_b64_tr_b16 v[188:189], v231 offset:36864
    v_mfma_f32_16x16x32_bf16 v[156:159], v[204:207], v[132:135], v[156:159]
    ds_read_b64_tr_b16 v[190:191], v231 offset:37376
    s_waitcnt lgkmcnt(4)
    v_mfma_f32_16x16x32_bf16 v[144:147], v[176:179], v[64:67], v[144:147]
    ds_read_b64_tr_b16 v[192:193], v228 offset:0
    v_mfma_f32_16x16x32_bf16 v[148:151], v[176:179], v[136:139], v[148:151]
    ds_read_b64_tr_b16 v[194:195], v228 offset:512
    v_mfma_f32_16x16x32_bf16 v[152:155], v[180:183], v[64:67], v[152:155]
    ds_read_b64_tr_b16 v[196:197], v229 offset:0
    v_mfma_f32_16x16x32_bf16 v[156:159], v[180:183], v[136:139], v[156:159]
    ds_read_b64_tr_b16 v[198:199], v229 offset:512
    s_waitcnt lgkmcnt(4)
    v_mfma_f32_16x16x32_bf16 v[160:163], v[184:187], v[68:71], v[144:147]
    ds_read_b64_tr_b16 v[200:201], v228 offset:4096
    v_mfma_f32_16x16x32_bf16 v[164:167], v[184:187], v[140:143], v[148:151]
    ds_read_b64_tr_b16 v[202:203], v228 offset:4608
    v_mfma_f32_16x16x32_bf16 v[168:171], v[188:191], v[68:71], v[152:155]
    ds_read_b64_tr_b16 v[204:205], v229 offset:4096
    v_mfma_f32_16x16x32_bf16 v[172:175], v[188:191], v[140:143], v[156:159]
    ds_read_b64_tr_b16 v[206:207], v229 offset:4608
    s_setprio 2
    s_add_u32 m0, s64, 32768
    s_add_u32 s62, s33, 2359936
    buffer_load_dwordx4 v232, s[12:15], s62 offen lds
    s_add_u32 m0, s64, 40960
    s_add_u32 s62, s33, 2949760
    buffer_load_dwordx4 v232, s[12:15], s62 offen lds
    s_nop 1
    v_exp_f32 v216, v160
    v_exp_f32 v217, v161
    v_exp_f32 v218, v162
    v_exp_f32 v219, v163
    v_fma_f32 v220, v216, 0.5, 1.0
    v_fma_f32 v221, v217, 0.5, 1.0
    v_fma_f32 v222, v218, 0.5, 1.0
    v_fma_f32 v223, v219, 0.5, 1.0
    v_fma_f32 v220, v216, v220, 1.0
    v_fma_f32 v221, v217, v221, 1.0
    v_fma_f32 v222, v218, v222, 1.0
    v_fma_f32 v223, v219, v223, 1.0
    v_rcp_f32 v220, v220
    v_rcp_f32 v221, v221
    v_rcp_f32 v222, v222
    v_rcp_f32 v223, v223
    v_fma_f32 v216, -v160, v220, v160
    v_fma_f32 v217, -v161, v221, v161
    v_fma_f32 v218, -v162, v222, v162
    v_fma_f32 v219, -v163, v223, v163
    v_cvt_pk_bf16_f32 v244, v216, v217
    v_cvt_pk_bf16_f32 v245, v218, v219
    v_exp_f32 v216, v168
    v_exp_f32 v217, v169
    v_exp_f32 v218, v170
    v_exp_f32 v219, v171
    v_fma_f32 v220, v216, 0.5, 1.0
    v_fma_f32 v221, v217, 0.5, 1.0
    s_add_u32 m0, s64, 49152
    s_add_u32 s62, s33, 3539584
    buffer_load_dwordx4 v232, s[12:15], s62 offen lds
    s_setprio 0
    s_waitcnt lgkmcnt(4)
    v_mfma_f32_16x16x32_bf16 v[144:147], v[192:195], v[0:3], v[208:211]
    v_mfma_f32_16x16x32_bf16 v[148:151], v[192:195], v[72:75], v[208:211]
    s_waitcnt vmcnt(3) lgkmcnt(0)
    s_barrier
    ds_read_b64_tr_b16 v[176:177], v228 offset:8192
    ds_read_b64_tr_b16 v[178:179], v228 offset:8704
    v_mfma_f32_16x16x32_bf16 v[152:155], v[196:199], v[0:3], v[212:215]
    ds_read_b64_tr_b16 v[180:181], v229 offset:8192
    v_mfma_f32_16x16x32_bf16 v[156:159], v[196:199], v[72:75], v[212:215]
    ds_read_b64_tr_b16 v[182:183], v229 offset:8704
    v_mfma_f32_16x16x32_bf16 v[144:147], v[200:203], v[4:7], v[144:147]
    ds_read_b64_tr_b16 v[184:185], v228 offset:12288
    v_mfma_f32_16x16x32_bf16 v[148:151], v[200:203], v[76:79], v[148:151]
    ds_read_b64_tr_b16 v[186:187], v228 offset:12800
    v_mfma_f32_16x16x32_bf16 v[152:155], v[204:207], v[4:7], v[152:155]
    ds_read_b64_tr_b16 v[188:189], v229 offset:12288
    v_mfma_f32_16x16x32_bf16 v[156:159], v[204:207], v[76:79], v[156:159]
    ds_read_b64_tr_b16 v[190:191], v229 offset:12800
    s_waitcnt lgkmcnt(4)
    v_mfma_f32_16x16x32_bf16 v[144:147], v[176:179], v[8:11], v[144:147]
    ds_read_b64_tr_b16 v[192:193], v228 offset:16384
    v_mfma_f32_16x16x32_bf16 v[148:151], v[176:179], v[80:83], v[148:151]
    ds_read_b64_tr_b16 v[194:195], v228 offset:16896
    v_mfma_f32_16x16x32_bf16 v[152:155], v[180:183], v[8:11], v[152:155]
    ds_read_b64_tr_b16 v[196:197], v229 offset:16384
    v_mfma_f32_16x16x32_bf16 v[156:159], v[180:183], v[80:83], v[156:159]
    ds_read_b64_tr_b16 v[198:199], v229 offset:16896
    s_waitcnt lgkmcnt(4)
    v_mfma_f32_16x16x32_bf16 v[144:147], v[184:187], v[12:15], v[144:147]
    ds_read_b64_tr_b16 v[200:201], v228 offset:20480
    v_mfma_f32_16x16x32_bf16 v[148:151], v[184:187], v[84:87], v[148:151]
    ds_read_b64_tr_b16 v[202:203], v228 offset:20992
    v_mfma_f32_16x16x32_bf16 v[152:155], v[188:191], v[12:15], v[152:155]
    ds_read_b64_tr_b16 v[204:205], v229 offset:20480
    v_mfma_f32_16x16x32_bf16 v[156:159], v[188:191], v[84:87], v[156:159]
    ds_read_b64_tr_b16 v[206:207], v229 offset:20992
    s_waitcnt lgkmcnt(4)
    v_mfma_f32_16x16x32_bf16 v[144:147], v[192:195], v[16:19], v[144:147]
    ds_read_b64_tr_b16 v[176:177], v228 offset:24576
    v_mfma_f32_16x16x32_bf16 v[148:151], v[192:195], v[88:91], v[148:151]
    ds_read_b64_tr_b16 v[178:179], v228 offset:25088
    v_mfma_f32_16x16x32_bf16 v[152:155], v[196:199], v[16:19], v[152:155]
    ds_read_b64_tr_b16 v[180:181], v229 offset:24576
    v_mfma_f32_16x16x32_bf16 v[156:159], v[196:199], v[88:91], v[156:159]
    ds_read_b64_tr_b16 v[182:183], v229 offset:25088
    s_waitcnt lgkmcnt(4)
    v_mfma_f32_16x16x32_bf16 v[144:147], v[200:203], v[20:23], v[144:147]
    ds_read_b64_tr_b16 v[184:185], v228 offset:28672
    v_mfma_f32_16x16x32_bf16 v[148:151], v[200:203], v[92:95], v[148:151]
    ds_read_b64_tr_b16 v[186:187], v228 offset:29184
    v_mfma_f32_16x16x32_bf16 v[152:155], v[204:207], v[20:23], v[152:155]
    ds_read_b64_tr_b16 v[188:189], v229 offset:28672
    v_mfma_f32_16x16x32_bf16 v[156:159], v[204:207], v[92:95], v[156:159]
    ds_read_b64_tr_b16 v[190:191], v229 offset:29184
    s_setprio 2
    v_fma_f32 v222, v218, 0.5, 1.0
    v_fma_f32 v223, v219, 0.5, 1.0
    v_fma_f32 v220, v216, v220, 1.0
    s_add_u32 m0, s64, 57344
    s_add_u32 s62, s33, 4129408
    buffer_load_dwordx4 v232, s[12:15], s62 offen lds
    v_fma_f32 v221, v217, v221, 1.0
    v_fma_f32 v222, v218, v222, 1.0
    s_add_u32 m0, s64, 65536
    s_add_u32 s62, s33, 4719232
    buffer_load_dwordx4 v232, s[12:15], s62 offen lds
    v_fma_f32 v223, v219, v223, 1.0
    v_rcp_f32 v220, v220
    ds_read_b128 v[0:3], v241 offset:24576
    v_rcp_f32 v221, v221
    v_rcp_f32 v222, v222
    ds_read_b128 v[12:15], v241 offset:25600
    v_rcp_f32 v223, v223
    v_fma_f32 v216, -v168, v220, v168
    v_fma_f32 v217, -v169, v221, v169
    ds_read_b128 v[72:75], v241 offset:26624
    v_fma_f32 v218, -v170, v222, v170
    v_fma_f32 v219, -v171, v223, v171
    ds_read_b128 v[84:87], v241 offset:27648
    v_cvt_pk_bf16_f32 v246, v216, v217
    v_cvt_pk_bf16_f32 v247, v218, v219
    ds_read_b128 v[4:7], v241 offset:32768
    ds_write_b128 v243, v[244:247] offset:16384
    v_exp_f32 v216, v164
    ds_read_b128 v[16:19], v241 offset:33792
    v_exp_f32 v217, v165
    v_exp_f32 v218, v166
    s_waitcnt lgkmcnt(14)
    ds_read_b128 v[76:79], v241 offset:34816
    v_exp_f32 v219, v167
    v_fma_f32 v220, v216, 0.5, 1.0
    v_fma_f32 v221, v217, 0.5, 1.0
    s_waitcnt lgkmcnt(14)
    ds_read_b128 v[88:91], v241 offset:35840
    v_fma_f32 v222, v218, 0.5, 1.0
    v_fma_f32 v223, v219, 0.5, 1.0
    s_waitcnt lgkmcnt(14)
    ds_read_b128 v[8:11], v240 offset:0
    v_fma_f32 v220, v216, v220, 1.0
    v_fma_f32 v221, v217, v221, 1.0
    s_waitcnt lgkmcnt(14)
    ds_read_b128 v[20:23], v240 offset:1024
    v_fma_f32 v222, v218, v222, 1.0
    v_fma_f32 v223, v219, v223, 1.0
    s_waitcnt lgkmcnt(14)
    ds_read_b128 v[80:83], v240 offset:2048
    v_rcp_f32 v220, v220
    v_rcp_f32 v221, v221
    s_waitcnt lgkmcnt(14)
    ds_read_b128 v[92:95], v240 offset:3072
    s_setprio 0
    v_mfma_f32_16x16x32_bf16 v[144:147], v[176:179], v[24:27], v[144:147]
    v_mfma_f32_16x16x32_bf16 v[148:151], v[176:179], v[96:99], v[148:151]
    s_waitcnt vmcnt(2) lgkmcnt(13)
    s_barrier
    ds_read_b64_tr_b16 v[192:193], v230 offset:0
    ds_read_b64_tr_b16 v[194:195], v230 offset:512
    v_mfma_f32_16x16x32_bf16 v[152:155], v[180:183], v[24:27], v[152:155]
    s_waitcnt lgkmcnt(14)
    ds_read_b64_tr_b16 v[196:197], v231 offset:0
    v_mfma_f32_16x16x32_bf16 v[156:159], v[180:183], v[96:99], v[156:159]
    s_waitcnt lgkmcnt(14)
    ds_read_b64_tr_b16 v[198:199], v231 offset:512
    v_mfma_f32_16x16x32_bf16 v[144:147], v[184:187], v[28:31], v[144:147]
    s_waitcnt lgkmcnt(14)
    ds_read_b64_tr_b16 v[200:201], v230 offset:4096
    v_mfma_f32_16x16x32_bf16 v[148:151], v[184:187], v[100:103], v[148:151]
    s_waitcnt lgkmcnt(14)
    ds_read_b64_tr_b16 v[202:203], v230 offset:4608
    v_mfma_f32_16x16x32_bf16 v[152:155], v[188:191], v[28:31], v[152:155]
    s_waitcnt lgkmcnt(14)
    ds_read_b64_tr_b16 v[204:205], v231 offset:4096
    v_mfma_f32_16x16x32_bf16 v[156:159], v[188:191], v[100:103], v[156:159]
    s_waitcnt lgkmcnt(14)
    ds_read_b64_tr_b16 v[206:207], v231 offset:4608
    s_waitcnt lgkmcnt(4)
    v_mfma_f32_16x16x32_bf16 v[144:147], v[192:195], v[32:35], v[144:147]
    ds_read_b64_tr_b16 v[176:177], v230 offset:8192
    v_mfma_f32_16x16x32_bf16 v[148:151], v[192:195], v[104:107], v[148:151]
    ds_read_b64_tr_b16 v[178:179], v230 offset:8704
    v_mfma_f32_16x16x32_bf16 v[152:155], v[196:199], v[32:35], v[152:155]
    ds_read_b64_tr_b16 v[180:181], v231 offset:8192
    v_mfma_f32_16x16x32_bf16 v[156:159], v[196:199], v[104:107], v[156:159]
    ds_read_b64_tr_b16 v[182:183], v231 offset:8704
    s_waitcnt lgkmcnt(4)
    v_mfma_f32_16x16x32_bf16 v[144:147], v[200:203], v[36:39], v[144:147]
    ds_read_b64_tr_b16 v[184:185], v230 offset:12288
    v_mfma_f32_16x16x32_bf16 v[148:151], v[200:203], v[108:111], v[148:151]
    ds_read_b64_tr_b16 v[186:187], v230 offset:12800
    v_mfma_f32_16x16x32_bf16 v[152:155], v[204:207], v[36:39], v[152:155]
    ds_read_b64_tr_b16 v[188:189], v231 offset:12288
    v_mfma_f32_16x16x32_bf16 v[156:159], v[204:207], v[108:111], v[156:159]
    ds_read_b64_tr_b16 v[190:191], v231 offset:12800
    s_waitcnt lgkmcnt(4)
    v_mfma_f32_16x16x32_bf16 v[144:147], v[176:179], v[40:43], v[144:147]
    ds_read_b64_tr_b16 v[192:193], v230 offset:16384
    v_mfma_f32_16x16x32_bf16 v[148:151], v[176:179], v[112:115], v[148:151]
    ds_read_b64_tr_b16 v[194:195], v230 offset:16896
    v_mfma_f32_16x16x32_bf16 v[152:155], v[180:183], v[40:43], v[152:155]
    ds_read_b64_tr_b16 v[196:197], v231 offset:16384
    v_mfma_f32_16x16x32_bf16 v[156:159], v[180:183], v[112:115], v[156:159]
    ds_read_b64_tr_b16 v[198:199], v231 offset:16896
    s_waitcnt lgkmcnt(4)
    v_mfma_f32_16x16x32_bf16 v[144:147], v[184:187], v[44:47], v[144:147]
    ds_read_b64_tr_b16 v[200:201], v230 offset:20480
    v_mfma_f32_16x16x32_bf16 v[148:151], v[184:187], v[116:119], v[148:151]
    ds_read_b64_tr_b16 v[202:203], v230 offset:20992
    v_mfma_f32_16x16x32_bf16 v[152:155], v[188:191], v[44:47], v[152:155]
    ds_read_b64_tr_b16 v[204:205], v231 offset:20480
    v_mfma_f32_16x16x32_bf16 v[156:159], v[188:191], v[116:119], v[156:159]
    ds_read_b64_tr_b16 v[206:207], v231 offset:20992
    s_setprio 2
    v_rcp_f32 v222, v222
    v_rcp_f32 v223, v223
    v_fma_f32 v216, -v164, v220, v164
    ds_read_b128 v[24:27], v240 offset:8192
    v_fma_f32 v217, -v165, v221, v165
    v_fma_f32 v218, -v166, v222, v166
    v_fma_f32 v219, -v167, v223, v167
    ds_read_b128 v[36:39], v240 offset:9216
    v_cvt_pk_bf16_f32 v248, v216, v217
    v_cvt_pk_bf16_f32 v249, v218, v219
    ds_read_b128 v[96:99], v240 offset:10240
    v_exp_f32 v216, v172
    v_exp_f32 v217, v173
    v_exp_f32 v218, v174
    ds_read_b128 v[108:111], v240 offset:11264
    v_exp_f32 v219, v175
    v_fma_f32 v220, v216, 0.5, 1.0
    ds_read_b128 v[28:31], v240 offset:16384
    v_fma_f32 v221, v217, 0.5, 1.0
    v_fma_f32 v222, v218, 0.5, 1.0
    v_fma_f32 v223, v219, 0.5, 1.0
    ds_read_b128 v[40:43], v240 offset:17408
    v_fma_f32 v220, v216, v220, 1.0
    v_fma_f32 v221, v217, v221, 1.0
    v_fma_f32 v222, v218, v222, 1.0
    ds_read_b128 v[100:103], v240 offset:18432
    v_fma_f32 v223, v219, v223, 1.0
    v_rcp_f32 v220, v220
    s_waitcnt lgkmcnt(14)
    ds_read_b128 v[112:115], v240 offset:19456
    v_rcp_f32 v221, v221
    v_rcp_f32 v222, v222
    v_rcp_f32 v223, v223
    s_waitcnt lgkmcnt(14)
    ds_read_b128 v[32:35], v240 offset:24576
    v_fma_f32 v216, -v172, v220, v172
    v_fma_f32 v217, -v173, v221, v173
    s_waitcnt lgkmcnt(14)
    ds_read_b128 v[44:47], v240 offset:25600
    v_fma_f32 v218, -v174, v222, v174
    v_fma_f32 v219, -v175, v223, v175
    v_cvt_pk_bf16_f32 v250, v216, v217
    s_waitcnt lgkmcnt(14)
    ds_read_b128 v[104:107], v240 offset:26624
    v_cvt_pk_bf16_f32 v251, v218, v219
    s_waitcnt lgkmcnt(14)
    ds_write_b128 v243, v[248:251] offset:17408
    s_waitcnt lgkmcnt(14)
    ds_read_b128 v[116:119], v240 offset:27648
    s_setprio 0
    v_mfma_f32_16x16x32_bf16 v[144:147], v[192:195], v[48:51], v[144:147]
    v_mfma_f32_16x16x32_bf16 v[148:151], v[192:195], v[120:123], v[148:151]
    s_waitcnt vmcnt(0) lgkmcnt(1)
    s_barrier
    ds_read_b64_tr_b16 v[176:177], v230 offset:24576
    v_mfma_f32_16x16x32_bf16 v[152:155], v[196:199], v[48:51], v[152:155]
    ds_read_b64_tr_b16 v[178:179], v230 offset:25088
    v_mfma_f32_16x16x32_bf16 v[156:159], v[196:199], v[120:123], v[156:159]
    ds_read_b64_tr_b16 v[180:181], v231 offset:24576
    v_mfma_f32_16x16x32_bf16 v[144:147], v[200:203], v[52:55], v[144:147]
    ds_read_b64_tr_b16 v[182:183], v231 offset:25088
    v_mfma_f32_16x16x32_bf16 v[148:151], v[200:203], v[124:127], v[148:151]
    ds_read_b64_tr_b16 v[184:185], v230 offset:28672
    v_mfma_f32_16x16x32_bf16 v[152:155], v[204:207], v[52:55], v[152:155]
    ds_read_b64_tr_b16 v[186:187], v230 offset:29184
    v_mfma_f32_16x16x32_bf16 v[156:159], v[204:207], v[124:127], v[156:159]
    ds_read_b64_tr_b16 v[188:189], v231 offset:28672
    s_waitcnt lgkmcnt(3)
    v_mfma_f32_16x16x32_bf16 v[144:147], v[176:179], v[56:59], v[144:147]
    ds_read_b64_tr_b16 v[190:191], v231 offset:29184
    v_mfma_f32_16x16x32_bf16 v[148:151], v[176:179], v[128:131], v[148:151]
    ds_read_b64_tr_b16 v[192:193], v230 offset:32768
    v_mfma_f32_16x16x32_bf16 v[152:155], v[180:183], v[56:59], v[152:155]
    ds_read_b64_tr_b16 v[194:195], v230 offset:33280
    v_mfma_f32_16x16x32_bf16 v[156:159], v[180:183], v[128:131], v[156:159]
    ds_read_b64_tr_b16 v[196:197], v231 offset:32768
    s_waitcnt lgkmcnt(3)
    v_mfma_f32_16x16x32_bf16 v[144:147], v[184:187], v[60:63], v[144:147]
    ds_read_b64_tr_b16 v[198:199], v231 offset:33280
    v_mfma_f32_16x16x32_bf16 v[148:151], v[184:187], v[132:135], v[148:151]
    ds_read_b64_tr_b16 v[200:201], v230 offset:36864
    v_mfma_f32_16x16x32_bf16 v[152:155], v[188:191], v[60:63], v[152:155]
    ds_read_b64_tr_b16 v[202:203], v230 offset:37376
    v_mfma_f32_16x16x32_bf16 v[156:159], v[188:191], v[132:135], v[156:159]
    ds_read_b64_tr_b16 v[204:205], v231 offset:36864
    s_waitcnt lgkmcnt(3)
    v_mfma_f32_16x16x32_bf16 v[144:147], v[192:195], v[64:67], v[144:147]
    ds_read_b64_tr_b16 v[206:207], v231 offset:37376
    v_mfma_f32_16x16x32_bf16 v[148:151], v[192:195], v[136:139], v[148:151]
    v_mfma_f32_16x16x32_bf16 v[152:155], v[196:199], v[64:67], v[152:155]
    v_mfma_f32_16x16x32_bf16 v[156:159], v[196:199], v[136:139], v[156:159]
    s_waitcnt lgkmcnt(0)
    v_mfma_f32_16x16x32_bf16 v[160:163], v[200:203], v[68:71], v[144:147]
    v_mfma_f32_16x16x32_bf16 v[164:167], v[200:203], v[140:143], v[148:151]
    v_mfma_f32_16x16x32_bf16 v[168:171], v[204:207], v[68:71], v[152:155]
    v_mfma_f32_16x16x32_bf16 v[172:175], v[204:207], v[140:143], v[156:159]
    s_setprio 2
    v_add_u32 v228, 49152, v238
    v_add_u32 v229, 98304, v238
    v_mov_b32 v231, 0x7ffffff0
    v_lshl_add_u32 v230, v239, 3, s35
    v_cmp_gt_u32 vcc, 64, v239
    s_nop 1
    v_cndmask_b32 v230, v231, v230, vcc
    s_nop 3
    v_exp_f32 v216, v160
    v_exp_f32 v217, v161
    v_exp_f32 v218, v162
    v_exp_f32 v219, v163
    s_add_u32 m0, s64, 0
    s_add_u32 s62, s34, 0
    buffer_load_dwordx4 v233, s[16:19], s62 offen lds
    v_fma_f32 v220, v216, 0.5, 1.0
    v_fma_f32 v221, v217, 0.5, 1.0
    v_fma_f32 v222, v218, 0.5, 1.0
    v_fma_f32 v223, v219, 0.5, 1.0
    s_add_u32 m0, s64, 4096
    s_add_u32 s62, s34, 36864
    buffer_load_dwordx4 v233, s[16:19], s62 offen lds
    v_fma_f32 v220, v216, v220, 1.0
    v_fma_f32 v221, v217, v221, 1.0
    v_fma_f32 v222, v218, v222, 1.0
    v_fma_f32 v223, v219, v223, 1.0
    s_add_u32 m0, s64, 8192
    s_add_u32 s62, s34, 73728
    buffer_load_dwordx4 v233, s[16:19], s62 offen lds
    v_rcp_f32 v220, v220
    v_rcp_f32 v221, v221
    v_rcp_f32 v222, v222
    v_rcp_f32 v223, v223
    s_add_u32 m0, s64, 12288
    s_add_u32 s62, s34, 110592
    buffer_load_dwordx4 v233, s[16:19], s62 offen lds
    v_fma_f32 v216, -v160, v220, v160
    v_fma_f32 v217, -v161, v221, v161
    v_fma_f32 v218, -v162, v222, v162
    v_fma_f32 v219, -v163, v223, v163
    s_add_u32 m0, s64, 16384
    s_add_u32 s62, s34, 147456
    buffer_load_dwordx4 v233, s[16:19], s62 offen lds
    v_cvt_pk_bf16_f32 v244, v216, v217
    v_cvt_pk_bf16_f32 v245, v218, v219
    v_exp_f32 v216, v168
    v_exp_f32 v217, v169
    s_add_u32 m0, s64, 20480
    s_add_u32 s62, s34, 184320
    buffer_load_dwordx4 v233, s[16:19], s62 offen lds
    v_exp_f32 v218, v170
    v_exp_f32 v219, v171
    v_fma_f32 v220, v216, 0.5, 1.0
    v_fma_f32 v221, v217, 0.5, 1.0
    ds_read_b128 v[48:51], v241 offset:0
    v_fma_f32 v222, v218, 0.5, 1.0
    v_fma_f32 v223, v219, 0.5, 1.0
    v_fma_f32 v220, v216, v220, 1.0
    v_fma_f32 v221, v217, v221, 1.0
    ds_read_b128 v[60:63], v241 offset:1024
    v_fma_f32 v222, v218, v222, 1.0
    v_fma_f32 v223, v219, v223, 1.0
    v_rcp_f32 v220, v220
    ds_read_b128 v[120:123], v241 offset:2048
    v_rcp_f32 v221, v221
    v_rcp_f32 v222, v222
    v_rcp_f32 v223, v223
    v_fma_f32 v216, -v168, v220, v168
    ds_read_b128 v[132:135], v241 offset:3072
    v_fma_f32 v217, -v169, v221, v169
    v_fma_f32 v218, -v170, v222, v170
    v_fma_f32 v219, -v171, v223, v171
    v_cvt_pk_bf16_f32 v246, v216, v217
    ds_read_b128 v[52:55], v241 offset:8192
    v_cvt_pk_bf16_f32 v247, v218, v219
    ds_write_b128 v243, v[244:247] offset:24576
    v_exp_f32 v216, v164
    v_exp_f32 v217, v165
    ds_read_b128 v[64:67], v241 offset:9216
    v_exp_f32 v218, v166
    v_exp_f32 v219, v167
    v_fma_f32 v220, v216, 0.5, 1.0
    v_fma_f32 v221, v217, 0.5, 1.0
    ds_read_b128 v[124:127], v241 offset:10240
    v_fma_f32 v222, v218, 0.5, 1.0
    v_fma_f32 v223, v219, 0.5, 1.0
    v_fma_f32 v220, v216, v220, 1.0
    v_fma_f32 v221, v217, v221, 1.0
    ds_read_b128 v[136:139], v241 offset:11264
    v_fma_f32 v222, v218, v222, 1.0
    v_fma_f32 v223, v219, v223, 1.0
    v_rcp_f32 v220, v220
    v_rcp_f32 v221, v221
    ds_read_b128 v[56:59], v241 offset:16384
    v_rcp_f32 v222, v222
    v_rcp_f32 v223, v223
    v_fma_f32 v216, -v164, v220, v164
    v_fma_f32 v217, -v165, v221, v165
    ds_read_b128 v[68:71], v241 offset:17408
    v_fma_f32 v218, -v166, v222, v166
    v_fma_f32 v219, -v167, v223, v167
    v_cvt_pk_bf16_f32 v248, v216, v217
    v_cvt_pk_bf16_f32 v249, v218, v219
    ds_read_b128 v[128:131], v241 offset:18432
    v_exp_f32 v216, v172
    v_exp_f32 v217, v173
    v_exp_f32 v218, v174
    ds_read_b128 v[140:143], v241 offset:19456
    v_exp_f32 v219, v175
    v_fma_f32 v220, v216, 0.5, 1.0
    v_fma_f32 v221, v217, 0.5, 1.0
    v_fma_f32 v222, v218, 0.5, 1.0
    v_fma_f32 v223, v219, 0.5, 1.0
    v_fma_f32 v220, v216, v220, 1.0
    v_fma_f32 v221, v217, v221, 1.0
    v_fma_f32 v222, v218, v222, 1.0
    v_fma_f32 v223, v219, v223, 1.0
    v_rcp_f32 v220, v220
    v_rcp_f32 v221, v221
    v_rcp_f32 v222, v222
    v_rcp_f32 v223, v223
    v_fma_f32 v216, -v172, v220, v172
    v_fma_f32 v217, -v173, v221, v173
    v_fma_f32 v218, -v174, v222, v174
    v_fma_f32 v219, -v175, v223, v175
    v_cvt_pk_bf16_f32 v250, v216, v217
    v_cvt_pk_bf16_f32 v251, v218, v219
    ds_write_b128 v243, v[248:251] offset:25600
    s_waitcnt lgkmcnt(0)
    s_waitcnt vmcnt(0)
    s_barrier
    ds_read_b64_tr_b16 v[208:209], v238 offset:0
    ds_read_b64_tr_b16 v[210:211], v238 offset:2048
    ds_read_b64_tr_b16 v[212:213], v238 offset:4096
    ds_read_b64_tr_b16 v[214:215], v238 offset:6144
    ds_read_b64_tr_b16 v[216:217], v238 offset:8192
    ds_read_b64_tr_b16 v[218:219], v238 offset:10240
    s_add_u32 m0, s64, 49152
    s_add_u32 s62, s34, 128
    buffer_load_dwordx4 v233, s[16:19], s62 offen lds
    s_add_u32 m0, s64, 53248
    s_add_u32 s62, s34, 36992
    buffer_load_dwordx4 v233, s[16:19], s62 offen lds
    s_add_u32 m0, s64, 57344
    s_add_u32 s62, s34, 73856
    buffer_load_dwordx4 v233, s[16:19], s62 offen lds
    s_add_u32 m0, s64, 61440
    s_add_u32 s62, s34, 110720
    buffer_load_dwordx4 v233, s[16:19], s62 offen lds
    s_add_u32 m0, s64, 65536
    s_add_u32 s62, s34, 147584
    buffer_load_dwordx4 v233, s[16:19], s62 offen lds
    s_add_u32 m0, s64, 69632
    s_add_u32 s62, s34, 184448
    buffer_load_dwordx4 v233, s[16:19], s62 offen lds
    s_setprio 0
    s_waitcnt lgkmcnt(4)
    v_mfma_f32_16x16x32_bf16 v[192:195], v[208:211], v[0:3], 0
    ds_read_b64_tr_b16 v[220:221], v238 offset:12288
    s_waitcnt lgkmcnt(3)
    v_mfma_f32_16x16x32_bf16 v[192:195], v[212:215], v[4:7], v[192:195]
    ds_read_b64_tr_b16 v[222:223], v238 offset:14336
    v_mfma_f32_16x16x32_bf16 v[196:199], v[208:211], v[12:15], 0
    ds_read_b64_tr_b16 v[224:225], v238 offset:16384
    v_mfma_f32_16x16x32_bf16 v[196:199], v[212:215], v[16:19], v[196:199]
    ds_read_b64_tr_b16 v[226:227], v238 offset:18432
    v_mfma_f32_16x16x32_bf16 v[200:203], v[208:211], v[72:75], 0
    ds_read_b128 v[144:147], v241 offset:40960
    v_mfma_f32_16x16x32_bf16 v[200:203], v[212:215], v[76:79], v[200:203]
    ds_read_b128 v[156:159], v241 offset:41984
    v_mfma_f32_16x16x32_bf16 v[204:207], v[208:211], v[84:87], 0
    ds_read_b128 v[168:171], v241 offset:43008
    v_mfma_f32_16x16x32_bf16 v[204:207], v[212:215], v[88:91], v[204:207]
    ds_read_b64_tr_b16 v[208:209], v238 offset:20480
    s_waitcnt lgkmcnt(8)
    v_mfma_f32_16x16x32_bf16 v[192:195], v[216:219], v[8:11], v[192:195]
    ds_read_b64_tr_b16 v[210:211], v238 offset:22528
    s_waitcnt lgkmcnt(7)
    v_mfma_f32_16x16x32_bf16 v[192:195], v[220:223], v[24:27], v[192:195]
    ds_read_b64_tr_b16 v[212:213], v238 offset:24576
    v_mfma_f32_16x16x32_bf16 v[196:199], v[216:219], v[20:23], v[196:199]
    ds_read_b64_tr_b16 v[214:215], v238 offset:26624
    v_mfma_f32_16x16x32_bf16 v[196:199], v[220:223], v[36:39], v[196:199]
    ds_read_b128 v[180:183], v241 offset:44032
    v_mfma_f32_16x16x32_bf16 v[200:203], v[216:219], v[80:83], v[200:203]
    ds_read_b128 v[148:151], v241 offset:24576
    v_mfma_f32_16x16x32_bf16 v[200:203], v[220:223], v[96:99], v[200:203]
    ds_read_b128 v[160:163], v241 offset:25600
    v_mfma_f32_16x16x32_bf16 v[204:207], v[216:219], v[92:95], v[204:207]
    ds_read_b128 v[172:175], v241 offset:26624
    v_mfma_f32_16x16x32_bf16 v[204:207], v[220:223], v[108:111], v[204:207]
    ds_read_b64_tr_b16 v[216:217], v238 offset:28672
    s_waitcnt lgkmcnt(12)
    v_mfma_f32_16x16x32_bf16 v[192:195], v[224:227], v[28:31], v[192:195]
    ds_read_b64_tr_b16 v[218:219], v238 offset:30720
    s_waitcnt lgkmcnt(8)
    v_mfma_f32_16x16x32_bf16 v[192:195], v[208:211], v[32:35], v[192:195]
    ds_read_b64_tr_b16 v[220:221], v238 offset:32768
    v_mfma_f32_16x16x32_bf16 v[196:199], v[224:227], v[40:43], v[196:199]
    ds_read_b64_tr_b16 v[222:223], v238 offset:34816
    v_mfma_f32_16x16x32_bf16 v[196:199], v[208:211], v[44:47], v[196:199]
    ds_read_b128 v[184:187], v241 offset:27648
    v_mfma_f32_16x16x32_bf16 v[200:203], v[224:227], v[100:103], v[200:203]
    ds_read_b128 v[152:155], v241 offset:32768
    v_mfma_f32_16x16x32_bf16 v[200:203], v[208:211], v[104:107], v[200:203]
    ds_read_b128 v[164:167], v241 offset:33792
    v_mfma_f32_16x16x32_bf16 v[204:207], v[224:227], v[112:115], v[204:207]
    ds_read_b128 v[176:179], v241 offset:34816
    v_mfma_f32_16x16x32_bf16 v[204:207], v[208:211], v[116:119], v[204:207]
    ds_read_b64_tr_b16 v[224:225], v238 offset:36864
    s_waitcnt lgkmcnt(13)
    v_mfma_f32_16x16x32_bf16 v[192:195], v[212:215], v[48:51], v[192:195]
    ds_read_b64_tr_b16 v[226:227], v238 offset:38912
    s_waitcnt lgkmcnt(8)
    v_mfma_f32_16x16x32_bf16 v[192:195], v[216:219], v[52:55], v[192:195]
    ds_read_b64_tr_b16 v[208:209], v238 offset:40960
    v_mfma_f32_16x16x32_bf16 v[196:199], v[212:215], v[60:63], v[196:199]
    ds_read_b64_tr_b16 v[210:211], v238 offset:43008
    v_mfma_f32_16x16x32_bf16 v[196:199], v[216:219], v[64:67], v[196:199]
    ds_read_b128 v[188:191], v241 offset:35840
    v_mfma_f32_16x16x32_bf16 v[200:203], v[212:215], v[120:123], v[200:203]
    v_mfma_f32_16x16x32_bf16 v[200:203], v[216:219], v[124:127], v[200:203]
    v_mfma_f32_16x16x32_bf16 v[204:207], v[212:215], v[132:135], v[204:207]
    v_mfma_f32_16x16x32_bf16 v[204:207], v[216:219], v[136:139], v[204:207]
    ds_read_b64_tr_b16 v[212:213], v238 offset:45056
    s_waitcnt lgkmcnt(1)
    s_barrier
    v_mfma_f32_16x16x32_bf16 v[192:195], v[220:223], v[56:59], v[192:195]
    ds_read_b64_tr_b16 v[214:215], v238 offset:47104
    v_mfma_f32_16x16x32_bf16 v[192:195], v[224:227], v[144:147], v[192:195]
    v_mfma_f32_16x16x32_bf16 v[196:199], v[220:223], v[68:71], v[196:199]
    v_mfma_f32_16x16x32_bf16 v[196:199], v[224:227], v[156:159], v[196:199]
    v_mfma_f32_16x16x32_bf16 v[200:203], v[220:223], v[128:131], v[200:203]
    v_mfma_f32_16x16x32_bf16 v[200:203], v[224:227], v[168:171], v[200:203]
    v_mfma_f32_16x16x32_bf16 v[204:207], v[220:223], v[140:143], v[204:207]
    v_mfma_f32_16x16x32_bf16 v[204:207], v[224:227], v[180:183], v[204:207]
    v_mfma_f32_16x16x32_bf16 v[192:195], v[208:211], v[148:151], v[192:195]
    s_waitcnt lgkmcnt(0)
    v_mfma_f32_16x16x32_bf16 v[192:195], v[212:215], v[152:155], v[192:195]
    v_mfma_f32_16x16x32_bf16 v[196:199], v[208:211], v[160:163], v[196:199]
    v_mfma_f32_16x16x32_bf16 v[196:199], v[212:215], v[164:167], v[196:199]
    v_mfma_f32_16x16x32_bf16 v[200:203], v[208:211], v[172:175], v[200:203]
    v_mfma_f32_16x16x32_bf16 v[200:203], v[212:215], v[176:179], v[200:203]
    v_mfma_f32_16x16x32_bf16 v[204:207], v[208:211], v[184:187], v[204:207]
    v_mfma_f32_16x16x32_bf16 v[204:207], v[212:215], v[188:191], v[204:207]
    s_setprio 2
    s_add_u32 m0, s64, 98304
    s_add_u32 s62, s34, 256
    buffer_load_dwordx4 v233, s[16:19], s62 offen lds
    s_add_u32 m0, s64, 102400
    s_add_u32 s62, s34, 37120
    buffer_load_dwordx4 v233, s[16:19], s62 offen lds
    v_cvt_pk_bf16_f32 v244, v192, v193
    v_cvt_pk_bf16_f32 v245, v194, v195
    v_cvt_pk_bf16_f32 v246, v196, v197
    v_cvt_pk_bf16_f32 v247, v198, v199
    s_add_u32 m0, s64, 106496
    s_add_u32 s62, s34, 73984
    buffer_load_dwordx4 v233, s[16:19], s62 offen lds
    v_cvt_pk_bf16_f32 v248, v200, v201
    v_cvt_pk_bf16_f32 v249, v202, v203
    v_cvt_pk_bf16_f32 v250, v204, v205
    s_add_u32 m0, s64, 110592
    s_add_u32 s62, s34, 110848
    buffer_load_dwordx4 v233, s[16:19], s62 offen lds
    v_cvt_pk_bf16_f32 v251, v206, v207
    s_nop 0
    v_permlane16_swap_b32 v244, v246
    s_add_u32 m0, s64, 114688
    s_add_u32 s62, s34, 147712
    buffer_load_dwordx4 v233, s[16:19], s62 offen lds
    v_permlane16_swap_b32 v245, v247
    v_permlane16_swap_b32 v248, v250
    v_permlane16_swap_b32 v249, v251
    s_add_u32 m0, s64, 118784
    s_add_u32 s62, s34, 184576
    buffer_load_dwordx4 v233, s[16:19], s62 offen lds
    s_mov_b32 s65, 0
    buffer_store_dwordx4 v[244:247], v237, s[20:23], s65 offen sc1
    s_mov_b32 s65, 479232
    buffer_store_dwordx4 v[248:251], v237, s[20:23], s65 offen sc1
    s_waitcnt vmcnt(8)
    s_barrier
    ds_read_b64_tr_b16 v[216:217], v228 offset:0
    ds_read_b64_tr_b16 v[218:219], v228 offset:2048
    ds_read_b64_tr_b16 v[220:221], v228 offset:4096
    ds_read_b64_tr_b16 v[222:223], v228 offset:6144
    ds_read_b64_tr_b16 v[224:225], v228 offset:8192
    ds_read_b64_tr_b16 v[226:227], v228 offset:10240
    s_setprio 0
    s_waitcnt lgkmcnt(4)
    v_mfma_f32_16x16x32_bf16 v[192:195], v[216:219], v[0:3], 0
    ds_read_b64_tr_b16 v[208:209], v228 offset:12288
    s_waitcnt lgkmcnt(3)
    v_mfma_f32_16x16x32_bf16 v[192:195], v[220:223], v[4:7], v[192:195]
    ds_read_b64_tr_b16 v[210:211], v228 offset:14336
    v_mfma_f32_16x16x32_bf16 v[196:199], v[216:219], v[12:15], 0
    ds_read_b64_tr_b16 v[212:213], v228 offset:16384
    v_mfma_f32_16x16x32_bf16 v[196:199], v[220:223], v[16:19], v[196:199]
    ds_read_b64_tr_b16 v[214:215], v228 offset:18432
    v_mfma_f32_16x16x32_bf16 v[200:203], v[216:219], v[72:75], 0
    v_mfma_f32_16x16x32_bf16 v[200:203], v[220:223], v[76:79], v[200:203]
    v_mfma_f32_16x16x32_bf16 v[204:207], v[216:219], v[84:87], 0
    v_mfma_f32_16x16x32_bf16 v[204:207], v[220:223], v[88:91], v[204:207]
    ds_read_b64_tr_b16 v[216:217], v228 offset:20480
    s_waitcnt lgkmcnt(5)
    v_mfma_f32_16x16x32_bf16 v[192:195], v[224:227], v[8:11], v[192:195]
    ds_read_b64_tr_b16 v[218:219], v228 offset:22528
    s_waitcnt lgkmcnt(4)
    v_mfma_f32_16x16x32_bf16 v[192:195], v[208:211], v[24:27], v[192:195]
    ds_read_b64_tr_b16 v[220:221], v228 offset:24576
    v_mfma_f32_16x16x32_bf16 v[196:199], v[224:227], v[20:23], v[196:199]
    ds_read_b64_tr_b16 v[222:223], v228 offset:26624
    v_mfma_f32_16x16x32_bf16 v[196:199], v[208:211], v[36:39], v[196:199]
    v_mfma_f32_16x16x32_bf16 v[200:203], v[224:227], v[80:83], v[200:203]
    v_mfma_f32_16x16x32_bf16 v[200:203], v[208:211], v[96:99], v[200:203]
    v_mfma_f32_16x16x32_bf16 v[204:207], v[224:227], v[92:95], v[204:207]
    v_mfma_f32_16x16x32_bf16 v[204:207], v[208:211], v[108:111], v[204:207]
    ds_read_b64_tr_b16 v[224:225], v228 offset:28672
    s_waitcnt lgkmcnt(5)
    v_mfma_f32_16x16x32_bf16 v[192:195], v[212:215], v[28:31], v[192:195]
    ds_read_b64_tr_b16 v[226:227], v228 offset:30720
    s_waitcnt lgkmcnt(4)
    v_mfma_f32_16x16x32_bf16 v[192:195], v[216:219], v[32:35], v[192:195]
    ds_read_b64_tr_b16 v[208:209], v228 offset:32768
    v_mfma_f32_16x16x32_bf16 v[196:199], v[212:215], v[40:43], v[196:199]
    ds_read_b64_tr_b16 v[210:211], v228 offset:34816
    v_mfma_f32_16x16x32_bf16 v[196:199], v[216:219], v[44:47], v[196:199]
    v_mfma_f32_16x16x32_bf16 v[200:203], v[212:215], v[100:103], v[200:203]
    v_mfma_f32_16x16x32_bf16 v[200:203], v[216:219], v[104:107], v[200:203]
    v_mfma_f32_16x16x32_bf16 v[204:207], v[212:215], v[112:115], v[204:207]
    v_mfma_f32_16x16x32_bf16 v[204:207], v[216:219], v[116:119], v[204:207]
    ds_read_b64_tr_b16 v[212:213], v228 offset:36864
    s_waitcnt lgkmcnt(5)
    v_mfma_f32_16x16x32_bf16 v[192:195], v[220:223], v[48:51], v[192:195]
    ds_read_b64_tr_b16 v[214:215], v228 offset:38912
    s_waitcnt lgkmcnt(4)
    v_mfma_f32_16x16x32_bf16 v[192:195], v[224:227], v[52:55], v[192:195]
    ds_read_b64_tr_b16 v[216:217], v228 offset:40960
    v_mfma_f32_16x16x32_bf16 v[196:199], v[220:223], v[60:63], v[196:199]
    ds_read_b64_tr_b16 v[218:219], v228 offset:43008
    v_mfma_f32_16x16x32_bf16 v[196:199], v[224:227], v[64:67], v[196:199]
    v_mfma_f32_16x16x32_bf16 v[200:203], v[220:223], v[120:123], v[200:203]
    v_mfma_f32_16x16x32_bf16 v[200:203], v[224:227], v[124:127], v[200:203]
    v_mfma_f32_16x16x32_bf16 v[204:207], v[220:223], v[132:135], v[204:207]
    v_mfma_f32_16x16x32_bf16 v[204:207], v[224:227], v[136:139], v[204:207]
    ds_read_b64_tr_b16 v[220:221], v228 offset:45056
    s_waitcnt lgkmcnt(5)
    v_mfma_f32_16x16x32_bf16 v[192:195], v[208:211], v[56:59], v[192:195]
    ds_read_b64_tr_b16 v[222:223], v228 offset:47104
    s_waitcnt lgkmcnt(4)
    v_mfma_f32_16x16x32_bf16 v[192:195], v[212:215], v[144:147], v[192:195]
    v_mfma_f32_16x16x32_bf16 v[196:199], v[208:211], v[68:71], v[196:199]
    v_mfma_f32_16x16x32_bf16 v[196:199], v[212:215], v[156:159], v[196:199]
    v_mfma_f32_16x16x32_bf16 v[200:203], v[208:211], v[128:131], v[200:203]
    v_mfma_f32_16x16x32_bf16 v[200:203], v[212:215], v[168:171], v[200:203]
    v_mfma_f32_16x16x32_bf16 v[204:207], v[208:211], v[140:143], v[204:207]
    v_mfma_f32_16x16x32_bf16 v[204:207], v[212:215], v[180:183], v[204:207]
    s_waitcnt lgkmcnt(2)
    v_mfma_f32_16x16x32_bf16 v[192:195], v[216:219], v[148:151], v[192:195]
    s_waitcnt lgkmcnt(0)
    v_mfma_f32_16x16x32_bf16 v[192:195], v[220:223], v[152:155], v[192:195]
    v_mfma_f32_16x16x32_bf16 v[196:199], v[216:219], v[160:163], v[196:199]
    v_mfma_f32_16x16x32_bf16 v[196:199], v[220:223], v[164:167], v[196:199]
    v_mfma_f32_16x16x32_bf16 v[200:203], v[216:219], v[172:175], v[200:203]
    v_mfma_f32_16x16x32_bf16 v[200:203], v[220:223], v[176:179], v[200:203]
    v_mfma_f32_16x16x32_bf16 v[204:207], v[216:219], v[184:187], v[204:207]
    v_mfma_f32_16x16x32_bf16 v[204:207], v[220:223], v[188:191], v[204:207]
    s_setprio 2
    s_add_u32 m0, s64, 0
    s_add_u32 s62, s34, 384
    buffer_load_dwordx4 v233, s[16:19], s62 offen lds
    s_add_u32 m0, s64, 4096
    s_add_u32 s62, s34, 37248
    buffer_load_dwordx4 v233, s[16:19], s62 offen lds
    v_cvt_pk_bf16_f32 v244, v192, v193
    v_cvt_pk_bf16_f32 v245, v194, v195
    v_cvt_pk_bf16_f32 v246, v196, v197
    v_cvt_pk_bf16_f32 v247, v198, v199
    s_add_u32 m0, s64, 8192
    s_add_u32 s62, s34, 74112
    buffer_load_dwordx4 v233, s[16:19], s62 offen lds
    v_cvt_pk_bf16_f32 v248, v200, v201
    v_cvt_pk_bf16_f32 v249, v202, v203
    v_cvt_pk_bf16_f32 v250, v204, v205
    s_add_u32 m0, s64, 12288
    s_add_u32 s62, s34, 110976
    buffer_load_dwordx4 v233, s[16:19], s62 offen lds
    v_cvt_pk_bf16_f32 v251, v206, v207
    s_nop 0
    v_permlane16_swap_b32 v244, v246
    s_add_u32 m0, s64, 16384
    s_add_u32 s62, s34, 147840
    buffer_load_dwordx4 v233, s[16:19], s62 offen lds
    v_permlane16_swap_b32 v245, v247
    v_permlane16_swap_b32 v248, v250
    v_permlane16_swap_b32 v249, v251
    s_add_u32 m0, s64, 20480
    s_add_u32 s62, s34, 184704
    buffer_load_dwordx4 v233, s[16:19], s62 offen lds
    s_mov_b32 s65, 4096
    buffer_store_dwordx4 v[244:247], v237, s[20:23], s65 offen sc1
    s_mov_b32 s65, 483328
    buffer_store_dwordx4 v[248:251], v237, s[20:23], s65 offen sc1
    s_waitcnt vmcnt(8)
    s_barrier
    ds_read_b64_tr_b16 v[224:225], v229 offset:0
    ds_read_b64_tr_b16 v[226:227], v229 offset:2048
    ds_read_b64_tr_b16 v[208:209], v229 offset:4096
    ds_read_b64_tr_b16 v[210:211], v229 offset:6144
    ds_read_b64_tr_b16 v[212:213], v229 offset:8192
    ds_read_b64_tr_b16 v[214:215], v229 offset:10240
    s_setprio 0
    s_waitcnt lgkmcnt(4)
    v_mfma_f32_16x16x32_bf16 v[192:195], v[224:227], v[0:3], 0
    ds_read_b64_tr_b16 v[216:217], v229 offset:12288
    s_waitcnt lgkmcnt(3)
    v_mfma_f32_16x16x32_bf16 v[192:195], v[208:211], v[4:7], v[192:195]
    ds_read_b64_tr_b16 v[218:219], v229 offset:14336
    v_mfma_f32_16x16x32_bf16 v[196:199], v[224:227], v[12:15], 0
    ds_read_b64_tr_b16 v[220:221], v229 offset:16384
    v_mfma_f32_16x16x32_bf16 v[196:199], v[208:211], v[16:19], v[196:199]
    ds_read_b64_tr_b16 v[222:223], v229 offset:18432
    v_mfma_f32_16x16x32_bf16 v[200:203], v[224:227], v[72:75], 0
    v_mfma_f32_16x16x32_bf16 v[200:203], v[208:211], v[76:79], v[200:203]
    v_mfma_f32_16x16x32_bf16 v[204:207], v[224:227], v[84:87], 0
    v_mfma_f32_16x16x32_bf16 v[204:207], v[208:211], v[88:91], v[204:207]
    ds_read_b64_tr_b16 v[224:225], v229 offset:20480
    s_waitcnt lgkmcnt(5)
    v_mfma_f32_16x16x32_bf16 v[192:195], v[212:215], v[8:11], v[192:195]
    ds_read_b64_tr_b16 v[226:227], v229 offset:22528
    s_waitcnt lgkmcnt(4)
    v_mfma_f32_16x16x32_bf16 v[192:195], v[216:219], v[24:27], v[192:195]
    ds_read_b64_tr_b16 v[208:209], v229 offset:24576
    v_mfma_f32_16x16x32_bf16 v[196:199], v[212:215], v[20:23], v[196:199]
    ds_read_b64_tr_b16 v[210:211], v229 offset:26624
    v_mfma_f32_16x16x32_bf16 v[196:199], v[216:219], v[36:39], v[196:199]
    v_mfma_f32_16x16x32_bf16 v[200:203], v[212:215], v[80:83], v[200:203]
    v_mfma_f32_16x16x32_bf16 v[200:203], v[216:219], v[96:99], v[200:203]
    v_mfma_f32_16x16x32_bf16 v[204:207], v[212:215], v[92:95], v[204:207]
    v_mfma_f32_16x16x32_bf16 v[204:207], v[216:219], v[108:111], v[204:207]
    ds_read_b64_tr_b16 v[212:213], v229 offset:28672
    s_waitcnt lgkmcnt(5)
    v_mfma_f32_16x16x32_bf16 v[192:195], v[220:223], v[28:31], v[192:195]
    ds_read_b64_tr_b16 v[214:215], v229 offset:30720
    s_waitcnt lgkmcnt(4)
    v_mfma_f32_16x16x32_bf16 v[192:195], v[224:227], v[32:35], v[192:195]
    ds_read_b64_tr_b16 v[216:217], v229 offset:32768
    v_mfma_f32_16x16x32_bf16 v[196:199], v[220:223], v[40:43], v[196:199]
    ds_read_b64_tr_b16 v[218:219], v229 offset:34816
    v_mfma_f32_16x16x32_bf16 v[196:199], v[224:227], v[44:47], v[196:199]
    v_mfma_f32_16x16x32_bf16 v[200:203], v[220:223], v[100:103], v[200:203]
    v_mfma_f32_16x16x32_bf16 v[200:203], v[224:227], v[104:107], v[200:203]
    v_mfma_f32_16x16x32_bf16 v[204:207], v[220:223], v[112:115], v[204:207]
    v_mfma_f32_16x16x32_bf16 v[204:207], v[224:227], v[116:119], v[204:207]
    ds_read_b64_tr_b16 v[220:221], v229 offset:36864
    s_waitcnt lgkmcnt(5)
    v_mfma_f32_16x16x32_bf16 v[192:195], v[208:211], v[48:51], v[192:195]
    ds_read_b64_tr_b16 v[222:223], v229 offset:38912
    s_waitcnt lgkmcnt(4)
    v_mfma_f32_16x16x32_bf16 v[192:195], v[212:215], v[52:55], v[192:195]
    ds_read_b64_tr_b16 v[224:225], v229 offset:40960
    v_mfma_f32_16x16x32_bf16 v[196:199], v[208:211], v[60:63], v[196:199]
    ds_read_b64_tr_b16 v[226:227], v229 offset:43008
    v_mfma_f32_16x16x32_bf16 v[196:199], v[212:215], v[64:67], v[196:199]
    v_mfma_f32_16x16x32_bf16 v[200:203], v[208:211], v[120:123], v[200:203]
    v_mfma_f32_16x16x32_bf16 v[200:203], v[212:215], v[124:127], v[200:203]
    v_mfma_f32_16x16x32_bf16 v[204:207], v[208:211], v[132:135], v[204:207]
    v_mfma_f32_16x16x32_bf16 v[204:207], v[212:215], v[136:139], v[204:207]
    ds_read_b64_tr_b16 v[208:209], v229 offset:45056
    s_waitcnt lgkmcnt(5)
    v_mfma_f32_16x16x32_bf16 v[192:195], v[216:219], v[56:59], v[192:195]
    ds_read_b64_tr_b16 v[210:211], v229 offset:47104
    s_waitcnt lgkmcnt(4)
    v_mfma_f32_16x16x32_bf16 v[192:195], v[220:223], v[144:147], v[192:195]
    v_mfma_f32_16x16x32_bf16 v[196:199], v[216:219], v[68:71], v[196:199]
    v_mfma_f32_16x16x32_bf16 v[196:199], v[220:223], v[156:159], v[196:199]
    v_mfma_f32_16x16x32_bf16 v[200:203], v[216:219], v[128:131], v[200:203]
    v_mfma_f32_16x16x32_bf16 v[200:203], v[220:223], v[168:171], v[200:203]
    v_mfma_f32_16x16x32_bf16 v[204:207], v[216:219], v[140:143], v[204:207]
    v_mfma_f32_16x16x32_bf16 v[204:207], v[220:223], v[180:183], v[204:207]
    s_waitcnt lgkmcnt(2)
    v_mfma_f32_16x16x32_bf16 v[192:195], v[224:227], v[148:151], v[192:195]
    s_waitcnt lgkmcnt(0)
    v_mfma_f32_16x16x32_bf16 v[192:195], v[208:211], v[152:155], v[192:195]
    v_mfma_f32_16x16x32_bf16 v[196:199], v[224:227], v[160:163], v[196:199]
    v_mfma_f32_16x16x32_bf16 v[196:199], v[208:211], v[164:167], v[196:199]
    v_mfma_f32_16x16x32_bf16 v[200:203], v[224:227], v[172:175], v[200:203]
    v_mfma_f32_16x16x32_bf16 v[200:203], v[208:211], v[176:179], v[200:203]
    v_mfma_f32_16x16x32_bf16 v[204:207], v[224:227], v[184:187], v[204:207]
    v_mfma_f32_16x16x32_bf16 v[204:207], v[208:211], v[188:191], v[204:207]
    s_setprio 2
    s_add_u32 m0, s64, 49152
    s_add_u32 s62, s34, 512
    buffer_load_dwordx4 v233, s[16:19], s62 offen lds
    s_add_u32 m0, s64, 53248
    s_add_u32 s62, s34, 37376
    buffer_load_dwordx4 v233, s[16:19], s62 offen lds
    v_cvt_pk_bf16_f32 v244, v192, v193
    v_cvt_pk_bf16_f32 v245, v194, v195
    v_cvt_pk_bf16_f32 v246, v196, v197
    v_cvt_pk_bf16_f32 v247, v198, v199
    s_add_u32 m0, s64, 57344
    s_add_u32 s62, s34, 74240
    buffer_load_dwordx4 v233, s[16:19], s62 offen lds
    v_cvt_pk_bf16_f32 v248, v200, v201
    v_cvt_pk_bf16_f32 v249, v202, v203
    v_cvt_pk_bf16_f32 v250, v204, v205
    s_add_u32 m0, s64, 61440
    s_add_u32 s62, s34, 111104
    buffer_load_dwordx4 v233, s[16:19], s62 offen lds
    v_cvt_pk_bf16_f32 v251, v206, v207
    s_nop 0
    v_permlane16_swap_b32 v244, v246
    s_add_u32 m0, s64, 65536
    s_add_u32 s62, s34, 147968
    buffer_load_dwordx4 v233, s[16:19], s62 offen lds
    v_permlane16_swap_b32 v245, v247
    v_permlane16_swap_b32 v248, v250
    v_permlane16_swap_b32 v249, v251
    s_add_u32 m0, s64, 69632
    s_add_u32 s62, s34, 184832
    buffer_load_dwordx4 v233, s[16:19], s62 offen lds
    s_mov_b32 s65, 8192
    buffer_store_dwordx4 v[244:247], v237, s[20:23], s65 offen sc1
    s_mov_b32 s65, 487424
    buffer_store_dwordx4 v[248:251], v237, s[20:23], s65 offen sc1
    s_waitcnt vmcnt(8)
    s_barrier
    ds_read_b64_tr_b16 v[212:213], v238 offset:0
    ds_read_b64_tr_b16 v[214:215], v238 offset:2048
    ds_read_b64_tr_b16 v[216:217], v238 offset:4096
    ds_read_b64_tr_b16 v[218:219], v238 offset:6144
    ds_read_b64_tr_b16 v[220:221], v238 offset:8192
    ds_read_b64_tr_b16 v[222:223], v238 offset:10240
    s_setprio 0
    s_waitcnt lgkmcnt(4)
    v_mfma_f32_16x16x32_bf16 v[192:195], v[212:215], v[0:3], 0
    ds_read_b64_tr_b16 v[224:225], v238 offset:12288
    s_waitcnt lgkmcnt(3)
    v_mfma_f32_16x16x32_bf16 v[192:195], v[216:219], v[4:7], v[192:195]
    ds_read_b64_tr_b16 v[226:227], v238 offset:14336
    v_mfma_f32_16x16x32_bf16 v[196:199], v[212:215], v[12:15], 0
    ds_read_b64_tr_b16 v[208:209], v238 offset:16384
    v_mfma_f32_16x16x32_bf16 v[196:199], v[216:219], v[16:19], v[196:199]
    ds_read_b64_tr_b16 v[210:211], v238 offset:18432
    v_mfma_f32_16x16x32_bf16 v[200:203], v[212:215], v[72:75], 0
    v_mfma_f32_16x16x32_bf16 v[200:203], v[216:219], v[76:79], v[200:203]
    v_mfma_f32_16x16x32_bf16 v[204:207], v[212:215], v[84:87], 0
    v_mfma_f32_16x16x32_bf16 v[204:207], v[216:219], v[88:91], v[204:207]
    ds_read_b64_tr_b16 v[212:213], v238 offset:20480
    s_waitcnt lgkmcnt(5)
    v_mfma_f32_16x16x32_bf16 v[192:195], v[220:223], v[8:11], v[192:195]
    ds_read_b64_tr_b16 v[214:215], v238 offset:22528
    s_waitcnt lgkmcnt(4)
    v_mfma_f32_16x16x32_bf16 v[192:195], v[224:227], v[24:27], v[192:195]
    ds_read_b64_tr_b16 v[216:217], v238 offset:24576
    v_mfma_f32_16x16x32_bf16 v[196:199], v[220:223], v[20:23], v[196:199]
    ds_read_b64_tr_b16 v[218:219], v238 offset:26624
    v_mfma_f32_16x16x32_bf16 v[196:199], v[224:227], v[36:39], v[196:199]
    v_mfma_f32_16x16x32_bf16 v[200:203], v[220:223], v[80:83], v[200:203]
    v_mfma_f32_16x16x32_bf16 v[200:203], v[224:227], v[96:99], v[200:203]
    v_mfma_f32_16x16x32_bf16 v[204:207], v[220:223], v[92:95], v[204:207]
    v_mfma_f32_16x16x32_bf16 v[204:207], v[224:227], v[108:111], v[204:207]
    ds_read_b64_tr_b16 v[220:221], v238 offset:28672
    s_waitcnt lgkmcnt(5)
    v_mfma_f32_16x16x32_bf16 v[192:195], v[208:211], v[28:31], v[192:195]
    ds_read_b64_tr_b16 v[222:223], v238 offset:30720
    s_waitcnt lgkmcnt(4)
    v_mfma_f32_16x16x32_bf16 v[192:195], v[212:215], v[32:35], v[192:195]
    ds_read_b64_tr_b16 v[224:225], v238 offset:32768
    v_mfma_f32_16x16x32_bf16 v[196:199], v[208:211], v[40:43], v[196:199]
    ds_read_b64_tr_b16 v[226:227], v238 offset:34816
    v_mfma_f32_16x16x32_bf16 v[196:199], v[212:215], v[44:47], v[196:199]
    v_mfma_f32_16x16x32_bf16 v[200:203], v[208:211], v[100:103], v[200:203]
    v_mfma_f32_16x16x32_bf16 v[200:203], v[212:215], v[104:107], v[200:203]
    v_mfma_f32_16x16x32_bf16 v[204:207], v[208:211], v[112:115], v[204:207]
    v_mfma_f32_16x16x32_bf16 v[204:207], v[212:215], v[116:119], v[204:207]
    ds_read_b64_tr_b16 v[208:209], v238 offset:36864
    s_waitcnt lgkmcnt(5)
    v_mfma_f32_16x16x32_bf16 v[192:195], v[216:219], v[48:51], v[192:195]
    ds_read_b64_tr_b16 v[210:211], v238 offset:38912
    s_waitcnt lgkmcnt(4)
    v_mfma_f32_16x16x32_bf16 v[192:195], v[220:223], v[52:55], v[192:195]
    ds_read_b64_tr_b16 v[212:213], v238 offset:40960
    v_mfma_f32_16x16x32_bf16 v[196:199], v[216:219], v[60:63], v[196:199]
    ds_read_b64_tr_b16 v[214:215], v238 offset:43008
    v_mfma_f32_16x16x32_bf16 v[196:199], v[220:223], v[64:67], v[196:199]
    v_mfma_f32_16x16x32_bf16 v[200:203], v[216:219], v[120:123], v[200:203]
    v_mfma_f32_16x16x32_bf16 v[200:203], v[220:223], v[124:127], v[200:203]
    v_mfma_f32_16x16x32_bf16 v[204:207], v[216:219], v[132:135], v[204:207]
    v_mfma_f32_16x16x32_bf16 v[204:207], v[220:223], v[136:139], v[204:207]
    ds_read_b64_tr_b16 v[216:217], v238 offset:45056
    s_waitcnt lgkmcnt(5)
    v_mfma_f32_16x16x32_bf16 v[192:195], v[224:227], v[56:59], v[192:195]
    ds_read_b64_tr_b16 v[218:219], v238 offset:47104
    s_waitcnt lgkmcnt(4)
    v_mfma_f32_16x16x32_bf16 v[192:195], v[208:211], v[144:147], v[192:195]
    v_mfma_f32_16x16x32_bf16 v[196:199], v[224:227], v[68:71], v[196:199]
    v_mfma_f32_16x16x32_bf16 v[196:199], v[208:211], v[156:159], v[196:199]
    v_mfma_f32_16x16x32_bf16 v[200:203], v[224:227], v[128:131], v[200:203]
    v_mfma_f32_16x16x32_bf16 v[200:203], v[208:211], v[168:171], v[200:203]
    v_mfma_f32_16x16x32_bf16 v[204:207], v[224:227], v[140:143], v[204:207]
    v_mfma_f32_16x16x32_bf16 v[204:207], v[208:211], v[180:183], v[204:207]
    s_waitcnt lgkmcnt(2)
    v_mfma_f32_16x16x32_bf16 v[192:195], v[212:215], v[148:151], v[192:195]
    s_waitcnt lgkmcnt(0)
    v_mfma_f32_16x16x32_bf16 v[192:195], v[216:219], v[152:155], v[192:195]
    v_mfma_f32_16x16x32_bf16 v[196:199], v[212:215], v[160:163], v[196:199]
    v_mfma_f32_16x16x32_bf16 v[196:199], v[216:219], v[164:167], v[196:199]
    v_mfma_f32_16x16x32_bf16 v[200:203], v[212:215], v[172:175], v[200:203]
    v_mfma_f32_16x16x32_bf16 v[200:203], v[216:219], v[176:179], v[200:203]
    v_mfma_f32_16x16x32_bf16 v[204:207], v[212:215], v[184:187], v[204:207]
    v_mfma_f32_16x16x32_bf16 v[204:207], v[216:219], v[188:191], v[204:207]
    s_setprio 2
    s_add_u32 m0, s64, 98304
    s_add_u32 s62, s34, 640
    buffer_load_dwordx4 v233, s[16:19], s62 offen lds
    s_add_u32 m0, s64, 102400
    s_add_u32 s62, s34, 37504
    buffer_load_dwordx4 v233, s[16:19], s62 offen lds
    v_cvt_pk_bf16_f32 v244, v192, v193
    v_cvt_pk_bf16_f32 v245, v194, v195
    v_cvt_pk_bf16_f32 v246, v196, v197
    v_cvt_pk_bf16_f32 v247, v198, v199
    s_add_u32 m0, s64, 106496
    s_add_u32 s62, s34, 74368
    buffer_load_dwordx4 v233, s[16:19], s62 offen lds
    v_cvt_pk_bf16_f32 v248, v200, v201
    v_cvt_pk_bf16_f32 v249, v202, v203
    v_cvt_pk_bf16_f32 v250, v204, v205
    s_add_u32 m0, s64, 110592
    s_add_u32 s62, s34, 111232
    buffer_load_dwordx4 v233, s[16:19], s62 offen lds
    v_cvt_pk_bf16_f32 v251, v206, v207
    s_nop 0
    v_permlane16_swap_b32 v244, v246
    s_add_u32 m0, s64, 114688
    s_add_u32 s62, s34, 148096
    buffer_load_dwordx4 v233, s[16:19], s62 offen lds
    v_permlane16_swap_b32 v245, v247
    v_permlane16_swap_b32 v248, v250
    v_permlane16_swap_b32 v249, v251
    s_add_u32 m0, s64, 118784
    s_add_u32 s62, s34, 184960
    buffer_load_dwordx4 v233, s[16:19], s62 offen lds
    s_mov_b32 s65, 12288
    buffer_store_dwordx4 v[244:247], v237, s[20:23], s65 offen sc1
    s_mov_b32 s65, 491520
    buffer_store_dwordx4 v[248:251], v237, s[20:23], s65 offen sc1
    s_waitcnt vmcnt(8)
    s_barrier
    ds_read_b64_tr_b16 v[220:221], v228 offset:0
    ds_read_b64_tr_b16 v[222:223], v228 offset:2048
    ds_read_b64_tr_b16 v[224:225], v228 offset:4096
    ds_read_b64_tr_b16 v[226:227], v228 offset:6144
    ds_read_b64_tr_b16 v[208:209], v228 offset:8192
    ds_read_b64_tr_b16 v[210:211], v228 offset:10240
    s_setprio 0
    s_waitcnt lgkmcnt(4)
    v_mfma_f32_16x16x32_bf16 v[192:195], v[220:223], v[0:3], 0
    ds_read_b64_tr_b16 v[212:213], v228 offset:12288
    s_waitcnt lgkmcnt(3)
    v_mfma_f32_16x16x32_bf16 v[192:195], v[224:227], v[4:7], v[192:195]
    ds_read_b64_tr_b16 v[214:215], v228 offset:14336
    v_mfma_f32_16x16x32_bf16 v[196:199], v[220:223], v[12:15], 0
    ds_read_b64_tr_b16 v[216:217], v228 offset:16384
    v_mfma_f32_16x16x32_bf16 v[196:199], v[224:227], v[16:19], v[196:199]
    ds_read_b64_tr_b16 v[218:219], v228 offset:18432
    v_mfma_f32_16x16x32_bf16 v[200:203], v[220:223], v[72:75], 0
    v_mfma_f32_16x16x32_bf16 v[200:203], v[224:227], v[76:79], v[200:203]
    v_mfma_f32_16x16x32_bf16 v[204:207], v[220:223], v[84:87], 0
    v_mfma_f32_16x16x32_bf16 v[204:207], v[224:227], v[88:91], v[204:207]
    ds_read_b64_tr_b16 v[220:221], v228 offset:20480
    s_waitcnt lgkmcnt(5)
    v_mfma_f32_16x16x32_bf16 v[192:195], v[208:211], v[8:11], v[192:195]
    ds_read_b64_tr_b16 v[222:223], v228 offset:22528
    s_waitcnt lgkmcnt(4)
    v_mfma_f32_16x16x32_bf16 v[192:195], v[212:215], v[24:27], v[192:195]
    ds_read_b64_tr_b16 v[224:225], v228 offset:24576
    v_mfma_f32_16x16x32_bf16 v[196:199], v[208:211], v[20:23], v[196:199]
    ds_read_b64_tr_b16 v[226:227], v228 offset:26624
    v_mfma_f32_16x16x32_bf16 v[196:199], v[212:215], v[36:39], v[196:199]
    v_mfma_f32_16x16x32_bf16 v[200:203], v[208:211], v[80:83], v[200:203]
    v_mfma_f32_16x16x32_bf16 v[200:203], v[212:215], v[96:99], v[200:203]
    v_mfma_f32_16x16x32_bf16 v[204:207], v[208:211], v[92:95], v[204:207]
    v_mfma_f32_16x16x32_bf16 v[204:207], v[212:215], v[108:111], v[204:207]
    ds_read_b64_tr_b16 v[208:209], v228 offset:28672
    s_waitcnt lgkmcnt(5)
    v_mfma_f32_16x16x32_bf16 v[192:195], v[216:219], v[28:31], v[192:195]
    ds_read_b64_tr_b16 v[210:211], v228 offset:30720
    s_waitcnt lgkmcnt(4)
    v_mfma_f32_16x16x32_bf16 v[192:195], v[220:223], v[32:35], v[192:195]
    ds_read_b64_tr_b16 v[212:213], v228 offset:32768
    v_mfma_f32_16x16x32_bf16 v[196:199], v[216:219], v[40:43], v[196:199]
    ds_read_b64_tr_b16 v[214:215], v228 offset:34816
    v_mfma_f32_16x16x32_bf16 v[196:199], v[220:223], v[44:47], v[196:199]
    v_mfma_f32_16x16x32_bf16 v[200:203], v[216:219], v[100:103], v[200:203]
    v_mfma_f32_16x16x32_bf16 v[200:203], v[220:223], v[104:107], v[200:203]
    v_mfma_f32_16x16x32_bf16 v[204:207], v[216:219], v[112:115], v[204:207]
    v_mfma_f32_16x16x32_bf16 v[204:207], v[220:223], v[116:119], v[204:207]
    ds_read_b64_tr_b16 v[216:217], v228 offset:36864
    s_waitcnt lgkmcnt(5)
    v_mfma_f32_16x16x32_bf16 v[192:195], v[224:227], v[48:51], v[192:195]
    ds_read_b64_tr_b16 v[218:219], v228 offset:38912
    s_waitcnt lgkmcnt(4)
    v_mfma_f32_16x16x32_bf16 v[192:195], v[208:211], v[52:55], v[192:195]
    ds_read_b64_tr_b16 v[220:221], v228 offset:40960
    v_mfma_f32_16x16x32_bf16 v[196:199], v[224:227], v[60:63], v[196:199]
    ds_read_b64_tr_b16 v[222:223], v228 offset:43008
    v_mfma_f32_16x16x32_bf16 v[196:199], v[208:211], v[64:67], v[196:199]
    v_mfma_f32_16x16x32_bf16 v[200:203], v[224:227], v[120:123], v[200:203]
    v_mfma_f32_16x16x32_bf16 v[200:203], v[208:211], v[124:127], v[200:203]
    v_mfma_f32_16x16x32_bf16 v[204:207], v[224:227], v[132:135], v[204:207]
    v_mfma_f32_16x16x32_bf16 v[204:207], v[208:211], v[136:139], v[204:207]
    ds_read_b64_tr_b16 v[224:225], v228 offset:45056
    s_waitcnt lgkmcnt(5)
    v_mfma_f32_16x16x32_bf16 v[192:195], v[212:215], v[56:59], v[192:195]
    ds_read_b64_tr_b16 v[226:227], v228 offset:47104
    s_waitcnt lgkmcnt(4)
    v_mfma_f32_16x16x32_bf16 v[192:195], v[216:219], v[144:147], v[192:195]
    v_mfma_f32_16x16x32_bf16 v[196:199], v[212:215], v[68:71], v[196:199]
    v_mfma_f32_16x16x32_bf16 v[196:199], v[216:219], v[156:159], v[196:199]
    v_mfma_f32_16x16x32_bf16 v[200:203], v[212:215], v[128:131], v[200:203]
    v_mfma_f32_16x16x32_bf16 v[200:203], v[216:219], v[168:171], v[200:203]
    v_mfma_f32_16x16x32_bf16 v[204:207], v[212:215], v[140:143], v[204:207]
    v_mfma_f32_16x16x32_bf16 v[204:207], v[216:219], v[180:183], v[204:207]
    s_waitcnt lgkmcnt(2)
    v_mfma_f32_16x16x32_bf16 v[192:195], v[220:223], v[148:151], v[192:195]
    s_waitcnt lgkmcnt(0)
    v_mfma_f32_16x16x32_bf16 v[192:195], v[224:227], v[152:155], v[192:195]
    v_mfma_f32_16x16x32_bf16 v[196:199], v[220:223], v[160:163], v[196:199]
    v_mfma_f32_16x16x32_bf16 v[196:199], v[224:227], v[164:167], v[196:199]
    v_mfma_f32_16x16x32_bf16 v[200:203], v[220:223], v[172:175], v[200:203]
    v_mfma_f32_16x16x32_bf16 v[200:203], v[224:227], v[176:179], v[200:203]
    v_mfma_f32_16x16x32_bf16 v[204:207], v[220:223], v[184:187], v[204:207]
    v_mfma_f32_16x16x32_bf16 v[204:207], v[224:227], v[188:191], v[204:207]
    s_setprio 2
    s_add_u32 m0, s64, 0
    s_add_u32 s62, s34, 768
    buffer_load_dwordx4 v233, s[16:19], s62 offen lds
    s_add_u32 m0, s64, 4096
    s_add_u32 s62, s34, 37632
    buffer_load_dwordx4 v233, s[16:19], s62 offen lds
    v_cvt_pk_bf16_f32 v244, v192, v193
    v_cvt_pk_bf16_f32 v245, v194, v195
    v_cvt_pk_bf16_f32 v246, v196, v197
    v_cvt_pk_bf16_f32 v247, v198, v199
    s_add_u32 m0, s64, 8192
    s_add_u32 s62, s34, 74496
    buffer_load_dwordx4 v233, s[16:19], s62 offen lds
    v_cvt_pk_bf16_f32 v248, v200, v201
    v_cvt_pk_bf16_f32 v249, v202, v203
    v_cvt_pk_bf16_f32 v250, v204, v205
    s_add_u32 m0, s64, 12288
    s_add_u32 s62, s34, 111360
    buffer_load_dwordx4 v233, s[16:19], s62 offen lds
    v_cvt_pk_bf16_f32 v251, v206, v207
    s_nop 0
    v_permlane16_swap_b32 v244, v246
    s_add_u32 m0, s64, 16384
    s_add_u32 s62, s34, 148224
    buffer_load_dwordx4 v233, s[16:19], s62 offen lds
    v_permlane16_swap_b32 v245, v247
    v_permlane16_swap_b32 v248, v250
    v_permlane16_swap_b32 v249, v251
    s_add_u32 m0, s64, 20480
    s_add_u32 s62, s34, 185088
    buffer_load_dwordx4 v233, s[16:19], s62 offen lds
    s_mov_b32 s65, 16384
    buffer_store_dwordx4 v[244:247], v237, s[20:23], s65 offen sc1
    s_mov_b32 s65, 495616
    buffer_store_dwordx4 v[248:251], v237, s[20:23], s65 offen sc1
    s_waitcnt vmcnt(8)
    s_barrier
    ds_read_b64_tr_b16 v[208:209], v229 offset:0
    ds_read_b64_tr_b16 v[210:211], v229 offset:2048
    ds_read_b64_tr_b16 v[212:213], v229 offset:4096
    ds_read_b64_tr_b16 v[214:215], v229 offset:6144
    ds_read_b64_tr_b16 v[216:217], v229 offset:8192
    ds_read_b64_tr_b16 v[218:219], v229 offset:10240
    s_setprio 0
    s_waitcnt lgkmcnt(4)
    v_mfma_f32_16x16x32_bf16 v[192:195], v[208:211], v[0:3], 0
    ds_read_b64_tr_b16 v[220:221], v229 offset:12288
    s_waitcnt lgkmcnt(3)
    v_mfma_f32_16x16x32_bf16 v[192:195], v[212:215], v[4:7], v[192:195]
    ds_read_b64_tr_b16 v[222:223], v229 offset:14336
    v_mfma_f32_16x16x32_bf16 v[196:199], v[208:211], v[12:15], 0
    ds_read_b64_tr_b16 v[224:225], v229 offset:16384
    v_mfma_f32_16x16x32_bf16 v[196:199], v[212:215], v[16:19], v[196:199]
    ds_read_b64_tr_b16 v[226:227], v229 offset:18432
    v_mfma_f32_16x16x32_bf16 v[200:203], v[208:211], v[72:75], 0
    v_mfma_f32_16x16x32_bf16 v[200:203], v[212:215], v[76:79], v[200:203]
    v_mfma_f32_16x16x32_bf16 v[204:207], v[208:211], v[84:87], 0
    v_mfma_f32_16x16x32_bf16 v[204:207], v[212:215], v[88:91], v[204:207]
    ds_read_b64_tr_b16 v[208:209], v229 offset:20480
    s_waitcnt lgkmcnt(5)
    v_mfma_f32_16x16x32_bf16 v[192:195], v[216:219], v[8:11], v[192:195]
    ds_read_b64_tr_b16 v[210:211], v229 offset:22528
    s_waitcnt lgkmcnt(4)
    v_mfma_f32_16x16x32_bf16 v[192:195], v[220:223], v[24:27], v[192:195]
    ds_read_b64_tr_b16 v[212:213], v229 offset:24576
    v_mfma_f32_16x16x32_bf16 v[196:199], v[216:219], v[20:23], v[196:199]
    ds_read_b64_tr_b16 v[214:215], v229 offset:26624
    v_mfma_f32_16x16x32_bf16 v[196:199], v[220:223], v[36:39], v[196:199]
    v_mfma_f32_16x16x32_bf16 v[200:203], v[216:219], v[80:83], v[200:203]
    v_mfma_f32_16x16x32_bf16 v[200:203], v[220:223], v[96:99], v[200:203]
    v_mfma_f32_16x16x32_bf16 v[204:207], v[216:219], v[92:95], v[204:207]
    v_mfma_f32_16x16x32_bf16 v[204:207], v[220:223], v[108:111], v[204:207]
    ds_read_b64_tr_b16 v[216:217], v229 offset:28672
    s_waitcnt lgkmcnt(5)
    v_mfma_f32_16x16x32_bf16 v[192:195], v[224:227], v[28:31], v[192:195]
    ds_read_b64_tr_b16 v[218:219], v229 offset:30720
    s_waitcnt lgkmcnt(4)
    v_mfma_f32_16x16x32_bf16 v[192:195], v[208:211], v[32:35], v[192:195]
    ds_read_b64_tr_b16 v[220:221], v229 offset:32768
    v_mfma_f32_16x16x32_bf16 v[196:199], v[224:227], v[40:43], v[196:199]
    ds_read_b64_tr_b16 v[222:223], v229 offset:34816
    v_mfma_f32_16x16x32_bf16 v[196:199], v[208:211], v[44:47], v[196:199]
    v_mfma_f32_16x16x32_bf16 v[200:203], v[224:227], v[100:103], v[200:203]
    v_mfma_f32_16x16x32_bf16 v[200:203], v[208:211], v[104:107], v[200:203]
    v_mfma_f32_16x16x32_bf16 v[204:207], v[224:227], v[112:115], v[204:207]
    v_mfma_f32_16x16x32_bf16 v[204:207], v[208:211], v[116:119], v[204:207]
    ds_read_b64_tr_b16 v[224:225], v229 offset:36864
    s_waitcnt lgkmcnt(5)
    v_mfma_f32_16x16x32_bf16 v[192:195], v[212:215], v[48:51], v[192:195]
    ds_read_b64_tr_b16 v[226:227], v229 offset:38912
    s_waitcnt lgkmcnt(4)
    v_mfma_f32_16x16x32_bf16 v[192:195], v[216:219], v[52:55], v[192:195]
    ds_read_b64_tr_b16 v[208:209], v229 offset:40960
    v_mfma_f32_16x16x32_bf16 v[196:199], v[212:215], v[60:63], v[196:199]
    ds_read_b64_tr_b16 v[210:211], v229 offset:43008
    v_mfma_f32_16x16x32_bf16 v[196:199], v[216:219], v[64:67], v[196:199]
    v_mfma_f32_16x16x32_bf16 v[200:203], v[212:215], v[120:123], v[200:203]
    v_mfma_f32_16x16x32_bf16 v[200:203], v[216:219], v[124:127], v[200:203]
    v_mfma_f32_16x16x32_bf16 v[204:207], v[212:215], v[132:135], v[204:207]
    v_mfma_f32_16x16x32_bf16 v[204:207], v[216:219], v[136:139], v[204:207]
    ds_read_b64_tr_b16 v[212:213], v229 offset:45056
    s_waitcnt lgkmcnt(5)
    v_mfma_f32_16x16x32_bf16 v[192:195], v[220:223], v[56:59], v[192:195]
    ds_read_b64_tr_b16 v[214:215], v229 offset:47104
    s_waitcnt lgkmcnt(4)
    v_mfma_f32_16x16x32_bf16 v[192:195], v[224:227], v[144:147], v[192:195]
    v_mfma_f32_16x16x32_bf16 v[196:199], v[220:223], v[68:71], v[196:199]
    v_mfma_f32_16x16x32_bf16 v[196:199], v[224:227], v[156:159], v[196:199]
    v_mfma_f32_16x16x32_bf16 v[200:203], v[220:223], v[128:131], v[200:203]
    v_mfma_f32_16x16x32_bf16 v[200:203], v[224:227], v[168:171], v[200:203]
    v_mfma_f32_16x16x32_bf16 v[204:207], v[220:223], v[140:143], v[204:207]
    v_mfma_f32_16x16x32_bf16 v[204:207], v[224:227], v[180:183], v[204:207]
    s_waitcnt lgkmcnt(2)
    v_mfma_f32_16x16x32_bf16 v[192:195], v[208:211], v[148:151], v[192:195]
    s_waitcnt lgkmcnt(0)
    v_mfma_f32_16x16x32_bf16 v[192:195], v[212:215], v[152:155], v[192:195]
    v_mfma_f32_16x16x32_bf16 v[196:199], v[208:211], v[160:163], v[196:199]
    v_mfma_f32_16x16x32_bf16 v[196:199], v[212:215], v[164:167], v[196:199]
    v_mfma_f32_16x16x32_bf16 v[200:203], v[208:211], v[172:175], v[200:203]
    v_mfma_f32_16x16x32_bf16 v[200:203], v[212:215], v[176:179], v[200:203]
    v_mfma_f32_16x16x32_bf16 v[204:207], v[208:211], v[184:187], v[204:207]
    v_mfma_f32_16x16x32_bf16 v[204:207], v[212:215], v[188:191], v[204:207]
    s_setprio 2
    s_add_u32 m0, s64, 49152
    s_add_u32 s62, s34, 896
    buffer_load_dwordx4 v233, s[16:19], s62 offen lds
    s_add_u32 m0, s64, 53248
    s_add_u32 s62, s34, 37760
    buffer_load_dwordx4 v233, s[16:19], s62 offen lds
    v_cvt_pk_bf16_f32 v244, v192, v193
    v_cvt_pk_bf16_f32 v245, v194, v195
    v_cvt_pk_bf16_f32 v246, v196, v197
    v_cvt_pk_bf16_f32 v247, v198, v199
    s_add_u32 m0, s64, 57344
    s_add_u32 s62, s34, 74624
    buffer_load_dwordx4 v233, s[16:19], s62 offen lds
    v_cvt_pk_bf16_f32 v248, v200, v201
    v_cvt_pk_bf16_f32 v249, v202, v203
    v_cvt_pk_bf16_f32 v250, v204, v205
    s_add_u32 m0, s64, 61440
    s_add_u32 s62, s34, 111488
    buffer_load_dwordx4 v233, s[16:19], s62 offen lds
    v_cvt_pk_bf16_f32 v251, v206, v207
    s_nop 0
    v_permlane16_swap_b32 v244, v246
    s_add_u32 m0, s64, 65536
    s_add_u32 s62, s34, 148352
    buffer_load_dwordx4 v233, s[16:19], s62 offen lds
    v_permlane16_swap_b32 v245, v247
    v_permlane16_swap_b32 v248, v250
    v_permlane16_swap_b32 v249, v251
    s_add_u32 m0, s64, 69632
    s_add_u32 s62, s34, 185216
    buffer_load_dwordx4 v233, s[16:19], s62 offen lds
    s_mov_b32 s65, 20480
    buffer_store_dwordx4 v[244:247], v237, s[20:23], s65 offen sc1
    s_mov_b32 s65, 499712
    buffer_store_dwordx4 v[248:251], v237, s[20:23], s65 offen sc1
    s_waitcnt vmcnt(8)
    s_barrier
    ds_read_b64_tr_b16 v[216:217], v238 offset:0
    ds_read_b64_tr_b16 v[218:219], v238 offset:2048
    ds_read_b64_tr_b16 v[220:221], v238 offset:4096
    ds_read_b64_tr_b16 v[222:223], v238 offset:6144
    ds_read_b64_tr_b16 v[224:225], v238 offset:8192
    ds_read_b64_tr_b16 v[226:227], v238 offset:10240
    s_setprio 0
    s_waitcnt lgkmcnt(4)
    v_mfma_f32_16x16x32_bf16 v[192:195], v[216:219], v[0:3], 0
    ds_read_b64_tr_b16 v[208:209], v238 offset:12288
    s_waitcnt lgkmcnt(3)
    v_mfma_f32_16x16x32_bf16 v[192:195], v[220:223], v[4:7], v[192:195]
    ds_read_b64_tr_b16 v[210:211], v238 offset:14336
    v_mfma_f32_16x16x32_bf16 v[196:199], v[216:219], v[12:15], 0
    ds_read_b64_tr_b16 v[212:213], v238 offset:16384
    v_mfma_f32_16x16x32_bf16 v[196:199], v[220:223], v[16:19], v[196:199]
    ds_read_b64_tr_b16 v[214:215], v238 offset:18432
    v_mfma_f32_16x16x32_bf16 v[200:203], v[216:219], v[72:75], 0
    v_mfma_f32_16x16x32_bf16 v[200:203], v[220:223], v[76:79], v[200:203]
    v_mfma_f32_16x16x32_bf16 v[204:207], v[216:219], v[84:87], 0
    v_mfma_f32_16x16x32_bf16 v[204:207], v[220:223], v[88:91], v[204:207]
    ds_read_b64_tr_b16 v[216:217], v238 offset:20480
    s_waitcnt lgkmcnt(5)
    v_mfma_f32_16x16x32_bf16 v[192:195], v[224:227], v[8:11], v[192:195]
    ds_read_b64_tr_b16 v[218:219], v238 offset:22528
    s_waitcnt lgkmcnt(4)
    v_mfma_f32_16x16x32_bf16 v[192:195], v[208:211], v[24:27], v[192:195]
    ds_read_b64_tr_b16 v[220:221], v238 offset:24576
    v_mfma_f32_16x16x32_bf16 v[196:199], v[224:227], v[20:23], v[196:199]
    ds_read_b64_tr_b16 v[222:223], v238 offset:26624
    v_mfma_f32_16x16x32_bf16 v[196:199], v[208:211], v[36:39], v[196:199]
    v_mfma_f32_16x16x32_bf16 v[200:203], v[224:227], v[80:83], v[200:203]
    v_mfma_f32_16x16x32_bf16 v[200:203], v[208:211], v[96:99], v[200:203]
    v_mfma_f32_16x16x32_bf16 v[204:207], v[224:227], v[92:95], v[204:207]
    v_mfma_f32_16x16x32_bf16 v[204:207], v[208:211], v[108:111], v[204:207]
    ds_read_b64_tr_b16 v[224:225], v238 offset:28672
    s_waitcnt lgkmcnt(5)
    v_mfma_f32_16x16x32_bf16 v[192:195], v[212:215], v[28:31], v[192:195]
    ds_read_b64_tr_b16 v[226:227], v238 offset:30720
    s_waitcnt lgkmcnt(4)
    v_mfma_f32_16x16x32_bf16 v[192:195], v[216:219], v[32:35], v[192:195]
    ds_read_b64_tr_b16 v[208:209], v238 offset:32768
    v_mfma_f32_16x16x32_bf16 v[196:199], v[212:215], v[40:43], v[196:199]
    ds_read_b64_tr_b16 v[210:211], v238 offset:34816
    v_mfma_f32_16x16x32_bf16 v[196:199], v[216:219], v[44:47], v[196:199]
    v_mfma_f32_16x16x32_bf16 v[200:203], v[212:215], v[100:103], v[200:203]
    v_mfma_f32_16x16x32_bf16 v[200:203], v[216:219], v[104:107], v[200:203]
    v_mfma_f32_16x16x32_bf16 v[204:207], v[212:215], v[112:115], v[204:207]
    v_mfma_f32_16x16x32_bf16 v[204:207], v[216:219], v[116:119], v[204:207]
    ds_read_b64_tr_b16 v[212:213], v238 offset:36864
    s_waitcnt lgkmcnt(5)
    v_mfma_f32_16x16x32_bf16 v[192:195], v[220:223], v[48:51], v[192:195]
    ds_read_b64_tr_b16 v[214:215], v238 offset:38912
    s_waitcnt lgkmcnt(4)
    v_mfma_f32_16x16x32_bf16 v[192:195], v[224:227], v[52:55], v[192:195]
    ds_read_b64_tr_b16 v[216:217], v238 offset:40960
    v_mfma_f32_16x16x32_bf16 v[196:199], v[220:223], v[60:63], v[196:199]
    ds_read_b64_tr_b16 v[218:219], v238 offset:43008
    v_mfma_f32_16x16x32_bf16 v[196:199], v[224:227], v[64:67], v[196:199]
    v_mfma_f32_16x16x32_bf16 v[200:203], v[220:223], v[120:123], v[200:203]
    v_mfma_f32_16x16x32_bf16 v[200:203], v[224:227], v[124:127], v[200:203]
    v_mfma_f32_16x16x32_bf16 v[204:207], v[220:223], v[132:135], v[204:207]
    v_mfma_f32_16x16x32_bf16 v[204:207], v[224:227], v[136:139], v[204:207]
    ds_read_b64_tr_b16 v[220:221], v238 offset:45056
    s_waitcnt lgkmcnt(5)
    v_mfma_f32_16x16x32_bf16 v[192:195], v[208:211], v[56:59], v[192:195]
    ds_read_b64_tr_b16 v[222:223], v238 offset:47104
    s_waitcnt lgkmcnt(4)
    v_mfma_f32_16x16x32_bf16 v[192:195], v[212:215], v[144:147], v[192:195]
    v_mfma_f32_16x16x32_bf16 v[196:199], v[208:211], v[68:71], v[196:199]
    v_mfma_f32_16x16x32_bf16 v[196:199], v[212:215], v[156:159], v[196:199]
    v_mfma_f32_16x16x32_bf16 v[200:203], v[208:211], v[128:131], v[200:203]
    v_mfma_f32_16x16x32_bf16 v[200:203], v[212:215], v[168:171], v[200:203]
    v_mfma_f32_16x16x32_bf16 v[204:207], v[208:211], v[140:143], v[204:207]
    v_mfma_f32_16x16x32_bf16 v[204:207], v[212:215], v[180:183], v[204:207]
    s_waitcnt lgkmcnt(2)
    v_mfma_f32_16x16x32_bf16 v[192:195], v[216:219], v[148:151], v[192:195]
    s_waitcnt lgkmcnt(0)
    v_mfma_f32_16x16x32_bf16 v[192:195], v[220:223], v[152:155], v[192:195]
    v_mfma_f32_16x16x32_bf16 v[196:199], v[216:219], v[160:163], v[196:199]
    v_mfma_f32_16x16x32_bf16 v[196:199], v[220:223], v[164:167], v[196:199]
    v_mfma_f32_16x16x32_bf16 v[200:203], v[216:219], v[172:175], v[200:203]
    v_mfma_f32_16x16x32_bf16 v[200:203], v[220:223], v[176:179], v[200:203]
    v_mfma_f32_16x16x32_bf16 v[204:207], v[216:219], v[184:187], v[204:207]
    v_mfma_f32_16x16x32_bf16 v[204:207], v[220:223], v[188:191], v[204:207]
    s_setprio 2
    s_add_u32 m0, s64, 98304
    s_add_u32 s62, s34, 1024
    buffer_load_dwordx4 v233, s[16:19], s62 offen lds
    s_add_u32 m0, s64, 102400
    s_add_u32 s62, s34, 37888
    buffer_load_dwordx4 v233, s[16:19], s62 offen lds
    v_cvt_pk_bf16_f32 v244, v192, v193
    v_cvt_pk_bf16_f32 v245, v194, v195
    v_cvt_pk_bf16_f32 v246, v196, v197
    v_cvt_pk_bf16_f32 v247, v198, v199
    s_add_u32 m0, s64, 106496
    s_add_u32 s62, s34, 74752
    buffer_load_dwordx4 v233, s[16:19], s62 offen lds
    v_cvt_pk_bf16_f32 v248, v200, v201
    v_cvt_pk_bf16_f32 v249, v202, v203
    v_cvt_pk_bf16_f32 v250, v204, v205
    s_add_u32 m0, s64, 110592
    s_add_u32 s62, s34, 111616
    buffer_load_dwordx4 v233, s[16:19], s62 offen lds
    v_cvt_pk_bf16_f32 v251, v206, v207
    s_nop 0
    v_permlane16_swap_b32 v244, v246
    s_add_u32 m0, s64, 114688
    s_add_u32 s62, s34, 148480
    buffer_load_dwordx4 v233, s[16:19], s62 offen lds
    v_permlane16_swap_b32 v245, v247
    v_permlane16_swap_b32 v248, v250
    v_permlane16_swap_b32 v249, v251
    s_add_u32 m0, s64, 118784
    s_add_u32 s62, s34, 185344
    buffer_load_dwordx4 v233, s[16:19], s62 offen lds
    s_mov_b32 s65, 24576
    buffer_store_dwordx4 v[244:247], v237, s[20:23], s65 offen sc1
    s_mov_b32 s65, 503808
    buffer_store_dwordx4 v[248:251], v237, s[20:23], s65 offen sc1
    s_waitcnt vmcnt(8)
    s_barrier
    ds_read_b64_tr_b16 v[224:225], v228 offset:0
    ds_read_b64_tr_b16 v[226:227], v228 offset:2048
    ds_read_b64_tr_b16 v[208:209], v228 offset:4096
    ds_read_b64_tr_b16 v[210:211], v228 offset:6144
    ds_read_b64_tr_b16 v[212:213], v228 offset:8192
    ds_read_b64_tr_b16 v[214:215], v228 offset:10240
    s_setprio 0
    s_waitcnt lgkmcnt(4)
    v_mfma_f32_16x16x32_bf16 v[192:195], v[224:227], v[0:3], 0
    ds_read_b64_tr_b16 v[216:217], v228 offset:12288
    s_waitcnt lgkmcnt(3)
    v_mfma_f32_16x16x32_bf16 v[192:195], v[208:211], v[4:7], v[192:195]
    ds_read_b64_tr_b16 v[218:219], v228 offset:14336
    v_mfma_f32_16x16x32_bf16 v[196:199], v[224:227], v[12:15], 0
    ds_read_b64_tr_b16 v[220:221], v228 offset:16384
    v_mfma_f32_16x16x32_bf16 v[196:199], v[208:211], v[16:19], v[196:199]
    ds_read_b64_tr_b16 v[222:223], v228 offset:18432
    v_mfma_f32_16x16x32_bf16 v[200:203], v[224:227], v[72:75], 0
    v_mfma_f32_16x16x32_bf16 v[200:203], v[208:211], v[76:79], v[200:203]
    v_mfma_f32_16x16x32_bf16 v[204:207], v[224:227], v[84:87], 0
    v_mfma_f32_16x16x32_bf16 v[204:207], v[208:211], v[88:91], v[204:207]
    ds_read_b64_tr_b16 v[224:225], v228 offset:20480
    s_waitcnt lgkmcnt(5)
    v_mfma_f32_16x16x32_bf16 v[192:195], v[212:215], v[8:11], v[192:195]
    ds_read_b64_tr_b16 v[226:227], v228 offset:22528
    s_waitcnt lgkmcnt(4)
    v_mfma_f32_16x16x32_bf16 v[192:195], v[216:219], v[24:27], v[192:195]
    ds_read_b64_tr_b16 v[208:209], v228 offset:24576
    v_mfma_f32_16x16x32_bf16 v[196:199], v[212:215], v[20:23], v[196:199]
    ds_read_b64_tr_b16 v[210:211], v228 offset:26624
    v_mfma_f32_16x16x32_bf16 v[196:199], v[216:219], v[36:39], v[196:199]
    v_mfma_f32_16x16x32_bf16 v[200:203], v[212:215], v[80:83], v[200:203]
    v_mfma_f32_16x16x32_bf16 v[200:203], v[216:219], v[96:99], v[200:203]
    v_mfma_f32_16x16x32_bf16 v[204:207], v[212:215], v[92:95], v[204:207]
    v_mfma_f32_16x16x32_bf16 v[204:207], v[216:219], v[108:111], v[204:207]
    ds_read_b64_tr_b16 v[212:213], v228 offset:28672
    s_waitcnt lgkmcnt(5)
    v_mfma_f32_16x16x32_bf16 v[192:195], v[220:223], v[28:31], v[192:195]
    ds_read_b64_tr_b16 v[214:215], v228 offset:30720
    s_waitcnt lgkmcnt(4)
    v_mfma_f32_16x16x32_bf16 v[192:195], v[224:227], v[32:35], v[192:195]
    ds_read_b64_tr_b16 v[216:217], v228 offset:32768
    v_mfma_f32_16x16x32_bf16 v[196:199], v[220:223], v[40:43], v[196:199]
    ds_read_b64_tr_b16 v[218:219], v228 offset:34816
    v_mfma_f32_16x16x32_bf16 v[196:199], v[224:227], v[44:47], v[196:199]
    v_mfma_f32_16x16x32_bf16 v[200:203], v[220:223], v[100:103], v[200:203]
    v_mfma_f32_16x16x32_bf16 v[200:203], v[224:227], v[104:107], v[200:203]
    v_mfma_f32_16x16x32_bf16 v[204:207], v[220:223], v[112:115], v[204:207]
    v_mfma_f32_16x16x32_bf16 v[204:207], v[224:227], v[116:119], v[204:207]
    ds_read_b64_tr_b16 v[220:221], v228 offset:36864
    s_waitcnt lgkmcnt(5)
    v_mfma_f32_16x16x32_bf16 v[192:195], v[208:211], v[48:51], v[192:195]
    ds_read_b64_tr_b16 v[222:223], v228 offset:38912
    s_waitcnt lgkmcnt(4)
    v_mfma_f32_16x16x32_bf16 v[192:195], v[212:215], v[52:55], v[192:195]
    ds_read_b64_tr_b16 v[224:225], v228 offset:40960
    v_mfma_f32_16x16x32_bf16 v[196:199], v[208:211], v[60:63], v[196:199]
    ds_read_b64_tr_b16 v[226:227], v228 offset:43008
    v_mfma_f32_16x16x32_bf16 v[196:199], v[212:215], v[64:67], v[196:199]
    v_mfma_f32_16x16x32_bf16 v[200:203], v[208:211], v[120:123], v[200:203]
    v_mfma_f32_16x16x32_bf16 v[200:203], v[212:215], v[124:127], v[200:203]
    v_mfma_f32_16x16x32_bf16 v[204:207], v[208:211], v[132:135], v[204:207]
    v_mfma_f32_16x16x32_bf16 v[204:207], v[212:215], v[136:139], v[204:207]
    ds_read_b64_tr_b16 v[208:209], v228 offset:45056
    s_waitcnt lgkmcnt(5)
    v_mfma_f32_16x16x32_bf16 v[192:195], v[216:219], v[56:59], v[192:195]
    ds_read_b64_tr_b16 v[210:211], v228 offset:47104
    s_waitcnt lgkmcnt(4)
    v_mfma_f32_16x16x32_bf16 v[192:195], v[220:223], v[144:147], v[192:195]
    v_mfma_f32_16x16x32_bf16 v[196:199], v[216:219], v[68:71], v[196:199]
    v_mfma_f32_16x16x32_bf16 v[196:199], v[220:223], v[156:159], v[196:199]
    v_mfma_f32_16x16x32_bf16 v[200:203], v[216:219], v[128:131], v[200:203]
    v_mfma_f32_16x16x32_bf16 v[200:203], v[220:223], v[168:171], v[200:203]
    v_mfma_f32_16x16x32_bf16 v[204:207], v[216:219], v[140:143], v[204:207]
    v_mfma_f32_16x16x32_bf16 v[204:207], v[220:223], v[180:183], v[204:207]
    s_waitcnt lgkmcnt(2)
    v_mfma_f32_16x16x32_bf16 v[192:195], v[224:227], v[148:151], v[192:195]
    s_waitcnt lgkmcnt(0)
    v_mfma_f32_16x16x32_bf16 v[192:195], v[208:211], v[152:155], v[192:195]
    v_mfma_f32_16x16x32_bf16 v[196:199], v[224:227], v[160:163], v[196:199]
    v_mfma_f32_16x16x32_bf16 v[196:199], v[208:211], v[164:167], v[196:199]
    v_mfma_f32_16x16x32_bf16 v[200:203], v[224:227], v[172:175], v[200:203]
    v_mfma_f32_16x16x32_bf16 v[200:203], v[208:211], v[176:179], v[200:203]
    v_mfma_f32_16x16x32_bf16 v[204:207], v[224:227], v[184:187], v[204:207]
    v_mfma_f32_16x16x32_bf16 v[204:207], v[208:211], v[188:191], v[204:207]
    s_setprio 2
    s_nop 7
    v_cvt_pk_bf16_f32 v244, v192, v193
    v_cvt_pk_bf16_f32 v245, v194, v195
    v_cvt_pk_bf16_f32 v246, v196, v197
    v_cvt_pk_bf16_f32 v247, v198, v199
    v_cvt_pk_bf16_f32 v248, v200, v201
    v_cvt_pk_bf16_f32 v249, v202, v203
    v_cvt_pk_bf16_f32 v250, v204, v205
    v_cvt_pk_bf16_f32 v251, v206, v207
    s_nop 0
    v_permlane16_swap_b32 v244, v246
    v_permlane16_swap_b32 v245, v247
    v_permlane16_swap_b32 v248, v250
    v_permlane16_swap_b32 v249, v251
    s_mov_b32 s65, 28672
    buffer_store_dwordx4 v[244:247], v237, s[20:23], s65 offen sc1
    s_mov_b32 s65, 507904
    buffer_store_dwordx4 v[248:251], v237, s[20:23], s65 offen sc1
    s_waitcnt vmcnt(2)
    s_barrier
    ds_read_b64_tr_b16 v[212:213], v229 offset:0
    ds_read_b64_tr_b16 v[214:215], v229 offset:2048
    ds_read_b64_tr_b16 v[216:217], v229 offset:4096
    ds_read_b64_tr_b16 v[218:219], v229 offset:6144
    ds_read_b64_tr_b16 v[220:221], v229 offset:8192
    ds_read_b64_tr_b16 v[222:223], v229 offset:10240
    s_setprio 0
    s_waitcnt lgkmcnt(4)
    v_mfma_f32_16x16x32_bf16 v[192:195], v[212:215], v[0:3], 0
    ds_read_b64_tr_b16 v[224:225], v229 offset:12288
    s_waitcnt lgkmcnt(3)
    v_mfma_f32_16x16x32_bf16 v[192:195], v[216:219], v[4:7], v[192:195]
    ds_read_b64_tr_b16 v[226:227], v229 offset:14336
    v_mfma_f32_16x16x32_bf16 v[196:199], v[212:215], v[12:15], 0
    ds_read_b64_tr_b16 v[208:209], v229 offset:16384
    v_mfma_f32_16x16x32_bf16 v[196:199], v[216:219], v[16:19], v[196:199]
    ds_read_b64_tr_b16 v[210:211], v229 offset:18432
    v_mfma_f32_16x16x32_bf16 v[200:203], v[212:215], v[72:75], 0
    v_mfma_f32_16x16x32_bf16 v[200:203], v[216:219], v[76:79], v[200:203]
    v_mfma_f32_16x16x32_bf16 v[204:207], v[212:215], v[84:87], 0
    v_mfma_f32_16x16x32_bf16 v[204:207], v[216:219], v[88:91], v[204:207]
    ds_read_b64_tr_b16 v[212:213], v229 offset:20480
    s_waitcnt lgkmcnt(5)
    v_mfma_f32_16x16x32_bf16 v[192:195], v[220:223], v[8:11], v[192:195]
    ds_read_b64_tr_b16 v[214:215], v229 offset:22528
    s_waitcnt lgkmcnt(4)
    v_mfma_f32_16x16x32_bf16 v[192:195], v[224:227], v[24:27], v[192:195]
    ds_read_b64_tr_b16 v[216:217], v229 offset:24576
    v_mfma_f32_16x16x32_bf16 v[196:199], v[220:223], v[20:23], v[196:199]
    ds_read_b64_tr_b16 v[218:219], v229 offset:26624
    v_mfma_f32_16x16x32_bf16 v[196:199], v[224:227], v[36:39], v[196:199]
    v_mfma_f32_16x16x32_bf16 v[200:203], v[220:223], v[80:83], v[200:203]
    v_mfma_f32_16x16x32_bf16 v[200:203], v[224:227], v[96:99], v[200:203]
    v_mfma_f32_16x16x32_bf16 v[204:207], v[220:223], v[92:95], v[204:207]
    v_mfma_f32_16x16x32_bf16 v[204:207], v[224:227], v[108:111], v[204:207]
    ds_read_b64_tr_b16 v[220:221], v229 offset:28672
    s_waitcnt lgkmcnt(5)
    v_mfma_f32_16x16x32_bf16 v[192:195], v[208:211], v[28:31], v[192:195]
    ds_read_b64_tr_b16 v[222:223], v229 offset:30720
    s_waitcnt lgkmcnt(4)
    v_mfma_f32_16x16x32_bf16 v[192:195], v[212:215], v[32:35], v[192:195]
    ds_read_b64_tr_b16 v[224:225], v229 offset:32768
    v_mfma_f32_16x16x32_bf16 v[196:199], v[208:211], v[40:43], v[196:199]
    ds_read_b64_tr_b16 v[226:227], v229 offset:34816
    v_mfma_f32_16x16x32_bf16 v[196:199], v[212:215], v[44:47], v[196:199]
    v_mfma_f32_16x16x32_bf16 v[200:203], v[208:211], v[100:103], v[200:203]
    v_mfma_f32_16x16x32_bf16 v[200:203], v[212:215], v[104:107], v[200:203]
    v_mfma_f32_16x16x32_bf16 v[204:207], v[208:211], v[112:115], v[204:207]
    v_mfma_f32_16x16x32_bf16 v[204:207], v[212:215], v[116:119], v[204:207]
    ds_read_b64_tr_b16 v[208:209], v229 offset:36864
    s_waitcnt lgkmcnt(5)
    v_mfma_f32_16x16x32_bf16 v[192:195], v[216:219], v[48:51], v[192:195]
    ds_read_b64_tr_b16 v[210:211], v229 offset:38912
    s_waitcnt lgkmcnt(4)
    v_mfma_f32_16x16x32_bf16 v[192:195], v[220:223], v[52:55], v[192:195]
    ds_read_b64_tr_b16 v[212:213], v229 offset:40960
    v_mfma_f32_16x16x32_bf16 v[196:199], v[216:219], v[60:63], v[196:199]
    ds_read_b64_tr_b16 v[214:215], v229 offset:43008
    v_mfma_f32_16x16x32_bf16 v[196:199], v[220:223], v[64:67], v[196:199]
    v_mfma_f32_16x16x32_bf16 v[200:203], v[216:219], v[120:123], v[200:203]
    v_mfma_f32_16x16x32_bf16 v[200:203], v[220:223], v[124:127], v[200:203]
    v_mfma_f32_16x16x32_bf16 v[204:207], v[216:219], v[132:135], v[204:207]
    v_mfma_f32_16x16x32_bf16 v[204:207], v[220:223], v[136:139], v[204:207]
    ds_read_b64_tr_b16 v[216:217], v229 offset:45056
    s_waitcnt lgkmcnt(5)
    v_mfma_f32_16x16x32_bf16 v[192:195], v[224:227], v[56:59], v[192:195]
    ds_read_b64_tr_b16 v[218:219], v229 offset:47104
    s_waitcnt lgkmcnt(4)
    v_mfma_f32_16x16x32_bf16 v[192:195], v[208:211], v[144:147], v[192:195]
    v_mfma_f32_16x16x32_bf16 v[196:199], v[224:227], v[68:71], v[196:199]
    v_mfma_f32_16x16x32_bf16 v[196:199], v[208:211], v[156:159], v[196:199]
    v_mfma_f32_16x16x32_bf16 v[200:203], v[224:227], v[128:131], v[200:203]
    v_mfma_f32_16x16x32_bf16 v[200:203], v[208:211], v[168:171], v[200:203]
    v_mfma_f32_16x16x32_bf16 v[204:207], v[224:227], v[140:143], v[204:207]
    v_mfma_f32_16x16x32_bf16 v[204:207], v[208:211], v[180:183], v[204:207]
    s_waitcnt lgkmcnt(2)
    v_mfma_f32_16x16x32_bf16 v[192:195], v[212:215], v[148:151], v[192:195]
    s_waitcnt lgkmcnt(0)
    v_mfma_f32_16x16x32_bf16 v[192:195], v[216:219], v[152:155], v[192:195]
    v_mfma_f32_16x16x32_bf16 v[196:199], v[212:215], v[160:163], v[196:199]
    v_mfma_f32_16x16x32_bf16 v[196:199], v[216:219], v[164:167], v[196:199]
    v_mfma_f32_16x16x32_bf16 v[200:203], v[212:215], v[172:175], v[200:203]
    v_mfma_f32_16x16x32_bf16 v[200:203], v[216:219], v[176:179], v[200:203]
    v_mfma_f32_16x16x32_bf16 v[204:207], v[212:215], v[184:187], v[204:207]
    v_mfma_f32_16x16x32_bf16 v[204:207], v[216:219], v[188:191], v[204:207]
    s_setprio 2
    s_nop 7
    v_cvt_pk_bf16_f32 v244, v192, v193
    v_cvt_pk_bf16_f32 v245, v194, v195
    v_cvt_pk_bf16_f32 v246, v196, v197
    v_cvt_pk_bf16_f32 v247, v198, v199
    v_cvt_pk_bf16_f32 v248, v200, v201
    v_cvt_pk_bf16_f32 v249, v202, v203
    v_cvt_pk_bf16_f32 v250, v204, v205
    v_cvt_pk_bf16_f32 v251, v206, v207
    s_nop 0
    v_permlane16_swap_b32 v244, v246
    v_permlane16_swap_b32 v245, v247
    v_permlane16_swap_b32 v248, v250
    v_permlane16_swap_b32 v249, v251
    s_mov_b32 s65, 32768
    buffer_store_dwordx4 v[244:247], v237, s[20:23], s65 offen sc1
    s_mov_b32 s65, 512000
    buffer_store_dwordx4 v[248:251], v237, s[20:23], s65 offen sc1
    s_branch Lfin_4
Lph1_3:
    s_setprio 1
    v_mov_b32 v216, 0
    v_mov_b32 v217, 0
    v_mov_b32 v218, 0
    v_mov_b32 v219, 0
    s_waitcnt vmcnt(8)
    v_dot2c_f32_bf16 v216, s63, v144
    v_dot2c_f32_bf16 v218, v144, v144
    v_dot2c_f32_bf16 v217, s63, v145
    v_dot2c_f32_bf16 v219, v145, v145
    v_dot2c_f32_bf16 v216, s63, v146
    v_dot2c_f32_bf16 v218, v146, v146
    v_dot2c_f32_bf16 v217, s63, v147
    v_dot2c_f32_bf16 v219, v147, v147
    s_waitcnt vmcnt(7)
    v_dot2c_f32_bf16 v216, s63, v148
    v_dot2c_f32_bf16 v218, v148, v148
    v_dot2c_f32_bf16 v217, s63, v149
    v_dot2c_f32_bf16 v219, v149, v149
    v_dot2c_f32_bf16 v216, s63, v150
    v_dot2c_f32_bf16 v218, v150, v150
    v_dot2c_f32_bf16 v217, s63, v151
    v_dot2c_f32_bf16 v219, v151, v151
    s_waitcnt vmcnt(6)
    v_dot2c_f32_bf16 v216, s63, v152
    v_dot2c_f32_bf16 v218, v152, v152
    v_dot2c_f32_bf16 v217, s63, v153
    v_dot2c_f32_bf16 v219, v153, v153
    v_dot2c_f32_bf16 v216, s63, v154
    v_dot2c_f32_bf16 v218, v154, v154
    v_dot2c_f32_bf16 v217, s63, v155
    v_dot2c_f32_bf16 v219, v155, v155
    buffer_load_dwordx4 v[180:183], v245, s[8:11], s3 offen offset:0
    s_waitcnt vmcnt(6)
    v_dot2c_f32_bf16 v216, s63, v156
    v_dot2c_f32_bf16 v218, v156, v156
    v_dot2c_f32_bf16 v217, s63, v157
    v_dot2c_f32_bf16 v219, v157, v157
    v_dot2c_f32_bf16 v216, s63, v158
    v_dot2c_f32_bf16 v218, v158, v158
    v_dot2c_f32_bf16 v217, s63, v159
    v_dot2c_f32_bf16 v219, v159, v159
    s_waitcnt vmcnt(5)
    v_dot2c_f32_bf16 v216, s63, v160
    v_dot2c_f32_bf16 v218, v160, v160
    v_dot2c_f32_bf16 v217, s63, v161
    v_dot2c_f32_bf16 v219, v161, v161
    v_dot2c_f32_bf16 v216, s63, v162
    v_dot2c_f32_bf16 v218, v162, v162
    v_dot2c_f32_bf16 v217, s63, v163
    v_dot2c_f32_bf16 v219, v163, v163
    buffer_load_dwordx4 v[184:187], v245, s[8:11], s3 offen offset:128
    s_waitcnt vmcnt(5)
    v_dot2c_f32_bf16 v216, s63, v164
    v_dot2c_f32_bf16 v218, v164, v164
    v_dot2c_f32_bf16 v217, s63, v165
    v_dot2c_f32_bf16 v219, v165, v165
    v_dot2c_f32_bf16 v216, s63, v166
    v_dot2c_f32_bf16 v218, v166, v166
    v_dot2c_f32_bf16 v217, s63, v167
    v_dot2c_f32_bf16 v219, v167, v167
    s_waitcnt vmcnt(4)
    v_dot2c_f32_bf16 v216, s63, v168
    v_dot2c_f32_bf16 v218, v168, v168
    v_dot2c_f32_bf16 v217, s63, v169
    v_dot2c_f32_bf16 v219, v169, v169
    v_dot2c_f32_bf16 v216, s63, v170
    v_dot2c_f32_bf16 v218, v170, v170
    v_dot2c_f32_bf16 v217, s63, v171
    v_dot2c_f32_bf16 v219, v171, v171
    buffer_load_dwordx4 v[188:191], v245, s[8:11], s3 offen offset:256
    s_waitcnt vmcnt(4)
    v_dot2c_f32_bf16 v216, s63, v172
    v_dot2c_f32_bf16 v218, v172, v172
    v_dot2c_f32_bf16 v217, s63, v173
    v_dot2c_f32_bf16 v219, v173, v173
    v_dot2c_f32_bf16 v216, s63, v174
    v_dot2c_f32_bf16 v218, v174, v174
    v_dot2c_f32_bf16 v217, s63, v175
    v_dot2c_f32_bf16 v219, v175, v175
    s_waitcnt vmcnt(3)
    v_dot2c_f32_bf16 v216, s63, v176
    v_dot2c_f32_bf16 v218, v176, v176
    v_dot2c_f32_bf16 v217, s63, v177
    v_dot2c_f32_bf16 v219, v177, v177
    v_dot2c_f32_bf16 v216, s63, v178
    v_dot2c_f32_bf16 v218, v178, v178
    v_dot2c_f32_bf16 v217, s63, v179
    v_dot2c_f32_bf16 v219, v179, v179
    buffer_load_dwordx4 v[192:195], v245, s[8:11], s3 offen offset:384
    s_nop 2
    v_add_f32 v216, v216, v217
    v_add_f32 v218, v218, v219
    s_nop 0
    v_add_f32_dpp v217, v216, v216 quad_perm:[1,0,3,2] row_mask:0xf bank_mask:0xf
    v_add_f32_dpp v219, v218, v218 quad_perm:[1,0,3,2] row_mask:0xf bank_mask:0xf
    s_nop 0
    v_add_f32_dpp v216, v217, v217 quad_perm:[2,3,0,1] row_mask:0xf bank_mask:0xf
    v_add_f32_dpp v218, v219, v219 quad_perm:[2,3,0,1] row_mask:0xf bank_mask:0xf
    s_nop 0
    v_add_f32_dpp v217, v216, v216 row_half_mirror row_mask:0xf bank_mask:0xf
    v_add_f32_dpp v219, v218, v218 row_half_mirror row_mask:0xf bank_mask:0xf
    s_nop 0
    v_mul_f32 v220, 0x3ae38e39, v217
    v_mul_f32 v221, 0x3ae38e39, v219
    v_fma_f32 v221, -v220, v220, v221
    buffer_load_dwordx4 v[196:199], v245, s[8:11], s3 offen offset:512
    v_max_f32 v221, 0, v221
    v_cvt_pk_bf16_f32 v222, v220, v221
    v_and_b32 v221, 0xffff0000, v222
    v_lshlrev_b32 v222, 16, v222
    v_add_f32 v221, 0x3727c5ac, v221
    v_cvt_pk_bf16_f32 v221, v221, v221
    v_lshlrev_b32 v221, 16, v221
    v_sqrt_f32 v221, v221
    s_nop 0
    v_cvt_pk_bf16_f32 v221, v221, v221
    v_lshlrev_b32 v221, 16, v221
    v_rcp_f32 v223, v221
    s_nop 0
    v_mul_f32 v224, 0x3fb8aa3b, v223
    v_mul_f32 v226, v222, v224
    buffer_load_dwordx4 v[200:203], v245, s[8:11], s3 offen offset:640
    v_lshlrev_b32 v250, 16, v144
    v_and_b32 v251, 0xffff0000, v144
    v_lshlrev_b32 v252, 16, v145
    v_and_b32 v253, 0xffff0000, v145
    v_pk_fma_f32 v[250:251], v[250:251], v[224:225], v[226:227] op_sel_hi:[1,0,0] neg_lo:[0,0,1] neg_hi:[0,0,1]
    v_pk_fma_f32 v[252:253], v[252:253], v[224:225], v[226:227] op_sel_hi:[1,0,0] neg_lo:[0,0,1] neg_hi:[0,0,1]
    v_cvt_pk_bf16_f32 v144, v250, v251
    v_cvt_pk_bf16_f32 v145, v252, v253
    v_lshlrev_b32 v250, 16, v146
    v_and_b32 v251, 0xffff0000, v146
    v_lshlrev_b32 v252, 16, v147
    v_and_b32 v253, 0xffff0000, v147
    v_pk_fma_f32 v[250:251], v[250:251], v[224:225], v[226:227] op_sel_hi:[1,0,0] neg_lo:[0,0,1] neg_hi:[0,0,1]
    v_pk_fma_f32 v[252:253], v[252:253], v[224:225], v[226:227] op_sel_hi:[1,0,0] neg_lo:[0,0,1] neg_hi:[0,0,1]
    v_cvt_pk_bf16_f32 v146, v250, v251
    v_cvt_pk_bf16_f32 v147, v252, v253
    ds_write_b128 v254, v[144:147] offset:0
    v_lshlrev_b32 v250, 16, v148
    v_and_b32 v251, 0xffff0000, v148
    v_lshlrev_b32 v252, 16, v149
    v_and_b32 v253, 0xffff0000, v149
    buffer_load_dwordx4 v[204:207], v245, s[8:11], s3 offen offset:768
    v_pk_fma_f32 v[250:251], v[250:251], v[224:225], v[226:227] op_sel_hi:[1,0,0] neg_lo:[0,0,1] neg_hi:[0,0,1]
    v_pk_fma_f32 v[252:253], v[252:253], v[224:225], v[226:227] op_sel_hi:[1,0,0] neg_lo:[0,0,1] neg_hi:[0,0,1]
    v_cvt_pk_bf16_f32 v148, v250, v251
    v_cvt_pk_bf16_f32 v149, v252, v253
    v_lshlrev_b32 v250, 16, v150
    v_and_b32 v251, 0xffff0000, v150
    v_lshlrev_b32 v252, 16, v151
    v_and_b32 v253, 0xffff0000, v151
    v_pk_fma_f32 v[250:251], v[250:251], v[224:225], v[226:227] op_sel_hi:[1,0,0] neg_lo:[0,0,1] neg_hi:[0,0,1]
    v_pk_fma_f32 v[252:253], v[252:253], v[224:225], v[226:227] op_sel_hi:[1,0,0] neg_lo:[0,0,1] neg_hi:[0,0,1]
    v_cvt_pk_bf16_f32 v150, v250, v251
    v_cvt_pk_bf16_f32 v151, v252, v253
    ds_write_b128 v254, v[148:151] offset:2048
    v_lshlrev_b32 v250, 16, v152
    v_and_b32 v251, 0xffff0000, v152
    v_lshlrev_b32 v252, 16, v153
    v_and_b32 v253, 0xffff0000, v153
    v_pk_fma_f32 v[250:251], v[250:251], v[224:225], v[226:227] op_sel_hi:[1,0,0] neg_lo:[0,0,1] neg_hi:[0,0,1]
    v_pk_fma_f32 v[252:253], v[252:253], v[224:225], v[226:227] op_sel_hi:[1,0,0] neg_lo:[0,0,1] neg_hi:[0,0,1]
    v_cvt_pk_bf16_f32 v152, v250, v251
    buffer_load_dwordx4 v[208:211], v245, s[8:11], s3 offen offset:896
    v_cvt_pk_bf16_f32 v153, v252, v253
    v_lshlrev_b32 v250, 16, v154
    v_and_b32 v251, 0xffff0000, v154
    v_lshlrev_b32 v252, 16, v155
    v_and_b32 v253, 0xffff0000, v155
    v_pk_fma_f32 v[250:251], v[250:251], v[224:225], v[226:227] op_sel_hi:[1,0,0] neg_lo:[0,0,1] neg_hi:[0,0,1]
    v_pk_fma_f32 v[252:253], v[252:253], v[224:225], v[226:227] op_sel_hi:[1,0,0] neg_lo:[0,0,1] neg_hi:[0,0,1]
    v_cvt_pk_bf16_f32 v154, v250, v251
    v_cvt_pk_bf16_f32 v155, v252, v253
    ds_write_b128 v254, v[152:155] offset:4096
    v_lshlrev_b32 v250, 16, v156
    v_and_b32 v251, 0xffff0000, v156
    v_lshlrev_b32 v252, 16, v157
    v_and_b32 v253, 0xffff0000, v157
    v_pk_fma_f32 v[250:251], v[250:251], v[224:225], v[226:227] op_sel_hi:[1,0,0] neg_lo:[0,0,1] neg_hi:[0,0,1]
    v_pk_fma_f32 v[252:253], v[252:253], v[224:225], v[226:227] op_sel_hi:[1,0,0] neg_lo:[0,0,1] neg_hi:[0,0,1]
    v_cvt_pk_bf16_f32 v156, v250, v251
    v_cvt_pk_bf16_f32 v157, v252, v253
    v_lshlrev_b32 v250, 16, v158
    v_and_b32 v251, 0xffff0000, v158
    buffer_load_dwordx4 v[212:215], v245, s[8:11], s3 offen offset:1024
    v_lshlrev_b32 v252, 16, v159
    v_and_b32 v253, 0xffff0000, v159
    v_pk_fma_f32 v[250:251], v[250:251], v[224:225], v[226:227] op_sel_hi:[1,0,0] neg_lo:[0,0,1] neg_hi:[0,0,1]
    v_pk_fma_f32 v[252:253], v[252:253], v[224:225], v[226:227] op_sel_hi:[1,0,0] neg_lo:[0,0,1] neg_hi:[0,0,1]
    v_cvt_pk_bf16_f32 v158, v250, v251
    v_cvt_pk_bf16_f32 v159, v252, v253
    ds_write_b128 v254, v[156:159] offset:6144
    v_lshlrev_b32 v250, 16, v160
    v_and_b32 v251, 0xffff0000, v160
    v_lshlrev_b32 v252, 16, v161
    v_and_b32 v253, 0xffff0000, v161
    v_pk_fma_f32 v[250:251], v[250:251], v[224:225], v[226:227] op_sel_hi:[1,0,0] neg_lo:[0,0,1] neg_hi:[0,0,1]
    v_pk_fma_f32 v[252:253], v[252:253], v[224:225], v[226:227] op_sel_hi:[1,0,0] neg_lo:[0,0,1] neg_hi:[0,0,1]
    v_cvt_pk_bf16_f32 v160, v250, v251
    buffer_load_ushort v247, v246, s[24:27], s33 offen
    v_cvt_pk_bf16_f32 v161, v252, v253
    v_lshlrev_b32 v250, 16, v162
    v_and_b32 v251, 0xffff0000, v162
    v_lshlrev_b32 v252, 16, v163
    v_and_b32 v253, 0xffff0000, v163
    v_pk_fma_f32 v[250:251], v[250:251], v[224:225], v[226:227] op_sel_hi:[1,0,0] neg_lo:[0,0,1] neg_hi:[0,0,1]
    v_pk_fma_f32 v[252:253], v[252:253], v[224:225], v[226:227] op_sel_hi:[1,0,0] neg_lo:[0,0,1] neg_hi:[0,0,1]
    v_cvt_pk_bf16_f32 v162, v250, v251
    v_cvt_pk_bf16_f32 v163, v252, v253
    ds_write_b128 v254, v[160:163] offset:8192
    v_lshlrev_b32 v250, 16, v164
    v_and_b32 v251, 0xffff0000, v164
    v_lshlrev_b32 v252, 16, v165
    s_add_u32 m0, s64, 0
    s_add_u32 s62, s33, 0
    buffer_load_dwordx4 v232, s[12:15], s62 offen lds
    v_and_b32 v253, 0xffff0000, v165
    v_pk_fma_f32 v[250:251], v[250:251], v[224:225], v[226:227] op_sel_hi:[1,0,0] neg_lo:[0,0,1] neg_hi:[0,0,1]
    v_pk_fma_f32 v[252:253], v[252:253], v[224:225], v[226:227] op_sel_hi:[1,0,0] neg_lo:[0,0,1] neg_hi:[0,0,1]
    v_cvt_pk_bf16_f32 v164, v250, v251
    v_cvt_pk_bf16_f32 v165, v252, v253
    v_lshlrev_b32 v250, 16, v166
    v_and_b32 v251, 0xffff0000, v166
    v_lshlrev_b32 v252, 16, v167
    v_and_b32 v253, 0xffff0000, v167
    v_pk_fma_f32 v[250:251], v[250:251], v[224:225], v[226:227] op_sel_hi:[1,0,0] neg_lo:[0,0,1] neg_hi:[0,0,1]
    v_pk_fma_f32 v[252:253], v[252:253], v[224:225], v[226:227] op_sel_hi:[1,0,0] neg_lo:[0,0,1] neg_hi:[0,0,1]
    v_cvt_pk_bf16_f32 v166, v250, v251
    v_cvt_pk_bf16_f32 v167, v252, v253
    s_add_u32 m0, s64, 4096
    s_add_u32 s62, s33, 294912
    buffer_load_dwordx4 v232, s[12:15], s62 offen lds
    ds_write_b128 v254, v[164:167] offset:10240
    v_lshlrev_b32 v250, 16, v168
    v_and_b32 v251, 0xffff0000, v168
    v_lshlrev_b32 v252, 16, v169
    v_and_b32 v253, 0xffff0000, v169
    v_pk_fma_f32 v[250:251], v[250:251], v[224:225], v[226:227] op_sel_hi:[1,0,0] neg_lo:[0,0,1] neg_hi:[0,0,1]
    v_pk_fma_f32 v[252:253], v[252:253], v[224:225], v[226:227] op_sel_hi:[1,0,0] neg_lo:[0,0,1] neg_hi:[0,0,1]
    v_cvt_pk_bf16_f32 v168, v250, v251
    v_cvt_pk_bf16_f32 v169, v252, v253
    v_lshlrev_b32 v250, 16, v170
    v_and_b32 v251, 0xffff0000, v170
    v_lshlrev_b32 v252, 16, v171
    v_and_b32 v253, 0xffff0000, v171
    s_add_u32 m0, s64, 8192
    s_add_u32 s62, s33, 589824
    buffer_load_dwordx4 v232, s[12:15], s62 offen lds
    v_pk_fma_f32 v[250:251], v[250:251], v[224:225], v[226:227] op_sel_hi:[1,0,0] neg_lo:[0,0,1] neg_hi:[0,0,1]
    v_pk_fma_f32 v[252:253], v[252:253], v[224:225], v[226:227] op_sel_hi:[1,0,0] neg_lo:[0,0,1] neg_hi:[0,0,1]
    v_cvt_pk_bf16_f32 v170, v250, v251
    v_cvt_pk_bf16_f32 v171, v252, v253
    ds_write_b128 v254, v[168:171] offset:12288
    v_lshlrev_b32 v250, 16, v172
    v_and_b32 v251, 0xffff0000, v172
    v_lshlrev_b32 v252, 16, v173
    v_and_b32 v253, 0xffff0000, v173
    v_pk_fma_f32 v[250:251], v[250:251], v[224:225], v[226:227] op_sel_hi:[1,0,0] neg_lo:[0,0,1] neg_hi:[0,0,1]
    v_pk_fma_f32 v[252:253], v[252:253], v[224:225], v[226:227] op_sel_hi:[1,0,0] neg_lo:[0,0,1] neg_hi:[0,0,1]
    v_cvt_pk_bf16_f32 v172, v250, v251
    v_cvt_pk_bf16_f32 v173, v252, v253
    s_add_u32 m0, s64, 12288
    s_add_u32 s62, s33, 884736
    buffer_load_dwordx4 v232, s[12:15], s62 offen lds
    v_lshlrev_b32 v250, 16, v174
    v_and_b32 v251, 0xffff0000, v174
    v_lshlrev_b32 v252, 16, v175
    v_and_b32 v253, 0xffff0000, v175
    v_pk_fma_f32 v[250:251], v[250:251], v[224:225], v[226:227] op_sel_hi:[1,0,0] neg_lo:[0,0,1] neg_hi:[0,0,1]
    v_pk_fma_f32 v[252:253], v[252:253], v[224:225], v[226:227] op_sel_hi:[1,0,0] neg_lo:[0,0,1] neg_hi:[0,0,1]
    v_cvt_pk_bf16_f32 v174, v250, v251
    v_cvt_pk_bf16_f32 v175, v252, v253
    ds_write_b128 v254, v[172:175] offset:14336
    v_lshlrev_b32 v250, 16, v176
    v_and_b32 v251, 0xffff0000, v176
    v_lshlrev_b32 v252, 16, v177
    v_and_b32 v253, 0xffff0000, v177
    s_add_u32 m0, s64, 16384
    s_add_u32 s62, s33, 1179648
    buffer_load_dwordx4 v232, s[12:15], s62 offen lds
    v_pk_fma_f32 v[250:251], v[250:251], v[224:225], v[226:227] op_sel_hi:[1,0,0] neg_lo:[0,0,1] neg_hi:[0,0,1]
    v_pk_fma_f32 v[252:253], v[252:253], v[224:225], v[226:227] op_sel_hi:[1,0,0] neg_lo:[0,0,1] neg_hi:[0,0,1]
    v_cvt_pk_bf16_f32 v176, v250, v251
    v_cvt_pk_bf16_f32 v177, v252, v253
    v_lshlrev_b32 v250, 16, v178
    v_and_b32 v251, 0xffff0000, v178
    v_lshlrev_b32 v252, 16, v179
    v_and_b32 v253, 0xffff0000, v179
    v_pk_fma_f32 v[250:251], v[250:251], v[224:225], v[226:227] op_sel_hi:[1,0,0] neg_lo:[0,0,1] neg_hi:[0,0,1]
    v_pk_fma_f32 v[252:253], v[252:253], v[224:225], v[226:227] op_sel_hi:[1,0,0] neg_lo:[0,0,1] neg_hi:[0,0,1]
    v_cvt_pk_bf16_f32 v178, v250, v251
    v_cvt_pk_bf16_f32 v179, v252, v253
    ds_write_b128 v254, v[176:179] offset:16384
    s_add_u32 m0, s64, 20480
    s_add_u32 s62, s33, 1474560
    buffer_load_dwordx4 v232, s[12:15], s62 offen lds
    v_lshlrev_b32 v246, 2, v0
    v_add_u32 v246, 155648, v246
    v_mul_u32_u24 v1, 13108, v0
    v_lshrrev_b32 v1, 16, v1
    v_mul_u32_u24 v2, 5, v1
    v_sub_u32 v2, v0, v2
    v_mul_u32_u24 v1, 9216, v1
    v_lshl_add_u32 v1, v2, 7, v1
    v_mov_b32 v2, 0x7ffffff0
    v_cmp_gt_u32 vcc, 360, v0
    s_and_b32 s36, s28, 7
    s_mul_i32 s36, s36, 663552
    v_cndmask_b32 v244, v2, v1, vcc
    s_add_u32 s36, s36, s33
    v_subrev_u32 v3, 256, v0
    v_mul_u32_u24 v1, 13108, v3
    v_lshrrev_b32 v1, 16, v1
    v_mul_u32_u24 v2, 5, v1
    v_sub_u32 v2, v3, v2
    v_mul_u32_u24 v1, 9216, v1
    v_lshl_add_u32 v1, v2, 7, v1
    v_mov_b32 v2, 0x7ffffff0
    v_cmp_gt_u32 vcc, 360, v3
    s_and_b32 s36, s28, 7
    s_mul_i32 s36, s36, 663552
    v_cndmask_b32 v4, v2, v1, vcc
    s_add_u32 s36, s36, s33
    v_mov_b32 v216, 0
    v_mov_b32 v217, 0
    v_mov_b32 v218, 0
    v_mov_b32 v219, 0
    s_waitcnt vmcnt(15)
    v_dot2c_f32_bf16 v216, s63, v180
    v_dot2c_f32_bf16 v218, v180, v180
    v_dot2c_f32_bf16 v217, s63, v181
    v_dot2c_f32_bf16 v219, v181, v181
    v_dot2c_f32_bf16 v216, s63, v182
    v_dot2c_f32_bf16 v218, v182, v182
    v_dot2c_f32_bf16 v217, s63, v183
    v_dot2c_f32_bf16 v219, v183, v183
    s_waitcnt vmcnt(14)
    v_dot2c_f32_bf16 v216, s63, v184
    v_dot2c_f32_bf16 v218, v184, v184
    v_dot2c_f32_bf16 v217, s63, v185
    v_dot2c_f32_bf16 v219, v185, v185
    v_dot2c_f32_bf16 v216, s63, v186
    v_dot2c_f32_bf16 v218, v186, v186
    s_add_u32 m0, s64, 24576
    s_add_u32 s62, s33, 1769472
    buffer_load_dwordx4 v232, s[12:15], s62 offen lds
    v_dot2c_f32_bf16 v217, s63, v187
    v_dot2c_f32_bf16 v219, v187, v187
    s_waitcnt vmcnt(14)
    v_dot2c_f32_bf16 v216, s63, v188
    v_dot2c_f32_bf16 v218, v188, v188
    v_dot2c_f32_bf16 v217, s63, v189
    v_dot2c_f32_bf16 v219, v189, v189
    v_dot2c_f32_bf16 v216, s63, v190
    v_dot2c_f32_bf16 v218, v190, v190
    v_dot2c_f32_bf16 v217, s63, v191
    v_dot2c_f32_bf16 v219, v191, v191
    s_waitcnt vmcnt(13)
    v_dot2c_f32_bf16 v216, s63, v192
    v_dot2c_f32_bf16 v218, v192, v192
    v_dot2c_f32_bf16 v217, s63, v193
    v_dot2c_f32_bf16 v219, v193, v193
    v_dot2c_f32_bf16 v216, s63, v194
    v_dot2c_f32_bf16 v218, v194, v194
    v_dot2c_f32_bf16 v217, s63, v195
    v_dot2c_f32_bf16 v219, v195, v195
    s_add_u32 m0, s64, 28672
    s_add_u32 s62, s33, 2064384
    buffer_load_dwordx4 v232, s[12:15], s62 offen lds
    s_waitcnt vmcnt(13)
    v_dot2c_f32_bf16 v216, s63, v196
    v_dot2c_f32_bf16 v218, v196, v196
    v_dot2c_f32_bf16 v217, s63, v197
    v_dot2c_f32_bf16 v219, v197, v197
    v_dot2c_f32_bf16 v216, s63, v198
    v_dot2c_f32_bf16 v218, v198, v198
    v_dot2c_f32_bf16 v217, s63, v199
    v_dot2c_f32_bf16 v219, v199, v199
    s_waitcnt vmcnt(12)
    v_dot2c_f32_bf16 v216, s63, v200
    v_dot2c_f32_bf16 v218, v200, v200
    v_dot2c_f32_bf16 v217, s63, v201
    v_dot2c_f32_bf16 v219, v201, v201
    v_dot2c_f32_bf16 v216, s63, v202
    v_dot2c_f32_bf16 v218, v202, v202
    v_dot2c_f32_bf16 v217, s63, v203
    v_dot2c_f32_bf16 v219, v203, v203
    s_waitcnt vmcnt(11)
    v_dot2c_f32_bf16 v216, s63, v204
    v_dot2c_f32_bf16 v218, v204, v204
    s_add_u32 m0, s64, 32768
    s_add_u32 s62, s33, 2359296
    buffer_load_dwordx4 v232, s[12:15], s62 offen lds
    v_dot2c_f32_bf16 v217, s63, v205
    v_dot2c_f32_bf16 v219, v205, v205
    v_dot2c_f32_bf16 v216, s63, v206
    v_dot2c_f32_bf16 v218, v206, v206
    v_dot2c_f32_bf16 v217, s63, v207
    v_dot2c_f32_bf16 v219, v207, v207
    s_waitcnt vmcnt(11)
    v_dot2c_f32_bf16 v216, s63, v208
    v_dot2c_f32_bf16 v218, v208, v208
    v_dot2c_f32_bf16 v217, s63, v209
    v_dot2c_f32_bf16 v219, v209, v209
    v_dot2c_f32_bf16 v216, s63, v210
    v_dot2c_f32_bf16 v218, v210, v210
    v_dot2c_f32_bf16 v217, s63, v211
    v_dot2c_f32_bf16 v219, v211, v211
    s_waitcnt vmcnt(10)
    v_dot2c_f32_bf16 v216, s63, v212
    v_dot2c_f32_bf16 v218, v212, v212
    v_dot2c_f32_bf16 v217, s63, v213
    v_dot2c_f32_bf16 v219, v213, v213
    s_add_u32 m0, s64, 36864
    s_add_u32 s62, s33, 2654208
    buffer_load_dwordx4 v232, s[12:15], s62 offen lds
    v_dot2c_f32_bf16 v216, s63, v214
    v_dot2c_f32_bf16 v218, v214, v214
    v_dot2c_f32_bf16 v217, s63, v215
    v_dot2c_f32_bf16 v219, v215, v215
    s_nop 2
    v_add_f32 v216, v216, v217
    v_add_f32 v218, v218, v219
    s_nop 0
    v_add_f32_dpp v217, v216, v216 quad_perm:[1,0,3,2] row_mask:0xf bank_mask:0xf
    v_add_f32_dpp v219, v218, v218 quad_perm:[1,0,3,2] row_mask:0xf bank_mask:0xf
    s_nop 0
    v_add_f32_dpp v216, v217, v217 quad_perm:[2,3,0,1] row_mask:0xf bank_mask:0xf
    v_add_f32_dpp v218, v219, v219 quad_perm:[2,3,0,1] row_mask:0xf bank_mask:0xf
    s_nop 0
    v_add_f32_dpp v217, v216, v216 row_half_mirror row_mask:0xf bank_mask:0xf
    v_add_f32_dpp v219, v218, v218 row_half_mirror row_mask:0xf bank_mask:0xf
    s_nop 0
    v_mul_f32 v220, 0x3ae38e39, v217
    s_add_u32 m0, s64, 40960
    s_add_u32 s62, s33, 2949120
    buffer_load_dwordx4 v232, s[12:15], s62 offen lds
    v_mul_f32 v221, 0x3ae38e39, v219
    v_fma_f32 v221, -v220, v220, v221
    v_max_f32 v221, 0, v221
    v_cvt_pk_bf16_f32 v222, v220, v221
    v_and_b32 v221, 0xffff0000, v222
    v_lshlrev_b32 v222, 16, v222
    v_add_f32 v221, 0x3727c5ac, v221
    v_cvt_pk_bf16_f32 v221, v221, v221
    v_lshlrev_b32 v221, 16, v221
    v_sqrt_f32 v221, v221
    s_nop 0
    v_cvt_pk_bf16_f32 v221, v221, v221
    v_lshlrev_b32 v221, 16, v221
    v_rcp_f32 v223, v221
    s_nop 0
    v_mul_f32 v224, 0x3fb8aa3b, v223
    v_mul_f32 v226, v222, v224
    s_add_u32 m0, s64, 45056
    s_add_u32 s62, s33, 3244032
    buffer_load_dwordx4 v232, s[12:15], s62 offen lds
    s_waitcnt vmcnt(12)
    v_lshlrev_b32 v247, 16, v247
    v_mul_f32 v247, 0x3fb8aa3b, v247
    ds_write_b32 v246, v247
    s_setprio 0
    v_lshlrev_b32 v250, 16, v180
    v_and_b32 v251, 0xffff0000, v180
    v_lshlrev_b32 v252, 16, v181
    v_and_b32 v253, 0xffff0000, v181
    v_pk_fma_f32 v[250:251], v[250:251], v[224:225], v[226:227] op_sel_hi:[1,0,0] neg_lo:[0,0,1] neg_hi:[0,0,1]
    v_pk_fma_f32 v[252:253], v[252:253], v[224:225], v[226:227] op_sel_hi:[1,0,0] neg_lo:[0,0,1] neg_hi:[0,0,1]
    v_cvt_pk_bf16_f32 v180, v250, v251
    v_cvt_pk_bf16_f32 v181, v252, v253
    v_lshlrev_b32 v250, 16, v182
    v_and_b32 v251, 0xffff0000, v182
    v_lshlrev_b32 v252, 16, v183
    v_and_b32 v253, 0xffff0000, v183
    v_pk_fma_f32 v[250:251], v[250:251], v[224:225], v[226:227] op_sel_hi:[1,0,0] neg_lo:[0,0,1] neg_hi:[0,0,1]
    v_pk_fma_f32 v[252:253], v[252:253], v[224:225], v[226:227] op_sel_hi:[1,0,0] neg_lo:[0,0,1] neg_hi:[0,0,1]
    v_cvt_pk_bf16_f32 v182, v250, v251
    v_cvt_pk_bf16_f32 v183, v252, v253
    v_lshlrev_b32 v250, 16, v184
    v_and_b32 v251, 0xffff0000, v184
    v_lshlrev_b32 v252, 16, v185
    v_and_b32 v253, 0xffff0000, v185
    v_pk_fma_f32 v[250:251], v[250:251], v[224:225], v[226:227] op_sel_hi:[1,0,0] neg_lo:[0,0,1] neg_hi:[0,0,1]
    v_pk_fma_f32 v[252:253], v[252:253], v[224:225], v[226:227] op_sel_hi:[1,0,0] neg_lo:[0,0,1] neg_hi:[0,0,1]
    v_cvt_pk_bf16_f32 v184, v250, v251
    v_cvt_pk_bf16_f32 v185, v252, v253
    s_add_u32 m0, s64, 49152
    s_add_u32 s62, s33, 3538944
    buffer_load_dwordx4 v232, s[12:15], s62 offen lds
    v_lshlrev_b32 v250, 16, v186
    v_and_b32 v251, 0xffff0000, v186
    v_lshlrev_b32 v252, 16, v187
    v_and_b32 v253, 0xffff0000, v187
    v_pk_fma_f32 v[250:251], v[250:251], v[224:225], v[226:227] op_sel_hi:[1,0,0] neg_lo:[0,0,1] neg_hi:[0,0,1]
    v_pk_fma_f32 v[252:253], v[252:253], v[224:225], v[226:227] op_sel_hi:[1,0,0] neg_lo:[0,0,1] neg_hi:[0,0,1]
    v_cvt_pk_bf16_f32 v186, v250, v251
    v_cvt_pk_bf16_f32 v187, v252, v253
    v_lshlrev_b32 v250, 16, v188
    v_and_b32 v251, 0xffff0000, v188
    v_lshlrev_b32 v252, 16, v189
    v_and_b32 v253, 0xffff0000, v189
    v_pk_fma_f32 v[250:251], v[250:251], v[224:225], v[226:227] op_sel_hi:[1,0,0] neg_lo:[0,0,1] neg_hi:[0,0,1]
    v_pk_fma_f32 v[252:253], v[252:253], v[224:225], v[226:227] op_sel_hi:[1,0,0] neg_lo:[0,0,1] neg_hi:[0,0,1]
    v_cvt_pk_bf16_f32 v188, v250, v251
    v_cvt_pk_bf16_f32 v189, v252, v253
    v_lshlrev_b32 v250, 16, v190
    v_and_b32 v251, 0xffff0000, v190
    v_lshlrev_b32 v252, 16, v191
    v_and_b32 v253, 0xffff0000, v191
    v_pk_fma_f32 v[250:251], v[250:251], v[224:225], v[226:227] op_sel_hi:[1,0,0] neg_lo:[0,0,1] neg_hi:[0,0,1]
    v_pk_fma_f32 v[252:253], v[252:253], v[224:225], v[226:227] op_sel_hi:[1,0,0] neg_lo:[0,0,1] neg_hi:[0,0,1]
    v_cvt_pk_bf16_f32 v190, v250, v251
    v_cvt_pk_bf16_f32 v191, v252, v253
    s_add_u32 m0, s64, 53248
    s_add_u32 s62, s33, 3833856
    buffer_load_dwordx4 v232, s[12:15], s62 offen lds
    v_lshlrev_b32 v250, 16, v192
    v_and_b32 v251, 0xffff0000, v192
    v_lshlrev_b32 v252, 16, v193
    v_and_b32 v253, 0xffff0000, v193
    v_pk_fma_f32 v[250:251], v[250:251], v[224:225], v[226:227] op_sel_hi:[1,0,0] neg_lo:[0,0,1] neg_hi:[0,0,1]
    v_pk_fma_f32 v[252:253], v[252:253], v[224:225], v[226:227] op_sel_hi:[1,0,0] neg_lo:[0,0,1] neg_hi:[0,0,1]
    v_cvt_pk_bf16_f32 v192, v250, v251
    v_cvt_pk_bf16_f32 v193, v252, v253
    v_lshlrev_b32 v250, 16, v194
    v_and_b32 v251, 0xffff0000, v194
    v_lshlrev_b32 v252, 16, v195
    v_and_b32 v253, 0xffff0000, v195
    v_pk_fma_f32 v[250:251], v[250:251], v[224:225], v[226:227] op_sel_hi:[1,0,0] neg_lo:[0,0,1] neg_hi:[0,0,1]
    v_pk_fma_f32 v[252:253], v[252:253], v[224:225], v[226:227] op_sel_hi:[1,0,0] neg_lo:[0,0,1] neg_hi:[0,0,1]
    v_cvt_pk_bf16_f32 v194, v250, v251
    v_cvt_pk_bf16_f32 v195, v252, v253
    v_lshlrev_b32 v250, 16, v196
    v_and_b32 v251, 0xffff0000, v196
    v_lshlrev_b32 v252, 16, v197
    v_and_b32 v253, 0xffff0000, v197
    v_pk_fma_f32 v[250:251], v[250:251], v[224:225], v[226:227] op_sel_hi:[1,0,0] neg_lo:[0,0,1] neg_hi:[0,0,1]
    v_pk_fma_f32 v[252:253], v[252:253], v[224:225], v[226:227] op_sel_hi:[1,0,0] neg_lo:[0,0,1] neg_hi:[0,0,1]
    v_cvt_pk_bf16_f32 v196, v250, v251
    v_cvt_pk_bf16_f32 v197, v252, v253
    s_add_u32 m0, s64, 57344
    s_add_u32 s62, s33, 4128768
    buffer_load_dwordx4 v232, s[12:15], s62 offen lds
    v_lshlrev_b32 v250, 16, v198
    v_and_b32 v251, 0xffff0000, v198
    v_lshlrev_b32 v252, 16, v199
    v_and_b32 v253, 0xffff0000, v199
    v_pk_fma_f32 v[250:251], v[250:251], v[224:225], v[226:227] op_sel_hi:[1,0,0] neg_lo:[0,0,1] neg_hi:[0,0,1]
    v_pk_fma_f32 v[252:253], v[252:253], v[224:225], v[226:227] op_sel_hi:[1,0,0] neg_lo:[0,0,1] neg_hi:[0,0,1]
    v_cvt_pk_bf16_f32 v198, v250, v251
    v_cvt_pk_bf16_f32 v199, v252, v253
    v_lshlrev_b32 v250, 16, v200
    v_and_b32 v251, 0xffff0000, v200
    v_lshlrev_b32 v252, 16, v201
    v_and_b32 v253, 0xffff0000, v201
    v_pk_fma_f32 v[250:251], v[250:251], v[224:225], v[226:227] op_sel_hi:[1,0,0] neg_lo:[0,0,1] neg_hi:[0,0,1]
    v_pk_fma_f32 v[252:253], v[252:253], v[224:225], v[226:227] op_sel_hi:[1,0,0] neg_lo:[0,0,1] neg_hi:[0,0,1]
    v_cvt_pk_bf16_f32 v200, v250, v251
    v_cvt_pk_bf16_f32 v201, v252, v253
    v_lshlrev_b32 v250, 16, v202
    v_and_b32 v251, 0xffff0000, v202
    v_lshlrev_b32 v252, 16, v203
    v_and_b32 v253, 0xffff0000, v203
    v_pk_fma_f32 v[250:251], v[250:251], v[224:225], v[226:227] op_sel_hi:[1,0,0] neg_lo:[0,0,1] neg_hi:[0,0,1]
    v_pk_fma_f32 v[252:253], v[252:253], v[224:225], v[226:227] op_sel_hi:[1,0,0] neg_lo:[0,0,1] neg_hi:[0,0,1]
    v_cvt_pk_bf16_f32 v202, v250, v251
    v_cvt_pk_bf16_f32 v203, v252, v253
    s_add_u32 m0, s64, 61440
    s_add_u32 s62, s33, 4423680
    buffer_load_dwordx4 v232, s[12:15], s62 offen lds
    v_lshlrev_b32 v250, 16, v204
    v_and_b32 v251, 0xffff0000, v204
    v_lshlrev_b32 v252, 16, v205
    v_and_b32 v253, 0xffff0000, v205
    v_pk_fma_f32 v[250:251], v[250:251], v[224:225], v[226:227] op_sel_hi:[1,0,0] neg_lo:[0,0,1] neg_hi:[0,0,1]
    v_pk_fma_f32 v[252:253], v[252:253], v[224:225], v[226:227] op_sel_hi:[1,0,0] neg_lo:[0,0,1] neg_hi:[0,0,1]
    v_cvt_pk_bf16_f32 v204, v250, v251
    v_cvt_pk_bf16_f32 v205, v252, v253
    v_lshlrev_b32 v250, 16, v206
    v_and_b32 v251, 0xffff0000, v206
    v_lshlrev_b32 v252, 16, v207
    v_and_b32 v253, 0xffff0000, v207
    v_pk_fma_f32 v[250:251], v[250:251], v[224:225], v[226:227] op_sel_hi:[1,0,0] neg_lo:[0,0,1] neg_hi:[0,0,1]
    v_pk_fma_f32 v[252:253], v[252:253], v[224:225], v[226:227] op_sel_hi:[1,0,0] neg_lo:[0,0,1] neg_hi:[0,0,1]
    v_cvt_pk_bf16_f32 v206, v250, v251
    v_cvt_pk_bf16_f32 v207, v252, v253
    v_lshlrev_b32 v250, 16, v208
    v_and_b32 v251, 0xffff0000, v208
    v_lshlrev_b32 v252, 16, v209
    v_and_b32 v253, 0xffff0000, v209
    v_pk_fma_f32 v[250:251], v[250:251], v[224:225], v[226:227] op_sel_hi:[1,0,0] neg_lo:[0,0,1] neg_hi:[0,0,1]
    v_pk_fma_f32 v[252:253], v[252:253], v[224:225], v[226:227] op_sel_hi:[1,0,0] neg_lo:[0,0,1] neg_hi:[0,0,1]
    v_cvt_pk_bf16_f32 v208, v250, v251
    v_cvt_pk_bf16_f32 v209, v252, v253
    s_add_u32 m0, s64, 65536
    s_add_u32 s62, s33, 4718592
    buffer_load_dwordx4 v232, s[12:15], s62 offen lds
    v_lshlrev_b32 v250, 16, v210
    v_and_b32 v251, 0xffff0000, v210
    v_lshlrev_b32 v252, 16, v211
    v_and_b32 v253, 0xffff0000, v211
    v_pk_fma_f32 v[250:251], v[250:251], v[224:225], v[226:227] op_sel_hi:[1,0,0] neg_lo:[0,0,1] neg_hi:[0,0,1]
    v_pk_fma_f32 v[252:253], v[252:253], v[224:225], v[226:227] op_sel_hi:[1,0,0] neg_lo:[0,0,1] neg_hi:[0,0,1]
    v_cvt_pk_bf16_f32 v210, v250, v251
    v_cvt_pk_bf16_f32 v211, v252, v253
    v_lshlrev_b32 v250, 16, v212
    v_and_b32 v251, 0xffff0000, v212
    v_lshlrev_b32 v252, 16, v213
    v_and_b32 v253, 0xffff0000, v213
    v_pk_fma_f32 v[250:251], v[250:251], v[224:225], v[226:227] op_sel_hi:[1,0,0] neg_lo:[0,0,1] neg_hi:[0,0,1]
    v_pk_fma_f32 v[252:253], v[252:253], v[224:225], v[226:227] op_sel_hi:[1,0,0] neg_lo:[0,0,1] neg_hi:[0,0,1]
    v_cvt_pk_bf16_f32 v212, v250, v251
    v_cvt_pk_bf16_f32 v213, v252, v253
    v_lshlrev_b32 v250, 16, v214
    v_and_b32 v251, 0xffff0000, v214
    v_lshlrev_b32 v252, 16, v215
    v_and_b32 v253, 0xffff0000, v215
    v_pk_fma_f32 v[250:251], v[250:251], v[224:225], v[226:227] op_sel_hi:[1,0,0] neg_lo:[0,0,1] neg_hi:[0,0,1]
    v_pk_fma_f32 v[252:253], v[252:253], v[224:225], v[226:227] op_sel_hi:[1,0,0] neg_lo:[0,0,1] neg_hi:[0,0,1]
    v_cvt_pk_bf16_f32 v214, v250, v251
    v_cvt_pk_bf16_f32 v215, v252, v253
    s_add_u32 m0, s64, 69632
    s_add_u32 s62, s33, 5013504
    buffer_load_dwordx4 v232, s[12:15], s62 offen lds
    buffer_load_dword v234, v4, s[12:15], s36 offen offset:128
    buffer_load_dword v234, v244, s[12:15], s36 offen offset:128
    s_waitcnt lgkmcnt(0)
    s_barrier
    s_setprio 0
    ds_read_b128 v[0:3], v255 offset:0
    ds_read_b128 v[4:7], v248 offset:1024
    ds_read_b128 v[8:11], v255 offset:2048
    ds_read_b128 v[12:15], v248 offset:3072
    ds_read_b128 v[16:19], v255 offset:4096
    ds_read_b128 v[20:23], v248 offset:5120
    ds_read_b128 v[24:27], v255 offset:6144
    ds_read_b128 v[28:31], v248 offset:7168
    ds_read_b128 v[32:35], v255 offset:8192
    ds_read_b128 v[36:39], v248 offset:9216
    ds_read_b128 v[40:43], v255 offset:10240
    ds_read_b128 v[44:47], v248 offset:11264
    ds_read_b128 v[48:51], v255 offset:12288
    ds_read_b128 v[52:55], v248 offset:13312
    ds_read_b128 v[56:59], v255 offset:14336
    s_waitcnt lgkmcnt(14)
    ds_read_b128 v[60:63], v248 offset:15360
    s_waitcnt lgkmcnt(14)
    ds_read_b128 v[64:67], v255 offset:16384
    s_waitcnt lgkmcnt(14)
    ds_read_b128 v[68:71], v248 offset:17408
    s_waitcnt lgkmcnt(0)
    s_barrier
    ds_write_b128 v254, v[180:183] offset:0
    ds_write_b128 v254, v[184:187] offset:2048
    ds_write_b128 v254, v[188:191] offset:4096
    ds_write_b128 v254, v[192:195] offset:6144
    ds_write_b128 v254, v[196:199] offset:8192
    ds_write_b128 v254, v[200:203] offset:10240
    ds_write_b128 v254, v[204:207] offset:12288
    ds_write_b128 v254, v[208:211] offset:14336
    ds_write_b128 v254, v[212:215] offset:16384
    v_add_u32 v243, 0x8000, v235
    s_and_b32 s56, s30, 1
    s_lshl_b32 s56, s56, 12
    s_add_u32 s56, s56, 73728
    v_add_u32 v240, s56, v239
    v_add_u32 v241, 0x8000, v240
    s_waitcnt vmcnt(18) lgkmcnt(0)
    s_barrier
    ds_read_b128 v[72:75], v255 offset:0
    ds_read_b128 v[76:79], v248 offset:1024
    ds_read_b128 v[80:83], v255 offset:2048
    ds_read_b128 v[208:211], v236 offset:0
    ds_read_b128 v[212:215], v236 offset:64
    ds_read_b64_tr_b16 v[176:177], v228 offset:0
    ds_read_b64_tr_b16 v[178:179], v228 offset:512
    ds_read_b64_tr_b16 v[180:181], v229 offset:0
    ds_read_b64_tr_b16 v[182:183], v229 offset:512
    ds_read_b64_tr_b16 v[184:185], v228 offset:4096
    ds_read_b64_tr_b16 v[186:187], v228 offset:4608
    ds_read_b64_tr_b16 v[188:189], v229 offset:4096
    ds_read_b64_tr_b16 v[190:191], v229 offset:4608
    s_waitcnt vmcnt(12) lgkmcnt(0)
    s_barrier
    ds_read_b128 v[84:87], v248 offset:3072
    ds_read_b128 v[88:91], v255 offset:4096
    ds_read_b128 v[92:95], v248 offset:5120
    ds_read_b128 v[96:99], v255 offset:6144
    ds_read_b128 v[100:103], v248 offset:7168
    ds_read_b128 v[104:107], v255 offset:8192
    ds_read_b128 v[108:111], v248 offset:9216
    ds_read_b128 v[112:115], v255 offset:10240
    ds_read_b128 v[116:119], v248 offset:11264
    ds_read_b128 v[120:123], v255 offset:12288
    ds_read_b128 v[124:127], v248 offset:13312
    ds_read_b128 v[128:131], v255 offset:14336
    ds_read_b128 v[132:135], v248 offset:15360
    ds_read_b128 v[136:139], v255 offset:16384
    ds_read_b128 v[140:143], v248 offset:17408
    s_add_u32 m0, s64, 4096
    s_add_u32 s62, s33, 295040
    buffer_load_dwordx4 v232, s[12:15], s62 offen lds
    s_setprio 0
    v_mfma_f32_16x16x32_bf16 v[144:147], v[176:179], v[0:3], v[208:211]
    s_waitcnt lgkmcnt(14)
    ds_read_b64_tr_b16 v[192:193], v228 offset:8192
    s_waitcnt lgkmcnt(14)
    ds_read_b64_tr_b16 v[194:195], v228 offset:8704
    v_mfma_f32_16x16x32_bf16 v[148:151], v[176:179], v[72:75], v[208:211]
    s_waitcnt lgkmcnt(14)
    ds_read_b64_tr_b16 v[196:197], v229 offset:8192
    s_waitcnt lgkmcnt(14)
    ds_read_b64_tr_b16 v[198:199], v229 offset:8704
    v_mfma_f32_16x16x32_bf16 v[152:155], v[180:183], v[0:3], v[212:215]
    s_waitcnt lgkmcnt(14)
    ds_read_b64_tr_b16 v[200:201], v228 offset:12288
    s_waitcnt lgkmcnt(14)
    ds_read_b64_tr_b16 v[202:203], v228 offset:12800
    v_mfma_f32_16x16x32_bf16 v[156:159], v[180:183], v[72:75], v[212:215]
    s_waitcnt lgkmcnt(14)
    ds_read_b64_tr_b16 v[204:205], v229 offset:12288
    v_mfma_f32_16x16x32_bf16 v[144:147], v[184:187], v[4:7], v[144:147]
    s_waitcnt lgkmcnt(14)
    ds_read_b64_tr_b16 v[206:207], v229 offset:12800
    v_mfma_f32_16x16x32_bf16 v[148:151], v[184:187], v[76:79], v[148:151]
    s_waitcnt lgkmcnt(14)
    ds_read_b64_tr_b16 v[176:177], v228 offset:16384
    v_mfma_f32_16x16x32_bf16 v[152:155], v[188:191], v[4:7], v[152:155]
    s_waitcnt lgkmcnt(14)
    ds_read_b64_tr_b16 v[178:179], v228 offset:16896
    v_mfma_f32_16x16x32_bf16 v[156:159], v[188:191], v[76:79], v[156:159]
    s_waitcnt lgkmcnt(14)
    ds_read_b64_tr_b16 v[180:181], v229 offset:16384
    s_waitcnt lgkmcnt(7)
    v_mfma_f32_16x16x32_bf16 v[144:147], v[192:195], v[8:11], v[144:147]
    ds_read_b64_tr_b16 v[182:183], v229 offset:16896
    v_mfma_f32_16x16x32_bf16 v[148:151], v[192:195], v[80:83], v[148:151]
    ds_read_b64_tr_b16 v[184:185], v228 offset:20480
    v_mfma_f32_16x16x32_bf16 v[152:155], v[196:199], v[8:11], v[152:155]
    ds_read_b64_tr_b16 v[186:187], v228 offset:20992
    v_mfma_f32_16x16x32_bf16 v[156:159], v[196:199], v[80:83], v[156:159]
    ds_read_b64_tr_b16 v[188:189], v229 offset:20480
    s_waitcnt lgkmcnt(7)
    v_mfma_f32_16x16x32_bf16 v[144:147], v[200:203], v[12:15], v[144:147]
    s_setprio 1
    ds_read_b64_tr_b16 v[190:191], v229 offset:20992
    v_mfma_f32_16x16x32_bf16 v[148:151], v[200:203], v[84:87], v[148:151]
    ds_read_b64_tr_b16 v[192:193], v228 offset:24576
    v_mfma_f32_16x16x32_bf16 v[152:155], v[204:207], v[12:15], v[152:155]
    ds_read_b64_tr_b16 v[194:195], v228 offset:25088
    v_mfma_f32_16x16x32_bf16 v[156:159], v[204:207], v[84:87], v[156:159]
    ds_read_b64_tr_b16 v[196:197], v229 offset:24576
    s_waitcnt lgkmcnt(7)
    v_mfma_f32_16x16x32_bf16 v[144:147], v[176:179], v[16:19], v[144:147]
    ds_read_b64_tr_b16 v[198:199], v229 offset:25088
    v_mfma_f32_16x16x32_bf16 v[148:151], v[176:179], v[88:91], v[148:151]
    ds_read_b64_tr_b16 v[200:201], v228 offset:28672
    v_mfma_f32_16x16x32_bf16 v[152:155], v[180:183], v[16:19], v[152:155]
    ds_read_b64_tr_b16 v[202:203], v228 offset:29184
    v_mfma_f32_16x16x32_bf16 v[156:159], v[180:183], v[88:91], v[156:159]
    ds_read_b64_tr_b16 v[204:205], v229 offset:28672
    s_waitcnt lgkmcnt(7)
    v_mfma_f32_16x16x32_bf16 v[144:147], v[184:187], v[20:23], v[144:147]
    ds_read_b64_tr_b16 v[206:207], v229 offset:29184
    v_mfma_f32_16x16x32_bf16 v[148:151], v[184:187], v[92:95], v[148:151]
    v_mfma_f32_16x16x32_bf16 v[152:155], v[188:191], v[20:23], v[152:155]
    v_mfma_f32_16x16x32_bf16 v[156:159], v[188:191], v[92:95], v[156:159]
    s_setprio 2
    s_waitcnt vmcnt(7) lgkmcnt(0)
    s_barrier
    s_add_u32 m0, s64, 12288
    s_add_u32 s62, s33, 884864
    buffer_load_dwordx4 v232, s[12:15], s62 offen lds
    s_add_u32 m0, s64, 20480
    s_add_u32 s62, s33, 1474688
    buffer_load_dwordx4 v232, s[12:15], s62 offen lds
    s_add_u32 m0, s64, 28672
    s_add_u32 s62, s33, 2064512
    buffer_load_dwordx4 v232, s[12:15], s62 offen lds
    ds_read_b128 v[208:211], v236 offset:256
    ds_read_b128 v[212:215], v236 offset:320
    v_mov_b32 v216, 0
    buffer_load_dwordx2 v[252:253], v216, s[52:55], 0 offen sc1
    s_setprio 0
    v_mfma_f32_16x16x32_bf16 v[144:147], v[192:195], v[24:27], v[144:147]
    ds_read_b64_tr_b16 v[176:177], v230 offset:0
    ds_read_b64_tr_b16 v[178:179], v230 offset:512
    v_mfma_f32_16x16x32_bf16 v[148:151], v[192:195], v[96:99], v[148:151]
    ds_read_b64_tr_b16 v[180:181], v231 offset:0
    ds_read_b64_tr_b16 v[182:183], v231 offset:512
    v_mfma_f32_16x16x32_bf16 v[152:155], v[196:199], v[24:27], v[152:155]
    ds_read_b64_tr_b16 v[184:185], v230 offset:4096
    ds_read_b64_tr_b16 v[186:187], v230 offset:4608
    v_mfma_f32_16x16x32_bf16 v[156:159], v[196:199], v[96:99], v[156:159]
    ds_read_b64_tr_b16 v[188:189], v231 offset:4096
    v_mfma_f32_16x16x32_bf16 v[144:147], v[200:203], v[28:31], v[144:147]
    ds_read_b64_tr_b16 v[190:191], v231 offset:4608
    v_mfma_f32_16x16x32_bf16 v[148:151], v[200:203], v[100:103], v[148:151]
    ds_read_b64_tr_b16 v[192:193], v230 offset:8192
    v_mfma_f32_16x16x32_bf16 v[152:155], v[204:207], v[28:31], v[152:155]
    ds_read_b64_tr_b16 v[194:195], v230 offset:8704
    v_mfma_f32_16x16x32_bf16 v[156:159], v[204:207], v[100:103], v[156:159]
    ds_read_b64_tr_b16 v[196:197], v231 offset:8192
    s_waitcnt lgkmcnt(7)
    v_mfma_f32_16x16x32_bf16 v[144:147], v[176:179], v[32:35], v[144:147]
    ds_read_b64_tr_b16 v[198:199], v231 offset:8704
    v_mfma_f32_16x16x32_bf16 v[148:151], v[176:179], v[104:107], v[148:151]
    ds_read_b64_tr_b16 v[200:201], v230 offset:12288
    v_mfma_f32_16x16x32_bf16 v[152:155], v[180:183], v[32:35], v[152:155]
    ds_read_b64_tr_b16 v[202:203], v230 offset:12800
    v_mfma_f32_16x16x32_bf16 v[156:159], v[180:183], v[104:107], v[156:159]
    ds_read_b64_tr_b16 v[204:205], v231 offset:12288
    s_waitcnt lgkmcnt(7)
    v_mfma_f32_16x16x32_bf16 v[144:147], v[184:187], v[36:39], v[144:147]
    s_setprio 1
    ds_read_b64_tr_b16 v[206:207], v231 offset:12800
    v_mfma_f32_16x16x32_bf16 v[148:151], v[184:187], v[108:111], v[148:151]
    ds_read_b64_tr_b16 v[176:177], v230 offset:16384
    v_mfma_f32_16x16x32_bf16 v[152:155], v[188:191], v[36:39], v[152:155]
    ds_read_b64_tr_b16 v[178:179], v230 offset:16896
    v_mfma_f32_16x16x32_bf16 v[156:159], v[188:191], v[108:111], v[156:159]
    ds_read_b64_tr_b16 v[180:181], v231 offset:16384
    s_waitcnt lgkmcnt(7)
    v_mfma_f32_16x16x32_bf16 v[144:147], v[192:195], v[40:43], v[144:147]
    ds_read_b64_tr_b16 v[182:183], v231 offset:16896
    v_mfma_f32_16x16x32_bf16 v[148:151], v[192:195], v[112:115], v[148:151]
    ds_read_b64_tr_b16 v[184:185], v230 offset:20480
    v_mfma_f32_16x16x32_bf16 v[152:155], v[196:199], v[40:43], v[152:155]
    ds_read_b64_tr_b16 v[186:187], v230 offset:20992
    v_mfma_f32_16x16x32_bf16 v[156:159], v[196:199], v[112:115], v[156:159]
    ds_read_b64_tr_b16 v[188:189], v231 offset:20480
    s_waitcnt lgkmcnt(7)
    v_mfma_f32_16x16x32_bf16 v[144:147], v[200:203], v[44:47], v[144:147]
    ds_read_b64_tr_b16 v[190:191], v231 offset:20992
    v_mfma_f32_16x16x32_bf16 v[148:151], v[200:203], v[116:119], v[148:151]
    v_mfma_f32_16x16x32_bf16 v[152:155], v[204:207], v[44:47], v[152:155]
    v_mfma_f32_16x16x32_bf16 v[156:159], v[204:207], v[116:119], v[156:159]
    s_setprio 2
    s_waitcnt vmcnt(4) lgkmcnt(0)
    s_barrier
    s_add_u32 m0, s64, 36864
    s_add_u32 s62, s33, 2654336
    buffer_load_dwordx4 v232, s[12:15], s62 offen lds
    s_add_u32 m0, s64, 45056
    s_add_u32 s62, s33, 3244160
    buffer_load_dwordx4 v232, s[12:15], s62 offen lds
    s_add_u32 m0, s64, 53248
    s_add_u32 s62, s33, 3833984
    buffer_load_dwordx4 v232, s[12:15], s62 offen lds
    s_setprio 0
    v_mfma_f32_16x16x32_bf16 v[144:147], v[176:179], v[48:51], v[144:147]
    ds_read_b64_tr_b16 v[192:193], v230 offset:24576
    ds_read_b64_tr_b16 v[194:195], v230 offset:25088
    v_mfma_f32_16x16x32_bf16 v[148:151], v[176:179], v[120:123], v[148:151]
    ds_read_b64_tr_b16 v[196:197], v231 offset:24576
    ds_read_b64_tr_b16 v[198:199], v231 offset:25088
    v_mfma_f32_16x16x32_bf16 v[152:155], v[180:183], v[48:51], v[152:155]
    ds_read_b64_tr_b16 v[200:201], v230 offset:28672
    ds_read_b64_tr_b16 v[202:203], v230 offset:29184
    v_mfma_f32_16x16x32_bf16 v[156:159], v[180:183], v[120:123], v[156:159]
    ds_read_b64_tr_b16 v[204:205], v231 offset:28672
    v_mfma_f32_16x16x32_bf16 v[144:147], v[184:187], v[52:55], v[144:147]
    ds_read_b64_tr_b16 v[206:207], v231 offset:29184
    v_mfma_f32_16x16x32_bf16 v[148:151], v[184:187], v[124:127], v[148:151]
    ds_read_b64_tr_b16 v[176:177], v230 offset:32768
    v_mfma_f32_16x16x32_bf16 v[152:155], v[188:191], v[52:55], v[152:155]
    ds_read_b64_tr_b16 v[178:179], v230 offset:33280
    v_mfma_f32_16x16x32_bf16 v[156:159], v[188:191], v[124:127], v[156:159]
    ds_read_b64_tr_b16 v[180:181], v231 offset:32768
    s_waitcnt lgkmcnt(7)
    v_mfma_f32_16x16x32_bf16 v[144:147], v[192:195], v[56:59], v[144:147]
    ds_read_b64_tr_b16 v[182:183], v231 offset:33280
    v_mfma_f32_16x16x32_bf16 v[148:151], v[192:195], v[128:131], v[148:151]
    ds_read_b64_tr_b16 v[184:185], v230 offset:36864
    v_mfma_f32_16x16x32_bf16 v[152:155], v[196:199], v[56:59], v[152:155]
    ds_read_b64_tr_b16 v[186:187], v230 offset:37376
    v_mfma_f32_16x16x32_bf16 v[156:159], v[196:199], v[128:131], v[156:159]
    ds_read_b64_tr_b16 v[188:189], v231 offset:36864
    s_waitcnt lgkmcnt(7)
    v_mfma_f32_16x16x32_bf16 v[144:147], v[200:203], v[60:63], v[144:147]
    s_setprio 1
    ds_read_b64_tr_b16 v[190:191], v231 offset:37376
    v_mfma_f32_16x16x32_bf16 v[148:151], v[200:203], v[132:135], v[148:151]
    ds_read_b64_tr_b16 v[192:193], v228 offset:0
    v_mfma_f32_16x16x32_bf16 v[152:155], v[204:207], v[60:63], v[152:155]
    ds_read_b64_tr_b16 v[194:195], v228 offset:512
    v_mfma_f32_16x16x32_bf16 v[156:159], v[204:207], v[132:135], v[156:159]
    ds_read_b64_tr_b16 v[196:197], v229 offset:0
    s_waitcnt lgkmcnt(7)
    v_mfma_f32_16x16x32_bf16 v[144:147], v[176:179], v[64:67], v[144:147]
    ds_read_b64_tr_b16 v[198:199], v229 offset:512
    v_mfma_f32_16x16x32_bf16 v[148:151], v[176:179], v[136:139], v[148:151]
    ds_read_b64_tr_b16 v[200:201], v228 offset:4096
    v_mfma_f32_16x16x32_bf16 v[152:155], v[180:183], v[64:67], v[152:155]
    ds_read_b64_tr_b16 v[202:203], v228 offset:4608
    v_mfma_f32_16x16x32_bf16 v[156:159], v[180:183], v[136:139], v[156:159]
    ds_read_b64_tr_b16 v[204:205], v229 offset:4096
    s_waitcnt lgkmcnt(7)
    v_mfma_f32_16x16x32_bf16 v[160:163], v[184:187], v[68:71], v[144:147]
    ds_read_b64_tr_b16 v[206:207], v229 offset:4608
    v_mfma_f32_16x16x32_bf16 v[164:167], v[184:187], v[140:143], v[148:151]
    v_mfma_f32_16x16x32_bf16 v[168:171], v[188:191], v[68:71], v[152:155]
    v_mfma_f32_16x16x32_bf16 v[172:175], v[188:191], v[140:143], v[156:159]
    s_setprio 2
    s_nop 7
    v_exp_f32 v216, v160
    v_exp_f32 v217, v161
    v_exp_f32 v218, v162
    v_exp_f32 v219, v163
    s_waitcnt vmcnt(4) lgkmcnt(0)
    s_barrier
    v_fma_f32 v220, v216, 0.5, 1.0
    v_fma_f32 v221, v217, 0.5, 1.0
    v_fma_f32 v222, v218, 0.5, 1.0
    v_fma_f32 v223, v219, 0.5, 1.0
    v_fma_f32 v220, v216, v220, 1.0
    v_fma_f32 v221, v217, v221, 1.0
    v_fma_f32 v222, v218, v222, 1.0
    v_fma_f32 v223, v219, v223, 1.0
    s_add_u32 m0, s64, 61440
    s_add_u32 s62, s33, 4423808
    buffer_load_dwordx4 v232, s[12:15], s62 offen lds
    v_rcp_f32 v220, v220
    v_rcp_f32 v221, v221
    v_rcp_f32 v222, v222
    v_rcp_f32 v223, v223
    v_fma_f32 v216, -v160, v220, v160
    v_fma_f32 v217, -v161, v221, v161
    v_fma_f32 v218, -v162, v222, v162
    v_fma_f32 v219, -v163, v223, v163
    s_add_u32 m0, s64, 69632
    s_add_u32 s62, s33, 5013632
    buffer_load_dwordx4 v232, s[12:15], s62 offen lds
    v_cvt_pk_bf16_f32 v244, v216, v217
    v_cvt_pk_bf16_f32 v245, v218, v219
    v_exp_f32 v216, v168
    v_exp_f32 v217, v169
    v_exp_f32 v218, v170
    v_exp_f32 v219, v171
    v_fma_f32 v220, v216, 0.5, 1.0
    v_fma_f32 v221, v217, 0.5, 1.0
    s_add_u32 m0, s64, 4096
    s_add_u32 s62, s33, 295168
    buffer_load_dwordx4 v232, s[12:15], s62 offen lds
    s_setprio 0
    v_mfma_f32_16x16x32_bf16 v[144:147], v[192:195], v[0:3], v[208:211]
    ds_read_b64_tr_b16 v[176:177], v228 offset:8192
    ds_read_b64_tr_b16 v[178:179], v228 offset:8704
    v_mfma_f32_16x16x32_bf16 v[148:151], v[192:195], v[72:75], v[208:211]
    ds_read_b64_tr_b16 v[180:181], v229 offset:8192
    ds_read_b64_tr_b16 v[182:183], v229 offset:8704
    v_mfma_f32_16x16x32_bf16 v[152:155], v[196:199], v[0:3], v[212:215]
    ds_read_b64_tr_b16 v[184:185], v228 offset:12288
    ds_read_b64_tr_b16 v[186:187], v228 offset:12800
    v_mfma_f32_16x16x32_bf16 v[156:159], v[196:199], v[72:75], v[212:215]
    ds_read_b64_tr_b16 v[188:189], v229 offset:12288
    v_mfma_f32_16x16x32_bf16 v[144:147], v[200:203], v[4:7], v[144:147]
    ds_read_b64_tr_b16 v[190:191], v229 offset:12800
    v_mfma_f32_16x16x32_bf16 v[148:151], v[200:203], v[76:79], v[148:151]
    ds_read_b64_tr_b16 v[192:193], v228 offset:16384
    v_mfma_f32_16x16x32_bf16 v[152:155], v[204:207], v[4:7], v[152:155]
    ds_read_b64_tr_b16 v[194:195], v228 offset:16896
    v_mfma_f32_16x16x32_bf16 v[156:159], v[204:207], v[76:79], v[156:159]
    ds_read_b64_tr_b16 v[196:197], v229 offset:16384
    s_waitcnt lgkmcnt(7)
    v_mfma_f32_16x16x32_bf16 v[144:147], v[176:179], v[8:11], v[144:147]
    ds_read_b64_tr_b16 v[198:199], v229 offset:16896
    v_mfma_f32_16x16x32_bf16 v[148:151], v[176:179], v[80:83], v[148:151]
    ds_read_b64_tr_b16 v[200:201], v228 offset:20480
    v_mfma_f32_16x16x32_bf16 v[152:155], v[180:183], v[8:11], v[152:155]
    ds_read_b64_tr_b16 v[202:203], v228 offset:20992
    v_mfma_f32_16x16x32_bf16 v[156:159], v[180:183], v[80:83], v[156:159]
    ds_read_b64_tr_b16 v[204:205], v229 offset:20480
    s_waitcnt lgkmcnt(7)
    v_mfma_f32_16x16x32_bf16 v[144:147], v[184:187], v[12:15], v[144:147]
    s_setprio 1
    ds_read_b64_tr_b16 v[206:207], v229 offset:20992
    v_mfma_f32_16x16x32_bf16 v[148:151], v[184:187], v[84:87], v[148:151]
    ds_read_b64_tr_b16 v[176:177], v228 offset:24576
    v_mfma_f32_16x16x32_bf16 v[152:155], v[188:191], v[12:15], v[152:155]
    ds_read_b64_tr_b16 v[178:179], v228 offset:25088
    v_mfma_f32_16x16x32_bf16 v[156:159], v[188:191], v[84:87], v[156:159]
    ds_read_b64_tr_b16 v[180:181], v229 offset:24576
    s_waitcnt lgkmcnt(7)
    v_mfma_f32_16x16x32_bf16 v[144:147], v[192:195], v[16:19], v[144:147]
    ds_read_b64_tr_b16 v[182:183], v229 offset:25088
    v_mfma_f32_16x16x32_bf16 v[148:151], v[192:195], v[88:91], v[148:151]
    ds_read_b64_tr_b16 v[184:185], v228 offset:28672
    v_mfma_f32_16x16x32_bf16 v[152:155], v[196:199], v[16:19], v[152:155]
    ds_read_b64_tr_b16 v[186:187], v228 offset:29184
    v_mfma_f32_16x16x32_bf16 v[156:159], v[196:199], v[88:91], v[156:159]
    ds_read_b64_tr_b16 v[188:189], v229 offset:28672
    s_waitcnt lgkmcnt(7)
    v_mfma_f32_16x16x32_bf16 v[144:147], v[200:203], v[20:23], v[144:147]
    ds_read_b64_tr_b16 v[190:191], v229 offset:29184
    v_mfma_f32_16x16x32_bf16 v[148:151], v[200:203], v[92:95], v[148:151]
    v_mfma_f32_16x16x32_bf16 v[152:155], v[204:207], v[20:23], v[152:155]
    v_mfma_f32_16x16x32_bf16 v[156:159], v[204:207], v[92:95], v[156:159]
    s_setprio 2
    v_fma_f32 v222, v218, 0.5, 1.0
    v_fma_f32 v223, v219, 0.5, 1.0
    v_fma_f32 v220, v216, v220, 1.0
    v_fma_f32 v221, v217, v221, 1.0
    s_waitcnt vmcnt(3) lgkmcnt(0)
    s_barrier
    v_fma_f32 v222, v218, v222, 1.0
    v_fma_f32 v223, v219, v223, 1.0
    v_rcp_f32 v220, v220
    v_rcp_f32 v221, v221
    v_rcp_f32 v222, v222
    v_rcp_f32 v223, v223
    s_add_u32 m0, s64, 12288
    s_add_u32 s62, s33, 884992
    buffer_load_dwordx4 v232, s[12:15], s62 offen lds
    v_fma_f32 v216, -v168, v220, v168
    v_fma_f32 v217, -v169, v221, v169
    v_fma_f32 v218, -v170, v222, v170
    v_fma_f32 v219, -v171, v223, v171
    v_cvt_pk_bf16_f32 v246, v216, v217
    s_add_u32 m0, s64, 20480
    s_add_u32 s62, s33, 1474816
    buffer_load_dwordx4 v232, s[12:15], s62 offen lds
    v_cvt_pk_bf16_f32 v247, v218, v219
    ds_write_b128 v243, v[244:247] offset:32768
    v_exp_f32 v216, v164
    v_exp_f32 v217, v165
    v_exp_f32 v218, v166
    v_exp_f32 v219, v167
    s_add_u32 m0, s64, 28672
    s_add_u32 s62, s33, 2064640
    buffer_load_dwordx4 v232, s[12:15], s62 offen lds
    v_fma_f32 v220, v216, 0.5, 1.0
    v_fma_f32 v221, v217, 0.5, 1.0
    v_fma_f32 v222, v218, 0.5, 1.0
    v_fma_f32 v223, v219, 0.5, 1.0
    v_fma_f32 v220, v216, v220, 1.0
    ds_read_b128 v[208:211], v236 offset:512
    v_fma_f32 v221, v217, v221, 1.0
    v_fma_f32 v222, v218, v222, 1.0
    v_fma_f32 v223, v219, v223, 1.0
    v_rcp_f32 v220, v220
    v_rcp_f32 v221, v221
    ds_read_b128 v[212:215], v236 offset:576
    s_setprio 0
    v_mfma_f32_16x16x32_bf16 v[144:147], v[176:179], v[24:27], v[144:147]
    ds_read_b64_tr_b16 v[192:193], v230 offset:0
    ds_read_b64_tr_b16 v[194:195], v230 offset:512
    v_mfma_f32_16x16x32_bf16 v[148:151], v[176:179], v[96:99], v[148:151]
    ds_read_b64_tr_b16 v[196:197], v231 offset:0
    ds_read_b64_tr_b16 v[198:199], v231 offset:512
    v_mfma_f32_16x16x32_bf16 v[152:155], v[180:183], v[24:27], v[152:155]
    ds_read_b64_tr_b16 v[200:201], v230 offset:4096
    ds_read_b64_tr_b16 v[202:203], v230 offset:4608
    v_mfma_f32_16x16x32_bf16 v[156:159], v[180:183], v[96:99], v[156:159]
    ds_read_b64_tr_b16 v[204:205], v231 offset:4096
    v_mfma_f32_16x16x32_bf16 v[144:147], v[184:187], v[28:31], v[144:147]
    ds_read_b64_tr_b16 v[206:207], v231 offset:4608
    v_mfma_f32_16x16x32_bf16 v[148:151], v[184:187], v[100:103], v[148:151]
    ds_read_b64_tr_b16 v[176:177], v230 offset:8192
    v_mfma_f32_16x16x32_bf16 v[152:155], v[188:191], v[28:31], v[152:155]
    ds_read_b64_tr_b16 v[178:179], v230 offset:8704
    v_mfma_f32_16x16x32_bf16 v[156:159], v[188:191], v[100:103], v[156:159]
    ds_read_b64_tr_b16 v[180:181], v231 offset:8192
    s_waitcnt lgkmcnt(7)
    v_mfma_f32_16x16x32_bf16 v[144:147], v[192:195], v[32:35], v[144:147]
    ds_read_b64_tr_b16 v[182:183], v231 offset:8704
    v_mfma_f32_16x16x32_bf16 v[148:151], v[192:195], v[104:107], v[148:151]
    ds_read_b64_tr_b16 v[184:185], v230 offset:12288
    v_mfma_f32_16x16x32_bf16 v[152:155], v[196:199], v[32:35], v[152:155]
    ds_read_b64_tr_b16 v[186:187], v230 offset:12800
    v_mfma_f32_16x16x32_bf16 v[156:159], v[196:199], v[104:107], v[156:159]
    ds_read_b64_tr_b16 v[188:189], v231 offset:12288
    s_waitcnt lgkmcnt(7)
    v_mfma_f32_16x16x32_bf16 v[144:147], v[200:203], v[36:39], v[144:147]
    s_setprio 1
    ds_read_b64_tr_b16 v[190:191], v231 offset:12800
    v_mfma_f32_16x16x32_bf16 v[148:151], v[200:203], v[108:111], v[148:151]
    ds_read_b64_tr_b16 v[192:193], v230 offset:16384
    v_mfma_f32_16x16x32_bf16 v[152:155], v[204:207], v[36:39], v[152:155]
    ds_read_b64_tr_b16 v[194:195], v230 offset:16896
    v_mfma_f32_16x16x32_bf16 v[156:159], v[204:207], v[108:111], v[156:159]
    ds_read_b64_tr_b16 v[196:197], v231 offset:16384
    s_waitcnt lgkmcnt(7)
    v_mfma_f32_16x16x32_bf16 v[144:147], v[176:179], v[40:43], v[144:147]
    ds_read_b64_tr_b16 v[198:199], v231 offset:16896
    v_mfma_f32_16x16x32_bf16 v[148:151], v[176:179], v[112:115], v[148:151]
    ds_read_b64_tr_b16 v[200:201], v230 offset:20480
    v_mfma_f32_16x16x32_bf16 v[152:155], v[180:183], v[40:43], v[152:155]
    ds_read_b64_tr_b16 v[202:203], v230 offset:20992
    v_mfma_f32_16x16x32_bf16 v[156:159], v[180:183], v[112:115], v[156:159]
    ds_read_b64_tr_b16 v[204:205], v231 offset:20480
    s_waitcnt lgkmcnt(7)
    v_mfma_f32_16x16x32_bf16 v[144:147], v[184:187], v[44:47], v[144:147]
    ds_read_b64_tr_b16 v[206:207], v231 offset:20992
    v_mfma_f32_16x16x32_bf16 v[148:151], v[184:187], v[116:119], v[148:151]
    v_mfma_f32_16x16x32_bf16 v[152:155], v[188:191], v[44:47], v[152:155]
    v_mfma_f32_16x16x32_bf16 v[156:159], v[188:191], v[116:119], v[156:159]
    s_setprio 2
    v_rcp_f32 v222, v222
    v_rcp_f32 v223, v223
    v_fma_f32 v216, -v164, v220, v164
    v_fma_f32 v217, -v165, v221, v165
    s_waitcnt vmcnt(3) lgkmcnt(0)
    s_barrier
    v_fma_f32 v218, -v166, v222, v166
    v_fma_f32 v219, -v167, v223, v167
    v_cvt_pk_bf16_f32 v248, v216, v217
    v_cvt_pk_bf16_f32 v249, v218, v219
    v_exp_f32 v216, v172
    v_exp_f32 v217, v173
    v_exp_f32 v218, v174
    v_exp_f32 v219, v175
    v_fma_f32 v220, v216, 0.5, 1.0
    s_add_u32 m0, s64, 36864
    s_add_u32 s62, s33, 2654464
    buffer_load_dwordx4 v232, s[12:15], s62 offen lds
    v_fma_f32 v221, v217, 0.5, 1.0
    v_fma_f32 v222, v218, 0.5, 1.0
    v_fma_f32 v223, v219, 0.5, 1.0
    v_fma_f32 v220, v216, v220, 1.0
    v_fma_f32 v221, v217, v221, 1.0
    v_fma_f32 v222, v218, v222, 1.0
    v_fma_f32 v223, v219, v223, 1.0
    v_rcp_f32 v220, v220
    v_rcp_f32 v221, v221
    s_add_u32 m0, s64, 45056
    s_add_u32 s62, s33, 3244288
    buffer_load_dwordx4 v232, s[12:15], s62 offen lds
    v_rcp_f32 v222, v222
    v_rcp_f32 v223, v223
    v_fma_f32 v216, -v172, v220, v172
    v_fma_f32 v217, -v173, v221, v173
    v_fma_f32 v218, -v174, v222, v174
    v_fma_f32 v219, -v175, v223, v175
    v_cvt_pk_bf16_f32 v250, v216, v217
    v_cvt_pk_bf16_f32 v251, v218, v219
    ds_write_b128 v243, v[248:251] offset:33792
    s_add_u32 m0, s64, 53248
    s_add_u32 s62, s33, 3834112
    buffer_load_dwordx4 v232, s[12:15], s62 offen lds
    s_setprio 0
    v_mfma_f32_16x16x32_bf16 v[144:147], v[192:195], v[48:51], v[144:147]
    ds_read_b64_tr_b16 v[176:177], v230 offset:24576
    ds_read_b64_tr_b16 v[178:179], v230 offset:25088
    v_mfma_f32_16x16x32_bf16 v[148:151], v[192:195], v[120:123], v[148:151]
    ds_read_b64_tr_b16 v[180:181], v231 offset:24576
    ds_read_b64_tr_b16 v[182:183], v231 offset:25088
    v_mfma_f32_16x16x32_bf16 v[152:155], v[196:199], v[48:51], v[152:155]
    ds_read_b64_tr_b16 v[184:185], v230 offset:28672
    ds_read_b64_tr_b16 v[186:187], v230 offset:29184
    v_mfma_f32_16x16x32_bf16 v[156:159], v[196:199], v[120:123], v[156:159]
    ds_read_b64_tr_b16 v[188:189], v231 offset:28672
    v_mfma_f32_16x16x32_bf16 v[144:147], v[200:203], v[52:55], v[144:147]
    ds_read_b64_tr_b16 v[190:191], v231 offset:29184
    v_mfma_f32_16x16x32_bf16 v[148:151], v[200:203], v[124:127], v[148:151]
    ds_read_b64_tr_b16 v[192:193], v230 offset:32768
    v_mfma_f32_16x16x32_bf16 v[152:155], v[204:207], v[52:55], v[152:155]
    ds_read_b64_tr_b16 v[194:195], v230 offset:33280
    v_mfma_f32_16x16x32_bf16 v[156:159], v[204:207], v[124:127], v[156:159]
    ds_read_b64_tr_b16 v[196:197], v231 offset:32768
    s_waitcnt lgkmcnt(7)
    v_mfma_f32_16x16x32_bf16 v[144:147], v[176:179], v[56:59], v[144:147]
    ds_read_b64_tr_b16 v[198:199], v231 offset:33280
    v_mfma_f32_16x16x32_bf16 v[148:151], v[176:179], v[128:131], v[148:151]
    ds_read_b64_tr_b16 v[200:201], v230 offset:36864
    v_mfma_f32_16x16x32_bf16 v[152:155], v[180:183], v[56:59], v[152:155]
    ds_read_b64_tr_b16 v[202:203], v230 offset:37376
    v_mfma_f32_16x16x32_bf16 v[156:159], v[180:183], v[128:131], v[156:159]
    ds_read_b64_tr_b16 v[204:205], v231 offset:36864
    s_waitcnt lgkmcnt(7)
    v_mfma_f32_16x16x32_bf16 v[144:147], v[184:187], v[60:63], v[144:147]
    s_setprio 1
    ds_read_b64_tr_b16 v[206:207], v231 offset:37376
    v_mfma_f32_16x16x32_bf16 v[148:151], v[184:187], v[132:135], v[148:151]
    ds_read_b64_tr_b16 v[176:177], v228 offset:0
    v_mfma_f32_16x16x32_bf16 v[152:155], v[188:191], v[60:63], v[152:155]
    ds_read_b64_tr_b16 v[178:179], v228 offset:512
    v_mfma_f32_16x16x32_bf16 v[156:159], v[188:191], v[132:135], v[156:159]
    ds_read_b64_tr_b16 v[180:181], v229 offset:0
    s_waitcnt lgkmcnt(7)
    v_mfma_f32_16x16x32_bf16 v[144:147], v[192:195], v[64:67], v[144:147]
    ds_read_b64_tr_b16 v[182:183], v229 offset:512
    v_mfma_f32_16x16x32_bf16 v[148:151], v[192:195], v[136:139], v[148:151]
    ds_read_b64_tr_b16 v[184:185], v228 offset:4096
    v_mfma_f32_16x16x32_bf16 v[152:155], v[196:199], v[64:67], v[152:155]
    ds_read_b64_tr_b16 v[186:187], v228 offset:4608
    v_mfma_f32_16x16x32_bf16 v[156:159], v[196:199], v[136:139], v[156:159]
    ds_read_b64_tr_b16 v[188:189], v229 offset:4096
    s_waitcnt lgkmcnt(7)
    v_mfma_f32_16x16x32_bf16 v[160:163], v[200:203], v[68:71], v[144:147]
    ds_read_b64_tr_b16 v[190:191], v229 offset:4608
    v_mfma_f32_16x16x32_bf16 v[164:167], v[200:203], v[140:143], v[148:151]
    v_mfma_f32_16x16x32_bf16 v[168:171], v[204:207], v[68:71], v[152:155]
    v_mfma_f32_16x16x32_bf16 v[172:175], v[204:207], v[140:143], v[156:159]
    s_setprio 2
    s_nop 7
    v_exp_f32 v216, v160
    v_exp_f32 v217, v161
    v_exp_f32 v218, v162
    v_exp_f32 v219, v163
    s_waitcnt vmcnt(3) lgkmcnt(0)
    s_barrier
    v_fma_f32 v220, v216, 0.5, 1.0
    v_fma_f32 v221, v217, 0.5, 1.0
    v_fma_f32 v222, v218, 0.5, 1.0
    v_fma_f32 v223, v219, 0.5, 1.0
    v_fma_f32 v220, v216, v220, 1.0
    v_fma_f32 v221, v217, v221, 1.0
    v_fma_f32 v222, v218, v222, 1.0
    v_fma_f32 v223, v219, v223, 1.0
    s_add_u32 m0, s64, 61440
    s_add_u32 s62, s33, 4423936
    buffer_load_dwordx4 v232, s[12:15], s62 offen lds
    v_rcp_f32 v220, v220
    v_rcp_f32 v221, v221
    v_rcp_f32 v222, v222
    v_rcp_f32 v223, v223
    v_fma_f32 v216, -v160, v220, v160
    v_fma_f32 v217, -v161, v221, v161
    v_fma_f32 v218, -v162, v222, v162
    v_fma_f32 v219, -v163, v223, v163
    s_add_u32 m0, s64, 69632
    s_add_u32 s62, s33, 5013760
    buffer_load_dwordx4 v232, s[12:15], s62 offen lds
    v_cvt_pk_bf16_f32 v244, v216, v217
    v_cvt_pk_bf16_f32 v245, v218, v219
    v_exp_f32 v216, v168
    v_exp_f32 v217, v169
    v_exp_f32 v218, v170
    v_exp_f32 v219, v171
    v_fma_f32 v220, v216, 0.5, 1.0
    v_fma_f32 v221, v217, 0.5, 1.0
    s_add_u32 m0, s64, 4096
    s_add_u32 s62, s33, 295296
    buffer_load_dwordx4 v232, s[12:15], s62 offen lds
    s_setprio 0
    v_mfma_f32_16x16x32_bf16 v[144:147], v[176:179], v[0:3], v[208:211]
    ds_read_b64_tr_b16 v[192:193], v228 offset:8192
    ds_read_b64_tr_b16 v[194:195], v228 offset:8704
    v_mfma_f32_16x16x32_bf16 v[148:151], v[176:179], v[72:75], v[208:211]
    ds_read_b64_tr_b16 v[196:197], v229 offset:8192
    ds_read_b64_tr_b16 v[198:199], v229 offset:8704
    v_mfma_f32_16x16x32_bf16 v[152:155], v[180:183], v[0:3], v[212:215]
    ds_read_b64_tr_b16 v[200:201], v228 offset:12288
    ds_read_b64_tr_b16 v[202:203], v228 offset:12800
    v_mfma_f32_16x16x32_bf16 v[156:159], v[180:183], v[72:75], v[212:215]
    ds_read_b64_tr_b16 v[204:205], v229 offset:12288
    v_mfma_f32_16x16x32_bf16 v[144:147], v[184:187], v[4:7], v[144:147]
    ds_read_b64_tr_b16 v[206:207], v229 offset:12800
    v_mfma_f32_16x16x32_bf16 v[148:151], v[184:187], v[76:79], v[148:151]
    ds_read_b64_tr_b16 v[176:177], v228 offset:16384
    v_mfma_f32_16x16x32_bf16 v[152:155], v[188:191], v[4:7], v[152:155]
    ds_read_b64_tr_b16 v[178:179], v228 offset:16896
    v_mfma_f32_16x16x32_bf16 v[156:159], v[188:191], v[76:79], v[156:159]
    ds_read_b64_tr_b16 v[180:181], v229 offset:16384
    s_waitcnt lgkmcnt(7)
    v_mfma_f32_16x16x32_bf16 v[144:147], v[192:195], v[8:11], v[144:147]
    ds_read_b64_tr_b16 v[182:183], v229 offset:16896
    v_mfma_f32_16x16x32_bf16 v[148:151], v[192:195], v[80:83], v[148:151]
    ds_read_b64_tr_b16 v[184:185], v228 offset:20480
    v_mfma_f32_16x16x32_bf16 v[152:155], v[196:199], v[8:11], v[152:155]
    ds_read_b64_tr_b16 v[186:187], v228 offset:20992
    v_mfma_f32_16x16x32_bf16 v[156:159], v[196:199], v[80:83], v[156:159]
    ds_read_b64_tr_b16 v[188:189], v229 offset:20480
    s_waitcnt lgkmcnt(7)
    v_mfma_f32_16x16x32_bf16 v[144:147], v[200:203], v[12:15], v[144:147]
    s_setprio 1
    ds_read_b64_tr_b16 v[190:191], v229 offset:20992
    v_mfma_f32_16x16x32_bf16 v[148:151], v[200:203], v[84:87], v[148:151]
    ds_read_b64_tr_b16 v[192:193], v228 offset:24576
    v_mfma_f32_16x16x32_bf16 v[152:155], v[204:207], v[12:15], v[152:155]
    ds_read_b64_tr_b16 v[194:195], v228 offset:25088
    v_mfma_f32_16x16x32_bf16 v[156:159], v[204:207], v[84:87], v[156:159]
    ds_read_b64_tr_b16 v[196:197], v229 offset:24576
    s_waitcnt lgkmcnt(7)
    v_mfma_f32_16x16x32_bf16 v[144:147], v[176:179], v[16:19], v[144:147]
    ds_read_b64_tr_b16 v[198:199], v229 offset:25088
    v_mfma_f32_16x16x32_bf16 v[148:151], v[176:179], v[88:91], v[148:151]
    ds_read_b64_tr_b16 v[200:201], v228 offset:28672
    v_mfma_f32_16x16x32_bf16 v[152:155], v[180:183], v[16:19], v[152:155]
    ds_read_b64_tr_b16 v[202:203], v228 offset:29184
    v_mfma_f32_16x16x32_bf16 v[156:159], v[180:183], v[88:91], v[156:159]
    ds_read_b64_tr_b16 v[204:205], v229 offset:28672
    s_waitcnt lgkmcnt(7)
    v_mfma_f32_16x16x32_bf16 v[144:147], v[184:187], v[20:23], v[144:147]
    ds_read_b64_tr_b16 v[206:207], v229 offset:29184
    v_mfma_f32_16x16x32_bf16 v[148:151], v[184:187], v[92:95], v[148:151]
    v_mfma_f32_16x16x32_bf16 v[152:155], v[188:191], v[20:23], v[152:155]
    v_mfma_f32_16x16x32_bf16 v[156:159], v[188:191], v[92:95], v[156:159]
    s_setprio 2
    v_fma_f32 v222, v218, 0.5, 1.0
    v_fma_f32 v223, v219, 0.5, 1.0
    v_fma_f32 v220, v216, v220, 1.0
    v_fma_f32 v221, v217, v221, 1.0
    s_waitcnt vmcnt(3) lgkmcnt(0)
    s_barrier
    v_fma_f32 v222, v218, v222, 1.0
    v_fma_f32 v223, v219, v223, 1.0
    v_rcp_f32 v220, v220
    v_rcp_f32 v221, v221
    v_rcp_f32 v222, v222
    v_rcp_f32 v223, v223
    s_add_u32 m0, s64, 12288
    s_add_u32 s62, s33, 885120
    buffer_load_dwordx4 v232, s[12:15], s62 offen lds
    v_fma_f32 v216, -v168, v220, v168
    v_fma_f32 v217, -v169, v221, v169
    v_fma_f32 v218, -v170, v222, v170
    v_fma_f32 v219, -v171, v223, v171
    v_cvt_pk_bf16_f32 v246, v216, v217
    s_add_u32 m0, s64, 20480
    s_add_u32 s62, s33, 1474944
    buffer_load_dwordx4 v232, s[12:15], s62 offen lds
    v_cvt_pk_bf16_f32 v247, v218, v219
    ds_write_b128 v235, v[244:247] offset:8192
    v_exp_f32 v216, v164
    v_exp_f32 v217, v165
    v_exp_f32 v218, v166
    v_exp_f32 v219, v167
    s_add_u32 m0, s64, 28672
    s_add_u32 s62, s33, 2064768
    buffer_load_dwordx4 v232, s[12:15], s62 offen lds
    v_fma_f32 v220, v216, 0.5, 1.0
    v_fma_f32 v221, v217, 0.5, 1.0
    v_fma_f32 v222, v218, 0.5, 1.0
    v_fma_f32 v223, v219, 0.5, 1.0
    v_fma_f32 v220, v216, v220, 1.0
    ds_read_b128 v[208:211], v236 offset:768
    v_fma_f32 v221, v217, v221, 1.0
    v_fma_f32 v222, v218, v222, 1.0
    v_fma_f32 v223, v219, v223, 1.0
    v_rcp_f32 v220, v220
    v_rcp_f32 v221, v221
    ds_read_b128 v[212:215], v236 offset:832
    s_setprio 0
    v_mfma_f32_16x16x32_bf16 v[144:147], v[192:195], v[24:27], v[144:147]
    ds_read_b64_tr_b16 v[176:177], v230 offset:0
    ds_read_b64_tr_b16 v[178:179], v230 offset:512
    v_mfma_f32_16x16x32_bf16 v[148:151], v[192:195], v[96:99], v[148:151]
    ds_read_b64_tr_b16 v[180:181], v231 offset:0
    ds_read_b64_tr_b16 v[182:183], v231 offset:512
    v_mfma_f32_16x16x32_bf16 v[152:155], v[196:199], v[24:27], v[152:155]
    ds_read_b64_tr_b16 v[184:185], v230 offset:4096
    ds_read_b64_tr_b16 v[186:187], v230 offset:4608
    v_mfma_f32_16x16x32_bf16 v[156:159], v[196:199], v[96:99], v[156:159]
    ds_read_b64_tr_b16 v[188:189], v231 offset:4096
    v_mfma_f32_16x16x32_bf16 v[144:147], v[200:203], v[28:31], v[144:147]
    ds_read_b64_tr_b16 v[190:191], v231 offset:4608
    v_mfma_f32_16x16x32_bf16 v[148:151], v[200:203], v[100:103], v[148:151]
    ds_read_b64_tr_b16 v[192:193], v230 offset:8192
    v_mfma_f32_16x16x32_bf16 v[152:155], v[204:207], v[28:31], v[152:155]
    ds_read_b64_tr_b16 v[194:195], v230 offset:8704
    v_mfma_f32_16x16x32_bf16 v[156:159], v[204:207], v[100:103], v[156:159]
    ds_read_b64_tr_b16 v[196:197], v231 offset:8192
    s_waitcnt lgkmcnt(7)
    v_mfma_f32_16x16x32_bf16 v[144:147], v[176:179], v[32:35], v[144:147]
    ds_read_b64_tr_b16 v[198:199], v231 offset:8704
    v_mfma_f32_16x16x32_bf16 v[148:151], v[176:179], v[104:107], v[148:151]
    ds_read_b64_tr_b16 v[200:201], v230 offset:12288
    v_mfma_f32_16x16x32_bf16 v[152:155], v[180:183], v[32:35], v[152:155]
    ds_read_b64_tr_b16 v[202:203], v230 offset:12800
    v_mfma_f32_16x16x32_bf16 v[156:159], v[180:183], v[104:107], v[156:159]
    ds_read_b64_tr_b16 v[204:205], v231 offset:12288
    s_waitcnt lgkmcnt(7)
    v_mfma_f32_16x16x32_bf16 v[144:147], v[184:187], v[36:39], v[144:147]
    s_setprio 1
    ds_read_b64_tr_b16 v[206:207], v231 offset:12800
    v_mfma_f32_16x16x32_bf16 v[148:151], v[184:187], v[108:111], v[148:151]
    ds_read_b64_tr_b16 v[176:177], v230 offset:16384
    v_mfma_f32_16x16x32_bf16 v[152:155], v[188:191], v[36:39], v[152:155]
    ds_read_b64_tr_b16 v[178:179], v230 offset:16896
    v_mfma_f32_16x16x32_bf16 v[156:159], v[188:191], v[108:111], v[156:159]
    ds_read_b64_tr_b16 v[180:181], v231 offset:16384
    s_waitcnt lgkmcnt(7)
    v_mfma_f32_16x16x32_bf16 v[144:147], v[192:195], v[40:43], v[144:147]
    ds_read_b64_tr_b16 v[182:183], v231 offset:16896
    v_mfma_f32_16x16x32_bf16 v[148:151], v[192:195], v[112:115], v[148:151]
    ds_read_b64_tr_b16 v[184:185], v230 offset:20480
    v_mfma_f32_16x16x32_bf16 v[152:155], v[196:199], v[40:43], v[152:155]
    ds_read_b64_tr_b16 v[186:187], v230 offset:20992
    v_mfma_f32_16x16x32_bf16 v[156:159], v[196:199], v[112:115], v[156:159]
    ds_read_b64_tr_b16 v[188:189], v231 offset:20480
    s_waitcnt lgkmcnt(7)
    v_mfma_f32_16x16x32_bf16 v[144:147], v[200:203], v[44:47], v[144:147]
    ds_read_b64_tr_b16 v[190:191], v231 offset:20992
    v_mfma_f32_16x16x32_bf16 v[148:151], v[200:203], v[116:119], v[148:151]
    v_mfma_f32_16x16x32_bf16 v[152:155], v[204:207], v[44:47], v[152:155]
    v_mfma_f32_16x16x32_bf16 v[156:159], v[204:207], v[116:119], v[156:159]
    s_setprio 2
    v_rcp_f32 v222, v222
    v_rcp_f32 v223, v223
    v_fma_f32 v216, -v164, v220, v164
    v_fma_f32 v217, -v165, v221, v165
    s_waitcnt vmcnt(3) lgkmcnt(0)
    s_barrier
    v_fma_f32 v218, -v166, v222, v166
    v_fma_f32 v219, -v167, v223, v167
    v_cvt_pk_bf16_f32 v248, v216, v217
    v_cvt_pk_bf16_f32 v249, v218, v219
    v_exp_f32 v216, v172
    v_exp_f32 v217, v173
    v_exp_f32 v218, v174
    v_exp_f32 v219, v175
    v_fma_f32 v220, v216, 0.5, 1.0
    s_add_u32 m0, s64, 36864
    s_add_u32 s62, s33, 2654592
    buffer_load_dwordx4 v232, s[12:15], s62 offen lds
    v_fma_f32 v221, v217, 0.5, 1.0
    v_fma_f32 v222, v218, 0.5, 1.0
    v_fma_f32 v223, v219, 0.5, 1.0
    v_fma_f32 v220, v216, v220, 1.0
    v_fma_f32 v221, v217, v221, 1.0
    v_fma_f32 v222, v218, v222, 1.0
    v_fma_f32 v223, v219, v223, 1.0
    v_rcp_f32 v220, v220
    v_rcp_f32 v221, v221
    s_add_u32 m0, s64, 45056
    s_add_u32 s62, s33, 3244416
    buffer_load_dwordx4 v232, s[12:15], s62 offen lds
    v_rcp_f32 v222, v222
    v_rcp_f32 v223, v223
    v_fma_f32 v216, -v172, v220, v172
    v_fma_f32 v217, -v173, v221, v173
    v_fma_f32 v218, -v174, v222, v174
    v_fma_f32 v219, -v175, v223, v175
    v_cvt_pk_bf16_f32 v250, v216, v217
    v_cvt_pk_bf16_f32 v251, v218, v219
    ds_write_b128 v235, v[248:251] offset:9216
    s_add_u32 m0, s64, 53248
    s_add_u32 s62, s33, 3834240
    buffer_load_dwordx4 v232, s[12:15], s62 offen lds
    s_setprio 0
    v_mfma_f32_16x16x32_bf16 v[144:147], v[176:179], v[48:51], v[144:147]
    ds_read_b64_tr_b16 v[192:193], v230 offset:24576
    ds_read_b64_tr_b16 v[194:195], v230 offset:25088
    v_mfma_f32_16x16x32_bf16 v[148:151], v[176:179], v[120:123], v[148:151]
    ds_read_b64_tr_b16 v[196:197], v231 offset:24576
    ds_read_b64_tr_b16 v[198:199], v231 offset:25088
    v_mfma_f32_16x16x32_bf16 v[152:155], v[180:183], v[48:51], v[152:155]
    ds_read_b64_tr_b16 v[200:201], v230 offset:28672
    ds_read_b64_tr_b16 v[202:203], v230 offset:29184
    v_mfma_f32_16x16x32_bf16 v[156:159], v[180:183], v[120:123], v[156:159]
    ds_read_b64_tr_b16 v[204:205], v231 offset:28672
    v_mfma_f32_16x16x32_bf16 v[144:147], v[184:187], v[52:55], v[144:147]
    ds_read_b64_tr_b16 v[206:207], v231 offset:29184
    v_mfma_f32_16x16x32_bf16 v[148:151], v[184:187], v[124:127], v[148:151]
    ds_read_b64_tr_b16 v[176:177], v230 offset:32768
    v_mfma_f32_16x16x32_bf16 v[152:155], v[188:191], v[52:55], v[152:155]
    ds_read_b64_tr_b16 v[178:179], v230 offset:33280
    v_mfma_f32_16x16x32_bf16 v[156:159], v[188:191], v[124:127], v[156:159]
    ds_read_b64_tr_b16 v[180:181], v231 offset:32768
    s_waitcnt lgkmcnt(7)
    v_mfma_f32_16x16x32_bf16 v[144:147], v[192:195], v[56:59], v[144:147]
    ds_read_b64_tr_b16 v[182:183], v231 offset:33280
    v_mfma_f32_16x16x32_bf16 v[148:151], v[192:195], v[128:131], v[148:151]
    ds_read_b64_tr_b16 v[184:185], v230 offset:36864
    v_mfma_f32_16x16x32_bf16 v[152:155], v[196:199], v[56:59], v[152:155]
    ds_read_b64_tr_b16 v[186:187], v230 offset:37376
    v_mfma_f32_16x16x32_bf16 v[156:159], v[196:199], v[128:131], v[156:159]
    ds_read_b64_tr_b16 v[188:189], v231 offset:36864
    s_waitcnt lgkmcnt(7)
    v_mfma_f32_16x16x32_bf16 v[144:147], v[200:203], v[60:63], v[144:147]
    s_setprio 1
    ds_read_b64_tr_b16 v[190:191], v231 offset:37376
    v_mfma_f32_16x16x32_bf16 v[148:151], v[200:203], v[132:135], v[148:151]
    ds_read_b64_tr_b16 v[192:193], v228 offset:0
    v_mfma_f32_16x16x32_bf16 v[152:155], v[204:207], v[60:63], v[152:155]
    ds_read_b64_tr_b16 v[194:195], v228 offset:512
    v_mfma_f32_16x16x32_bf16 v[156:159], v[204:207], v[132:135], v[156:159]
    ds_read_b64_tr_b16 v[196:197], v229 offset:0
    s_waitcnt lgkmcnt(7)
    v_mfma_f32_16x16x32_bf16 v[144:147], v[176:179], v[64:67], v[144:147]
    ds_read_b64_tr_b16 v[198:199], v229 offset:512
    v_mfma_f32_16x16x32_bf16 v[148:151], v[176:179], v[136:139], v[148:151]
    ds_read_b64_tr_b16 v[200:201], v228 offset:4096
    v_mfma_f32_16x16x32_bf16 v[152:155], v[180:183], v[64:67], v[152:155]
    ds_read_b64_tr_b16 v[202:203], v228 offset:4608
    v_mfma_f32_16x16x32_bf16 v[156:159], v[180:183], v[136:139], v[156:159]
    ds_read_b64_tr_b16 v[204:205], v229 offset:4096
    s_waitcnt lgkmcnt(7)
    v_mfma_f32_16x16x32_bf16 v[160:163], v[184:187], v[68:71], v[144:147]
    ds_read_b64_tr_b16 v[206:207], v229 offset:4608
    v_mfma_f32_16x16x32_bf16 v[164:167], v[184:187], v[140:143], v[148:151]
    v_mfma_f32_16x16x32_bf16 v[168:171], v[188:191], v[68:71], v[152:155]
    v_mfma_f32_16x16x32_bf16 v[172:175], v[188:191], v[140:143], v[156:159]
    s_setprio 2
    s_nop 7
    v_exp_f32 v216, v160
    v_exp_f32 v217, v161
    v_exp_f32 v218, v162
    v_exp_f32 v219, v163
    s_waitcnt vmcnt(3) lgkmcnt(0)
    s_barrier
    v_fma_f32 v220, v216, 0.5, 1.0
    v_fma_f32 v221, v217, 0.5, 1.0
    v_fma_f32 v222, v218, 0.5, 1.0
    v_fma_f32 v223, v219, 0.5, 1.0
    v_fma_f32 v220, v216, v220, 1.0
    v_fma_f32 v221, v217, v221, 1.0
    v_fma_f32 v222, v218, v222, 1.0
    v_fma_f32 v223, v219, v223, 1.0
    s_add_u32 m0, s64, 61440
    s_add_u32 s62, s33, 4424064
    buffer_load_dwordx4 v232, s[12:15], s62 offen lds
    v_rcp_f32 v220, v220
    v_rcp_f32 v221, v221
    v_rcp_f32 v222, v222
    v_rcp_f32 v223, v223
    v_fma_f32 v216, -v160, v220, v160
    v_fma_f32 v217, -v161, v221, v161
    v_fma_f32 v218, -v162, v222, v162
    v_fma_f32 v219, -v163, v223, v163
    s_add_u32 m0, s64, 69632
    s_add_u32 s62, s33, 5013888
    buffer_load_dwordx4 v232, s[12:15], s62 offen lds
    v_cvt_pk_bf16_f32 v244, v216, v217
    v_cvt_pk_bf16_f32 v245, v218, v219
    v_exp_f32 v216, v168
    v_exp_f32 v217, v169
    v_exp_f32 v218, v170
    v_exp_f32 v219, v171
    v_fma_f32 v220, v216, 0.5, 1.0
    v_fma_f32 v221, v217, 0.5, 1.0
    s_add_u32 m0, s64, 4096
    s_add_u32 s62, s33, 295424
    buffer_load_dwordx4 v232, s[12:15], s62 offen lds
    s_setprio 0
    v_mfma_f32_16x16x32_bf16 v[144:147], v[192:195], v[0:3], v[208:211]
    ds_read_b64_tr_b16 v[176:177], v228 offset:8192
    ds_read_b64_tr_b16 v[178:179], v228 offset:8704
    v_mfma_f32_16x16x32_bf16 v[148:151], v[192:195], v[72:75], v[208:211]
    ds_read_b64_tr_b16 v[180:181], v229 offset:8192
    ds_read_b64_tr_b16 v[182:183], v229 offset:8704
    v_mfma_f32_16x16x32_bf16 v[152:155], v[196:199], v[0:3], v[212:215]
    ds_read_b64_tr_b16 v[184:185], v228 offset:12288
    ds_read_b64_tr_b16 v[186:187], v228 offset:12800
    v_mfma_f32_16x16x32_bf16 v[156:159], v[196:199], v[72:75], v[212:215]
    ds_read_b64_tr_b16 v[188:189], v229 offset:12288
    v_mfma_f32_16x16x32_bf16 v[144:147], v[200:203], v[4:7], v[144:147]
    ds_read_b64_tr_b16 v[190:191], v229 offset:12800
    v_mfma_f32_16x16x32_bf16 v[148:151], v[200:203], v[76:79], v[148:151]
    ds_read_b64_tr_b16 v[192:193], v228 offset:16384
    v_mfma_f32_16x16x32_bf16 v[152:155], v[204:207], v[4:7], v[152:155]
    ds_read_b64_tr_b16 v[194:195], v228 offset:16896
    v_mfma_f32_16x16x32_bf16 v[156:159], v[204:207], v[76:79], v[156:159]
    ds_read_b64_tr_b16 v[196:197], v229 offset:16384
    s_waitcnt lgkmcnt(7)
    v_mfma_f32_16x16x32_bf16 v[144:147], v[176:179], v[8:11], v[144:147]
    ds_read_b64_tr_b16 v[198:199], v229 offset:16896
    v_mfma_f32_16x16x32_bf16 v[148:151], v[176:179], v[80:83], v[148:151]
    ds_read_b64_tr_b16 v[200:201], v228 offset:20480
    v_mfma_f32_16x16x32_bf16 v[152:155], v[180:183], v[8:11], v[152:155]
    ds_read_b64_tr_b16 v[202:203], v228 offset:20992
    v_mfma_f32_16x16x32_bf16 v[156:159], v[180:183], v[80:83], v[156:159]
    ds_read_b64_tr_b16 v[204:205], v229 offset:20480
    s_waitcnt lgkmcnt(7)
    v_mfma_f32_16x16x32_bf16 v[144:147], v[184:187], v[12:15], v[144:147]
    s_setprio 1
    ds_read_b64_tr_b16 v[206:207], v229 offset:20992
    v_mfma_f32_16x16x32_bf16 v[148:151], v[184:187], v[84:87], v[148:151]
    ds_read_b64_tr_b16 v[176:177], v228 offset:24576
    v_mfma_f32_16x16x32_bf16 v[152:155], v[188:191], v[12:15], v[152:155]
    ds_read_b64_tr_b16 v[178:179], v228 offset:25088
    v_mfma_f32_16x16x32_bf16 v[156:159], v[188:191], v[84:87], v[156:159]
    ds_read_b64_tr_b16 v[180:181], v229 offset:24576
    s_waitcnt lgkmcnt(7)
    v_mfma_f32_16x16x32_bf16 v[144:147], v[192:195], v[16:19], v[144:147]
    ds_read_b64_tr_b16 v[182:183], v229 offset:25088
    v_mfma_f32_16x16x32_bf16 v[148:151], v[192:195], v[88:91], v[148:151]
    ds_read_b64_tr_b16 v[184:185], v228 offset:28672
    v_mfma_f32_16x16x32_bf16 v[152:155], v[196:199], v[16:19], v[152:155]
    ds_read_b64_tr_b16 v[186:187], v228 offset:29184
    v_mfma_f32_16x16x32_bf16 v[156:159], v[196:199], v[88:91], v[156:159]
    ds_read_b64_tr_b16 v[188:189], v229 offset:28672
    s_waitcnt lgkmcnt(7)
    v_mfma_f32_16x16x32_bf16 v[144:147], v[200:203], v[20:23], v[144:147]
    ds_read_b64_tr_b16 v[190:191], v229 offset:29184
    v_mfma_f32_16x16x32_bf16 v[148:151], v[200:203], v[92:95], v[148:151]
    v_mfma_f32_16x16x32_bf16 v[152:155], v[204:207], v[20:23], v[152:155]
    v_mfma_f32_16x16x32_bf16 v[156:159], v[204:207], v[92:95], v[156:159]
    s_setprio 2
    v_fma_f32 v222, v218, 0.5, 1.0
    v_fma_f32 v223, v219, 0.5, 1.0
    v_fma_f32 v220, v216, v220, 1.0
    v_fma_f32 v221, v217, v221, 1.0
    s_waitcnt vmcnt(3) lgkmcnt(0)
    s_barrier
    v_fma_f32 v222, v218, v222, 1.0
    v_fma_f32 v223, v219, v223, 1.0
    v_rcp_f32 v220, v220
    v_rcp_f32 v221, v221
    v_rcp_f32 v222, v222
    v_rcp_f32 v223, v223
    s_add_u32 m0, s64, 12288
    s_add_u32 s62, s33, 885248
    buffer_load_dwordx4 v232, s[12:15], s62 offen lds
    v_fma_f32 v216, -v168, v220, v168
    v_fma_f32 v217, -v169, v221, v169
    v_fma_f32 v218, -v170, v222, v170
    v_fma_f32 v219, -v171, v223, v171
    v_cvt_pk_bf16_f32 v246, v216, v217
    s_add_u32 m0, s64, 20480
    s_add_u32 s62, s33, 1475072
    buffer_load_dwordx4 v232, s[12:15], s62 offen lds
    v_cvt_pk_bf16_f32 v247, v218, v219
    ds_write_b128 v235, v[244:247] offset:24576
    v_exp_f32 v216, v164
    v_exp_f32 v217, v165
    v_exp_f32 v218, v166
    v_exp_f32 v219, v167
    s_add_u32 m0, s64, 28672
    s_add_u32 s62, s33, 2064896
    buffer_load_dwordx4 v232, s[12:15], s62 offen lds
    v_fma_f32 v220, v216, 0.5, 1.0
    v_fma_f32 v221, v217, 0.5, 1.0
    v_fma_f32 v222, v218, 0.5, 1.0
    v_fma_f32 v223, v219, 0.5, 1.0
    v_fma_f32 v220, v216, v220, 1.0
    ds_read_b128 v[208:211], v236 offset:1024
    v_fma_f32 v221, v217, v221, 1.0
    v_fma_f32 v222, v218, v222, 1.0
    v_fma_f32 v223, v219, v223, 1.0
    v_rcp_f32 v220, v220
    v_rcp_f32 v221, v221
    ds_read_b128 v[212:215], v236 offset:1088
    s_setprio 0
    v_mfma_f32_16x16x32_bf16 v[144:147], v[176:179], v[24:27], v[144:147]
    ds_read_b64_tr_b16 v[192:193], v230 offset:0
    ds_read_b64_tr_b16 v[194:195], v230 offset:512
    v_mfma_f32_16x16x32_bf16 v[148:151], v[176:179], v[96:99], v[148:151]
    ds_read_b64_tr_b16 v[196:197], v231 offset:0
    ds_read_b64_tr_b16 v[198:199], v231 offset:512
    v_mfma_f32_16x16x32_bf16 v[152:155], v[180:183], v[24:27], v[152:155]
    ds_read_b64_tr_b16 v[200:201], v230 offset:4096
    ds_read_b64_tr_b16 v[202:203], v230 offset:4608
    v_mfma_f32_16x16x32_bf16 v[156:159], v[180:183], v[96:99], v[156:159]
    ds_read_b64_tr_b16 v[204:205], v231 offset:4096
    v_mfma_f32_16x16x32_bf16 v[144:147], v[184:187], v[28:31], v[144:147]
    ds_read_b64_tr_b16 v[206:207], v231 offset:4608
    v_mfma_f32_16x16x32_bf16 v[148:151], v[184:187], v[100:103], v[148:151]
    ds_read_b64_tr_b16 v[176:177], v230 offset:8192
    v_mfma_f32_16x16x32_bf16 v[152:155], v[188:191], v[28:31], v[152:155]
    ds_read_b64_tr_b16 v[178:179], v230 offset:8704
    v_mfma_f32_16x16x32_bf16 v[156:159], v[188:191], v[100:103], v[156:159]
    ds_read_b64_tr_b16 v[180:181], v231 offset:8192
    s_waitcnt lgkmcnt(7)
    v_mfma_f32_16x16x32_bf16 v[144:147], v[192:195], v[32:35], v[144:147]
    ds_read_b64_tr_b16 v[182:183], v231 offset:8704
    v_mfma_f32_16x16x32_bf16 v[148:151], v[192:195], v[104:107], v[148:151]
    ds_read_b64_tr_b16 v[184:185], v230 offset:12288
    v_mfma_f32_16x16x32_bf16 v[152:155], v[196:199], v[32:35], v[152:155]
    ds_read_b64_tr_b16 v[186:187], v230 offset:12800
    v_mfma_f32_16x16x32_bf16 v[156:159], v[196:199], v[104:107], v[156:159]
    ds_read_b64_tr_b16 v[188:189], v231 offset:12288
    s_waitcnt lgkmcnt(7)
    v_mfma_f32_16x16x32_bf16 v[144:147], v[200:203], v[36:39], v[144:147]
    s_setprio 1
    ds_read_b64_tr_b16 v[190:191], v231 offset:12800
    v_mfma_f32_16x16x32_bf16 v[148:151], v[200:203], v[108:111], v[148:151]
    ds_read_b64_tr_b16 v[192:193], v230 offset:16384
    v_mfma_f32_16x16x32_bf16 v[152:155], v[204:207], v[36:39], v[152:155]
    ds_read_b64_tr_b16 v[194:195], v230 offset:16896
    v_mfma_f32_16x16x32_bf16 v[156:159], v[204:207], v[108:111], v[156:159]
    ds_read_b64_tr_b16 v[196:197], v231 offset:16384
    s_waitcnt lgkmcnt(7)
    v_mfma_f32_16x16x32_bf16 v[144:147], v[176:179], v[40:43], v[144:147]
    ds_read_b64_tr_b16 v[198:199], v231 offset:16896
    v_mfma_f32_16x16x32_bf16 v[148:151], v[176:179], v[112:115], v[148:151]
    ds_read_b64_tr_b16 v[200:201], v230 offset:20480
    v_mfma_f32_16x16x32_bf16 v[152:155], v[180:183], v[40:43], v[152:155]
    ds_read_b64_tr_b16 v[202:203], v230 offset:20992
    v_mfma_f32_16x16x32_bf16 v[156:159], v[180:183], v[112:115], v[156:159]
    ds_read_b64_tr_b16 v[204:205], v231 offset:20480
    s_waitcnt lgkmcnt(7)
    v_mfma_f32_16x16x32_bf16 v[144:147], v[184:187], v[44:47], v[144:147]
    ds_read_b64_tr_b16 v[206:207], v231 offset:20992
    v_mfma_f32_16x16x32_bf16 v[148:151], v[184:187], v[116:119], v[148:151]
    v_mfma_f32_16x16x32_bf16 v[152:155], v[188:191], v[44:47], v[152:155]
    v_mfma_f32_16x16x32_bf16 v[156:159], v[188:191], v[116:119], v[156:159]
    s_setprio 2
    v_rcp_f32 v222, v222
    v_rcp_f32 v223, v223
    v_fma_f32 v216, -v164, v220, v164
    v_fma_f32 v217, -v165, v221, v165
    s_waitcnt vmcnt(3) lgkmcnt(0)
    s_barrier
    v_fma_f32 v218, -v166, v222, v166
    v_fma_f32 v219, -v167, v223, v167
    v_cvt_pk_bf16_f32 v248, v216, v217
    v_cvt_pk_bf16_f32 v249, v218, v219
    v_exp_f32 v216, v172
    v_exp_f32 v217, v173
    v_exp_f32 v218, v174
    v_exp_f32 v219, v175
    v_fma_f32 v220, v216, 0.5, 1.0
    s_add_u32 m0, s64, 36864
    s_add_u32 s62, s33, 2654720
    buffer_load_dwordx4 v232, s[12:15], s62 offen lds
    v_fma_f32 v221, v217, 0.5, 1.0
    v_fma_f32 v222, v218, 0.5, 1.0
    v_fma_f32 v223, v219, 0.5, 1.0
    v_fma_f32 v220, v216, v220, 1.0
    v_fma_f32 v221, v217, v221, 1.0
    v_fma_f32 v222, v218, v222, 1.0
    v_fma_f32 v223, v219, v223, 1.0
    v_rcp_f32 v220, v220
    v_rcp_f32 v221, v221
    s_add_u32 m0, s64, 45056
    s_add_u32 s62, s33, 3244544
    buffer_load_dwordx4 v232, s[12:15], s62 offen lds
    v_rcp_f32 v222, v222
    v_rcp_f32 v223, v223
    v_fma_f32 v216, -v172, v220, v172
    v_fma_f32 v217, -v173, v221, v173
    v_fma_f32 v218, -v174, v222, v174
    v_fma_f32 v219, -v175, v223, v175
    v_cvt_pk_bf16_f32 v250, v216, v217
    v_cvt_pk_bf16_f32 v251, v218, v219
    ds_write_b128 v235, v[248:251] offset:25600
    s_add_u32 m0, s64, 53248
    s_add_u32 s62, s33, 3834368
    buffer_load_dwordx4 v232, s[12:15], s62 offen lds
    s_setprio 0
    v_mfma_f32_16x16x32_bf16 v[144:147], v[192:195], v[48:51], v[144:147]
    ds_read_b64_tr_b16 v[176:177], v230 offset:24576
    ds_read_b64_tr_b16 v[178:179], v230 offset:25088
    v_mfma_f32_16x16x32_bf16 v[148:151], v[192:195], v[120:123], v[148:151]
    ds_read_b64_tr_b16 v[180:181], v231 offset:24576
    ds_read_b64_tr_b16 v[182:183], v231 offset:25088
    v_mfma_f32_16x16x32_bf16 v[152:155], v[196:199], v[48:51], v[152:155]
    ds_read_b64_tr_b16 v[184:185], v230 offset:28672
    ds_read_b64_tr_b16 v[186:187], v230 offset:29184
    v_mfma_f32_16x16x32_bf16 v[156:159], v[196:199], v[120:123], v[156:159]
    ds_read_b64_tr_b16 v[188:189], v231 offset:28672
    v_mfma_f32_16x16x32_bf16 v[144:147], v[200:203], v[52:55], v[144:147]
    ds_read_b64_tr_b16 v[190:191], v231 offset:29184
    v_mfma_f32_16x16x32_bf16 v[148:151], v[200:203], v[124:127], v[148:151]
    ds_read_b64_tr_b16 v[192:193], v230 offset:32768
    v_mfma_f32_16x16x32_bf16 v[152:155], v[204:207], v[52:55], v[152:155]
    ds_read_b64_tr_b16 v[194:195], v230 offset:33280
    v_mfma_f32_16x16x32_bf16 v[156:159], v[204:207], v[124:127], v[156:159]
    ds_read_b64_tr_b16 v[196:197], v231 offset:32768
    s_waitcnt lgkmcnt(7)
    v_mfma_f32_16x16x32_bf16 v[144:147], v[176:179], v[56:59], v[144:147]
    ds_read_b64_tr_b16 v[198:199], v231 offset:33280
    v_mfma_f32_16x16x32_bf16 v[148:151], v[176:179], v[128:131], v[148:151]
    ds_read_b64_tr_b16 v[200:201], v230 offset:36864
    v_mfma_f32_16x16x32_bf16 v[152:155], v[180:183], v[56:59], v[152:155]
    ds_read_b64_tr_b16 v[202:203], v230 offset:37376
    v_mfma_f32_16x16x32_bf16 v[156:159], v[180:183], v[128:131], v[156:159]
    ds_read_b64_tr_b16 v[204:205], v231 offset:36864
    s_waitcnt lgkmcnt(7)
    v_mfma_f32_16x16x32_bf16 v[144:147], v[184:187], v[60:63], v[144:147]
    s_setprio 1
    ds_read_b64_tr_b16 v[206:207], v231 offset:37376
    v_mfma_f32_16x16x32_bf16 v[148:151], v[184:187], v[132:135], v[148:151]
    ds_read_b64_tr_b16 v[176:177], v228 offset:0
    v_mfma_f32_16x16x32_bf16 v[152:155], v[188:191], v[60:63], v[152:155]
    ds_read_b64_tr_b16 v[178:179], v228 offset:512
    v_mfma_f32_16x16x32_bf16 v[156:159], v[188:191], v[132:135], v[156:159]
    ds_read_b64_tr_b16 v[180:181], v229 offset:0
    s_waitcnt lgkmcnt(7)
    v_mfma_f32_16x16x32_bf16 v[144:147], v[192:195], v[64:67], v[144:147]
    ds_read_b64_tr_b16 v[182:183], v229 offset:512
    v_mfma_f32_16x16x32_bf16 v[148:151], v[192:195], v[136:139], v[148:151]
    ds_read_b64_tr_b16 v[184:185], v228 offset:4096
    v_mfma_f32_16x16x32_bf16 v[152:155], v[196:199], v[64:67], v[152:155]
    ds_read_b64_tr_b16 v[186:187], v228 offset:4608
    v_mfma_f32_16x16x32_bf16 v[156:159], v[196:199], v[136:139], v[156:159]
    ds_read_b64_tr_b16 v[188:189], v229 offset:4096
    s_waitcnt lgkmcnt(7)
    v_mfma_f32_16x16x32_bf16 v[160:163], v[200:203], v[68:71], v[144:147]
    ds_read_b64_tr_b16 v[190:191], v229 offset:4608
    v_mfma_f32_16x16x32_bf16 v[164:167], v[200:203], v[140:143], v[148:151]
    v_mfma_f32_16x16x32_bf16 v[168:171], v[204:207], v[68:71], v[152:155]
    v_mfma_f32_16x16x32_bf16 v[172:175], v[204:207], v[140:143], v[156:159]
    s_setprio 2
    s_nop 7
    v_exp_f32 v216, v160
    v_exp_f32 v217, v161
    v_exp_f32 v218, v162
    v_exp_f32 v219, v163
    s_waitcnt vmcnt(3) lgkmcnt(0)
    s_barrier
    v_fma_f32 v220, v216, 0.5, 1.0
    v_fma_f32 v221, v217, 0.5, 1.0
    v_fma_f32 v222, v218, 0.5, 1.0
    v_fma_f32 v223, v219, 0.5, 1.0
    v_fma_f32 v220, v216, v220, 1.0
    v_fma_f32 v221, v217, v221, 1.0
    v_fma_f32 v222, v218, v222, 1.0
    v_fma_f32 v223, v219, v223, 1.0
    s_add_u32 m0, s64, 61440
    s_add_u32 s62, s33, 4424192
    buffer_load_dwordx4 v232, s[12:15], s62 offen lds
    v_rcp_f32 v220, v220
    v_rcp_f32 v221, v221
    v_rcp_f32 v222, v222
    v_rcp_f32 v223, v223
    v_fma_f32 v216, -v160, v220, v160
    v_fma_f32 v217, -v161, v221, v161
    v_fma_f32 v218, -v162, v222, v162
    v_fma_f32 v219, -v163, v223, v163
    s_add_u32 m0, s64, 69632
    s_add_u32 s62, s33, 5014016
    buffer_load_dwordx4 v232, s[12:15], s62 offen lds
    v_cvt_pk_bf16_f32 v244, v216, v217
    v_cvt_pk_bf16_f32 v245, v218, v219
    v_exp_f32 v216, v168
    v_exp_f32 v217, v169
    v_exp_f32 v218, v170
    v_exp_f32 v219, v171
    v_fma_f32 v220, v216, 0.5, 1.0
    v_fma_f32 v221, v217, 0.5, 1.0
    s_add_u32 m0, s64, 4096
    s_add_u32 s62, s33, 295552
    buffer_load_dwordx4 v232, s[12:15], s62 offen lds
    s_setprio 0
    v_mfma_f32_16x16x32_bf16 v[144:147], v[176:179], v[0:3], v[208:211]
    ds_read_b64_tr_b16 v[192:193], v228 offset:8192
    ds_read_b64_tr_b16 v[194:195], v228 offset:8704
    v_mfma_f32_16x16x32_bf16 v[148:151], v[176:179], v[72:75], v[208:211]
    ds_read_b64_tr_b16 v[196:197], v229 offset:8192
    ds_read_b64_tr_b16 v[198:199], v229 offset:8704
    v_mfma_f32_16x16x32_bf16 v[152:155], v[180:183], v[0:3], v[212:215]
    ds_read_b64_tr_b16 v[200:201], v228 offset:12288
    ds_read_b64_tr_b16 v[202:203], v228 offset:12800
    v_mfma_f32_16x16x32_bf16 v[156:159], v[180:183], v[72:75], v[212:215]
    ds_read_b64_tr_b16 v[204:205], v229 offset:12288
    v_mfma_f32_16x16x32_bf16 v[144:147], v[184:187], v[4:7], v[144:147]
    ds_read_b64_tr_b16 v[206:207], v229 offset:12800
    v_mfma_f32_16x16x32_bf16 v[148:151], v[184:187], v[76:79], v[148:151]
    ds_read_b64_tr_b16 v[176:177], v228 offset:16384
    v_mfma_f32_16x16x32_bf16 v[152:155], v[188:191], v[4:7], v[152:155]
    ds_read_b64_tr_b16 v[178:179], v228 offset:16896
    v_mfma_f32_16x16x32_bf16 v[156:159], v[188:191], v[76:79], v[156:159]
    ds_read_b64_tr_b16 v[180:181], v229 offset:16384
    s_waitcnt lgkmcnt(7)
    v_mfma_f32_16x16x32_bf16 v[144:147], v[192:195], v[8:11], v[144:147]
    ds_read_b64_tr_b16 v[182:183], v229 offset:16896
    v_mfma_f32_16x16x32_bf16 v[148:151], v[192:195], v[80:83], v[148:151]
    ds_read_b64_tr_b16 v[184:185], v228 offset:20480
    v_mfma_f32_16x16x32_bf16 v[152:155], v[196:199], v[8:11], v[152:155]
    ds_read_b64_tr_b16 v[186:187], v228 offset:20992
    v_mfma_f32_16x16x32_bf16 v[156:159], v[196:199], v[80:83], v[156:159]
    ds_read_b64_tr_b16 v[188:189], v229 offset:20480
    s_waitcnt lgkmcnt(7)
    v_mfma_f32_16x16x32_bf16 v[144:147], v[200:203], v[12:15], v[144:147]
    s_setprio 1
    ds_read_b64_tr_b16 v[190:191], v229 offset:20992
    v_mfma_f32_16x16x32_bf16 v[148:151], v[200:203], v[84:87], v[148:151]
    ds_read_b64_tr_b16 v[192:193], v228 offset:24576
    v_mfma_f32_16x16x32_bf16 v[152:155], v[204:207], v[12:15], v[152:155]
    ds_read_b64_tr_b16 v[194:195], v228 offset:25088
    v_mfma_f32_16x16x32_bf16 v[156:159], v[204:207], v[84:87], v[156:159]
    ds_read_b64_tr_b16 v[196:197], v229 offset:24576
    s_waitcnt lgkmcnt(7)
    v_mfma_f32_16x16x32_bf16 v[144:147], v[176:179], v[16:19], v[144:147]
    ds_read_b64_tr_b16 v[198:199], v229 offset:25088
    v_mfma_f32_16x16x32_bf16 v[148:151], v[176:179], v[88:91], v[148:151]
    ds_read_b64_tr_b16 v[200:201], v228 offset:28672
    v_mfma_f32_16x16x32_bf16 v[152:155], v[180:183], v[16:19], v[152:155]
    ds_read_b64_tr_b16 v[202:203], v228 offset:29184
    v_mfma_f32_16x16x32_bf16 v[156:159], v[180:183], v[88:91], v[156:159]
    ds_read_b64_tr_b16 v[204:205], v229 offset:28672
    s_waitcnt lgkmcnt(7)
    v_mfma_f32_16x16x32_bf16 v[144:147], v[184:187], v[20:23], v[144:147]
    ds_read_b64_tr_b16 v[206:207], v229 offset:29184
    v_mfma_f32_16x16x32_bf16 v[148:151], v[184:187], v[92:95], v[148:151]
    v_mfma_f32_16x16x32_bf16 v[152:155], v[188:191], v[20:23], v[152:155]
    v_mfma_f32_16x16x32_bf16 v[156:159], v[188:191], v[92:95], v[156:159]
    s_setprio 2
    v_fma_f32 v222, v218, 0.5, 1.0
    v_fma_f32 v223, v219, 0.5, 1.0
    v_fma_f32 v220, v216, v220, 1.0
    v_fma_f32 v221, v217, v221, 1.0
    s_waitcnt vmcnt(3) lgkmcnt(0)
    s_barrier
    v_fma_f32 v222, v218, v222, 1.0
    v_fma_f32 v223, v219, v223, 1.0
    v_rcp_f32 v220, v220
    v_rcp_f32 v221, v221
    v_rcp_f32 v222, v222
    v_rcp_f32 v223, v223
    s_add_u32 m0, s64, 12288
    s_add_u32 s62, s33, 885376
    buffer_load_dwordx4 v232, s[12:15], s62 offen lds
    v_fma_f32 v216, -v168, v220, v168
    v_fma_f32 v217, -v169, v221, v169
    v_fma_f32 v218, -v170, v222, v170
    v_fma_f32 v219, -v171, v223, v171
    v_cvt_pk_bf16_f32 v246, v216, v217
    s_add_u32 m0, s64, 20480
    s_add_u32 s62, s33, 1475200
    buffer_load_dwordx4 v232, s[12:15], s62 offen lds
    v_cvt_pk_bf16_f32 v247, v218, v219
    ds_write_b128 v243, v[244:247] offset:8192
    v_exp_f32 v216, v164
    v_exp_f32 v217, v165
    v_exp_f32 v218, v166
    v_exp_f32 v219, v167
    s_add_u32 m0, s64, 28672
    s_add_u32 s62, s33, 2065024
    buffer_load_dwordx4 v232, s[12:15], s62 offen lds
    v_fma_f32 v220, v216, 0.5, 1.0
    v_fma_f32 v221, v217, 0.5, 1.0
    v_fma_f32 v222, v218, 0.5, 1.0
    v_fma_f32 v223, v219, 0.5, 1.0
    v_fma_f32 v220, v216, v220, 1.0
    ds_read_b128 v[208:211], v236 offset:1280
    v_fma_f32 v221, v217, v221, 1.0
    v_fma_f32 v222, v218, v222, 1.0
    v_fma_f32 v223, v219, v223, 1.0
    v_rcp_f32 v220, v220
    v_rcp_f32 v221, v221
    ds_read_b128 v[212:215], v236 offset:1344
    s_setprio 0
    v_mfma_f32_16x16x32_bf16 v[144:147], v[192:195], v[24:27], v[144:147]
    ds_read_b64_tr_b16 v[176:177], v230 offset:0
    ds_read_b64_tr_b16 v[178:179], v230 offset:512
    v_mfma_f32_16x16x32_bf16 v[148:151], v[192:195], v[96:99], v[148:151]
    ds_read_b64_tr_b16 v[180:181], v231 offset:0
    ds_read_b64_tr_b16 v[182:183], v231 offset:512
    v_mfma_f32_16x16x32_bf16 v[152:155], v[196:199], v[24:27], v[152:155]
    ds_read_b64_tr_b16 v[184:185], v230 offset:4096
    ds_read_b64_tr_b16 v[186:187], v230 offset:4608
    v_mfma_f32_16x16x32_bf16 v[156:159], v[196:199], v[96:99], v[156:159]
    ds_read_b64_tr_b16 v[188:189], v231 offset:4096
    v_mfma_f32_16x16x32_bf16 v[144:147], v[200:203], v[28:31], v[144:147]
    ds_read_b64_tr_b16 v[190:191], v231 offset:4608
    v_mfma_f32_16x16x32_bf16 v[148:151], v[200:203], v[100:103], v[148:151]
    ds_read_b64_tr_b16 v[192:193], v230 offset:8192
    v_mfma_f32_16x16x32_bf16 v[152:155], v[204:207], v[28:31], v[152:155]
    ds_read_b64_tr_b16 v[194:195], v230 offset:8704
    v_mfma_f32_16x16x32_bf16 v[156:159], v[204:207], v[100:103], v[156:159]
    ds_read_b64_tr_b16 v[196:197], v231 offset:8192
    s_waitcnt lgkmcnt(7)
    v_mfma_f32_16x16x32_bf16 v[144:147], v[176:179], v[32:35], v[144:147]
    ds_read_b64_tr_b16 v[198:199], v231 offset:8704
    v_mfma_f32_16x16x32_bf16 v[148:151], v[176:179], v[104:107], v[148:151]
    ds_read_b64_tr_b16 v[200:201], v230 offset:12288
    v_mfma_f32_16x16x32_bf16 v[152:155], v[180:183], v[32:35], v[152:155]
    ds_read_b64_tr_b16 v[202:203], v230 offset:12800
    v_mfma_f32_16x16x32_bf16 v[156:159], v[180:183], v[104:107], v[156:159]
    ds_read_b64_tr_b16 v[204:205], v231 offset:12288
    s_waitcnt lgkmcnt(7)
    v_mfma_f32_16x16x32_bf16 v[144:147], v[184:187], v[36:39], v[144:147]
    s_setprio 1
    ds_read_b64_tr_b16 v[206:207], v231 offset:12800
    v_mfma_f32_16x16x32_bf16 v[148:151], v[184:187], v[108:111], v[148:151]
    ds_read_b64_tr_b16 v[176:177], v230 offset:16384
    v_mfma_f32_16x16x32_bf16 v[152:155], v[188:191], v[36:39], v[152:155]
    ds_read_b64_tr_b16 v[178:179], v230 offset:16896
    v_mfma_f32_16x16x32_bf16 v[156:159], v[188:191], v[108:111], v[156:159]
    ds_read_b64_tr_b16 v[180:181], v231 offset:16384
    s_waitcnt lgkmcnt(7)
    v_mfma_f32_16x16x32_bf16 v[144:147], v[192:195], v[40:43], v[144:147]
    ds_read_b64_tr_b16 v[182:183], v231 offset:16896
    v_mfma_f32_16x16x32_bf16 v[148:151], v[192:195], v[112:115], v[148:151]
    ds_read_b64_tr_b16 v[184:185], v230 offset:20480
    v_mfma_f32_16x16x32_bf16 v[152:155], v[196:199], v[40:43], v[152:155]
    ds_read_b64_tr_b16 v[186:187], v230 offset:20992
    v_mfma_f32_16x16x32_bf16 v[156:159], v[196:199], v[112:115], v[156:159]
    ds_read_b64_tr_b16 v[188:189], v231 offset:20480
    s_waitcnt lgkmcnt(7)
    v_mfma_f32_16x16x32_bf16 v[144:147], v[200:203], v[44:47], v[144:147]
    ds_read_b64_tr_b16 v[190:191], v231 offset:20992
    v_mfma_f32_16x16x32_bf16 v[148:151], v[200:203], v[116:119], v[148:151]
    v_mfma_f32_16x16x32_bf16 v[152:155], v[204:207], v[44:47], v[152:155]
    v_mfma_f32_16x16x32_bf16 v[156:159], v[204:207], v[116:119], v[156:159]
    s_setprio 2
    v_rcp_f32 v222, v222
    v_rcp_f32 v223, v223
    v_fma_f32 v216, -v164, v220, v164
    v_fma_f32 v217, -v165, v221, v165
    s_waitcnt vmcnt(3) lgkmcnt(0)
    s_barrier
    v_fma_f32 v218, -v166, v222, v166
    v_fma_f32 v219, -v167, v223, v167
    v_cvt_pk_bf16_f32 v248, v216, v217
    v_cvt_pk_bf16_f32 v249, v218, v219
    v_exp_f32 v216, v172
    v_exp_f32 v217, v173
    v_exp_f32 v218, v174
    s_add_u32 m0, s64, 36864
    s_add_u32 s62, s33, 2654848
    buffer_load_dwordx4 v232, s[12:15], s62 offen lds
    v_exp_f32 v219, v175
    v_fma_f32 v220, v216, 0.5, 1.0
    v_fma_f32 v221, v217, 0.5, 1.0
    v_fma_f32 v222, v218, 0.5, 1.0
    v_fma_f32 v223, v219, 0.5, 1.0
    v_fma_f32 v220, v216, v220, 1.0
    v_fma_f32 v221, v217, v221, 1.0
    s_add_u32 m0, s64, 45056
    s_add_u32 s62, s33, 3244672
    buffer_load_dwordx4 v232, s[12:15], s62 offen lds
    v_fma_f32 v222, v218, v222, 1.0
    v_fma_f32 v223, v219, v223, 1.0
    v_rcp_f32 v220, v220
    v_rcp_f32 v221, v221
    v_rcp_f32 v222, v222
    v_rcp_f32 v223, v223
    v_fma_f32 v216, -v172, v220, v172
    s_add_u32 m0, s64, 53248
    s_add_u32 s62, s33, 3834496
    buffer_load_dwordx4 v232, s[12:15], s62 offen lds
    v_fma_f32 v217, -v173, v221, v173
    v_fma_f32 v218, -v174, v222, v174
    v_fma_f32 v219, -v175, v223, v175
    v_cvt_pk_bf16_f32 v250, v216, v217
    v_cvt_pk_bf16_f32 v251, v218, v219
    ds_write_b128 v243, v[248:251] offset:9216
    v_mov_b32 v254, 0x7ffffff0
    v_lshl_add_u32 v242, v239, 3, s35
    v_cmp_gt_u32 vcc, 64, v239
    s_nop 1
    v_cndmask_b32 v242, v254, v242, vcc
    s_lshl_b32 s56, s28, 7
    s_lshl_b32 s57, s29, 3
    s_add_u32 s56, s56, s57
    s_add_u32 s56, s56, 44843008
    s_cmp_eq_u32 s30, 4
    s_cselect_b32 s56, s56, 0x7ffffff0
    v_writelane_b32 v242, s56, 4
    buffer_store_dwordx2 v[252:253], v242, s[20:23], 0 offen sc1
    s_setprio 0
    v_mfma_f32_16x16x32_bf16 v[144:147], v[176:179], v[48:51], v[144:147]
    ds_read_b64_tr_b16 v[192:193], v230 offset:24576
    ds_read_b64_tr_b16 v[194:195], v230 offset:25088
    v_mfma_f32_16x16x32_bf16 v[148:151], v[176:179], v[120:123], v[148:151]
    ds_read_b64_tr_b16 v[196:197], v231 offset:24576
    ds_read_b64_tr_b16 v[198:199], v231 offset:25088
    v_mfma_f32_16x16x32_bf16 v[152:155], v[180:183], v[48:51], v[152:155]
    ds_read_b64_tr_b16 v[200:201], v230 offset:28672
    ds_read_b64_tr_b16 v[202:203], v230 offset:29184
    v_mfma_f32_16x16x32_bf16 v[156:159], v[180:183], v[120:123], v[156:159]
    ds_read_b64_tr_b16 v[204:205], v231 offset:28672
    v_mfma_f32_16x16x32_bf16 v[144:147], v[184:187], v[52:55], v[144:147]
    ds_read_b64_tr_b16 v[206:207], v231 offset:29184
    v_mfma_f32_16x16x32_bf16 v[148:151], v[184:187], v[124:127], v[148:151]
    ds_read_b64_tr_b16 v[176:177], v230 offset:32768
    v_mfma_f32_16x16x32_bf16 v[152:155], v[188:191], v[52:55], v[152:155]
    ds_read_b64_tr_b16 v[178:179], v230 offset:33280
    v_mfma_f32_16x16x32_bf16 v[156:159], v[188:191], v[124:127], v[156:159]
    ds_read_b64_tr_b16 v[180:181], v231 offset:32768
    s_waitcnt lgkmcnt(7)
    v_mfma_f32_16x16x32_bf16 v[144:147], v[192:195], v[56:59], v[144:147]
    ds_read_b64_tr_b16 v[182:183], v231 offset:33280
    v_mfma_f32_16x16x32_bf16 v[148:151], v[192:195], v[128:131], v[148:151]
    ds_read_b64_tr_b16 v[184:185], v230 offset:36864
    v_mfma_f32_16x16x32_bf16 v[152:155], v[196:199], v[56:59], v[152:155]
    ds_read_b64_tr_b16 v[186:187], v230 offset:37376
    v_mfma_f32_16x16x32_bf16 v[156:159], v[196:199], v[128:131], v[156:159]
    ds_read_b64_tr_b16 v[188:189], v231 offset:36864
    s_waitcnt lgkmcnt(7)
    v_mfma_f32_16x16x32_bf16 v[144:147], v[200:203], v[60:63], v[144:147]
    s_setprio 1
    ds_read_b64_tr_b16 v[190:191], v231 offset:37376
    v_mfma_f32_16x16x32_bf16 v[148:151], v[200:203], v[132:135], v[148:151]
    ds_read_b64_tr_b16 v[192:193], v228 offset:0
    v_mfma_f32_16x16x32_bf16 v[152:155], v[204:207], v[60:63], v[152:155]
    ds_read_b64_tr_b16 v[194:195], v228 offset:512
    v_mfma_f32_16x16x32_bf16 v[156:159], v[204:207], v[132:135], v[156:159]
    ds_read_b64_tr_b16 v[196:197], v229 offset:0
    s_waitcnt lgkmcnt(7)
    v_mfma_f32_16x16x32_bf16 v[144:147], v[176:179], v[64:67], v[144:147]
    ds_read_b64_tr_b16 v[198:199], v229 offset:512
    v_mfma_f32_16x16x32_bf16 v[148:151], v[176:179], v[136:139], v[148:151]
    ds_read_b64_tr_b16 v[200:201], v228 offset:4096
    v_mfma_f32_16x16x32_bf16 v[152:155], v[180:183], v[64:67], v[152:155]
    ds_read_b64_tr_b16 v[202:203], v228 offset:4608
    v_mfma_f32_16x16x32_bf16 v[156:159], v[180:183], v[136:139], v[156:159]
    ds_read_b64_tr_b16 v[204:205], v229 offset:4096
    s_waitcnt lgkmcnt(7)
    v_mfma_f32_16x16x32_bf16 v[160:163], v[184:187], v[68:71], v[144:147]
    ds_read_b64_tr_b16 v[206:207], v229 offset:4608
    v_mfma_f32_16x16x32_bf16 v[164:167], v[184:187], v[140:143], v[148:151]
    v_mfma_f32_16x16x32_bf16 v[168:171], v[188:191], v[68:71], v[152:155]
    v_mfma_f32_16x16x32_bf16 v[172:175], v[188:191], v[140:143], v[156:159]
    s_setprio 2
    s_nop 7
    v_exp_f32 v216, v160
    v_exp_f32 v217, v161
    v_exp_f32 v218, v162
    v_exp_f32 v219, v163
    s_waitcnt vmcnt(4) lgkmcnt(0)
    s_barrier
    v_fma_f32 v220, v216, 0.5, 1.0
    v_fma_f32 v221, v217, 0.5, 1.0
    v_fma_f32 v222, v218, 0.5, 1.0
    v_fma_f32 v223, v219, 0.5, 1.0
    v_fma_f32 v220, v216, v220, 1.0
    v_fma_f32 v221, v217, v221, 1.0
    v_fma_f32 v222, v218, v222, 1.0
    v_fma_f32 v223, v219, v223, 1.0
    v_rcp_f32 v220, v220
    v_rcp_f32 v221, v221
    v_rcp_f32 v222, v222
    v_rcp_f32 v223, v223
    s_add_u32 m0, s64, 61440
    s_add_u32 s62, s33, 4424320
    buffer_load_dwordx4 v232, s[12:15], s62 offen lds
    v_fma_f32 v216, -v160, v220, v160
    v_fma_f32 v217, -v161, v221, v161
    v_fma_f32 v218, -v162, v222, v162
    v_fma_f32 v219, -v163, v223, v163
    v_cvt_pk_bf16_f32 v244, v216, v217
    v_cvt_pk_bf16_f32 v245, v218, v219
    v_exp_f32 v216, v168
    v_exp_f32 v217, v169
    v_exp_f32 v218, v170
    v_exp_f32 v219, v171
    v_fma_f32 v220, v216, 0.5, 1.0
    v_fma_f32 v221, v217, 0.5, 1.0
    s_add_u32 m0, s64, 69632
    s_add_u32 s62, s33, 5014144
    buffer_load_dwordx4 v232, s[12:15], s62 offen lds
    s_setprio 0
    v_mfma_f32_16x16x32_bf16 v[144:147], v[192:195], v[0:3], v[208:211]
    ds_read_b64_tr_b16 v[176:177], v228 offset:8192
    ds_read_b64_tr_b16 v[178:179], v228 offset:8704
    v_mfma_f32_16x16x32_bf16 v[148:151], v[192:195], v[72:75], v[208:211]
    ds_read_b64_tr_b16 v[180:181], v229 offset:8192
    ds_read_b64_tr_b16 v[182:183], v229 offset:8704
    v_mfma_f32_16x16x32_bf16 v[152:155], v[196:199], v[0:3], v[212:215]
    ds_read_b64_tr_b16 v[184:185], v228 offset:12288
    ds_read_b64_tr_b16 v[186:187], v228 offset:12800
    v_mfma_f32_16x16x32_bf16 v[156:159], v[196:199], v[72:75], v[212:215]
    ds_read_b64_tr_b16 v[188:189], v229 offset:12288
    v_mfma_f32_16x16x32_bf16 v[144:147], v[200:203], v[4:7], v[144:147]
    ds_read_b64_tr_b16 v[190:191], v229 offset:12800
    v_mfma_f32_16x16x32_bf16 v[148:151], v[200:203], v[76:79], v[148:151]
    ds_read_b64_tr_b16 v[192:193], v228 offset:16384
    v_mfma_f32_16x16x32_bf16 v[152:155], v[204:207], v[4:7], v[152:155]
    ds_read_b64_tr_b16 v[194:195], v228 offset:16896
    v_mfma_f32_16x16x32_bf16 v[156:159], v[204:207], v[76:79], v[156:159]
    ds_read_b64_tr_b16 v[196:197], v229 offset:16384
    s_waitcnt lgkmcnt(7)
    v_mfma_f32_16x16x32_bf16 v[144:147], v[176:179], v[8:11], v[144:147]
    ds_read_b64_tr_b16 v[198:199], v229 offset:16896
    v_mfma_f32_16x16x32_bf16 v[148:151], v[176:179], v[80:83], v[148:151]
    ds_read_b64_tr_b16 v[200:201], v228 offset:20480
    v_mfma_f32_16x16x32_bf16 v[152:155], v[180:183], v[8:11], v[152:155]
    ds_read_b64_tr_b16 v[202:203], v228 offset:20992
    v_mfma_f32_16x16x32_bf16 v[156:159], v[180:183], v[80:83], v[156:159]
    ds_read_b64_tr_b16 v[204:205], v229 offset:20480
    s_waitcnt lgkmcnt(7)
    v_mfma_f32_16x16x32_bf16 v[144:147], v[184:187], v[12:15], v[144:147]
    s_setprio 1
    ds_read_b64_tr_b16 v[206:207], v229 offset:20992
    v_mfma_f32_16x16x32_bf16 v[148:151], v[184:187], v[84:87], v[148:151]
    ds_read_b64_tr_b16 v[176:177], v228 offset:24576
    v_mfma_f32_16x16x32_bf16 v[152:155], v[188:191], v[12:15], v[152:155]
    ds_read_b64_tr_b16 v[178:179], v228 offset:25088
    v_mfma_f32_16x16x32_bf16 v[156:159], v[188:191], v[84:87], v[156:159]
    ds_read_b64_tr_b16 v[180:181], v229 offset:24576
    s_waitcnt lgkmcnt(7)
    v_mfma_f32_16x16x32_bf16 v[144:147], v[192:195], v[16:19], v[144:147]
    ds_read_b64_tr_b16 v[182:183], v229 offset:25088
    v_mfma_f32_16x16x32_bf16 v[148:151], v[192:195], v[88:91], v[148:151]
    ds_read_b64_tr_b16 v[184:185], v228 offset:28672
    v_mfma_f32_16x16x32_bf16 v[152:155], v[196:199], v[16:19], v[152:155]
    ds_read_b64_tr_b16 v[186:187], v228 offset:29184
    v_mfma_f32_16x16x32_bf16 v[156:159], v[196:199], v[88:91], v[156:159]
    ds_read_b64_tr_b16 v[188:189], v229 offset:28672
    s_waitcnt lgkmcnt(7)
    v_mfma_f32_16x16x32_bf16 v[144:147], v[200:203], v[20:23], v[144:147]
    ds_read_b64_tr_b16 v[190:191], v229 offset:29184
    v_mfma_f32_16x16x32_bf16 v[148:151], v[200:203], v[92:95], v[148:151]
    v_mfma_f32_16x16x32_bf16 v[152:155], v[204:207], v[20:23], v[152:155]
    v_mfma_f32_16x16x32_bf16 v[156:159], v[204:207], v[92:95], v[156:159]
    s_setprio 2
    v_fma_f32 v222, v218, 0.5, 1.0
    v_fma_f32 v223, v219, 0.5, 1.0
    v_fma_f32 v220, v216, v220, 1.0
    v_fma_f32 v221, v217, v221, 1.0
    s_waitcnt vmcnt(3) lgkmcnt(0)
    s_barrier
    v_fma_f32 v222, v218, v222, 1.0
    v_fma_f32 v223, v219, v223, 1.0
    v_rcp_f32 v220, v220
    ds_read_b128 v[0:3], v241 offset:24576
    v_rcp_f32 v221, v221
    v_rcp_f32 v222, v222
    ds_read_b128 v[12:15], v241 offset:25600
    v_rcp_f32 v223, v223
    v_fma_f32 v216, -v168, v220, v168
    ds_read_b128 v[72:75], v241 offset:26624
    v_fma_f32 v217, -v169, v221, v169
    v_fma_f32 v218, -v170, v222, v170
    ds_read_b128 v[84:87], v241 offset:27648
    v_fma_f32 v219, -v171, v223, v171
    v_cvt_pk_bf16_f32 v246, v216, v217
    v_cvt_pk_bf16_f32 v247, v218, v219
    ds_read_b128 v[4:7], v241 offset:32768
    ds_write_b128 v243, v[244:247] offset:40960
    v_exp_f32 v216, v164
    ds_read_b128 v[16:19], v241 offset:33792
    v_exp_f32 v217, v165
    v_exp_f32 v218, v166
    ds_read_b128 v[76:79], v241 offset:34816
    v_exp_f32 v219, v167
    v_fma_f32 v220, v216, 0.5, 1.0
    ds_read_b128 v[88:91], v241 offset:35840
    v_fma_f32 v221, v217, 0.5, 1.0
    v_fma_f32 v222, v218, 0.5, 1.0
    v_fma_f32 v223, v219, 0.5, 1.0
    ds_read_b128 v[8:11], v240 offset:0
    v_fma_f32 v220, v216, v220, 1.0
    v_fma_f32 v221, v217, v221, 1.0
    ds_read_b128 v[20:23], v240 offset:1024
    v_fma_f32 v222, v218, v222, 1.0
    v_fma_f32 v223, v219, v223, 1.0
    ds_read_b128 v[80:83], v240 offset:2048
    v_rcp_f32 v220, v220
    v_rcp_f32 v221, v221
    ds_read_b128 v[92:95], v240 offset:3072
    s_setprio 0
    v_mfma_f32_16x16x32_bf16 v[144:147], v[176:179], v[24:27], v[144:147]
    ds_read_b64_tr_b16 v[192:193], v230 offset:0
    ds_read_b64_tr_b16 v[194:195], v230 offset:512
    v_mfma_f32_16x16x32_bf16 v[148:151], v[176:179], v[96:99], v[148:151]
    s_waitcnt lgkmcnt(14)
    ds_read_b64_tr_b16 v[196:197], v231 offset:0
    s_waitcnt lgkmcnt(14)
    ds_read_b64_tr_b16 v[198:199], v231 offset:512
    v_mfma_f32_16x16x32_bf16 v[152:155], v[180:183], v[24:27], v[152:155]
    s_waitcnt lgkmcnt(14)
    ds_read_b64_tr_b16 v[200:201], v230 offset:4096
    s_waitcnt lgkmcnt(14)
    ds_read_b64_tr_b16 v[202:203], v230 offset:4608
    v_mfma_f32_16x16x32_bf16 v[156:159], v[180:183], v[96:99], v[156:159]
    s_waitcnt lgkmcnt(14)
    ds_read_b64_tr_b16 v[204:205], v231 offset:4096
    v_mfma_f32_16x16x32_bf16 v[144:147], v[184:187], v[28:31], v[144:147]
    s_waitcnt lgkmcnt(14)
    ds_read_b64_tr_b16 v[206:207], v231 offset:4608
    v_mfma_f32_16x16x32_bf16 v[148:151], v[184:187], v[100:103], v[148:151]
    s_waitcnt lgkmcnt(14)
    ds_read_b64_tr_b16 v[176:177], v230 offset:8192
    v_mfma_f32_16x16x32_bf16 v[152:155], v[188:191], v[28:31], v[152:155]
    s_waitcnt lgkmcnt(14)
    ds_read_b64_tr_b16 v[178:179], v230 offset:8704
    v_mfma_f32_16x16x32_bf16 v[156:159], v[188:191], v[100:103], v[156:159]
    s_waitcnt lgkmcnt(14)
    ds_read_b64_tr_b16 v[180:181], v231 offset:8192
    s_waitcnt lgkmcnt(7)
    v_mfma_f32_16x16x32_bf16 v[144:147], v[192:195], v[32:35], v[144:147]
    ds_read_b64_tr_b16 v[182:183], v231 offset:8704
    v_mfma_f32_16x16x32_bf16 v[148:151], v[192:195], v[104:107], v[148:151]
    ds_read_b64_tr_b16 v[184:185], v230 offset:12288
    v_mfma_f32_16x16x32_bf16 v[152:155], v[196:199], v[32:35], v[152:155]
    ds_read_b64_tr_b16 v[186:187], v230 offset:12800
    v_mfma_f32_16x16x32_bf16 v[156:159], v[196:199], v[104:107], v[156:159]
    ds_read_b64_tr_b16 v[188:189], v231 offset:12288
    s_waitcnt lgkmcnt(7)
    v_mfma_f32_16x16x32_bf16 v[144:147], v[200:203], v[36:39], v[144:147]
    s_setprio 1
    ds_read_b64_tr_b16 v[190:191], v231 offset:12800
    v_mfma_f32_16x16x32_bf16 v[148:151], v[200:203], v[108:111], v[148:151]
    ds_read_b64_tr_b16 v[192:193], v230 offset:16384
    v_mfma_f32_16x16x32_bf16 v[152:155], v[204:207], v[36:39], v[152:155]
    ds_read_b64_tr_b16 v[194:195], v230 offset:16896
    v_mfma_f32_16x16x32_bf16 v[156:159], v[204:207], v[108:111], v[156:159]
    ds_read_b64_tr_b16 v[196:197], v231 offset:16384
    s_waitcnt lgkmcnt(7)
    v_mfma_f32_16x16x32_bf16 v[144:147], v[176:179], v[40:43], v[144:147]
    ds_read_b64_tr_b16 v[198:199], v231 offset:16896
    v_mfma_f32_16x16x32_bf16 v[148:151], v[176:179], v[112:115], v[148:151]
    ds_read_b64_tr_b16 v[200:201], v230 offset:20480
    v_mfma_f32_16x16x32_bf16 v[152:155], v[180:183], v[40:43], v[152:155]
    ds_read_b64_tr_b16 v[202:203], v230 offset:20992
    v_mfma_f32_16x16x32_bf16 v[156:159], v[180:183], v[112:115], v[156:159]
    ds_read_b64_tr_b16 v[204:205], v231 offset:20480
    s_waitcnt lgkmcnt(7)
    v_mfma_f32_16x16x32_bf16 v[144:147], v[184:187], v[44:47], v[144:147]
    ds_read_b64_tr_b16 v[206:207], v231 offset:20992
    v_mfma_f32_16x16x32_bf16 v[148:151], v[184:187], v[116:119], v[148:151]
    v_mfma_f32_16x16x32_bf16 v[152:155], v[188:191], v[44:47], v[152:155]
    v_mfma_f32_16x16x32_bf16 v[156:159], v[188:191], v[116:119], v[156:159]
    s_setprio 2
    v_rcp_f32 v222, v222
    v_rcp_f32 v223, v223
    v_fma_f32 v216, -v164, v220, v164
    v_fma_f32 v217, -v165, v221, v165
    s_waitcnt vmcnt(0) lgkmcnt(0)
    s_barrier
    v_fma_f32 v218, -v166, v222, v166
    v_fma_f32 v219, -v167, v223, v167
    s_add_u32 m0, s64, 24576
    s_add_u32 s62, s34, 221184
    buffer_load_dwordx4 v233, s[16:19], s62 offen lds
    v_cvt_pk_bf16_f32 v248, v216, v217
    s_add_u32 m0, s64, 28672
    s_add_u32 s62, s34, 258048
    buffer_load_dwordx4 v233, s[16:19], s62 offen lds
    v_cvt_pk_bf16_f32 v249, v218, v219
    v_exp_f32 v216, v172
    s_add_u32 m0, s64, 32768
    s_add_u32 s62, s34, 294912
    buffer_load_dwordx4 v233, s[16:19], s62 offen lds
    v_exp_f32 v217, v173
    s_add_u32 m0, s64, 36864
    s_add_u32 s62, s34, 331776
    buffer_load_dwordx4 v233, s[16:19], s62 offen lds
    v_exp_f32 v218, v174
    v_exp_f32 v219, v175
    s_add_u32 m0, s64, 40960
    s_add_u32 s62, s34, 368640
    buffer_load_dwordx4 v233, s[16:19], s62 offen lds
    v_fma_f32 v220, v216, 0.5, 1.0
    s_add_u32 m0, s64, 45056
    s_add_u32 s62, s34, 405504
    buffer_load_dwordx4 v233, s[16:19], s62 offen lds
    v_fma_f32 v221, v217, 0.5, 1.0
    v_fma_f32 v222, v218, 0.5, 1.0
    ds_read_b128 v[24:27], v240 offset:8192
    v_fma_f32 v223, v219, 0.5, 1.0
    ds_read_b128 v[36:39], v240 offset:9216
    v_fma_f32 v220, v216, v220, 1.0
    v_fma_f32 v221, v217, v221, 1.0
    ds_read_b128 v[96:99], v240 offset:10240
    v_fma_f32 v222, v218, v222, 1.0
    ds_read_b128 v[108:111], v240 offset:11264
    v_fma_f32 v223, v219, v223, 1.0
    v_rcp_f32 v220, v220
    ds_read_b128 v[28:31], v240 offset:16384
    v_rcp_f32 v221, v221
    ds_read_b128 v[40:43], v240 offset:17408
    v_rcp_f32 v222, v222
    v_rcp_f32 v223, v223
    ds_read_b128 v[100:103], v240 offset:18432
    v_fma_f32 v216, -v172, v220, v172
    ds_read_b128 v[112:115], v240 offset:19456
    v_fma_f32 v217, -v173, v221, v173
    v_fma_f32 v218, -v174, v222, v174
    ds_read_b128 v[32:35], v240 offset:24576
    v_fma_f32 v219, -v175, v223, v175
    ds_read_b128 v[44:47], v240 offset:25600
    v_cvt_pk_bf16_f32 v250, v216, v217
    v_cvt_pk_bf16_f32 v251, v218, v219
    ds_read_b128 v[104:107], v240 offset:26624
    ds_write_b128 v243, v[248:251] offset:41984
    ds_read_b128 v[116:119], v240 offset:27648
    s_setprio 0
    v_mfma_f32_16x16x32_bf16 v[144:147], v[192:195], v[48:51], v[144:147]
    ds_read_b64_tr_b16 v[176:177], v230 offset:24576
    v_mfma_f32_16x16x32_bf16 v[148:151], v[192:195], v[120:123], v[148:151]
    ds_read_b64_tr_b16 v[178:179], v230 offset:25088
    v_mfma_f32_16x16x32_bf16 v[152:155], v[196:199], v[48:51], v[152:155]
    s_waitcnt lgkmcnt(14)
    ds_read_b64_tr_b16 v[180:181], v231 offset:24576
    v_mfma_f32_16x16x32_bf16 v[156:159], v[196:199], v[120:123], v[156:159]
    s_waitcnt lgkmcnt(14)
    ds_read_b64_tr_b16 v[182:183], v231 offset:25088
    v_mfma_f32_16x16x32_bf16 v[144:147], v[200:203], v[52:55], v[144:147]
    s_waitcnt lgkmcnt(14)
    ds_read_b64_tr_b16 v[184:185], v230 offset:28672
    v_mfma_f32_16x16x32_bf16 v[148:151], v[200:203], v[124:127], v[148:151]
    s_waitcnt lgkmcnt(14)
    ds_read_b64_tr_b16 v[186:187], v230 offset:29184
    v_mfma_f32_16x16x32_bf16 v[152:155], v[204:207], v[52:55], v[152:155]
    s_waitcnt lgkmcnt(14)
    ds_read_b64_tr_b16 v[188:189], v231 offset:28672
    v_mfma_f32_16x16x32_bf16 v[156:159], v[204:207], v[124:127], v[156:159]
    s_waitcnt lgkmcnt(14)
    ds_read_b64_tr_b16 v[190:191], v231 offset:29184
    s_waitcnt lgkmcnt(4)
    v_mfma_f32_16x16x32_bf16 v[144:147], v[176:179], v[56:59], v[144:147]
    ds_read_b64_tr_b16 v[192:193], v230 offset:32768
    v_mfma_f32_16x16x32_bf16 v[148:151], v[176:179], v[128:131], v[148:151]
    ds_read_b64_tr_b16 v[194:195], v230 offset:33280
    v_mfma_f32_16x16x32_bf16 v[152:155], v[180:183], v[56:59], v[152:155]
    ds_read_b64_tr_b16 v[196:197], v231 offset:32768
    v_mfma_f32_16x16x32_bf16 v[156:159], v[180:183], v[128:131], v[156:159]
    ds_read_b64_tr_b16 v[198:199], v231 offset:33280
    s_waitcnt lgkmcnt(4)
    v_mfma_f32_16x16x32_bf16 v[144:147], v[184:187], v[60:63], v[144:147]
    s_setprio 1
    ds_read_b64_tr_b16 v[200:201], v230 offset:36864
    v_mfma_f32_16x16x32_bf16 v[148:151], v[184:187], v[132:135], v[148:151]
    ds_read_b64_tr_b16 v[202:203], v230 offset:37376
    v_mfma_f32_16x16x32_bf16 v[152:155], v[188:191], v[60:63], v[152:155]
    ds_read_b64_tr_b16 v[204:205], v231 offset:36864
    v_mfma_f32_16x16x32_bf16 v[156:159], v[188:191], v[132:135], v[156:159]
    ds_read_b64_tr_b16 v[206:207], v231 offset:37376
    s_waitcnt lgkmcnt(4)
    v_mfma_f32_16x16x32_bf16 v[144:147], v[192:195], v[64:67], v[144:147]
    v_mfma_f32_16x16x32_bf16 v[148:151], v[192:195], v[136:139], v[148:151]
    v_mfma_f32_16x16x32_bf16 v[152:155], v[196:199], v[64:67], v[152:155]
    v_mfma_f32_16x16x32_bf16 v[156:159], v[196:199], v[136:139], v[156:159]
    s_waitcnt lgkmcnt(0)
    v_mfma_f32_16x16x32_bf16 v[160:163], v[200:203], v[68:71], v[144:147]
    v_mfma_f32_16x16x32_bf16 v[164:167], v[200:203], v[140:143], v[148:151]
    v_mfma_f32_16x16x32_bf16 v[168:171], v[204:207], v[68:71], v[152:155]
    v_mfma_f32_16x16x32_bf16 v[172:175], v[204:207], v[140:143], v[156:159]
    s_setprio 2
    v_add_u32 v228, 49152, v238
    v_add_u32 v229, 98304, v238
    v_mov_b32 v231, 0x7ffffff0
    v_lshl_add_u32 v230, v239, 3, s35
    v_cmp_gt_u32 vcc, 64, v239
    s_nop 1
    v_cndmask_b32 v230, v231, v230, vcc
    v_readfirstlane_b32 s7, v253
    v_readfirstlane_b32 s6, v252
    s_cmp_lg_u32 s7, 0
    s_cbranch_scc1 Ltg_5
    v_mov_b32 v216, 0
Lpolli_6:
    buffer_load_dwordx2 v[252:253], v216, s[52:55], 0 offen sc1
    s_waitcnt vmcnt(0)
    v_readfirstlane_b32 s7, v253
    v_readfirstlane_b32 s6, v252
    s_cmp_lg_u32 s7, 0
    s_cbranch_scc1 Lpdi_7
    s_sleep 8
    s_sub_u32 s5, s5, 1
    s_cbranch_scc0 Lpolli_6
    s_mov_b32 s5, 0
Lpdi_7:
Ltg_5:
    s_nop 3
    v_exp_f32 v216, v160
    v_exp_f32 v217, v161
    v_exp_f32 v218, v162
    v_exp_f32 v219, v163
    v_fma_f32 v220, v216, 0.5, 1.0
    v_fma_f32 v221, v217, 0.5, 1.0
    ds_read_b128 v[48:51], v241 offset:0
    v_fma_f32 v222, v218, 0.5, 1.0
    v_fma_f32 v223, v219, 0.5, 1.0
    v_fma_f32 v220, v216, v220, 1.0
    v_fma_f32 v221, v217, v221, 1.0
    v_fma_f32 v222, v218, v222, 1.0
    v_fma_f32 v223, v219, v223, 1.0
    ds_read_b128 v[60:63], v241 offset:1024
    v_rcp_f32 v220, v220
    v_rcp_f32 v221, v221
    v_rcp_f32 v222, v222
    v_rcp_f32 v223, v223
    v_fma_f32 v216, -v160, v220, v160
    v_fma_f32 v217, -v161, v221, v161
    ds_read_b128 v[120:123], v241 offset:2048
    v_fma_f32 v218, -v162, v222, v162
    v_fma_f32 v219, -v163, v223, v163
    v_cvt_pk_bf16_f32 v244, v216, v217
    v_cvt_pk_bf16_f32 v245, v218, v219
    v_exp_f32 v216, v168
    v_exp_f32 v217, v169
    ds_read_b128 v[132:135], v241 offset:3072
    v_exp_f32 v218, v170
    v_exp_f32 v219, v171
    v_fma_f32 v220, v216, 0.5, 1.0
    v_fma_f32 v221, v217, 0.5, 1.0
    v_fma_f32 v222, v218, 0.5, 1.0
    v_fma_f32 v223, v219, 0.5, 1.0
    ds_read_b128 v[52:55], v241 offset:8192
    v_fma_f32 v220, v216, v220, 1.0
    v_fma_f32 v221, v217, v221, 1.0
    v_fma_f32 v222, v218, v222, 1.0
    v_fma_f32 v223, v219, v223, 1.0
    v_rcp_f32 v220, v220
    ds_read_b128 v[64:67], v241 offset:9216
    v_rcp_f32 v221, v221
    v_rcp_f32 v222, v222
    v_rcp_f32 v223, v223
    v_fma_f32 v216, -v168, v220, v168
    v_fma_f32 v217, -v169, v221, v169
    v_fma_f32 v218, -v170, v222, v170
    ds_read_b128 v[124:127], v241 offset:10240
    v_fma_f32 v219, -v171, v223, v171
    v_cvt_pk_bf16_f32 v246, v216, v217
    v_cvt_pk_bf16_f32 v247, v218, v219
    ds_write_b128 v243, v[244:247] offset:32768
    v_exp_f32 v216, v164
    v_exp_f32 v217, v165
    ds_read_b128 v[136:139], v241 offset:11264
    v_exp_f32 v218, v166
    v_exp_f32 v219, v167
    v_fma_f32 v220, v216, 0.5, 1.0
    v_fma_f32 v221, v217, 0.5, 1.0
    v_fma_f32 v222, v218, 0.5, 1.0
    v_fma_f32 v223, v219, 0.5, 1.0
    ds_read_b128 v[56:59], v241 offset:16384
    v_fma_f32 v220, v216, v220, 1.0
    v_fma_f32 v221, v217, v221, 1.0
    v_fma_f32 v222, v218, v222, 1.0
    v_fma_f32 v223, v219, v223, 1.0
    v_rcp_f32 v220, v220
    v_rcp_f32 v221, v221
    ds_read_b128 v[68:71], v241 offset:17408
    v_rcp_f32 v222, v222
    v_rcp_f32 v223, v223
    v_fma_f32 v216, -v164, v220, v164
    v_fma_f32 v217, -v165, v221, v165
    v_fma_f32 v218, -v166, v222, v166
    v_fma_f32 v219, -v167, v223, v167
    ds_read_b128 v[128:131], v241 offset:18432
    v_cvt_pk_bf16_f32 v248, v216, v217
    v_cvt_pk_bf16_f32 v249, v218, v219
    v_exp_f32 v216, v172
    v_exp_f32 v217, v173
    v_exp_f32 v218, v174
    ds_read_b128 v[140:143], v241 offset:19456
    v_exp_f32 v219, v175
    v_fma_f32 v220, v216, 0.5, 1.0
    v_fma_f32 v221, v217, 0.5, 1.0
    v_fma_f32 v222, v218, 0.5, 1.0
    v_fma_f32 v223, v219, 0.5, 1.0
    v_fma_f32 v220, v216, v220, 1.0
    v_fma_f32 v221, v217, v221, 1.0
    v_fma_f32 v222, v218, v222, 1.0
    v_fma_f32 v223, v219, v223, 1.0
    v_rcp_f32 v220, v220
    v_rcp_f32 v221, v221
    v_rcp_f32 v222, v222
    v_rcp_f32 v223, v223
    v_fma_f32 v216, -v172, v220, v172
    v_fma_f32 v217, -v173, v221, v173
    v_fma_f32 v218, -v174, v222, v174
    v_fma_f32 v219, -v175, v223, v175
    v_cvt_pk_bf16_f32 v250, v216, v217
    v_cvt_pk_bf16_f32 v251, v218, v219
    ds_write_b128 v243, v[248:251] offset:33792
    s_waitcnt lgkmcnt(0)
    s_waitcnt vmcnt(0)
    s_barrier
    ds_read_b128 v[144:147], v241 offset:40960
    ds_read_b128 v[156:159], v241 offset:41984
    s_add_u32 m0, s64, 73728
    s_add_u32 s62, s34, 221312
    buffer_load_dwordx4 v233, s[16:19], s62 offen lds
    ds_read_b128 v[168:171], v241 offset:43008
    ds_read_b128 v[180:183], v241 offset:44032
    s_add_u32 m0, s64, 77824
    s_add_u32 s62, s34, 258176
    buffer_load_dwordx4 v233, s[16:19], s62 offen lds
    ds_read_b128 v[148:151], v241 offset:24576
    ds_read_b128 v[160:163], v241 offset:25600
    s_add_u32 m0, s64, 81920
    s_add_u32 s62, s34, 295040
    buffer_load_dwordx4 v233, s[16:19], s62 offen lds
    ds_read_b128 v[172:175], v241 offset:26624
    ds_read_b128 v[184:187], v241 offset:27648
    s_add_u32 m0, s64, 86016
    s_add_u32 s62, s34, 331904
    buffer_load_dwordx4 v233, s[16:19], s62 offen lds
    ds_read_b128 v[152:155], v241 offset:32768
    ds_read_b128 v[164:167], v241 offset:33792
    s_add_u32 m0, s64, 90112
    s_add_u32 s62, s34, 368768
    buffer_load_dwordx4 v233, s[16:19], s62 offen lds
    ds_read_b128 v[176:179], v241 offset:34816
    ds_read_b128 v[188:191], v241 offset:35840
    s_add_u32 m0, s64, 94208
    s_add_u32 s62, s34, 405632
    buffer_load_dwordx4 v233, s[16:19], s62 offen lds
    s_waitcnt lgkmcnt(0)
    s_barrier
    s_add_u32 m0, s64, 122880
    s_add_u32 s62, s34, 221440
    buffer_load_dwordx4 v233, s[16:19], s62 offen lds
    s_add_u32 m0, s64, 126976
    s_add_u32 s62, s34, 258304
    buffer_load_dwordx4 v233, s[16:19], s62 offen lds
    s_add_u32 m0, s64, 131072
    s_add_u32 s62, s34, 295168
    buffer_load_dwordx4 v233, s[16:19], s62 offen lds
    s_add_u32 m0, s64, 135168
    s_add_u32 s62, s34, 332032
    buffer_load_dwordx4 v233, s[16:19], s62 offen lds
    s_add_u32 m0, s64, 139264
    s_add_u32 s62, s34, 368896
    buffer_load_dwordx4 v233, s[16:19], s62 offen lds
    s_add_u32 m0, s64, 143360
    s_add_u32 s62, s34, 405760
    buffer_load_dwordx4 v233, s[16:19], s62 offen lds
    ds_read_b64_tr_b16 v[208:209], v238 offset:0
    ds_read_b64_tr_b16 v[210:211], v238 offset:2048
    ds_read_b64_tr_b16 v[212:213], v238 offset:4096
    ds_read_b64_tr_b16 v[214:215], v238 offset:6144
    ds_read_b64_tr_b16 v[216:217], v238 offset:8192
    ds_read_b64_tr_b16 v[218:219], v238 offset:10240
    s_setprio 0
    s_waitcnt lgkmcnt(4)
    v_mfma_f32_16x16x32_bf16 v[192:195], v[208:211], v[0:3], 0
    ds_read_b64_tr_b16 v[220:221], v238 offset:12288
    s_waitcnt lgkmcnt(3)
    v_mfma_f32_16x16x32_bf16 v[192:195], v[212:215], v[4:7], v[192:195]
    ds_read_b64_tr_b16 v[222:223], v238 offset:14336
    v_mfma_f32_16x16x32_bf16 v[196:199], v[208:211], v[12:15], 0
    ds_read_b64_tr_b16 v[224:225], v238 offset:16384
    v_mfma_f32_16x16x32_bf16 v[196:199], v[212:215], v[16:19], v[196:199]
    ds_read_b64_tr_b16 v[226:227], v238 offset:18432
    v_mfma_f32_16x16x32_bf16 v[200:203], v[208:211], v[72:75], 0
    v_mfma_f32_16x16x32_bf16 v[200:203], v[212:215], v[76:79], v[200:203]
    v_mfma_f32_16x16x32_bf16 v[204:207], v[208:211], v[84:87], 0
    v_mfma_f32_16x16x32_bf16 v[204:207], v[212:215], v[88:91], v[204:207]
    ds_read_b64_tr_b16 v[208:209], v238 offset:20480
    s_waitcnt lgkmcnt(5)
    v_mfma_f32_16x16x32_bf16 v[192:195], v[216:219], v[8:11], v[192:195]
    ds_read_b64_tr_b16 v[210:211], v238 offset:22528
    s_waitcnt lgkmcnt(4)
    v_mfma_f32_16x16x32_bf16 v[192:195], v[220:223], v[24:27], v[192:195]
    ds_read_b64_tr_b16 v[212:213], v238 offset:24576
    v_mfma_f32_16x16x32_bf16 v[196:199], v[216:219], v[20:23], v[196:199]
    ds_read_b64_tr_b16 v[214:215], v238 offset:26624
    v_mfma_f32_16x16x32_bf16 v[196:199], v[220:223], v[36:39], v[196:199]
    v_mfma_f32_16x16x32_bf16 v[200:203], v[216:219], v[80:83], v[200:203]
    v_mfma_f32_16x16x32_bf16 v[200:203], v[220:223], v[96:99], v[200:203]
    v_mfma_f32_16x16x32_bf16 v[204:207], v[216:219], v[92:95], v[204:207]
    v_mfma_f32_16x16x32_bf16 v[204:207], v[220:223], v[108:111], v[204:207]
    ds_read_b64_tr_b16 v[216:217], v238 offset:28672
    s_waitcnt lgkmcnt(5)
    v_mfma_f32_16x16x32_bf16 v[192:195], v[224:227], v[28:31], v[192:195]
    ds_read_b64_tr_b16 v[218:219], v238 offset:30720
    s_waitcnt lgkmcnt(4)
    v_mfma_f32_16x16x32_bf16 v[192:195], v[208:211], v[32:35], v[192:195]
    ds_read_b64_tr_b16 v[220:221], v238 offset:32768
    v_mfma_f32_16x16x32_bf16 v[196:199], v[224:227], v[40:43], v[196:199]
    ds_read_b64_tr_b16 v[222:223], v238 offset:34816
    v_mfma_f32_16x16x32_bf16 v[196:199], v[208:211], v[44:47], v[196:199]
    v_mfma_f32_16x16x32_bf16 v[200:203], v[224:227], v[100:103], v[200:203]
    v_mfma_f32_16x16x32_bf16 v[200:203], v[208:211], v[104:107], v[200:203]
    v_mfma_f32_16x16x32_bf16 v[204:207], v[224:227], v[112:115], v[204:207]
    v_mfma_f32_16x16x32_bf16 v[204:207], v[208:211], v[116:119], v[204:207]
    ds_read_b64_tr_b16 v[224:225], v238 offset:36864
    s_waitcnt lgkmcnt(5)
    v_mfma_f32_16x16x32_bf16 v[192:195], v[212:215], v[48:51], v[192:195]
    ds_read_b64_tr_b16 v[226:227], v238 offset:38912
    s_waitcnt lgkmcnt(4)
    v_mfma_f32_16x16x32_bf16 v[192:195], v[216:219], v[52:55], v[192:195]
    ds_read_b64_tr_b16 v[208:209], v238 offset:40960
    v_mfma_f32_16x16x32_bf16 v[196:199], v[212:215], v[60:63], v[196:199]
    ds_read_b64_tr_b16 v[210:211], v238 offset:43008
    v_mfma_f32_16x16x32_bf16 v[196:199], v[216:219], v[64:67], v[196:199]
    v_mfma_f32_16x16x32_bf16 v[200:203], v[212:215], v[120:123], v[200:203]
    v_mfma_f32_16x16x32_bf16 v[200:203], v[216:219], v[124:127], v[200:203]
    v_mfma_f32_16x16x32_bf16 v[204:207], v[212:215], v[132:135], v[204:207]
    v_mfma_f32_16x16x32_bf16 v[204:207], v[216:219], v[136:139], v[204:207]
    ds_read_b64_tr_b16 v[212:213], v238 offset:45056
    s_waitcnt lgkmcnt(5)
    v_mfma_f32_16x16x32_bf16 v[192:195], v[220:223], v[56:59], v[192:195]
    ds_read_b64_tr_b16 v[214:215], v238 offset:47104
    s_waitcnt lgkmcnt(4)
    v_mfma_f32_16x16x32_bf16 v[192:195], v[224:227], v[144:147], v[192:195]
    v_mfma_f32_16x16x32_bf16 v[196:199], v[220:223], v[68:71], v[196:199]
    v_mfma_f32_16x16x32_bf16 v[196:199], v[224:227], v[156:159], v[196:199]
    v_mfma_f32_16x16x32_bf16 v[200:203], v[220:223], v[128:131], v[200:203]
    v_mfma_f32_16x16x32_bf16 v[200:203], v[224:227], v[168:171], v[200:203]
    v_mfma_f32_16x16x32_bf16 v[204:207], v[220:223], v[140:143], v[204:207]
    v_mfma_f32_16x16x32_bf16 v[204:207], v[224:227], v[180:183], v[204:207]
    s_waitcnt lgkmcnt(2)
    v_mfma_f32_16x16x32_bf16 v[192:195], v[208:211], v[148:151], v[192:195]
    s_setprio 1
    s_waitcnt vmcnt(6) lgkmcnt(0)
    s_barrier
    v_mfma_f32_16x16x32_bf16 v[192:195], v[212:215], v[152:155], v[192:195]
    v_mfma_f32_16x16x32_bf16 v[196:199], v[208:211], v[160:163], v[196:199]
    v_mfma_f32_16x16x32_bf16 v[196:199], v[212:215], v[164:167], v[196:199]
    v_mfma_f32_16x16x32_bf16 v[200:203], v[208:211], v[172:175], v[200:203]
    v_mfma_f32_16x16x32_bf16 v[200:203], v[212:215], v[176:179], v[200:203]
    v_mfma_f32_16x16x32_bf16 v[204:207], v[208:211], v[184:187], v[204:207]
    v_mfma_f32_16x16x32_bf16 v[204:207], v[212:215], v[188:191], v[204:207]
    s_setprio 2
    s_add_u32 m0, s64, 24576
    s_add_u32 s62, s34, 221568
    buffer_load_dwordx4 v233, s[16:19], s62 offen lds
    s_add_u32 m0, s64, 28672
    s_add_u32 s62, s34, 258432
    buffer_load_dwordx4 v233, s[16:19], s62 offen lds
    v_cvt_pk_bf16_f32 v244, v192, v193
    v_cvt_pk_bf16_f32 v245, v194, v195
    v_cvt_pk_bf16_f32 v246, v196, v197
    v_cvt_pk_bf16_f32 v247, v198, v199
    s_add_u32 m0, s64, 32768
    s_add_u32 s62, s34, 295296
    buffer_load_dwordx4 v233, s[16:19], s62 offen lds
    v_cvt_pk_bf16_f32 v248, v200, v201
    v_cvt_pk_bf16_f32 v249, v202, v203
    v_cvt_pk_bf16_f32 v250, v204, v205
    s_add_u32 m0, s64, 36864
    s_add_u32 s62, s34, 332160
    buffer_load_dwordx4 v233, s[16:19], s62 offen lds
    v_cvt_pk_bf16_f32 v251, v206, v207
    s_nop 0
    v_permlane16_swap_b32 v244, v246
    s_add_u32 m0, s64, 40960
    s_add_u32 s62, s34, 369024
    buffer_load_dwordx4 v233, s[16:19], s62 offen lds
    v_permlane16_swap_b32 v245, v247
    v_permlane16_swap_b32 v248, v250
    v_permlane16_swap_b32 v249, v251
    s_add_u32 m0, s64, 45056
    s_add_u32 s62, s34, 405888
    buffer_load_dwordx4 v233, s[16:19], s62 offen lds
    s_mov_b32 s65, 0
    buffer_store_dwordx4 v[244:247], v237, s[20:23], s65 offen sc1
    s_mov_b32 s65, 479232
    buffer_store_dwordx4 v[248:251], v237, s[20:23], s65 offen sc1
    ds_read_b64_tr_b16 v[216:217], v228 offset:0
    ds_read_b64_tr_b16 v[218:219], v228 offset:2048
    ds_read_b64_tr_b16 v[220:221], v228 offset:4096
    ds_read_b64_tr_b16 v[222:223], v228 offset:6144
    ds_read_b64_tr_b16 v[224:225], v228 offset:8192
    ds_read_b64_tr_b16 v[226:227], v228 offset:10240
    s_setprio 0
    s_waitcnt lgkmcnt(4)
    v_mfma_f32_16x16x32_bf16 v[192:195], v[216:219], v[0:3], 0
    ds_read_b64_tr_b16 v[208:209], v228 offset:12288
    s_waitcnt lgkmcnt(3)
    v_mfma_f32_16x16x32_bf16 v[192:195], v[220:223], v[4:7], v[192:195]
    ds_read_b64_tr_b16 v[210:211], v228 offset:14336
    v_mfma_f32_16x16x32_bf16 v[196:199], v[216:219], v[12:15], 0
    ds_read_b64_tr_b16 v[212:213], v228 offset:16384
    v_mfma_f32_16x16x32_bf16 v[196:199], v[220:223], v[16:19], v[196:199]
    ds_read_b64_tr_b16 v[214:215], v228 offset:18432
    v_mfma_f32_16x16x32_bf16 v[200:203], v[216:219], v[72:75], 0
    v_mfma_f32_16x16x32_bf16 v[200:203], v[220:223], v[76:79], v[200:203]
    v_mfma_f32_16x16x32_bf16 v[204:207], v[216:219], v[84:87], 0
    v_mfma_f32_16x16x32_bf16 v[204:207], v[220:223], v[88:91], v[204:207]
    ds_read_b64_tr_b16 v[216:217], v228 offset:20480
    s_waitcnt lgkmcnt(5)
    v_mfma_f32_16x16x32_bf16 v[192:195], v[224:227], v[8:11], v[192:195]
    ds_read_b64_tr_b16 v[218:219], v228 offset:22528
    s_waitcnt lgkmcnt(4)
    v_mfma_f32_16x16x32_bf16 v[192:195], v[208:211], v[24:27], v[192:195]
    ds_read_b64_tr_b16 v[220:221], v228 offset:24576
    v_mfma_f32_16x16x32_bf16 v[196:199], v[224:227], v[20:23], v[196:199]
    ds_read_b64_tr_b16 v[222:223], v228 offset:26624
    v_mfma_f32_16x16x32_bf16 v[196:199], v[208:211], v[36:39], v[196:199]
    v_mfma_f32_16x16x32_bf16 v[200:203], v[224:227], v[80:83], v[200:203]
    v_mfma_f32_16x16x32_bf16 v[200:203], v[208:211], v[96:99], v[200:203]
    v_mfma_f32_16x16x32_bf16 v[204:207], v[224:227], v[92:95], v[204:207]
    v_mfma_f32_16x16x32_bf16 v[204:207], v[208:211], v[108:111], v[204:207]
    ds_read_b64_tr_b16 v[224:225], v228 offset:28672
    s_waitcnt lgkmcnt(5)
    v_mfma_f32_16x16x32_bf16 v[192:195], v[212:215], v[28:31], v[192:195]
    ds_read_b64_tr_b16 v[226:227], v228 offset:30720
    s_waitcnt lgkmcnt(4)
    v_mfma_f32_16x16x32_bf16 v[192:195], v[216:219], v[32:35], v[192:195]
    ds_read_b64_tr_b16 v[208:209], v228 offset:32768
    v_mfma_f32_16x16x32_bf16 v[196:199], v[212:215], v[40:43], v[196:199]
    ds_read_b64_tr_b16 v[210:211], v228 offset:34816
    v_mfma_f32_16x16x32_bf16 v[196:199], v[216:219], v[44:47], v[196:199]
    v_mfma_f32_16x16x32_bf16 v[200:203], v[212:215], v[100:103], v[200:203]
    v_mfma_f32_16x16x32_bf16 v[200:203], v[216:219], v[104:107], v[200:203]
    v_mfma_f32_16x16x32_bf16 v[204:207], v[212:215], v[112:115], v[204:207]
    v_mfma_f32_16x16x32_bf16 v[204:207], v[216:219], v[116:119], v[204:207]
    ds_read_b64_tr_b16 v[212:213], v228 offset:36864
    s_waitcnt lgkmcnt(5)
    v_mfma_f32_16x16x32_bf16 v[192:195], v[220:223], v[48:51], v[192:195]
    ds_read_b64_tr_b16 v[214:215], v228 offset:38912
    s_waitcnt lgkmcnt(4)
    v_mfma_f32_16x16x32_bf16 v[192:195], v[224:227], v[52:55], v[192:195]
    ds_read_b64_tr_b16 v[216:217], v228 offset:40960
    v_mfma_f32_16x16x32_bf16 v[196:199], v[220:223], v[60:63], v[196:199]
    ds_read_b64_tr_b16 v[218:219], v228 offset:43008
    v_mfma_f32_16x16x32_bf16 v[196:199], v[224:227], v[64:67], v[196:199]
    v_mfma_f32_16x16x32_bf16 v[200:203], v[220:223], v[120:123], v[200:203]
    v_mfma_f32_16x16x32_bf16 v[200:203], v[224:227], v[124:127], v[200:203]
    v_mfma_f32_16x16x32_bf16 v[204:207], v[220:223], v[132:135], v[204:207]
    v_mfma_f32_16x16x32_bf16 v[204:207], v[224:227], v[136:139], v[204:207]
    ds_read_b64_tr_b16 v[220:221], v228 offset:45056
    s_waitcnt lgkmcnt(5)
    v_mfma_f32_16x16x32_bf16 v[192:195], v[208:211], v[56:59], v[192:195]
    ds_read_b64_tr_b16 v[222:223], v228 offset:47104
    s_waitcnt lgkmcnt(4)
    v_mfma_f32_16x16x32_bf16 v[192:195], v[212:215], v[144:147], v[192:195]
    v_mfma_f32_16x16x32_bf16 v[196:199], v[208:211], v[68:71], v[196:199]
    v_mfma_f32_16x16x32_bf16 v[196:199], v[212:215], v[156:159], v[196:199]
    v_mfma_f32_16x16x32_bf16 v[200:203], v[208:211], v[128:131], v[200:203]
    v_mfma_f32_16x16x32_bf16 v[200:203], v[212:215], v[168:171], v[200:203]
    v_mfma_f32_16x16x32_bf16 v[204:207], v[208:211], v[140:143], v[204:207]
    v_mfma_f32_16x16x32_bf16 v[204:207], v[212:215], v[180:183], v[204:207]
    s_waitcnt lgkmcnt(2)
    v_mfma_f32_16x16x32_bf16 v[192:195], v[216:219], v[148:151], v[192:195]
    s_setprio 1
    s_waitcnt vmcnt(0) lgkmcnt(0)
    s_barrier
    v_mfma_f32_16x16x32_bf16 v[192:195], v[220:223], v[152:155], v[192:195]
    v_mfma_f32_16x16x32_bf16 v[196:199], v[216:219], v[160:163], v[196:199]
    v_mfma_f32_16x16x32_bf16 v[196:199], v[220:223], v[164:167], v[196:199]
    v_mfma_f32_16x16x32_bf16 v[200:203], v[216:219], v[172:175], v[200:203]
    v_mfma_f32_16x16x32_bf16 v[200:203], v[220:223], v[176:179], v[200:203]
    v_mfma_f32_16x16x32_bf16 v[204:207], v[216:219], v[184:187], v[204:207]
    v_mfma_f32_16x16x32_bf16 v[204:207], v[220:223], v[188:191], v[204:207]
    s_setprio 2
    s_add_u32 m0, s64, 73728
    s_add_u32 s62, s34, 221696
    buffer_load_dwordx4 v233, s[16:19], s62 offen lds
    s_add_u32 m0, s64, 77824
    s_add_u32 s62, s34, 258560
    buffer_load_dwordx4 v233, s[16:19], s62 offen lds
    v_cvt_pk_bf16_f32 v244, v192, v193
    v_cvt_pk_bf16_f32 v245, v194, v195
    v_cvt_pk_bf16_f32 v246, v196, v197
    v_cvt_pk_bf16_f32 v247, v198, v199
    s_add_u32 m0, s64, 81920
    s_add_u32 s62, s34, 295424
    buffer_load_dwordx4 v233, s[16:19], s62 offen lds
    v_cvt_pk_bf16_f32 v248, v200, v201
    v_cvt_pk_bf16_f32 v249, v202, v203
    v_cvt_pk_bf16_f32 v250, v204, v205
    s_add_u32 m0, s64, 86016
    s_add_u32 s62, s34, 332288
    buffer_load_dwordx4 v233, s[16:19], s62 offen lds
    v_cvt_pk_bf16_f32 v251, v206, v207
    s_nop 0
    v_permlane16_swap_b32 v244, v246
    s_add_u32 m0, s64, 90112
    s_add_u32 s62, s34, 369152
    buffer_load_dwordx4 v233, s[16:19], s62 offen lds
    v_permlane16_swap_b32 v245, v247
    v_permlane16_swap_b32 v248, v250
    v_permlane16_swap_b32 v249, v251
    s_add_u32 m0, s64, 94208
    s_add_u32 s62, s34, 406016
    buffer_load_dwordx4 v233, s[16:19], s62 offen lds
    s_mov_b32 s65, 4096
    buffer_store_dwordx4 v[244:247], v237, s[20:23], s65 offen sc1
    s_mov_b32 s65, 483328
    buffer_store_dwordx4 v[248:251], v237, s[20:23], s65 offen sc1
    s_add_u32 s56, s6, 1
    v_mov_b32 v252, s56
    buffer_store_dwordx2 v[252:253], v230, s[20:23], 0 offen sc1
    ds_read_b64_tr_b16 v[224:225], v229 offset:0
    ds_read_b64_tr_b16 v[226:227], v229 offset:2048
    ds_read_b64_tr_b16 v[208:209], v229 offset:4096
    ds_read_b64_tr_b16 v[210:211], v229 offset:6144
    ds_read_b64_tr_b16 v[212:213], v229 offset:8192
    ds_read_b64_tr_b16 v[214:215], v229 offset:10240
    s_setprio 0
    s_waitcnt lgkmcnt(4)
    v_mfma_f32_16x16x32_bf16 v[192:195], v[224:227], v[0:3], 0
    ds_read_b64_tr_b16 v[216:217], v229 offset:12288
    s_waitcnt lgkmcnt(3)
    v_mfma_f32_16x16x32_bf16 v[192:195], v[208:211], v[4:7], v[192:195]
    ds_read_b64_tr_b16 v[218:219], v229 offset:14336
    v_mfma_f32_16x16x32_bf16 v[196:199], v[224:227], v[12:15], 0
    ds_read_b64_tr_b16 v[220:221], v229 offset:16384
    v_mfma_f32_16x16x32_bf16 v[196:199], v[208:211], v[16:19], v[196:199]
    ds_read_b64_tr_b16 v[222:223], v229 offset:18432
    v_mfma_f32_16x16x32_bf16 v[200:203], v[224:227], v[72:75], 0
    v_mfma_f32_16x16x32_bf16 v[200:203], v[208:211], v[76:79], v[200:203]
    v_mfma_f32_16x16x32_bf16 v[204:207], v[224:227], v[84:87], 0
    v_mfma_f32_16x16x32_bf16 v[204:207], v[208:211], v[88:91], v[204:207]
    ds_read_b64_tr_b16 v[224:225], v229 offset:20480
    s_waitcnt lgkmcnt(5)
    v_mfma_f32_16x16x32_bf16 v[192:195], v[212:215], v[8:11], v[192:195]
    ds_read_b64_tr_b16 v[226:227], v229 offset:22528
    s_waitcnt lgkmcnt(4)
    v_mfma_f32_16x16x32_bf16 v[192:195], v[216:219], v[24:27], v[192:195]
    ds_read_b64_tr_b16 v[208:209], v229 offset:24576
    v_mfma_f32_16x16x32_bf16 v[196:199], v[212:215], v[20:23], v[196:199]
    ds_read_b64_tr_b16 v[210:211], v229 offset:26624
    v_mfma_f32_16x16x32_bf16 v[196:199], v[216:219], v[36:39], v[196:199]
    v_mfma_f32_16x16x32_bf16 v[200:203], v[212:215], v[80:83], v[200:203]
    v_mfma_f32_16x16x32_bf16 v[200:203], v[216:219], v[96:99], v[200:203]
    v_mfma_f32_16x16x32_bf16 v[204:207], v[212:215], v[92:95], v[204:207]
    v_mfma_f32_16x16x32_bf16 v[204:207], v[216:219], v[108:111], v[204:207]
    ds_read_b64_tr_b16 v[212:213], v229 offset:28672
    s_waitcnt lgkmcnt(5)
    v_mfma_f32_16x16x32_bf16 v[192:195], v[220:223], v[28:31], v[192:195]
    ds_read_b64_tr_b16 v[214:215], v229 offset:30720
    s_waitcnt lgkmcnt(4)
    v_mfma_f32_16x16x32_bf16 v[192:195], v[224:227], v[32:35], v[192:195]
    ds_read_b64_tr_b16 v[216:217], v229 offset:32768
    v_mfma_f32_16x16x32_bf16 v[196:199], v[220:223], v[40:43], v[196:199]
    ds_read_b64_tr_b16 v[218:219], v229 offset:34816
    v_mfma_f32_16x16x32_bf16 v[196:199], v[224:227], v[44:47], v[196:199]
    v_mfma_f32_16x16x32_bf16 v[200:203], v[220:223], v[100:103], v[200:203]
    v_mfma_f32_16x16x32_bf16 v[200:203], v[224:227], v[104:107], v[200:203]
    v_mfma_f32_16x16x32_bf16 v[204:207], v[220:223], v[112:115], v[204:207]
    v_mfma_f32_16x16x32_bf16 v[204:207], v[224:227], v[116:119], v[204:207]
    ds_read_b64_tr_b16 v[220:221], v229 offset:36864
    s_waitcnt lgkmcnt(5)
    v_mfma_f32_16x16x32_bf16 v[192:195], v[208:211], v[48:51], v[192:195]
    ds_read_b64_tr_b16 v[222:223], v229 offset:38912
    s_waitcnt lgkmcnt(4)
    v_mfma_f32_16x16x32_bf16 v[192:195], v[212:215], v[52:55], v[192:195]
    ds_read_b64_tr_b16 v[224:225], v229 offset:40960
    v_mfma_f32_16x16x32_bf16 v[196:199], v[208:211], v[60:63], v[196:199]
    ds_read_b64_tr_b16 v[226:227], v229 offset:43008
    v_mfma_f32_16x16x32_bf16 v[196:199], v[212:215], v[64:67], v[196:199]
    v_mfma_f32_16x16x32_bf16 v[200:203], v[208:211], v[120:123], v[200:203]
    v_mfma_f32_16x16x32_bf16 v[200:203], v[212:215], v[124:127], v[200:203]
    v_mfma_f32_16x16x32_bf16 v[204:207], v[208:211], v[132:135], v[204:207]
    v_mfma_f32_16x16x32_bf16 v[204:207], v[212:215], v[136:139], v[204:207]
    ds_read_b64_tr_b16 v[208:209], v229 offset:45056
    s_waitcnt lgkmcnt(5)
    v_mfma_f32_16x16x32_bf16 v[192:195], v[216:219], v[56:59], v[192:195]
    ds_read_b64_tr_b16 v[210:211], v229 offset:47104
    s_waitcnt lgkmcnt(4)
    v_mfma_f32_16x16x32_bf16 v[192:195], v[220:223], v[144:147], v[192:195]
    v_mfma_f32_16x16x32_bf16 v[196:199], v[216:219], v[68:71], v[196:199]
    v_mfma_f32_16x16x32_bf16 v[196:199], v[220:223], v[156:159], v[196:199]
    v_mfma_f32_16x16x32_bf16 v[200:203], v[216:219], v[128:131], v[200:203]
    v_mfma_f32_16x16x32_bf16 v[200:203], v[220:223], v[168:171], v[200:203]
    v_mfma_f32_16x16x32_bf16 v[204:207], v[216:219], v[140:143], v[204:207]
    v_mfma_f32_16x16x32_bf16 v[204:207], v[220:223], v[180:183], v[204:207]
    s_waitcnt lgkmcnt(2)
    v_mfma_f32_16x16x32_bf16 v[192:195], v[224:227], v[148:151], v[192:195]
    s_setprio 1
    s_waitcnt vmcnt(1) lgkmcnt(0)
    s_barrier
    v_mfma_f32_16x16x32_bf16 v[192:195], v[208:211], v[152:155], v[192:195]
    v_mfma_f32_16x16x32_bf16 v[196:199], v[224:227], v[160:163], v[196:199]
    v_mfma_f32_16x16x32_bf16 v[196:199], v[208:211], v[164:167], v[196:199]
    v_mfma_f32_16x16x32_bf16 v[200:203], v[224:227], v[172:175], v[200:203]
    v_mfma_f32_16x16x32_bf16 v[200:203], v[208:211], v[176:179], v[200:203]
    v_mfma_f32_16x16x32_bf16 v[204:207], v[224:227], v[184:187], v[204:207]
    v_mfma_f32_16x16x32_bf16 v[204:207], v[208:211], v[188:191], v[204:207]
    s_setprio 2
    s_add_u32 m0, s64, 122880
    s_add_u32 s62, s34, 221824
    buffer_load_dwordx4 v233, s[16:19], s62 offen lds
    s_add_u32 m0, s64, 126976
    s_add_u32 s62, s34, 258688
    buffer_load_dwordx4 v233, s[16:19], s62 offen lds
    v_cvt_pk_bf16_f32 v244, v192, v193
    v_cvt_pk_bf16_f32 v245, v194, v195
    v_cvt_pk_bf16_f32 v246, v196, v197
    v_cvt_pk_bf16_f32 v247, v198, v199
    s_add_u32 m0, s64, 131072
    s_add_u32 s62, s34, 295552
    buffer_load_dwordx4 v233, s[16:19], s62 offen lds
    v_cvt_pk_bf16_f32 v248, v200, v201
    v_cvt_pk_bf16_f32 v249, v202, v203
    v_cvt_pk_bf16_f32 v250, v204, v205
    s_add_u32 m0, s64, 135168
    s_add_u32 s62, s34, 332416
    buffer_load_dwordx4 v233, s[16:19], s62 offen lds
    v_cvt_pk_bf16_f32 v251, v206, v207
    s_nop 0
    v_permlane16_swap_b32 v244, v246
    s_add_u32 m0, s64, 139264
    s_add_u32 s62, s34, 369280
    buffer_load_dwordx4 v233, s[16:19], s62 offen lds
    v_permlane16_swap_b32 v245, v247
    v_permlane16_swap_b32 v248, v250
    v_permlane16_swap_b32 v249, v251
    s_add_u32 m0, s64, 143360
    s_add_u32 s62, s34, 406144
    buffer_load_dwordx4 v233, s[16:19], s62 offen lds
    s_mov_b32 s65, 8192
    buffer_store_dwordx4 v[244:247], v237, s[20:23], s65 offen sc1
    s_mov_b32 s65, 487424
    buffer_store_dwordx4 v[248:251], v237, s[20:23], s65 offen sc1
    s_add_u32 s56, s6, 2
    v_mov_b32 v252, s56
    buffer_store_dwordx2 v[252:253], v230, s[20:23], 0 offen sc1
    ds_read_b64_tr_b16 v[212:213], v238 offset:0
    ds_read_b64_tr_b16 v[214:215], v238 offset:2048
    ds_read_b64_tr_b16 v[216:217], v238 offset:4096
    ds_read_b64_tr_b16 v[218:219], v238 offset:6144
    ds_read_b64_tr_b16 v[220:221], v238 offset:8192
    ds_read_b64_tr_b16 v[222:223], v238 offset:10240
    s_setprio 0
    s_waitcnt lgkmcnt(4)
    v_mfma_f32_16x16x32_bf16 v[192:195], v[212:215], v[0:3], 0
    ds_read_b64_tr_b16 v[224:225], v238 offset:12288
    s_waitcnt lgkmcnt(3)
    v_mfma_f32_16x16x32_bf16 v[192:195], v[216:219], v[4:7], v[192:195]
    ds_read_b64_tr_b16 v[226:227], v238 offset:14336
    v_mfma_f32_16x16x32_bf16 v[196:199], v[212:215], v[12:15], 0
    ds_read_b64_tr_b16 v[208:209], v238 offset:16384
    v_mfma_f32_16x16x32_bf16 v[196:199], v[216:219], v[16:19], v[196:199]
    ds_read_b64_tr_b16 v[210:211], v238 offset:18432
    v_mfma_f32_16x16x32_bf16 v[200:203], v[212:215], v[72:75], 0
    v_mfma_f32_16x16x32_bf16 v[200:203], v[216:219], v[76:79], v[200:203]
    v_mfma_f32_16x16x32_bf16 v[204:207], v[212:215], v[84:87], 0
    v_mfma_f32_16x16x32_bf16 v[204:207], v[216:219], v[88:91], v[204:207]
    ds_read_b64_tr_b16 v[212:213], v238 offset:20480
    s_waitcnt lgkmcnt(5)
    v_mfma_f32_16x16x32_bf16 v[192:195], v[220:223], v[8:11], v[192:195]
    ds_read_b64_tr_b16 v[214:215], v238 offset:22528
    s_waitcnt lgkmcnt(4)
    v_mfma_f32_16x16x32_bf16 v[192:195], v[224:227], v[24:27], v[192:195]
    ds_read_b64_tr_b16 v[216:217], v238 offset:24576
    v_mfma_f32_16x16x32_bf16 v[196:199], v[220:223], v[20:23], v[196:199]
    ds_read_b64_tr_b16 v[218:219], v238 offset:26624
    v_mfma_f32_16x16x32_bf16 v[196:199], v[224:227], v[36:39], v[196:199]
    v_mfma_f32_16x16x32_bf16 v[200:203], v[220:223], v[80:83], v[200:203]
    v_mfma_f32_16x16x32_bf16 v[200:203], v[224:227], v[96:99], v[200:203]
    v_mfma_f32_16x16x32_bf16 v[204:207], v[220:223], v[92:95], v[204:207]
    v_mfma_f32_16x16x32_bf16 v[204:207], v[224:227], v[108:111], v[204:207]
    ds_read_b64_tr_b16 v[220:221], v238 offset:28672
    s_waitcnt lgkmcnt(5)
    v_mfma_f32_16x16x32_bf16 v[192:195], v[208:211], v[28:31], v[192:195]
    ds_read_b64_tr_b16 v[222:223], v238 offset:30720
    s_waitcnt lgkmcnt(4)
    v_mfma_f32_16x16x32_bf16 v[192:195], v[212:215], v[32:35], v[192:195]
    ds_read_b64_tr_b16 v[224:225], v238 offset:32768
    v_mfma_f32_16x16x32_bf16 v[196:199], v[208:211], v[40:43], v[196:199]
    ds_read_b64_tr_b16 v[226:227], v238 offset:34816
    v_mfma_f32_16x16x32_bf16 v[196:199], v[212:215], v[44:47], v[196:199]
    v_mfma_f32_16x16x32_bf16 v[200:203], v[208:211], v[100:103], v[200:203]
    v_mfma_f32_16x16x32_bf16 v[200:203], v[212:215], v[104:107], v[200:203]
    v_mfma_f32_16x16x32_bf16 v[204:207], v[208:211], v[112:115], v[204:207]
    v_mfma_f32_16x16x32_bf16 v[204:207], v[212:215], v[116:119], v[204:207]
    ds_read_b64_tr_b16 v[208:209], v238 offset:36864
    s_waitcnt lgkmcnt(5)
    v_mfma_f32_16x16x32_bf16 v[192:195], v[216:219], v[48:51], v[192:195]
    ds_read_b64_tr_b16 v[210:211], v238 offset:38912
    s_waitcnt lgkmcnt(4)
    v_mfma_f32_16x16x32_bf16 v[192:195], v[220:223], v[52:55], v[192:195]
    ds_read_b64_tr_b16 v[212:213], v238 offset:40960
    v_mfma_f32_16x16x32_bf16 v[196:199], v[216:219], v[60:63], v[196:199]
    ds_read_b64_tr_b16 v[214:215], v238 offset:43008
    v_mfma_f32_16x16x32_bf16 v[196:199], v[220:223], v[64:67], v[196:199]
    v_mfma_f32_16x16x32_bf16 v[200:203], v[216:219], v[120:123], v[200:203]
    v_mfma_f32_16x16x32_bf16 v[200:203], v[220:223], v[124:127], v[200:203]
    v_mfma_f32_16x16x32_bf16 v[204:207], v[216:219], v[132:135], v[204:207]
    v_mfma_f32_16x16x32_bf16 v[204:207], v[220:223], v[136:139], v[204:207]
    ds_read_b64_tr_b16 v[216:217], v238 offset:45056
    s_waitcnt lgkmcnt(5)
    v_mfma_f32_16x16x32_bf16 v[192:195], v[224:227], v[56:59], v[192:195]
    ds_read_b64_tr_b16 v[218:219], v238 offset:47104
    s_waitcnt lgkmcnt(4)
    v_mfma_f32_16x16x32_bf16 v[192:195], v[208:211], v[144:147], v[192:195]
    v_mfma_f32_16x16x32_bf16 v[196:199], v[224:227], v[68:71], v[196:199]
    v_mfma_f32_16x16x32_bf16 v[196:199], v[208:211], v[156:159], v[196:199]
    v_mfma_f32_16x16x32_bf16 v[200:203], v[224:227], v[128:131], v[200:203]
    v_mfma_f32_16x16x32_bf16 v[200:203], v[208:211], v[168:171], v[200:203]
    v_mfma_f32_16x16x32_bf16 v[204:207], v[224:227], v[140:143], v[204:207]
    v_mfma_f32_16x16x32_bf16 v[204:207], v[208:211], v[180:183], v[204:207]
    s_waitcnt lgkmcnt(2)
    v_mfma_f32_16x16x32_bf16 v[192:195], v[212:215], v[148:151], v[192:195]
    s_setprio 1
    s_waitcnt vmcnt(1) lgkmcnt(0)
    s_barrier
    v_mfma_f32_16x16x32_bf16 v[192:195], v[216:219], v[152:155], v[192:195]
    v_mfma_f32_16x16x32_bf16 v[196:199], v[212:215], v[160:163], v[196:199]
    v_mfma_f32_16x16x32_bf16 v[196:199], v[216:219], v[164:167], v[196:199]
    v_mfma_f32_16x16x32_bf16 v[200:203], v[212:215], v[172:175], v[200:203]
    v_mfma_f32_16x16x32_bf16 v[200:203], v[216:219], v[176:179], v[200:203]
    v_mfma_f32_16x16x32_bf16 v[204:207], v[212:215], v[184:187], v[204:207]
    v_mfma_f32_16x16x32_bf16 v[204:207], v[216:219], v[188:191], v[204:207]
    s_setprio 2
    s_add_u32 m0, s64, 24576
    s_add_u32 s62, s34, 221952
    buffer_load_dwordx4 v233, s[16:19], s62 offen lds
    s_add_u32 m0, s64, 28672
    s_add_u32 s62, s34, 258816
    buffer_load_dwordx4 v233, s[16:19], s62 offen lds
    v_cvt_pk_bf16_f32 v244, v192, v193
    v_cvt_pk_bf16_f32 v245, v194, v195
    v_cvt_pk_bf16_f32 v246, v196, v197
    v_cvt_pk_bf16_f32 v247, v198, v199
    s_add_u32 m0, s64, 32768
    s_add_u32 s62, s34, 295680
    buffer_load_dwordx4 v233, s[16:19], s62 offen lds
    v_cvt_pk_bf16_f32 v248, v200, v201
    v_cvt_pk_bf16_f32 v249, v202, v203
    v_cvt_pk_bf16_f32 v250, v204, v205
    s_add_u32 m0, s64, 36864
    s_add_u32 s62, s34, 332544
    buffer_load_dwordx4 v233, s[16:19], s62 offen lds
    v_cvt_pk_bf16_f32 v251, v206, v207
    s_nop 0
    v_permlane16_swap_b32 v244, v246
    s_add_u32 m0, s64, 40960
    s_add_u32 s62, s34, 369408
    buffer_load_dwordx4 v233, s[16:19], s62 offen lds
    v_permlane16_swap_b32 v245, v247
    v_permlane16_swap_b32 v248, v250
    v_permlane16_swap_b32 v249, v251
    s_add_u32 m0, s64, 45056
    s_add_u32 s62, s34, 406272
    buffer_load_dwordx4 v233, s[16:19], s62 offen lds
    s_mov_b32 s65, 12288
    buffer_store_dwordx4 v[244:247], v237, s[20:23], s65 offen sc1
    s_mov_b32 s65, 491520
    buffer_store_dwordx4 v[248:251], v237, s[20:23], s65 offen sc1
    s_add_u32 s56, s6, 3
    v_mov_b32 v252, s56
    buffer_store_dwordx2 v[252:253], v230, s[20:23], 0 offen sc1
    ds_read_b64_tr_b16 v[220:221], v228 offset:0
    ds_read_b64_tr_b16 v[222:223], v228 offset:2048
    ds_read_b64_tr_b16 v[224:225], v228 offset:4096
    ds_read_b64_tr_b16 v[226:227], v228 offset:6144
    ds_read_b64_tr_b16 v[208:209], v228 offset:8192
    ds_read_b64_tr_b16 v[210:211], v228 offset:10240
    s_setprio 0
    s_waitcnt lgkmcnt(4)
    v_mfma_f32_16x16x32_bf16 v[192:195], v[220:223], v[0:3], 0
    ds_read_b64_tr_b16 v[212:213], v228 offset:12288
    s_waitcnt lgkmcnt(3)
    v_mfma_f32_16x16x32_bf16 v[192:195], v[224:227], v[4:7], v[192:195]
    ds_read_b64_tr_b16 v[214:215], v228 offset:14336
    v_mfma_f32_16x16x32_bf16 v[196:199], v[220:223], v[12:15], 0
    ds_read_b64_tr_b16 v[216:217], v228 offset:16384
    v_mfma_f32_16x16x32_bf16 v[196:199], v[224:227], v[16:19], v[196:199]
    ds_read_b64_tr_b16 v[218:219], v228 offset:18432
    v_mfma_f32_16x16x32_bf16 v[200:203], v[220:223], v[72:75], 0
    v_mfma_f32_16x16x32_bf16 v[200:203], v[224:227], v[76:79], v[200:203]
    v_mfma_f32_16x16x32_bf16 v[204:207], v[220:223], v[84:87], 0
    v_mfma_f32_16x16x32_bf16 v[204:207], v[224:227], v[88:91], v[204:207]
    ds_read_b64_tr_b16 v[220:221], v228 offset:20480
    s_waitcnt lgkmcnt(5)
    v_mfma_f32_16x16x32_bf16 v[192:195], v[208:211], v[8:11], v[192:195]
    ds_read_b64_tr_b16 v[222:223], v228 offset:22528
    s_waitcnt lgkmcnt(4)
    v_mfma_f32_16x16x32_bf16 v[192:195], v[212:215], v[24:27], v[192:195]
    ds_read_b64_tr_b16 v[224:225], v228 offset:24576
    v_mfma_f32_16x16x32_bf16 v[196:199], v[208:211], v[20:23], v[196:199]
    ds_read_b64_tr_b16 v[226:227], v228 offset:26624
    v_mfma_f32_16x16x32_bf16 v[196:199], v[212:215], v[36:39], v[196:199]
    v_mfma_f32_16x16x32_bf16 v[200:203], v[208:211], v[80:83], v[200:203]
    v_mfma_f32_16x16x32_bf16 v[200:203], v[212:215], v[96:99], v[200:203]
    v_mfma_f32_16x16x32_bf16 v[204:207], v[208:211], v[92:95], v[204:207]
    v_mfma_f32_16x16x32_bf16 v[204:207], v[212:215], v[108:111], v[204:207]
    ds_read_b64_tr_b16 v[208:209], v228 offset:28672
    s_waitcnt lgkmcnt(5)
    v_mfma_f32_16x16x32_bf16 v[192:195], v[216:219], v[28:31], v[192:195]
    ds_read_b64_tr_b16 v[210:211], v228 offset:30720
    s_waitcnt lgkmcnt(4)
    v_mfma_f32_16x16x32_bf16 v[192:195], v[220:223], v[32:35], v[192:195]
    ds_read_b64_tr_b16 v[212:213], v228 offset:32768
    v_mfma_f32_16x16x32_bf16 v[196:199], v[216:219], v[40:43], v[196:199]
    ds_read_b64_tr_b16 v[214:215], v228 offset:34816
    v_mfma_f32_16x16x32_bf16 v[196:199], v[220:223], v[44:47], v[196:199]
    v_mfma_f32_16x16x32_bf16 v[200:203], v[216:219], v[100:103], v[200:203]
    v_mfma_f32_16x16x32_bf16 v[200:203], v[220:223], v[104:107], v[200:203]
    v_mfma_f32_16x16x32_bf16 v[204:207], v[216:219], v[112:115], v[204:207]
    v_mfma_f32_16x16x32_bf16 v[204:207], v[220:223], v[116:119], v[204:207]
    ds_read_b64_tr_b16 v[216:217], v228 offset:36864
    s_waitcnt lgkmcnt(5)
    v_mfma_f32_16x16x32_bf16 v[192:195], v[224:227], v[48:51], v[192:195]
    ds_read_b64_tr_b16 v[218:219], v228 offset:38912
    s_waitcnt lgkmcnt(4)
    v_mfma_f32_16x16x32_bf16 v[192:195], v[208:211], v[52:55], v[192:195]
    ds_read_b64_tr_b16 v[220:221], v228 offset:40960
    v_mfma_f32_16x16x32_bf16 v[196:199], v[224:227], v[60:63], v[196:199]
    ds_read_b64_tr_b16 v[222:223], v228 offset:43008
    v_mfma_f32_16x16x32_bf16 v[196:199], v[208:211], v[64:67], v[196:199]
    v_mfma_f32_16x16x32_bf16 v[200:203], v[224:227], v[120:123], v[200:203]
    v_mfma_f32_16x16x32_bf16 v[200:203], v[208:211], v[124:127], v[200:203]
    v_mfma_f32_16x16x32_bf16 v[204:207], v[224:227], v[132:135], v[204:207]
    v_mfma_f32_16x16x32_bf16 v[204:207], v[208:211], v[136:139], v[204:207]
    ds_read_b64_tr_b16 v[224:225], v228 offset:45056
    s_waitcnt lgkmcnt(5)
    v_mfma_f32_16x16x32_bf16 v[192:195], v[212:215], v[56:59], v[192:195]
    ds_read_b64_tr_b16 v[226:227], v228 offset:47104
    s_waitcnt lgkmcnt(4)
    v_mfma_f32_16x16x32_bf16 v[192:195], v[216:219], v[144:147], v[192:195]
    v_mfma_f32_16x16x32_bf16 v[196:199], v[212:215], v[68:71], v[196:199]
    v_mfma_f32_16x16x32_bf16 v[196:199], v[216:219], v[156:159], v[196:199]
    v_mfma_f32_16x16x32_bf16 v[200:203], v[212:215], v[128:131], v[200:203]
    v_mfma_f32_16x16x32_bf16 v[200:203], v[216:219], v[168:171], v[200:203]
    v_mfma_f32_16x16x32_bf16 v[204:207], v[212:215], v[140:143], v[204:207]
    v_mfma_f32_16x16x32_bf16 v[204:207], v[216:219], v[180:183], v[204:207]
    s_waitcnt lgkmcnt(2)
    v_mfma_f32_16x16x32_bf16 v[192:195], v[220:223], v[148:151], v[192:195]
    s_setprio 1
    s_waitcnt vmcnt(1) lgkmcnt(0)
    s_barrier
    v_mfma_f32_16x16x32_bf16 v[192:195], v[224:227], v[152:155], v[192:195]
    v_mfma_f32_16x16x32_bf16 v[196:199], v[220:223], v[160:163], v[196:199]
    v_mfma_f32_16x16x32_bf16 v[196:199], v[224:227], v[164:167], v[196:199]
    v_mfma_f32_16x16x32_bf16 v[200:203], v[220:223], v[172:175], v[200:203]
    v_mfma_f32_16x16x32_bf16 v[200:203], v[224:227], v[176:179], v[200:203]
    v_mfma_f32_16x16x32_bf16 v[204:207], v[220:223], v[184:187], v[204:207]
    v_mfma_f32_16x16x32_bf16 v[204:207], v[224:227], v[188:191], v[204:207]
    s_setprio 2
    s_add_u32 m0, s64, 73728
    s_add_u32 s62, s34, 222080
    buffer_load_dwordx4 v233, s[16:19], s62 offen lds
    s_add_u32 m0, s64, 77824
    s_add_u32 s62, s34, 258944
    buffer_load_dwordx4 v233, s[16:19], s62 offen lds
    v_cvt_pk_bf16_f32 v244, v192, v193
    v_cvt_pk_bf16_f32 v245, v194, v195
    v_cvt_pk_bf16_f32 v246, v196, v197
    v_cvt_pk_bf16_f32 v247, v198, v199
    s_add_u32 m0, s64, 81920
    s_add_u32 s62, s34, 295808
    buffer_load_dwordx4 v233, s[16:19], s62 offen lds
    v_cvt_pk_bf16_f32 v248, v200, v201
    v_cvt_pk_bf16_f32 v249, v202, v203
    v_cvt_pk_bf16_f32 v250, v204, v205
    s_add_u32 m0, s64, 86016
    s_add_u32 s62, s34, 332672
    buffer_load_dwordx4 v233, s[16:19], s62 offen lds
    v_cvt_pk_bf16_f32 v251, v206, v207
    s_nop 0
    v_permlane16_swap_b32 v244, v246
    s_add_u32 m0, s64, 90112
    s_add_u32 s62, s34, 369536
    buffer_load_dwordx4 v233, s[16:19], s62 offen lds
    v_permlane16_swap_b32 v245, v247
    v_permlane16_swap_b32 v248, v250
    v_permlane16_swap_b32 v249, v251
    s_add_u32 m0, s64, 94208
    s_add_u32 s62, s34, 406400
    buffer_load_dwordx4 v233, s[16:19], s62 offen lds
    s_mov_b32 s65, 16384
    buffer_store_dwordx4 v[244:247], v237, s[20:23], s65 offen sc1
    s_mov_b32 s65, 495616
    buffer_store_dwordx4 v[248:251], v237, s[20:23], s65 offen sc1
    s_add_u32 s56, s6, 4
    v_mov_b32 v252, s56
    buffer_store_dwordx2 v[252:253], v230, s[20:23], 0 offen sc1
    ds_read_b64_tr_b16 v[208:209], v229 offset:0
    ds_read_b64_tr_b16 v[210:211], v229 offset:2048
    ds_read_b64_tr_b16 v[212:213], v229 offset:4096
    ds_read_b64_tr_b16 v[214:215], v229 offset:6144
    ds_read_b64_tr_b16 v[216:217], v229 offset:8192
    ds_read_b64_tr_b16 v[218:219], v229 offset:10240
    s_setprio 0
    s_waitcnt lgkmcnt(4)
    v_mfma_f32_16x16x32_bf16 v[192:195], v[208:211], v[0:3], 0
    ds_read_b64_tr_b16 v[220:221], v229 offset:12288
    s_waitcnt lgkmcnt(3)
    v_mfma_f32_16x16x32_bf16 v[192:195], v[212:215], v[4:7], v[192:195]
    ds_read_b64_tr_b16 v[222:223], v229 offset:14336
    v_mfma_f32_16x16x32_bf16 v[196:199], v[208:211], v[12:15], 0
    ds_read_b64_tr_b16 v[224:225], v229 offset:16384
    v_mfma_f32_16x16x32_bf16 v[196:199], v[212:215], v[16:19], v[196:199]
    ds_read_b64_tr_b16 v[226:227], v229 offset:18432
    v_mfma_f32_16x16x32_bf16 v[200:203], v[208:211], v[72:75], 0
    v_mfma_f32_16x16x32_bf16 v[200:203], v[212:215], v[76:79], v[200:203]
    v_mfma_f32_16x16x32_bf16 v[204:207], v[208:211], v[84:87], 0
    v_mfma_f32_16x16x32_bf16 v[204:207], v[212:215], v[88:91], v[204:207]
    ds_read_b64_tr_b16 v[208:209], v229 offset:20480
    s_waitcnt lgkmcnt(5)
    v_mfma_f32_16x16x32_bf16 v[192:195], v[216:219], v[8:11], v[192:195]
    ds_read_b64_tr_b16 v[210:211], v229 offset:22528
    s_waitcnt lgkmcnt(4)
    v_mfma_f32_16x16x32_bf16 v[192:195], v[220:223], v[24:27], v[192:195]
    ds_read_b64_tr_b16 v[212:213], v229 offset:24576
    v_mfma_f32_16x16x32_bf16 v[196:199], v[216:219], v[20:23], v[196:199]
    ds_read_b64_tr_b16 v[214:215], v229 offset:26624
    v_mfma_f32_16x16x32_bf16 v[196:199], v[220:223], v[36:39], v[196:199]
    v_mfma_f32_16x16x32_bf16 v[200:203], v[216:219], v[80:83], v[200:203]
    v_mfma_f32_16x16x32_bf16 v[200:203], v[220:223], v[96:99], v[200:203]
    v_mfma_f32_16x16x32_bf16 v[204:207], v[216:219], v[92:95], v[204:207]
    v_mfma_f32_16x16x32_bf16 v[204:207], v[220:223], v[108:111], v[204:207]
    ds_read_b64_tr_b16 v[216:217], v229 offset:28672
    s_waitcnt lgkmcnt(5)
    v_mfma_f32_16x16x32_bf16 v[192:195], v[224:227], v[28:31], v[192:195]
    ds_read_b64_tr_b16 v[218:219], v229 offset:30720
    s_waitcnt lgkmcnt(4)
    v_mfma_f32_16x16x32_bf16 v[192:195], v[208:211], v[32:35], v[192:195]
    ds_read_b64_tr_b16 v[220:221], v229 offset:32768
    v_mfma_f32_16x16x32_bf16 v[196:199], v[224:227], v[40:43], v[196:199]
    ds_read_b64_tr_b16 v[222:223], v229 offset:34816
    v_mfma_f32_16x16x32_bf16 v[196:199], v[208:211], v[44:47], v[196:199]
    v_mfma_f32_16x16x32_bf16 v[200:203], v[224:227], v[100:103], v[200:203]
    v_mfma_f32_16x16x32_bf16 v[200:203], v[208:211], v[104:107], v[200:203]
    v_mfma_f32_16x16x32_bf16 v[204:207], v[224:227], v[112:115], v[204:207]
    v_mfma_f32_16x16x32_bf16 v[204:207], v[208:211], v[116:119], v[204:207]
    ds_read_b64_tr_b16 v[224:225], v229 offset:36864
    s_waitcnt lgkmcnt(5)
    v_mfma_f32_16x16x32_bf16 v[192:195], v[212:215], v[48:51], v[192:195]
    ds_read_b64_tr_b16 v[226:227], v229 offset:38912
    s_waitcnt lgkmcnt(4)
    v_mfma_f32_16x16x32_bf16 v[192:195], v[216:219], v[52:55], v[192:195]
    ds_read_b64_tr_b16 v[208:209], v229 offset:40960
    v_mfma_f32_16x16x32_bf16 v[196:199], v[212:215], v[60:63], v[196:199]
    ds_read_b64_tr_b16 v[210:211], v229 offset:43008
    v_mfma_f32_16x16x32_bf16 v[196:199], v[216:219], v[64:67], v[196:199]
    v_mfma_f32_16x16x32_bf16 v[200:203], v[212:215], v[120:123], v[200:203]
    v_mfma_f32_16x16x32_bf16 v[200:203], v[216:219], v[124:127], v[200:203]
    v_mfma_f32_16x16x32_bf16 v[204:207], v[212:215], v[132:135], v[204:207]
    v_mfma_f32_16x16x32_bf16 v[204:207], v[216:219], v[136:139], v[204:207]
    ds_read_b64_tr_b16 v[212:213], v229 offset:45056
    s_waitcnt lgkmcnt(5)
    v_mfma_f32_16x16x32_bf16 v[192:195], v[220:223], v[56:59], v[192:195]
    ds_read_b64_tr_b16 v[214:215], v229 offset:47104
    s_waitcnt lgkmcnt(4)
    v_mfma_f32_16x16x32_bf16 v[192:195], v[224:227], v[144:147], v[192:195]
    v_mfma_f32_16x16x32_bf16 v[196:199], v[220:223], v[68:71], v[196:199]
    v_mfma_f32_16x16x32_bf16 v[196:199], v[224:227], v[156:159], v[196:199]
    v_mfma_f32_16x16x32_bf16 v[200:203], v[220:223], v[128:131], v[200:203]
    v_mfma_f32_16x16x32_bf16 v[200:203], v[224:227], v[168:171], v[200:203]
    v_mfma_f32_16x16x32_bf16 v[204:207], v[220:223], v[140:143], v[204:207]
    v_mfma_f32_16x16x32_bf16 v[204:207], v[224:227], v[180:183], v[204:207]
    s_waitcnt lgkmcnt(2)
    v_mfma_f32_16x16x32_bf16 v[192:195], v[208:211], v[148:151], v[192:195]
    s_setprio 1
    s_waitcnt vmcnt(1) lgkmcnt(0)
    s_barrier
    v_mfma_f32_16x16x32_bf16 v[192:195], v[212:215], v[152:155], v[192:195]
    v_mfma_f32_16x16x32_bf16 v[196:199], v[208:211], v[160:163], v[196:199]
    v_mfma_f32_16x16x32_bf16 v[196:199], v[212:215], v[164:167], v[196:199]
    v_mfma_f32_16x16x32_bf16 v[200:203], v[208:211], v[172:175], v[200:203]
    v_mfma_f32_16x16x32_bf16 v[200:203], v[212:215], v[176:179], v[200:203]
    v_mfma_f32_16x16x32_bf16 v[204:207], v[208:211], v[184:187], v[204:207]
    v_mfma_f32_16x16x32_bf16 v[204:207], v[212:215], v[188:191], v[204:207]
    s_setprio 2
    s_add_u32 m0, s64, 122880
    s_add_u32 s62, s34, 222208
    buffer_load_dwordx4 v233, s[16:19], s62 offen lds
    s_add_u32 m0, s64, 126976
    s_add_u32 s62, s34, 259072
    buffer_load_dwordx4 v233, s[16:19], s62 offen lds
    v_cvt_pk_bf16_f32 v244, v192, v193
    v_cvt_pk_bf16_f32 v245, v194, v195
    v_cvt_pk_bf16_f32 v246, v196, v197
    v_cvt_pk_bf16_f32 v247, v198, v199
    s_add_u32 m0, s64, 131072
    s_add_u32 s62, s34, 295936
    buffer_load_dwordx4 v233, s[16:19], s62 offen lds
    v_cvt_pk_bf16_f32 v248, v200, v201
    v_cvt_pk_bf16_f32 v249, v202, v203
    v_cvt_pk_bf16_f32 v250, v204, v205
    s_add_u32 m0, s64, 135168
    s_add_u32 s62, s34, 332800
    buffer_load_dwordx4 v233, s[16:19], s62 offen lds
    v_cvt_pk_bf16_f32 v251, v206, v207
    s_nop 0
    v_permlane16_swap_b32 v244, v246
    s_add_u32 m0, s64, 139264
    s_add_u32 s62, s34, 369664
    buffer_load_dwordx4 v233, s[16:19], s62 offen lds
    v_permlane16_swap_b32 v245, v247
    v_permlane16_swap_b32 v248, v250
    v_permlane16_swap_b32 v249, v251
    s_add_u32 m0, s64, 143360
    s_add_u32 s62, s34, 406528
    buffer_load_dwordx4 v233, s[16:19], s62 offen lds
    s_mov_b32 s65, 20480
    buffer_store_dwordx4 v[244:247], v237, s[20:23], s65 offen sc1
    s_mov_b32 s65, 499712
    buffer_store_dwordx4 v[248:251], v237, s[20:23], s65 offen sc1
    s_add_u32 s56, s6, 5
    v_mov_b32 v252, s56
    buffer_store_dwordx2 v[252:253], v230, s[20:23], 0 offen sc1
    ds_read_b64_tr_b16 v[216:217], v238 offset:0
    ds_read_b64_tr_b16 v[218:219], v238 offset:2048
    ds_read_b64_tr_b16 v[220:221], v238 offset:4096
    ds_read_b64_tr_b16 v[222:223], v238 offset:6144
    ds_read_b64_tr_b16 v[224:225], v238 offset:8192
    ds_read_b64_tr_b16 v[226:227], v238 offset:10240
    s_setprio 0
    s_waitcnt lgkmcnt(4)
    v_mfma_f32_16x16x32_bf16 v[192:195], v[216:219], v[0:3], 0
    ds_read_b64_tr_b16 v[208:209], v238 offset:12288
    s_waitcnt lgkmcnt(3)
    v_mfma_f32_16x16x32_bf16 v[192:195], v[220:223], v[4:7], v[192:195]
    ds_read_b64_tr_b16 v[210:211], v238 offset:14336
    v_mfma_f32_16x16x32_bf16 v[196:199], v[216:219], v[12:15], 0
    ds_read_b64_tr_b16 v[212:213], v238 offset:16384
    v_mfma_f32_16x16x32_bf16 v[196:199], v[220:223], v[16:19], v[196:199]
    ds_read_b64_tr_b16 v[214:215], v238 offset:18432
    v_mfma_f32_16x16x32_bf16 v[200:203], v[216:219], v[72:75], 0
    v_mfma_f32_16x16x32_bf16 v[200:203], v[220:223], v[76:79], v[200:203]
    v_mfma_f32_16x16x32_bf16 v[204:207], v[216:219], v[84:87], 0
    v_mfma_f32_16x16x32_bf16 v[204:207], v[220:223], v[88:91], v[204:207]
    ds_read_b64_tr_b16 v[216:217], v238 offset:20480
    s_waitcnt lgkmcnt(5)
    v_mfma_f32_16x16x32_bf16 v[192:195], v[224:227], v[8:11], v[192:195]
    ds_read_b64_tr_b16 v[218:219], v238 offset:22528
    s_waitcnt lgkmcnt(4)
    v_mfma_f32_16x16x32_bf16 v[192:195], v[208:211], v[24:27], v[192:195]
    ds_read_b64_tr_b16 v[220:221], v238 offset:24576
    v_mfma_f32_16x16x32_bf16 v[196:199], v[224:227], v[20:23], v[196:199]
    ds_read_b64_tr_b16 v[222:223], v238 offset:26624
    v_mfma_f32_16x16x32_bf16 v[196:199], v[208:211], v[36:39], v[196:199]
    v_mfma_f32_16x16x32_bf16 v[200:203], v[224:227], v[80:83], v[200:203]
    v_mfma_f32_16x16x32_bf16 v[200:203], v[208:211], v[96:99], v[200:203]
    v_mfma_f32_16x16x32_bf16 v[204:207], v[224:227], v[92:95], v[204:207]
    v_mfma_f32_16x16x32_bf16 v[204:207], v[208:211], v[108:111], v[204:207]
    ds_read_b64_tr_b16 v[224:225], v238 offset:28672
    s_waitcnt lgkmcnt(5)
    v_mfma_f32_16x16x32_bf16 v[192:195], v[212:215], v[28:31], v[192:195]
    ds_read_b64_tr_b16 v[226:227], v238 offset:30720
    s_waitcnt lgkmcnt(4)
    v_mfma_f32_16x16x32_bf16 v[192:195], v[216:219], v[32:35], v[192:195]
    ds_read_b64_tr_b16 v[208:209], v238 offset:32768
    v_mfma_f32_16x16x32_bf16 v[196:199], v[212:215], v[40:43], v[196:199]
    ds_read_b64_tr_b16 v[210:211], v238 offset:34816
    v_mfma_f32_16x16x32_bf16 v[196:199], v[216:219], v[44:47], v[196:199]
    v_mfma_f32_16x16x32_bf16 v[200:203], v[212:215], v[100:103], v[200:203]
    v_mfma_f32_16x16x32_bf16 v[200:203], v[216:219], v[104:107], v[200:203]
    v_mfma_f32_16x16x32_bf16 v[204:207], v[212:215], v[112:115], v[204:207]
    v_mfma_f32_16x16x32_bf16 v[204:207], v[216:219], v[116:119], v[204:207]
    ds_read_b64_tr_b16 v[212:213], v238 offset:36864
    s_waitcnt lgkmcnt(5)
    v_mfma_f32_16x16x32_bf16 v[192:195], v[220:223], v[48:51], v[192:195]
    ds_read_b64_tr_b16 v[214:215], v238 offset:38912
    s_waitcnt lgkmcnt(4)
    v_mfma_f32_16x16x32_bf16 v[192:195], v[224:227], v[52:55], v[192:195]
    ds_read_b64_tr_b16 v[216:217], v238 offset:40960
    v_mfma_f32_16x16x32_bf16 v[196:199], v[220:223], v[60:63], v[196:199]
    ds_read_b64_tr_b16 v[218:219], v238 offset:43008
    v_mfma_f32_16x16x32_bf16 v[196:199], v[224:227], v[64:67], v[196:199]
    v_mfma_f32_16x16x32_bf16 v[200:203], v[220:223], v[120:123], v[200:203]
    v_mfma_f32_16x16x32_bf16 v[200:203], v[224:227], v[124:127], v[200:203]
    v_mfma_f32_16x16x32_bf16 v[204:207], v[220:223], v[132:135], v[204:207]
    v_mfma_f32_16x16x32_bf16 v[204:207], v[224:227], v[136:139], v[204:207]
    ds_read_b64_tr_b16 v[220:221], v238 offset:45056
    s_waitcnt lgkmcnt(5)
    v_mfma_f32_16x16x32_bf16 v[192:195], v[208:211], v[56:59], v[192:195]
    ds_read_b64_tr_b16 v[222:223], v238 offset:47104
    s_waitcnt lgkmcnt(4)
    v_mfma_f32_16x16x32_bf16 v[192:195], v[212:215], v[144:147], v[192:195]
    v_mfma_f32_16x16x32_bf16 v[196:199], v[208:211], v[68:71], v[196:199]
    v_mfma_f32_16x16x32_bf16 v[196:199], v[212:215], v[156:159], v[196:199]
    v_mfma_f32_16x16x32_bf16 v[200:203], v[208:211], v[128:131], v[200:203]
    v_mfma_f32_16x16x32_bf16 v[200:203], v[212:215], v[168:171], v[200:203]
    v_mfma_f32_16x16x32_bf16 v[204:207], v[208:211], v[140:143], v[204:207]
    v_mfma_f32_16x16x32_bf16 v[204:207], v[212:215], v[180:183], v[204:207]
    s_waitcnt lgkmcnt(2)
    v_mfma_f32_16x16x32_bf16 v[192:195], v[216:219], v[148:151], v[192:195]
    s_setprio 1
    s_waitcnt vmcnt(1) lgkmcnt(0)
    s_barrier
    v_mfma_f32_16x16x32_bf16 v[192:195], v[220:223], v[152:155], v[192:195]
    v_mfma_f32_16x16x32_bf16 v[196:199], v[216:219], v[160:163], v[196:199]
    v_mfma_f32_16x16x32_bf16 v[196:199], v[220:223], v[164:167], v[196:199]
    v_mfma_f32_16x16x32_bf16 v[200:203], v[216:219], v[172:175], v[200:203]
    v_mfma_f32_16x16x32_bf16 v[200:203], v[220:223], v[176:179], v[200:203]
    v_mfma_f32_16x16x32_bf16 v[204:207], v[216:219], v[184:187], v[204:207]
    v_mfma_f32_16x16x32_bf16 v[204:207], v[220:223], v[188:191], v[204:207]
    s_setprio 2
    s_nop 7
    v_cvt_pk_bf16_f32 v244, v192, v193
    v_cvt_pk_bf16_f32 v245, v194, v195
    v_cvt_pk_bf16_f32 v246, v196, v197
    v_cvt_pk_bf16_f32 v247, v198, v199
    v_cvt_pk_bf16_f32 v248, v200, v201
    v_cvt_pk_bf16_f32 v249, v202, v203
    v_cvt_pk_bf16_f32 v250, v204, v205
    v_cvt_pk_bf16_f32 v251, v206, v207
    s_nop 0
    v_permlane16_swap_b32 v244, v246
    v_permlane16_swap_b32 v245, v247
    v_permlane16_swap_b32 v248, v250
    v_permlane16_swap_b32 v249, v251
    s_mov_b32 s65, 24576
    buffer_store_dwordx4 v[244:247], v237, s[20:23], s65 offen sc1
    s_mov_b32 s65, 503808
    buffer_store_dwordx4 v[248:251], v237, s[20:23], s65 offen sc1
    s_add_u32 s56, s6, 6
    v_mov_b32 v252, s56
    buffer_store_dwordx2 v[252:253], v230, s[20:23], 0 offen sc1
    ds_read_b64_tr_b16 v[224:225], v228 offset:0
    ds_read_b64_tr_b16 v[226:227], v228 offset:2048
    ds_read_b64_tr_b16 v[208:209], v228 offset:4096
    ds_read_b64_tr_b16 v[210:211], v228 offset:6144
    ds_read_b64_tr_b16 v[212:213], v228 offset:8192
    ds_read_b64_tr_b16 v[214:215], v228 offset:10240
    s_setprio 0
    s_waitcnt lgkmcnt(4)
    v_mfma_f32_16x16x32_bf16 v[192:195], v[224:227], v[0:3], 0
    ds_read_b64_tr_b16 v[216:217], v228 offset:12288
    s_waitcnt lgkmcnt(3)
    v_mfma_f32_16x16x32_bf16 v[192:195], v[208:211], v[4:7], v[192:195]
    ds_read_b64_tr_b16 v[218:219], v228 offset:14336
    v_mfma_f32_16x16x32_bf16 v[196:199], v[224:227], v[12:15], 0
    ds_read_b64_tr_b16 v[220:221], v228 offset:16384
    v_mfma_f32_16x16x32_bf16 v[196:199], v[208:211], v[16:19], v[196:199]
    ds_read_b64_tr_b16 v[222:223], v228 offset:18432
    v_mfma_f32_16x16x32_bf16 v[200:203], v[224:227], v[72:75], 0
    v_mfma_f32_16x16x32_bf16 v[200:203], v[208:211], v[76:79], v[200:203]
    v_mfma_f32_16x16x32_bf16 v[204:207], v[224:227], v[84:87], 0
    v_mfma_f32_16x16x32_bf16 v[204:207], v[208:211], v[88:91], v[204:207]
    ds_read_b64_tr_b16 v[224:225], v228 offset:20480
    s_waitcnt lgkmcnt(5)
    v_mfma_f32_16x16x32_bf16 v[192:195], v[212:215], v[8:11], v[192:195]
    ds_read_b64_tr_b16 v[226:227], v228 offset:22528
    s_waitcnt lgkmcnt(4)
    v_mfma_f32_16x16x32_bf16 v[192:195], v[216:219], v[24:27], v[192:195]
    ds_read_b64_tr_b16 v[208:209], v228 offset:24576
    v_mfma_f32_16x16x32_bf16 v[196:199], v[212:215], v[20:23], v[196:199]
    ds_read_b64_tr_b16 v[210:211], v228 offset:26624
    v_mfma_f32_16x16x32_bf16 v[196:199], v[216:219], v[36:39], v[196:199]
    v_mfma_f32_16x16x32_bf16 v[200:203], v[212:215], v[80:83], v[200:203]
    v_mfma_f32_16x16x32_bf16 v[200:203], v[216:219], v[96:99], v[200:203]
    v_mfma_f32_16x16x32_bf16 v[204:207], v[212:215], v[92:95], v[204:207]
    v_mfma_f32_16x16x32_bf16 v[204:207], v[216:219], v[108:111], v[204:207]
    ds_read_b64_tr_b16 v[212:213], v228 offset:28672
    s_waitcnt lgkmcnt(5)
    v_mfma_f32_16x16x32_bf16 v[192:195], v[220:223], v[28:31], v[192:195]
    ds_read_b64_tr_b16 v[214:215], v228 offset:30720
    s_waitcnt lgkmcnt(4)
    v_mfma_f32_16x16x32_bf16 v[192:195], v[224:227], v[32:35], v[192:195]
    ds_read_b64_tr_b16 v[216:217], v228 offset:32768
    v_mfma_f32_16x16x32_bf16 v[196:199], v[220:223], v[40:43], v[196:199]
    ds_read_b64_tr_b16 v[218:219], v228 offset:34816
    v_mfma_f32_16x16x32_bf16 v[196:199], v[224:227], v[44:47], v[196:199]
    v_mfma_f32_16x16x32_bf16 v[200:203], v[220:223], v[100:103], v[200:203]
    v_mfma_f32_16x16x32_bf16 v[200:203], v[224:227], v[104:107], v[200:203]
    v_mfma_f32_16x16x32_bf16 v[204:207], v[220:223], v[112:115], v[204:207]
    v_mfma_f32_16x16x32_bf16 v[204:207], v[224:227], v[116:119], v[204:207]
    ds_read_b64_tr_b16 v[220:221], v228 offset:36864
    s_waitcnt lgkmcnt(5)
    v_mfma_f32_16x16x32_bf16 v[192:195], v[208:211], v[48:51], v[192:195]
    ds_read_b64_tr_b16 v[222:223], v228 offset:38912
    s_waitcnt lgkmcnt(4)
    v_mfma_f32_16x16x32_bf16 v[192:195], v[212:215], v[52:55], v[192:195]
    ds_read_b64_tr_b16 v[224:225], v228 offset:40960
    v_mfma_f32_16x16x32_bf16 v[196:199], v[208:211], v[60:63], v[196:199]
    ds_read_b64_tr_b16 v[226:227], v228 offset:43008
    v_mfma_f32_16x16x32_bf16 v[196:199], v[212:215], v[64:67], v[196:199]
    v_mfma_f32_16x16x32_bf16 v[200:203], v[208:211], v[120:123], v[200:203]
    v_mfma_f32_16x16x32_bf16 v[200:203], v[212:215], v[124:127], v[200:203]
    v_mfma_f32_16x16x32_bf16 v[204:207], v[208:211], v[132:135], v[204:207]
    v_mfma_f32_16x16x32_bf16 v[204:207], v[212:215], v[136:139], v[204:207]
    ds_read_b64_tr_b16 v[208:209], v228 offset:45056
    s_waitcnt lgkmcnt(5)
    v_mfma_f32_16x16x32_bf16 v[192:195], v[216:219], v[56:59], v[192:195]
    ds_read_b64_tr_b16 v[210:211], v228 offset:47104
    s_waitcnt lgkmcnt(4)
    v_mfma_f32_16x16x32_bf16 v[192:195], v[220:223], v[144:147], v[192:195]
    v_mfma_f32_16x16x32_bf16 v[196:199], v[216:219], v[68:71], v[196:199]
    v_mfma_f32_16x16x32_bf16 v[196:199], v[220:223], v[156:159], v[196:199]
    v_mfma_f32_16x16x32_bf16 v[200:203], v[216:219], v[128:131], v[200:203]
    v_mfma_f32_16x16x32_bf16 v[200:203], v[220:223], v[168:171], v[200:203]
    v_mfma_f32_16x16x32_bf16 v[204:207], v[216:219], v[140:143], v[204:207]
    v_mfma_f32_16x16x32_bf16 v[204:207], v[220:223], v[180:183], v[204:207]
    s_waitcnt lgkmcnt(2)
    v_mfma_f32_16x16x32_bf16 v[192:195], v[224:227], v[148:151], v[192:195]
    s_setprio 1
    s_waitcnt vmcnt(1) lgkmcnt(0)
    s_barrier
    v_mfma_f32_16x16x32_bf16 v[192:195], v[208:211], v[152:155], v[192:195]
    v_mfma_f32_16x16x32_bf16 v[196:199], v[224:227], v[160:163], v[196:199]
    v_mfma_f32_16x16x32_bf16 v[196:199], v[208:211], v[164:167], v[196:199]
    v_mfma_f32_16x16x32_bf16 v[200:203], v[224:227], v[172:175], v[200:203]
    v_mfma_f32_16x16x32_bf16 v[200:203], v[208:211], v[176:179], v[200:203]
    v_mfma_f32_16x16x32_bf16 v[204:207], v[224:227], v[184:187], v[204:207]
    v_mfma_f32_16x16x32_bf16 v[204:207], v[208:211], v[188:191], v[204:207]
    s_setprio 2
    s_nop 7
    v_cvt_pk_bf16_f32 v244, v192, v193
    v_cvt_pk_bf16_f32 v245, v194, v195
    v_cvt_pk_bf16_f32 v246, v196, v197
    v_cvt_pk_bf16_f32 v247, v198, v199
    v_cvt_pk_bf16_f32 v248, v200, v201
    v_cvt_pk_bf16_f32 v249, v202, v203
    v_cvt_pk_bf16_f32 v250, v204, v205
    v_cvt_pk_bf16_f32 v251, v206, v207
    s_nop 0
    v_permlane16_swap_b32 v244, v246
    v_permlane16_swap_b32 v245, v247
    v_permlane16_swap_b32 v248, v250
    v_permlane16_swap_b32 v249, v251
    s_mov_b32 s65, 28672
    buffer_store_dwordx4 v[244:247], v237, s[20:23], s65 offen sc1
    s_mov_b32 s65, 507904
    buffer_store_dwordx4 v[248:251], v237, s[20:23], s65 offen sc1
    s_lshl_b32 s56, s28, 7
    s_lshl_b32 s57, s29, 3
    s_add_u32 s56, s56, s57
    s_add_u32 s56, s56, 44843008
    s_cmp_eq_u32 s30, 4
    s_cselect_b32 s56, s56, 0x7ffffff0
    v_mov_b32 v230, 0x7ffffff0
    v_writelane_b32 v230, s56, 0
    s_add_u32 s56, s6, 7
    v_mov_b32 v252, s56
    buffer_store_dwordx2 v[252:253], v230, s[20:23], 0 offen sc1
    ds_read_b64_tr_b16 v[212:213], v229 offset:0
    ds_read_b64_tr_b16 v[214:215], v229 offset:2048
    ds_read_b64_tr_b16 v[216:217], v229 offset:4096
    ds_read_b64_tr_b16 v[218:219], v229 offset:6144
    ds_read_b64_tr_b16 v[220:221], v229 offset:8192
    ds_read_b64_tr_b16 v[222:223], v229 offset:10240
    s_setprio 0
    s_waitcnt lgkmcnt(4)
    v_mfma_f32_16x16x32_bf16 v[192:195], v[212:215], v[0:3], 0
    ds_read_b64_tr_b16 v[224:225], v229 offset:12288
    s_waitcnt lgkmcnt(3)
    v_mfma_f32_16x16x32_bf16 v[192:195], v[216:219], v[4:7], v[192:195]
    ds_read_b64_tr_b16 v[226:227], v229 offset:14336
    v_mfma_f32_16x16x32_bf16 v[196:199], v[212:215], v[12:15], 0
    ds_read_b64_tr_b16 v[208:209], v229 offset:16384
    v_mfma_f32_16x16x32_bf16 v[196:199], v[216:219], v[16:19], v[196:199]
    ds_read_b64_tr_b16 v[210:211], v229 offset:18432
    v_mfma_f32_16x16x32_bf16 v[200:203], v[212:215], v[72:75], 0
    v_mfma_f32_16x16x32_bf16 v[200:203], v[216:219], v[76:79], v[200:203]
    v_mfma_f32_16x16x32_bf16 v[204:207], v[212:215], v[84:87], 0
    v_mfma_f32_16x16x32_bf16 v[204:207], v[216:219], v[88:91], v[204:207]
    ds_read_b64_tr_b16 v[212:213], v229 offset:20480
    s_waitcnt lgkmcnt(5)
    v_mfma_f32_16x16x32_bf16 v[192:195], v[220:223], v[8:11], v[192:195]
    ds_read_b64_tr_b16 v[214:215], v229 offset:22528
    s_waitcnt lgkmcnt(4)
    v_mfma_f32_16x16x32_bf16 v[192:195], v[224:227], v[24:27], v[192:195]
    ds_read_b64_tr_b16 v[216:217], v229 offset:24576
    v_mfma_f32_16x16x32_bf16 v[196:199], v[220:223], v[20:23], v[196:199]
    ds_read_b64_tr_b16 v[218:219], v229 offset:26624
    v_mfma_f32_16x16x32_bf16 v[196:199], v[224:227], v[36:39], v[196:199]
    v_mfma_f32_16x16x32_bf16 v[200:203], v[220:223], v[80:83], v[200:203]
    v_mfma_f32_16x16x32_bf16 v[200:203], v[224:227], v[96:99], v[200:203]
    v_mfma_f32_16x16x32_bf16 v[204:207], v[220:223], v[92:95], v[204:207]
    v_mfma_f32_16x16x32_bf16 v[204:207], v[224:227], v[108:111], v[204:207]
    ds_read_b64_tr_b16 v[220:221], v229 offset:28672
    s_waitcnt lgkmcnt(5)
    v_mfma_f32_16x16x32_bf16 v[192:195], v[208:211], v[28:31], v[192:195]
    ds_read_b64_tr_b16 v[222:223], v229 offset:30720
    s_waitcnt lgkmcnt(4)
    v_mfma_f32_16x16x32_bf16 v[192:195], v[212:215], v[32:35], v[192:195]
    ds_read_b64_tr_b16 v[224:225], v229 offset:32768
    v_mfma_f32_16x16x32_bf16 v[196:199], v[208:211], v[40:43], v[196:199]
    ds_read_b64_tr_b16 v[226:227], v229 offset:34816
    v_mfma_f32_16x16x32_bf16 v[196:199], v[212:215], v[44:47], v[196:199]
    v_mfma_f32_16x16x32_bf16 v[200:203], v[208:211], v[100:103], v[200:203]
    v_mfma_f32_16x16x32_bf16 v[200:203], v[212:215], v[104:107], v[200:203]
    v_mfma_f32_16x16x32_bf16 v[204:207], v[208:211], v[112:115], v[204:207]
    v_mfma_f32_16x16x32_bf16 v[204:207], v[212:215], v[116:119], v[204:207]
    ds_read_b64_tr_b16 v[208:209], v229 offset:36864
    s_waitcnt lgkmcnt(5)
    v_mfma_f32_16x16x32_bf16 v[192:195], v[216:219], v[48:51], v[192:195]
    ds_read_b64_tr_b16 v[210:211], v229 offset:38912
    s_waitcnt lgkmcnt(4)
    v_mfma_f32_16x16x32_bf16 v[192:195], v[220:223], v[52:55], v[192:195]
    ds_read_b64_tr_b16 v[212:213], v229 offset:40960
    v_mfma_f32_16x16x32_bf16 v[196:199], v[216:219], v[60:63], v[196:199]
    ds_read_b64_tr_b16 v[214:215], v229 offset:43008
    v_mfma_f32_16x16x32_bf16 v[196:199], v[220:223], v[64:67], v[196:199]
    v_mfma_f32_16x16x32_bf16 v[200:203], v[216:219], v[120:123], v[200:203]
    v_mfma_f32_16x16x32_bf16 v[200:203], v[220:223], v[124:127], v[200:203]
    v_mfma_f32_16x16x32_bf16 v[204:207], v[216:219], v[132:135], v[204:207]
    v_mfma_f32_16x16x32_bf16 v[204:207], v[220:223], v[136:139], v[204:207]
    ds_read_b64_tr_b16 v[216:217], v229 offset:45056
    s_waitcnt lgkmcnt(5)
    v_mfma_f32_16x16x32_bf16 v[192:195], v[224:227], v[56:59], v[192:195]
    ds_read_b64_tr_b16 v[218:219], v229 offset:47104
    s_waitcnt lgkmcnt(4)
    v_mfma_f32_16x16x32_bf16 v[192:195], v[208:211], v[144:147], v[192:195]
    v_mfma_f32_16x16x32_bf16 v[196:199], v[224:227], v[68:71], v[196:199]
    v_mfma_f32_16x16x32_bf16 v[196:199], v[208:211], v[156:159], v[196:199]
    v_mfma_f32_16x16x32_bf16 v[200:203], v[224:227], v[128:131], v[200:203]
    v_mfma_f32_16x16x32_bf16 v[200:203], v[208:211], v[168:171], v[200:203]
    v_mfma_f32_16x16x32_bf16 v[204:207], v[224:227], v[140:143], v[204:207]
    v_mfma_f32_16x16x32_bf16 v[204:207], v[208:211], v[180:183], v[204:207]
    s_waitcnt lgkmcnt(2)
    v_mfma_f32_16x16x32_bf16 v[192:195], v[212:215], v[148:151], v[192:195]
    s_waitcnt lgkmcnt(0)
    v_mfma_f32_16x16x32_bf16 v[192:195], v[216:219], v[152:155], v[192:195]
    v_mfma_f32_16x16x32_bf16 v[196:199], v[212:215], v[160:163], v[196:199]
    v_mfma_f32_16x16x32_bf16 v[196:199], v[216:219], v[164:167], v[196:199]
    v_mfma_f32_16x16x32_bf16 v[200:203], v[212:215], v[172:175], v[200:203]
    v_mfma_f32_16x16x32_bf16 v[200:203], v[216:219], v[176:179], v[200:203]
    v_mfma_f32_16x16x32_bf16 v[204:207], v[212:215], v[184:187], v[204:207]
    v_mfma_f32_16x16x32_bf16 v[204:207], v[216:219], v[188:191], v[204:207]
    s_setprio 2
    s_nop 7
    v_cvt_pk_bf16_f32 v244, v192, v193
    v_cvt_pk_bf16_f32 v245, v194, v195
    v_cvt_pk_bf16_f32 v246, v196, v197
    v_cvt_pk_bf16_f32 v247, v198, v199
    v_cvt_pk_bf16_f32 v248, v200, v201
    v_cvt_pk_bf16_f32 v249, v202, v203
    v_cvt_pk_bf16_f32 v250, v204, v205
    v_cvt_pk_bf16_f32 v251, v206, v207
    s_nop 0
    v_permlane16_swap_b32 v244, v246
    v_permlane16_swap_b32 v245, v247
    v_permlane16_swap_b32 v248, v250
    v_permlane16_swap_b32 v249, v251
    s_mov_b32 s65, 32768
    buffer_store_dwordx4 v[244:247], v237, s[20:23], s65 offen sc1
    s_mov_b32 s65, 512000
    buffer_store_dwordx4 v[248:251], v237, s[20:23], s65 offen sc1
Lfin_4:
    s_setprio 0
    s_load_dwordx2 s[12:13], s[0:1], 80
    v_lshrrev_b32 v40, 9, v239
    v_mul_u32_u24 v41, 36864, v40
    v_bfe_u32 v40, v239, 7, 2
    v_lshl_add_u32 v41, v40, 9, v41
    v_and_b32 v42, 0x70, v239
    v_add_u32 v41, v41, v42
    v_mul_u32_u24 v44, 72, v42
    v_lshl_add_u32 v44, v40, 4, v44
    s_lshl_b32 s56, s28, 2
    s_and_b32 s57, s29, 3
    s_add_u32 s56, s56, s57
    s_lshr_b32 s57, s29, 2
    s_add_u32 s57, s57, 6
    s_lshl_b32 s57, s57, 1
    s_add_u32 s57, s57, s32
    s_mul_i32 s58, s56, 479232
    s_lshl_b32 s59, s57, 11
    s_add_u32 s58, s58, s59
    s_lshl_b32 s59, s31, 7
    s_add_u32 s58, s58, s59
    v_add_u32 v41, s58, v41
    s_mul_i32 s56, s56, 36864
    s_mul_i32 s59, s31, 9216
    s_add_u32 s56, s56, s59
    s_lshl_b32 s57, s57, 6
    s_add_u32 s56, s56, s57
    v_mov_b32 v43, 0x7ffffff0
    v_cmp_gt_u32 vcc, 512, v239
    v_add_u32 v44, s56, v44
    s_nop 0
    v_cndmask_b32 v42, v43, v41, vcc
    v_cndmask_b32 v44, v43, v44, vcc
    s_lshl_b32 s56, s28, 7
    s_add_u32 s56, s56, 44843008
    v_bfe_u32 v45, v239, 4, 4
    s_and_b32 s57, s29, 3
    s_add_u32 s57, s57, 12
    v_mov_b32 v46, s57
    v_cmp_gt_u32 vcc, 12, v45
    s_nop 1
    v_cndmask_b32 v45, v46, v45, vcc
    v_lshl_add_u32 v45, v45, 3, s56
    v_mov_b32 v48, 0
    v_mov_b32 v49, 0
    v_mov_b32 v50, 0
    v_mov_b32 v51, 0
    v_mov_b32 v52, 0
    v_mov_b32 v53, 0
    v_mov_b32 v54, 0
    v_mov_b32 v55, 0
    s_mov_b32 s66, 0x00003f80
    s_mov_b32 s67, 0x3f800000
    s_waitcnt vmcnt(0) lgkmcnt(0)
    s_barrier
    s_and_b32 s13, s13, 0xffff
    s_mov_b32 s14, 2359296
    s_mov_b32 s15, 0x00020000
    s_cmp_lg_u32 s30, 4
    s_cbranch_scc1 Lq_8
    v_lshrrev_b32 v46, 4, v239
    v_cmp_eq_u32 vcc, s29, v46
    s_add_u32 s56, s6, 9
    v_mov_b32 v252, s56
    s_cmp_lt_u32 s29, 4
    s_cselect_b32 s57, 7, 9
    v_cndmask_b32 v46, v43, v45, vcc
    buffer_store_dwordx2 v[252:253], v46, s[20:23], 0 offen sc1
Lpollf_9:
    buffer_load_dwordx2 v[46:47], v45, s[20:23], 0 offen sc1
    s_waitcnt vmcnt(0)
    s_add_u32 s59, s6, s57
    v_subrev_u32 v46, s59, v46
    v_xor_b32 v47, s7, v47
    v_lshrrev_b32 v46, 4, v46
    v_or_b32 v46, v46, v47
    v_cmp_ne_u32 vcc, 0, v46
    s_cmp_eq_u64 vcc, 0
    s_cbranch_scc1 Lpdf_10
    s_sleep 6
    s_sub_u32 s5, s5, 1
    s_cbranch_scc0 Lpollf_9
    s_mov_b32 s5, 0
Lpdf_10:
Lq_8:
    s_barrier
    s_mov_b32 s62, 0
    buffer_load_dwordx4 v[0:3], v41, s[20:23], s62 offen sc1
    s_mov_b32 s62, 73728
    buffer_load_dwordx4 v[4:7], v41, s[20:23], s62 offen sc1
    s_mov_b32 s62, 147456
    buffer_load_dwordx4 v[8:11], v41, s[20:23], s62 offen sc1
    s_mov_b32 s62, 221184
    buffer_load_dwordx4 v[12:15], v41, s[20:23], s62 offen sc1
    s_mov_b32 s62, 294912
    buffer_load_dwordx4 v[16:19], v41, s[20:23], s62 offen sc1
    s_mov_b32 s62, 368640
    buffer_load_dwordx4 v[20:23], v41, s[20:23], s62 offen sc1
    s_mov_b32 s62, 442368
    buffer_load_dwordx4 v[24:27], v42, s[20:23], s62 offen sc1
    s_waitcnt vmcnt(6)
    v_dot2c_f32_bf16 v48, s66, v0
    v_dot2c_f32_bf16 v49, s67, v0
    v_dot2c_f32_bf16 v50, s66, v1
    v_dot2c_f32_bf16 v51, s67, v1
    v_dot2c_f32_bf16 v52, s66, v2
    v_dot2c_f32_bf16 v53, s67, v2
    v_dot2c_f32_bf16 v54, s66, v3
    v_dot2c_f32_bf16 v55, s67, v3
    s_waitcnt vmcnt(5)
    v_dot2c_f32_bf16 v48, s66, v4
    v_dot2c_f32_bf16 v49, s67, v4
    v_dot2c_f32_bf16 v50, s66, v5
    v_dot2c_f32_bf16 v51, s67, v5
    v_dot2c_f32_bf16 v52, s66, v6
    v_dot2c_f32_bf16 v53, s67, v6
    v_dot2c_f32_bf16 v54, s66, v7
    v_dot2c_f32_bf16 v55, s67, v7
    s_waitcnt vmcnt(4)
    v_dot2c_f32_bf16 v48, s66, v8
    v_dot2c_f32_bf16 v49, s67, v8
    v_dot2c_f32_bf16 v50, s66, v9
    v_dot2c_f32_bf16 v51, s67, v9
    v_dot2c_f32_bf16 v52, s66, v10
    v_dot2c_f32_bf16 v53, s67, v10
    v_dot2c_f32_bf16 v54, s66, v11
    v_dot2c_f32_bf16 v55, s67, v11
    s_waitcnt vmcnt(3)
    v_dot2c_f32_bf16 v48, s66, v12
    v_dot2c_f32_bf16 v49, s67, v12
    v_dot2c_f32_bf16 v50, s66, v13
    v_dot2c_f32_bf16 v51, s67, v13
    v_dot2c_f32_bf16 v52, s66, v14
    v_dot2c_f32_bf16 v53, s67, v14
    v_dot2c_f32_bf16 v54, s66, v15
    v_dot2c_f32_bf16 v55, s67, v15
    s_waitcnt vmcnt(2)
    v_dot2c_f32_bf16 v48, s66, v16
    v_dot2c_f32_bf16 v49, s67, v16
    v_dot2c_f32_bf16 v50, s66, v17
    v_dot2c_f32_bf16 v51, s67, v17
    v_dot2c_f32_bf16 v52, s66, v18
    v_dot2c_f32_bf16 v53, s67, v18
    v_dot2c_f32_bf16 v54, s66, v19
    v_dot2c_f32_bf16 v55, s67, v19
    s_waitcnt vmcnt(1)
    v_dot2c_f32_bf16 v48, s66, v20
    v_dot2c_f32_bf16 v49, s67, v20
    v_dot2c_f32_bf16 v50, s66, v21
    v_dot2c_f32_bf16 v51, s67, v21
    v_dot2c_f32_bf16 v52, s66, v22
    v_dot2c_f32_bf16 v53, s67, v22
    v_dot2c_f32_bf16 v54, s66, v23
    v_dot2c_f32_bf16 v55, s67, v23
    s_mov_b32 s56, 0x3f317218
    s_nop 1
    v_mov_b32 v56, v48
    v_mov_b32 v57, v49
    v_mov_b32 v58, v50
    v_mov_b32 v59, v51
    v_mov_b32 v60, v52
    v_mov_b32 v61, v53
    v_mov_b32 v62, v54
    v_mov_b32 v63, v55
    v_permlane32_swap_b32 v48, v56
    v_permlane32_swap_b32 v49, v57
    v_permlane32_swap_b32 v50, v58
    v_permlane32_swap_b32 v51, v59
    v_permlane32_swap_b32 v52, v60
    v_permlane32_swap_b32 v53, v61
    v_permlane32_swap_b32 v54, v62
    v_permlane32_swap_b32 v55, v63
    v_add_f32 v48, v48, v56
    v_add_f32 v49, v49, v57
    v_add_f32 v50, v50, v58
    v_add_f32 v51, v51, v59
    v_add_f32 v52, v52, v60
    v_add_f32 v53, v53, v61
    v_add_f32 v54, v54, v62
    v_add_f32 v55, v55, v63
    s_waitcnt vmcnt(0)
    v_lshlrev_b32 v56, 16, v24
    v_and_b32 v57, 0xffff0000, v24
    v_lshlrev_b32 v58, 16, v25
    v_and_b32 v59, 0xffff0000, v25
    v_lshlrev_b32 v60, 16, v26
    v_and_b32 v61, 0xffff0000, v26
    v_lshlrev_b32 v62, 16, v27
    v_and_b32 v63, 0xffff0000, v27
    v_fmac_f32 v56, s56, v48
    v_fmac_f32 v57, s56, v49
    v_fmac_f32 v58, s56, v50
    v_fmac_f32 v59, s56, v51
    v_fmac_f32 v60, s56, v52
    v_fmac_f32 v61, s56, v53
    v_fmac_f32 v62, s56, v54
    v_fmac_f32 v63, s56, v55
    v_cvt_pk_bf16_f32 v28, v56, v57
    v_cvt_pk_bf16_f32 v29, v58, v59
    v_cvt_pk_bf16_f32 v30, v60, v61
    v_cvt_pk_bf16_f32 v31, v62, v63
    buffer_store_dwordx4 v[28:31], v44, s[12:15], 0 offen
    s_endpgm
Lhelp_2:
    s_load_dwordx2 s[8:9], s[0:1], 0
    s_load_dwordx2 s[12:13], s[0:1], 8
    s_load_dwordx2 s[16:17], s[0:1], 16
    s_load_dwordx2 s[24:25], s[0:1], 24
    s_load_dwordx2 s[40:41], s[0:1], 32
    s_load_dwordx2 s[44:45], s[0:1], 40
    s_load_dwordx2 s[48:49], s[0:1], 80
    s_load_dwordx2 s[52:53], s[0:1], 88
    s_load_dwordx2 s[20:21], s[0:1], 96
    v_lshrrev_b32 v1, 6, v0
    v_and_b32 v241, 63, v0
    v_readfirstlane_b32 s30, v1
    s_sub_u32 s28, s2, 192
    v_lshlrev_b32 v239, 4, v241
    v_lshlrev_b32 v238, 4, v0
    s_and_b32 s31, s30, 3
    s_lshr_b32 s32, s30, 2
    s_waitcnt lgkmcnt(0)
    s_and_b32 s53, s53, 0xffff
    s_mov_b32 s54, 256
    s_mov_b32 s55, 0x00020000
    s_and_b32 s13, s13, 0xffff
    s_mov_b32 s14, 2359296
    s_mov_b32 s15, 0x00020000
    s_and_b32 s17, s17, 0xffff
    s_mov_b32 s18, 2359296
    s_mov_b32 s19, 0x00020000
    s_and_b32 s9, s9, 0xffff
    s_mov_b32 s10, 2359296
    s_mov_b32 s11, 0x00020000
    s_and_b32 s21, s21, 0xffff
    s_mov_b32 s22, 49049600
    s_mov_b32 s23, 0x00020000
    s_and_b32 s25, s25, 0xffff
    s_mov_b32 s26, 4608
    s_mov_b32 s27, 0x00020000
    s_and_b32 s41, s41, 0xffff
    s_mov_b32 s42, 2359296
    s_mov_b32 s43, 0x00020000
    s_and_b32 s45, s45, 0xffff
    s_mov_b32 s46, 1152
    s_mov_b32 s47, 0x00020000
    s_and_b32 s49, s49, 0xffff
    s_mov_b32 s50, 2359296
    s_mov_b32 s51, 0x00020000
    s_lshl_b32 s56, s28, 3
    s_add_u32 s56, s56, s30
    s_cmp_lg_u32 s56, 7
    s_cbranch_scc1 Ltag_11
    s_memrealtime s[56:57]
    v_mov_b32 v1, 0x7ffffff0
    v_writelane_b32 v1, 0, 0
    s_waitcnt lgkmcnt(0)
    s_lshl_b64 s[56:57], s[56:57], 4
    s_bitset1_b32 s57, 31
    v_mov_b32 v2, s56
    v_mov_b32 v3, s57
    buffer_store_dwordx2 v[2:3], v1, s[52:55], 0 offen sc1
Ltag_11:
    s_cmp_lg_u32 s30, 0
    s_cbranch_scc1 Lpw_12
    s_lshl_b32 s56, s28, 3
    s_add_u32 s56, s56, 44846592
    v_mov_b32 v1, 0x7ffffff0
    v_mov_b32 v2, 0
    v_mov_b32 v3, 0
    v_writelane_b32 v1, s56, 0
    buffer_store_dwordx2 v[2:3], v1, s[20:23], 0 offen sc1
Lpw_12:
    s_cmp_lg_u32 s30, 6
    s_cbranch_scc1 Lct_13
    s_getpc_b64 s[56:57]
Lhere_14:
    s_sub_u32 s56, s56, Lhere_14-parallel_sum__ssm_conv_h3__dense_activation_mish__prompt_kernel
    s_subb_u32 s57, s57, 0
    s_lshr_b32 s58, s28, 3
    s_lshl_b32 s58, s58, 13
    v_lshl_add_u32 v4, v241, 7, s58
    v_add_u32 v5, 0x10000, v4
    v_min_u32 v4, Lend_1-parallel_sum__ssm_conv_h3__dense_activation_mish__prompt_kernel, v4
    v_min_u32 v5, Lend_1-parallel_sum__ssm_conv_h3__dense_activation_mish__prompt_kernel, v5
    global_load_dword v140, v4, s[56:57]
    global_load_dword v140, v5, s[56:57]
Lct_13:
    s_mul_i32 s56, s28, 36864
    s_sub_u32 s57, s56, 4608
    v_add_u32 v4, s57, v238
    s_sub_u32 s57, s56, 1152
    v_add_u32 v5, s57, v238
    s_lshl_b32 s58, s30, 10
    s_add_u32 m0, s58, 0
    s_nop 0
    buffer_load_dwordx4 v4, s[12:15], 0 offen lds
    v_add_u32 v4, 8192, v4
    s_add_u32 m0, s58, 41984
    s_nop 0
    buffer_load_dwordx4 v5, s[16:19], 0 offen lds
    v_add_u32 v5, 8192, v5
    s_add_u32 m0, s58, 8192
    s_nop 0
    buffer_load_dwordx4 v4, s[12:15], 0 offen lds
    v_add_u32 v4, 8192, v4
    s_add_u32 m0, s58, 50176
    s_nop 0
    buffer_load_dwordx4 v5, s[16:19], 0 offen lds
    v_add_u32 v5, 8192, v5
    s_add_u32 m0, s58, 16384
    s_nop 0
    buffer_load_dwordx4 v4, s[12:15], 0 offen lds
    v_add_u32 v4, 8192, v4
    s_add_u32 m0, s58, 58368
    s_nop 0
    buffer_load_dwordx4 v5, s[16:19], 0 offen lds
    v_add_u32 v5, 8192, v5
    s_add_u32 m0, s58, 24576
    s_nop 0
    buffer_load_dwordx4 v4, s[12:15], 0 offen lds
    v_add_u32 v4, 8192, v4
    s_add_u32 m0, s58, 66560
    s_nop 0
    buffer_load_dwordx4 v5, s[16:19], 0 offen lds
    v_add_u32 v5, 8192, v5
    s_add_u32 m0, s58, 32768
    s_nop 0
    buffer_load_dwordx4 v4, s[12:15], 0 offen lds
    v_add_u32 v4, 8192, v4
    s_cmp_ge_u32 s30, 6
    s_cbranch_scc1 Ld_15
    s_add_u32 m0, s58, 74752
    s_nop 0
    buffer_load_dwordx4 v5, s[16:19], 0 offen lds
Ld_15:
    v_add_u32 v5, 8192, v5
    s_cmp_ge_u32 s30, 1
    s_cbranch_scc1 Ld_16
    s_add_u32 m0, s58, 40960
    s_nop 0
    buffer_load_dwordx4 v4, s[12:15], 0 offen lds
Ld_16:
    v_add_u32 v4, 8192, v4
    s_cmp_ge_u32 s30, 5
    s_cbranch_scc1 Ld_17
    s_add_u32 m0, s58, 80896
    s_nop 0
    buffer_load_dwordx4 v238, s[24:27], 0 offen lds
Ld_17:
    v_mov_b32 v4, 0
    s_lshl_b32 s56, s30, 12
    s_add_u32 s57, s56, 86016
    v_lshl_add_u32 v117, v239, 2, s57
    v_add_u32 v118, s57, v239
    s_lshl_b32 s57, s28, 2
    s_sub_u32 s57, 252, s57
    s_mul_i32 s57, s57, 18432
    s_add_u32 s62, s56, s57
    s_add_u32 s62, s62, 37765120
    v_mov_b32 v120, v0
    s_mov_b32 s36, s30
    s_movk_i32 s63, 3641
    s_waitcnt vmcnt(0)
    s_barrier
    buffer_load_dwordx2 v[6:7], v4, s[52:55], 0 offen sc1
    s_mul_i32 s64, s28, 36864
    s_lshl_b32 s58, s30, 10
    s_add_u32 m0, s58, 118784
    s_nop 0
    buffer_load_dwordx4 v238, s[8:11], s64 offen lds
    s_add_u32 s64, s64, 8192
    s_add_u32 m0, s58, 126976
    s_nop 0
    buffer_load_dwordx4 v238, s[8:11], s64 offen lds
    s_add_u32 s64, s64, 8192
    s_add_u32 m0, s58, 135168
    s_nop 0
    buffer_load_dwordx4 v238, s[8:11], s64 offen lds
    s_add_u32 s64, s64, 8192
    s_add_u32 m0, s58, 143360
    s_nop 0
    buffer_load_dwordx4 v238, s[8:11], s64 offen lds
    s_add_u32 s64, s64, 8192
    s_cmp_ge_u32 s30, 4
    s_cbranch_scc1 Ld_18
    s_add_u32 m0, s58, 151552
    s_nop 0
    buffer_load_dwordx4 v238, s[8:11], s64 offen lds
Ld_18:
    s_add_u32 s64, s64, 8192
    v_mov_b32 v2, 0
    v_mov_b32 v3, 0
    v_lshrrev_b32 v121, 1, v239
    v_add_u32 v121, 159744, v121
    ds_write_b64 v121, v[2:3]
Lprep_19:
    v_mul_u32_u24 v2, s63, v120
    v_lshrrev_b32 v2, 20, v2
    v_mul_u32_u24 v3, 288, v2
    v_sub_u32 v3, v120, v3
    v_sub_u32 v2, 3, v2
    v_mul_u32_u24 v116, 9216, v2
    v_lshl_add_u32 v116, v3, 2, v116
    v_lshlrev_b32 v119, 4, v3
    v_add_u32 v119, 80896, v119
    ds_read_b128 v[8:11], v119
    ds_read_b32 v12, v116 offset:0
    ds_read_b32 v13, v116 offset:1152
    ds_read_b32 v14, v116 offset:2304
    ds_read_b32 v15, v116 offset:3456
    ds_read_b32 v16, v116 offset:4608
    ds_read_b32 v17, v116 offset:5760
    ds_read_b32 v18, v116 offset:6912
    ds_read_b32 v19, v116 offset:8064
    ds_read_b32 v20, v116 offset:9216
    ds_read_b32 v21, v116 offset:10368
    ds_read_b32 v22, v116 offset:11520
    ds_read_b32 v23, v116 offset:12672
    s_waitcnt lgkmcnt(6)
    ds_read_b32 v24, v116 offset:41984
    ds_read_b32 v25, v116 offset:43136
    ds_read_b32 v26, v116 offset:44288
    ds_read_b32 v27, v116 offset:45440
    ds_read_b32 v28, v116 offset:46592
    ds_read_b32 v29, v116 offset:47744
    ds_read_b32 v30, v116 offset:48896
    ds_read_b32 v31, v116 offset:50048
    ds_read_b32 v32, v116 offset:51200
    v_lshlrev_b32 v58, 16, v8
    v_lshlrev_b32 v59, 16, v10
    v_and_b32 v60, 0xffff0000, v8
    v_and_b32 v61, 0xffff0000, v10
    v_lshlrev_b32 v62, 16, v9
    v_lshlrev_b32 v63, 16, v11
    v_and_b32 v64, 0xffff0000, v9
    v_and_b32 v65, 0xffff0000, v11
    s_waitcnt lgkmcnt(9)
    v_lshlrev_b32 v34, 16, v12
    v_and_b32 v35, 0xffff0000, v12
    v_lshlrev_b32 v36, 16, v13
    v_and_b32 v37, 0xffff0000, v13
    v_lshlrev_b32 v38, 16, v14
    v_and_b32 v39, 0xffff0000, v14
    v_lshlrev_b32 v40, 16, v15
    v_and_b32 v41, 0xffff0000, v15
    v_lshlrev_b32 v42, 16, v16
    v_and_b32 v43, 0xffff0000, v16
    v_lshlrev_b32 v44, 16, v17
    v_and_b32 v45, 0xffff0000, v17
    v_lshlrev_b32 v46, 16, v18
    v_and_b32 v47, 0xffff0000, v18
    v_lshlrev_b32 v48, 16, v19
    v_and_b32 v49, 0xffff0000, v19
    v_lshlrev_b32 v50, 16, v20
    v_and_b32 v51, 0xffff0000, v20
    v_lshlrev_b32 v52, 16, v21
    v_and_b32 v53, 0xffff0000, v21
    v_lshlrev_b32 v54, 16, v22
    v_and_b32 v55, 0xffff0000, v22
    v_lshlrev_b32 v56, 16, v23
    v_and_b32 v57, 0xffff0000, v23
    v_pk_mul_f32 v[66:67], v[34:35], v[64:65]
    v_pk_mul_f32 v[68:69], v[36:37], v[64:65]
    v_pk_mul_f32 v[70:71], v[38:39], v[64:65]
    v_pk_mul_f32 v[72:73], v[40:41], v[64:65]
    v_pk_mul_f32 v[74:75], v[42:43], v[64:65]
    v_pk_mul_f32 v[76:77], v[44:45], v[64:65]
    v_pk_mul_f32 v[78:79], v[46:47], v[64:65]
    v_pk_mul_f32 v[80:81], v[48:49], v[64:65]
    v_pk_mul_f32 v[82:83], v[50:51], v[64:65]
    v_pk_fma_f32 v[66:67], v[36:37], v[62:63], v[66:67]
    v_pk_fma_f32 v[68:69], v[38:39], v[62:63], v[68:69]
    v_pk_fma_f32 v[70:71], v[40:41], v[62:63], v[70:71]
    v_pk_fma_f32 v[72:73], v[42:43], v[62:63], v[72:73]
    v_pk_fma_f32 v[74:75], v[44:45], v[62:63], v[74:75]
    v_pk_fma_f32 v[76:77], v[46:47], v[62:63], v[76:77]
    v_pk_fma_f32 v[78:79], v[48:49], v[62:63], v[78:79]
    v_pk_fma_f32 v[80:81], v[50:51], v[62:63], v[80:81]
    v_pk_fma_f32 v[82:83], v[52:53], v[62:63], v[82:83]
    v_pk_fma_f32 v[66:67], v[38:39], v[60:61], v[66:67]
    v_pk_fma_f32 v[68:69], v[40:41], v[60:61], v[68:69]
    v_pk_fma_f32 v[70:71], v[42:43], v[60:61], v[70:71]
    v_pk_fma_f32 v[72:73], v[44:45], v[60:61], v[72:73]
    v_pk_fma_f32 v[74:75], v[46:47], v[60:61], v[74:75]
    v_pk_fma_f32 v[76:77], v[48:49], v[60:61], v[76:77]
    v_pk_fma_f32 v[78:79], v[50:51], v[60:61], v[78:79]
    v_pk_fma_f32 v[80:81], v[52:53], v[60:61], v[80:81]
    v_pk_fma_f32 v[82:83], v[54:55], v[60:61], v[82:83]
    v_pk_fma_f32 v[66:67], v[40:41], v[58:59], v[66:67]
    v_pk_fma_f32 v[68:69], v[42:43], v[58:59], v[68:69]
    v_pk_fma_f32 v[70:71], v[44:45], v[58:59], v[70:71]
    v_pk_fma_f32 v[72:73], v[46:47], v[58:59], v[72:73]
    v_pk_fma_f32 v[74:75], v[48:49], v[58:59], v[74:75]
    v_pk_fma_f32 v[76:77], v[50:51], v[58:59], v[76:77]
    v_pk_fma_f32 v[78:79], v[52:53], v[58:59], v[78:79]
    v_pk_fma_f32 v[80:81], v[54:55], v[58:59], v[80:81]
    v_pk_fma_f32 v[82:83], v[56:57], v[58:59], v[82:83]
    s_waitcnt lgkmcnt(0)
    v_lshlrev_b32 v34, 16, v24
    v_and_b32 v35, 0xffff0000, v24
    v_lshlrev_b32 v36, 16, v25
    v_and_b32 v37, 0xffff0000, v25
    v_lshlrev_b32 v38, 16, v26
    v_and_b32 v39, 0xffff0000, v26
    v_lshlrev_b32 v40, 16, v27
    v_and_b32 v41, 0xffff0000, v27
    v_lshlrev_b32 v42, 16, v28
    v_and_b32 v43, 0xffff0000, v28
    v_lshlrev_b32 v44, 16, v29
    v_and_b32 v45, 0xffff0000, v29
    v_lshlrev_b32 v46, 16, v30
    v_and_b32 v47, 0xffff0000, v30
    v_lshlrev_b32 v48, 16, v31
    v_and_b32 v49, 0xffff0000, v31
    v_lshlrev_b32 v50, 16, v32
    v_and_b32 v51, 0xffff0000, v32
    v_pk_mul_f32 v[66:67], v[66:67], v[34:35]
    v_pk_mul_f32 v[68:69], v[68:69], v[36:37]
    v_pk_mul_f32 v[70:71], v[70:71], v[38:39]
    v_pk_mul_f32 v[72:73], v[72:73], v[40:41]
    v_pk_mul_f32 v[74:75], v[74:75], v[42:43]
    v_pk_mul_f32 v[76:77], v[76:77], v[44:45]
    v_pk_mul_f32 v[78:79], v[78:79], v[46:47]
    v_pk_mul_f32 v[80:81], v[80:81], v[48:49]
    v_pk_mul_f32 v[82:83], v[82:83], v[50:51]
    v_cvt_pk_bf16_f32 v84, v80, v78
    v_cvt_pk_bf16_f32 v85, v76, v74
    v_cvt_pk_bf16_f32 v86, v72, v70
    v_cvt_pk_bf16_f32 v87, v68, v66
    ds_write_b128 v117, v[84:87] offset:0
    v_cvt_pk_bf16_f32 v88, v82, v80
    v_cvt_pk_bf16_f32 v89, v78, v76
    v_cvt_pk_bf16_f32 v90, v74, v72
    v_cvt_pk_bf16_f32 v91, v70, v68
    ds_write_b128 v117, v[88:91] offset:16
    v_cvt_pk_bf16_f32 v92, v81, v79
    v_cvt_pk_bf16_f32 v93, v77, v75
    v_cvt_pk_bf16_f32 v94, v73, v71
    v_cvt_pk_bf16_f32 v95, v69, v67
    ds_write_b128 v117, v[92:95] offset:32
    v_cvt_pk_bf16_f32 v96, v83, v81
    v_cvt_pk_bf16_f32 v97, v79, v77
    v_cvt_pk_bf16_f32 v98, v75, v73
    v_cvt_pk_bf16_f32 v99, v71, v69
    ds_write_b128 v117, v[96:99] offset:48
    ds_read_b128 v[100:103], v118 offset:0
    ds_read_b128 v[104:107], v118 offset:1024
    ds_read_b128 v[108:111], v118 offset:2048
    ds_read_b128 v[112:115], v118 offset:3072
    v_add_u32 v120, 512, v120
    s_waitcnt lgkmcnt(3)
    buffer_store_dwordx4 v[100:103], v239, s[20:23], s62 offen offset:0 sc1
    s_waitcnt lgkmcnt(2)
    buffer_store_dwordx4 v[104:107], v239, s[20:23], s62 offen offset:1024 sc1
    s_waitcnt lgkmcnt(1)
    buffer_store_dwordx4 v[108:111], v239, s[20:23], s62 offen offset:2048 sc1
    s_waitcnt lgkmcnt(0)
    buffer_store_dwordx4 v[112:115], v239, s[20:23], s62 offen offset:3072 sc1
    s_add_u32 s62, s62, 32768
    s_add_u32 s36, s36, 8
    s_cmp_lt_u32 s36, 18
    s_cbranch_scc1 Lprep_19
    s_waitcnt vmcnt(0)
    v_readfirstlane_b32 s7, v7
    v_readfirstlane_b32 s6, v6
    s_cmp_lg_u32 s7, 0
    s_cbranch_scc1 Ltg_20
Lpollt_21:
    buffer_load_dwordx2 v[6:7], v4, s[52:55], 0 offen sc1
    s_waitcnt vmcnt(0)
    v_readfirstlane_b32 s7, v7
    v_readfirstlane_b32 s6, v6
    s_cmp_lg_u32 s7, 0
    s_cbranch_scc1 Lpdt_22
    s_sleep 8
    s_sub_u32 s5, s5, 1
    s_cbranch_scc0 Lpollt_21
    s_mov_b32 s5, 0
Lpdt_22:
Ltg_20:
    s_waitcnt vmcnt(0)
    s_load_dwordx2 s[12:13], s[0:1], 72
    s_waitcnt lgkmcnt(0)
    s_barrier
    s_and_b32 s13, s13, 0xffff
    s_mov_b32 s14, 5308416
    s_mov_b32 s15, 0x00020000
    s_cmp_lg_u32 s30, 0
    s_cbranch_scc1 Lf_23
    s_lshl_b32 s56, s28, 3
    s_add_u32 s56, s56, 44846592
    v_mov_b32 v1, 0x7ffffff0
    s_add_u32 s59, s6, 0
    v_mov_b32 v2, s59
    v_mov_b32 v3, s7
    v_writelane_b32 v1, s56, 0
    buffer_store_dwordx2 v[2:3], v1, s[20:23], 0 offen sc1
Lf_23:
    v_and_b32 v6, 7, v241
    s_lshl_b32 s56, s31, 3
    v_add_u32 v6, s56, v6
    v_lshlrev_b32 v235, 3, v6
    v_add_u32 v235, 159744, v235
    v_mul_u32_u24 v236, 1152, v6
    v_bfe_u32 v7, v241, 3, 2
    v_lshl_add_u32 v236, v7, 4, v236
    v_lshrrev_b32 v7, 5, v241
    v_lshl_add_u32 v236, v7, 7, v236
    s_lshl_b32 s56, s32, 6
    v_add_u32 v236, s56, v236
    v_add_u32 v8, 118784, v236
    ds_read_b128 v[200:203], v8 offset:0
    ds_read_b128 v[204:207], v8 offset:256
    ds_read_b128 v[208:211], v8 offset:512
    ds_read_b128 v[212:215], v8 offset:768
    ds_read_b128 v[216:219], v8 offset:1024
    s_mul_i32 s56, s28, 36864
    v_add_u32 v9, s56, v236
    v_mov_b32 v7, 0x7ffffff0
    v_cmp_gt_u32 vcc, 32, v241
    s_mov_b32 s66, 0x3f803f80
    v_mov_b32 v12, 0
    v_mov_b32 v13, 0
    v_mov_b32 v14, 0
    v_mov_b32 v15, 0
    v_cndmask_b32 v236, v7, v9, vcc
    v_cndmask_b32 v237, v9, v7, vcc
    s_waitcnt lgkmcnt(0)
    s_barrier
    v_cndmask_b32 v216, 0, v216, vcc
    v_cndmask_b32 v217, 0, v217, vcc
    v_cndmask_b32 v218, 0, v218, vcc
    v_cndmask_b32 v219, 0, v219, vcc
    s_mul_i32 s34, s30, 8448
    s_lshl_b32 s33, s28, 3
    s_add_u32 s33, s33, s30
    s_lshl_b32 s56, s33, 12
    s_add_u32 m0, s34, 0
    s_add_u32 s62, s56, 0
    buffer_load_dwordx4 v239, s[40:43], s62 offen offset:0 lds
    buffer_load_dwordx4 v239, s[40:43], s62 offen offset:1024 lds
    buffer_load_dwordx4 v239, s[40:43], s62 offen offset:2048 lds
    buffer_load_dwordx4 v239, s[40:43], s62 offen offset:3072 lds
    s_add_u32 m0, s34, 4224
    s_add_u32 s62, s56, 4
    buffer_load_dwordx4 v239, s[40:43], s62 offen offset:0 lds
    buffer_load_dwordx4 v239, s[40:43], s62 offen offset:1024 lds
    buffer_load_dwordx4 v239, s[40:43], s62 offen offset:2048 lds
    buffer_load_dwordx4 v239, s[40:43], s62 offen offset:3072 lds
    s_mul_i32 s56, s32, 4224
    s_lshl_b32 s57, s31, 10
    s_add_u32 s56, s56, s57
    s_add_u32 m0, s56, 67584
    s_lshl_b32 s56, s28, 12
    s_add_u32 s56, s56, s57
    s_lshl_b32 s57, s32, 2
    s_add_u32 s56, s56, s57
    s_add_u32 s56, s56, 2097152
    buffer_load_dwordx4 v239, s[40:43], s56 offen lds
    s_lshl_b32 s56, s33, 1
    v_mov_b32 v6, s56
    buffer_load_ushort v242, v6, s[44:47], 0 offen
    s_lshl_b32 s56, s28, 1
    v_mov_b32 v7, s56
    buffer_load_ushort v245, v7, s[44:47], 0 offen offset:1024
    v_and_b32 v243, 15, v241
    v_lshrrev_b32 v244, 4, v241
    v_add_u32 v2, 1, v243
    v_and_b32 v3, 1, v2
    v_lshrrev_b32 v2, 1, v2
    v_lshlrev_b32 v4, 1, v244
    v_sub_u32 v2, v2, v4
    v_lshlrev_b32 v2, 3, v2
    v_mul_u32_u24 v4, 4224, v3
    v_add_u32 v2, v2, v4
    s_add_u32 s57, s34, 48
    v_add_u32 v220, s57, v2
    v_and_b32 v5, 1, v243
    v_mul_u32_u24 v2, 4576, v5
    v_lshrrev_b32 v3, 1, v243
    v_lshl_add_u32 v4, v3, 2, v244
    v_lshlrev_b32 v222, 4, v4
    v_lshl_add_u32 v222, v5, 3, v222
    v_mul_u32_u24 v253, 36864, v3
    v_lshl_add_u32 v253, v244, 4, v253
    v_lshl_add_u32 v253, v5, 3, v253
    v_sub_u32 v4, 31, v4
    v_lshl_add_u32 v2, v4, 4, v2
    s_mul_i32 s57, s30, 9216
    s_add_u32 s57, s57, 76032
    v_add_u32 v221, s57, v2
    v_add_u32 v222, s57, v222
    v_lshlrev_b32 v2, 2, v244
    v_sub_u32 v2, v243, v2
    v_subrev_u32 v223, 3, v2
    v_lshrrev_b32 v2, 8, v238
    v_mul_u32_u24 v240, 18432, v2
    v_and_b32 v3, 0xf0, v238
    v_add_u32 v240, v240, v3
    v_bfe_u32 v3, v238, 5, 3
    v_mul_u32_u24 v234, 9216, v3
    v_bfe_u32 v3, v238, 4, 1
    v_mul_u32_u24 v3, 4576, v3
    v_add_u32 v234, v234, v3
    v_lshl_add_u32 v234, v2, 4, v234
    v_add_u32 v234, 76032, v234
    v_lshrrev_b32 v2, 5, v238
    v_mul_u32_u24 v246, 18432, v2
    v_and_b32 v4, 16, v238
    v_add_u32 v246, v246, v4
    v_lshl_add_u32 v247, v2, 4, v3
    v_add_u32 v247, 149760, v247
    v_mov_b32 v8, 0
    v_mov_b32 v9, 0
    v_mov_b32 v10, 0
    v_mov_b32 v11, 0
    v_cmp_gt_u32 vcc, 7168, v238
    s_and_saveexec_b64 s[60:61], vcc
    ds_write_b128 v234, v[8:11] offset:4096
    s_mov_b64 exec, s[60:61]
    v_cmp_gt_u32 vcc, 896, v238
    s_and_saveexec_b64 s[60:61], vcc
    ds_write_b128 v247, v[8:11] offset:4096
    s_mov_b64 exec, s[60:61]
    v_dot2c_f32_bf16 v12, s66, v200
    v_dot2c_f32_bf16 v13, v200, v200
    v_dot2c_f32_bf16 v14, s66, v201
    v_dot2c_f32_bf16 v15, v201, v201
    v_dot2c_f32_bf16 v12, s66, v202
    v_dot2c_f32_bf16 v13, v202, v202
    v_dot2c_f32_bf16 v14, s66, v203
    v_dot2c_f32_bf16 v15, v203, v203
    v_dot2c_f32_bf16 v12, s66, v204
    v_dot2c_f32_bf16 v13, v204, v204
    v_dot2c_f32_bf16 v14, s66, v205
    v_dot2c_f32_bf16 v15, v205, v205
    v_dot2c_f32_bf16 v12, s66, v206
    v_dot2c_f32_bf16 v13, v206, v206
    v_dot2c_f32_bf16 v14, s66, v207
    v_dot2c_f32_bf16 v15, v207, v207
    v_dot2c_f32_bf16 v12, s66, v208
    v_dot2c_f32_bf16 v13, v208, v208
    v_dot2c_f32_bf16 v14, s66, v209
    v_dot2c_f32_bf16 v15, v209, v209
    v_dot2c_f32_bf16 v12, s66, v210
    v_dot2c_f32_bf16 v13, v210, v210
    v_dot2c_f32_bf16 v14, s66, v211
    v_dot2c_f32_bf16 v15, v211, v211
    v_dot2c_f32_bf16 v12, s66, v212
    v_dot2c_f32_bf16 v13, v212, v212
    v_dot2c_f32_bf16 v14, s66, v213
    v_dot2c_f32_bf16 v15, v213, v213
    v_dot2c_f32_bf16 v12, s66, v214
    v_dot2c_f32_bf16 v13, v214, v214
    v_dot2c_f32_bf16 v14, s66, v215
    v_dot2c_f32_bf16 v15, v215, v215
    v_dot2c_f32_bf16 v12, s66, v216
    v_dot2c_f32_bf16 v13, v216, v216
    v_dot2c_f32_bf16 v14, s66, v217
    v_dot2c_f32_bf16 v15, v217, v217
    v_dot2c_f32_bf16 v12, s66, v218
    v_dot2c_f32_bf16 v13, v218, v218
    v_dot2c_f32_bf16 v14, s66, v219
    v_dot2c_f32_bf16 v15, v219, v219
    s_nop 2
    v_add_f32 v12, v12, v14
    v_add_f32 v13, v13, v15
    s_nop 1
    v_add_f32_dpp v12, v12, v12 row_ror:8 row_mask:0xf bank_mask:0xf
    v_add_f32_dpp v13, v13, v13 row_ror:8 row_mask:0xf bank_mask:0xf
    v_mov_b32 v14, v12
    v_mov_b32 v15, v13
    s_nop 1
    v_permlane16_swap_b32 v12, v14
    v_permlane16_swap_b32 v13, v15
    v_add_f32 v12, v12, v14
    v_add_f32 v13, v13, v15
    v_mov_b32 v14, v12
    v_mov_b32 v15, v13
    s_nop 1
    v_permlane32_swap_b32 v12, v14
    v_permlane32_swap_b32 v13, v15
    v_add_f32 v12, v12, v14
    v_add_f32 v13, v13, v15
    s_mov_b64 exec, 0xff
    ds_add_f32 v235, v12
    ds_add_f32 v235, v13 offset:4
    s_mov_b64 exec, -1
    v_mov_b32 v7, 0x7ffffff0
    s_lshr_b32 s56, s28, 3
    s_and_b32 s57, s28, 3
    s_mul_i32 s57, s57, 1327104
    s_mul_i32 s56, s56, 165888
    s_add_u32 s39, s56, s57
    s_lshl_b32 s56, s30, 11
    v_lshl_add_u32 v248, v241, 7, s56
    v_cmp_gt_u32 vcc, 16, v241
    s_nop 1
    v_cndmask_b32 v248, v7, v248, vcc
    s_cmp_lg_u32 s30, 0
    s_cbranch_scc1 Lf_24
    v_lshrrev_b32 v4, 1, v239
    v_add_u32 v4, 44846592, v4
Lpollu_25:
    buffer_load_dwordx2 v[2:3], v4, s[20:23], 0 offen sc1
    s_waitcnt vmcnt(0)
    s_add_u32 s59, s6, 0
    v_subrev_u32 v2, s59, v2
    v_xor_b32 v3, s7, v3
    v_lshrrev_b32 v2, 4, v2
    v_or_b32 v2, v2, v3
    v_cmp_ne_u32 vcc, 0, v2
    s_cmp_eq_u64 vcc, 0
    s_cbranch_scc1 Lpdu_26
    s_sleep 2
    s_sub_u32 s5, s5, 1
    s_cbranch_scc0 Lpollu_25
    s_mov_b32 s5, 0
Lpdu_26:
Lf_24:
    s_barrier
    s_lshl_b32 s56, s28, 8
    s_add_u32 s56, s56, 37765120
    buffer_load_dwordx4 v[160:163], v240, s[20:23], s56 offen sc1
    s_add_u32 s56, s56, 589824
    buffer_load_dwordx4 v[164:167], v240, s[20:23], s56 offen sc1
    s_add_u32 s56, s56, 589824
    buffer_load_dwordx4 v[168:171], v240, s[20:23], s56 offen sc1
    s_add_u32 s56, s56, 589824
    buffer_load_dwordx4 v[172:175], v240, s[20:23], s56 offen sc1
    s_add_u32 s56, s56, 589824
    buffer_load_dwordx4 v[176:179], v240, s[20:23], s56 offen sc1
    s_add_u32 s56, s56, 589824
    buffer_load_dwordx4 v[180:183], v240, s[20:23], s56 offen sc1
    s_add_u32 s56, s56, 589824
    buffer_load_dwordx4 v[184:187], v240, s[20:23], s56 offen sc1
    s_add_u32 s56, s56, 589824
    buffer_load_dwordx4 v[188:191], v240, s[20:23], s56 offen sc1
    s_lshl_b32 s56, s28, 5
    s_add_u32 s56, s56, 37781504
    buffer_load_dwordx4 v[192:195], v246, s[20:23], s56 offen sc1
    s_waitcnt vmcnt(9)
    s_sub_u32 s56, 8, s30
    s_lshl_b32 s58, s30, 6
    s_mul_i32 s64, s56, 8448
    s_add_u32 s64, s64, s58
    s_mul_i32 s65, s56, 9216
    s_add_u32 s65, s65, s58
    s_lshl_b32 s66, s30, 4
    v_add_u32 v220, s64, v220
    v_add_u32 v221, s65, v221
    v_add_u32 v223, s66, v223
    s_mov_b32 s67, 67584
    v_add_u32 v250, 0, v223
    v_cmp_eq_u32 vcc, 0, v250
    v_max_i32 v251, 0, v250
    v_lshl_add_u32 v228, v251, 2, s67
    v_cndmask_b32 v224, 0, v245, vcc
    v_add_u32 v250, 1, v223
    v_cmp_eq_u32 vcc, 0, v250
    v_max_i32 v251, 0, v250
    v_lshl_add_u32 v229, v251, 2, s67
    v_cndmask_b32 v225, 0, v245, vcc
    v_add_u32 v250, 2, v223
    v_cmp_eq_u32 vcc, 0, v250
    v_max_i32 v251, 0, v250
    v_lshl_add_u32 v230, v251, 2, s67
    v_cndmask_b32 v226, 0, v245, vcc
    v_add_u32 v250, 3, v223
    v_cmp_eq_u32 vcc, 0, v250
    v_max_i32 v251, 0, v250
    v_lshl_add_u32 v231, v251, 2, s67
    v_cndmask_b32 v227, 0, v245, vcc
    s_waitcnt vmcnt(8)
    ds_write_b128 v234, v[160:163] offset:0
    s_waitcnt vmcnt(7)
    ds_write_b128 v234, v[164:167] offset:512
    s_waitcnt vmcnt(6)
    ds_write_b128 v234, v[168:171] offset:1024
    s_waitcnt vmcnt(5)
    ds_write_b128 v234, v[172:175] offset:1536
    s_waitcnt vmcnt(4)
    ds_write_b128 v234, v[176:179] offset:2048
    s_waitcnt vmcnt(3)
    ds_write_b128 v234, v[180:183] offset:2560
    s_waitcnt vmcnt(2)
    ds_write_b128 v234, v[184:187] offset:3072
    s_waitcnt vmcnt(1)
    ds_write_b128 v234, v[188:191] offset:3584
    s_waitcnt vmcnt(0)
    ds_write_b128 v247, v[192:195]
    s_waitcnt lgkmcnt(0)
    s_barrier
    ds_read_b32 v32, v228
    ds_read_b32 v33, v229
    ds_read_b32 v34, v230
    ds_read_b32 v35, v231
    ds_read_b128 v[36:39], v221 offset:0
    ds_read_b128 v[40:43], v221 offset:512
    ds_read_b128 v[44:47], v221 offset:1024
    ds_read_b128 v[48:51], v221 offset:1536
    ds_read_b128 v[52:55], v221 offset:2048
    ds_read_b128 v[56:59], v221 offset:2560
    ds_read_b128 v[60:63], v221 offset:3072
    ds_read_b128 v[64:67], v221 offset:3584
    v_add_u32 v250, 0, v223
    v_cmp_le_i32 vcc, 0, v250
    s_nop 1
    s_waitcnt lgkmcnt(8)
    v_cndmask_b32 v32, 0, v32, vcc
    v_add_u32 v250, 1, v223
    v_cmp_le_i32 vcc, 0, v250
    s_nop 1
    v_cndmask_b32 v33, 0, v33, vcc
    v_add_u32 v250, 2, v223
    v_cmp_le_i32 vcc, 0, v250
    s_nop 1
    v_cndmask_b32 v34, 0, v34, vcc
    v_add_u32 v250, 3, v223
    v_cmp_le_i32 vcc, 0, v250
    s_nop 1
    v_cndmask_b32 v35, 0, v35, vcc
    s_waitcnt lgkmcnt(7)
    v_mfma_f32_16x16x32_bf16 v[188:191], v[224:227], v[36:39], 0
    ds_read_b64 v[68:69], v220 offset:448
    ds_read_b64 v[70:71], v220 offset:456
    s_waitcnt lgkmcnt(8)
    v_mfma_f32_16x16x32_bf16 v[184:187], v[224:227], v[40:43], 0
    ds_read_b64 v[72:73], v220 offset:960
    ds_read_b64 v[74:75], v220 offset:968
    s_waitcnt lgkmcnt(9)
    v_mfma_f32_16x16x32_bf16 v[180:183], v[224:227], v[44:47], 0
    ds_read_b64 v[76:77], v220 offset:1472
    ds_read_b64 v[78:79], v220 offset:1480
    s_waitcnt lgkmcnt(10)
    v_mfma_f32_16x16x32_bf16 v[176:179], v[224:227], v[48:51], 0
    ds_read_b64 v[80:81], v220 offset:1984
    ds_read_b64 v[82:83], v220 offset:1992
    s_waitcnt lgkmcnt(11)
    v_mfma_f32_16x16x32_bf16 v[172:175], v[224:227], v[52:55], 0
    ds_read_b64 v[84:85], v220 offset:2496
    ds_read_b64 v[86:87], v220 offset:2504
    s_waitcnt lgkmcnt(12)
    v_mfma_f32_16x16x32_bf16 v[168:171], v[224:227], v[56:59], 0
    s_waitcnt lgkmcnt(11)
    v_mfma_f32_16x16x32_bf16 v[164:167], v[224:227], v[60:63], 0
    ds_read_b64 v[88:89], v220 offset:3008
    ds_read_b64 v[90:91], v220 offset:3016
    s_waitcnt lgkmcnt(12)
    v_mfma_f32_16x16x32_bf16 v[160:163], v[224:227], v[64:67], 0
    v_mfma_f32_16x16x32_bf16 v[188:191], v[32:35], v[36:39], v[188:191]
    s_waitcnt lgkmcnt(4)
    ds_read_b64 v[92:93], v220 offset:3520
    ds_read_b64 v[94:95], v220 offset:3528
    v_mfma_f32_16x16x32_bf16 v[184:187], v[32:35], v[40:43], v[184:187]
    v_mfma_f32_16x16x32_bf16 v[180:183], v[32:35], v[44:47], v[180:183]
    v_mfma_f32_16x16x32_bf16 v[176:179], v[32:35], v[48:51], v[176:179]
    buffer_load_dword v252, v248, s[12:15], s39 offen
    s_add_u32 s39, s39, 16384
    v_mfma_f32_16x16x32_bf16 v[172:175], v[32:35], v[52:55], v[172:175]
    v_mfma_f32_16x16x32_bf16 v[168:171], v[32:35], v[56:59], v[168:171]
    v_mfma_f32_16x16x32_bf16 v[164:167], v[32:35], v[60:63], v[164:167]
    v_mfma_f32_16x16x32_bf16 v[160:163], v[32:35], v[64:67], v[160:163]
    v_mfma_f32_16x16x32_bf16 v[188:191], v[68:71], v[40:43], v[188:191]
    v_mfma_f32_16x16x32_bf16 v[184:187], v[68:71], v[44:47], v[184:187]
    buffer_load_dword v252, v248, s[12:15], s39 offen
    s_add_u32 s39, s39, 16384
    v_mfma_f32_16x16x32_bf16 v[180:183], v[68:71], v[48:51], v[180:183]
    v_mfma_f32_16x16x32_bf16 v[176:179], v[68:71], v[52:55], v[176:179]
    v_mfma_f32_16x16x32_bf16 v[172:175], v[68:71], v[56:59], v[172:175]
    v_mfma_f32_16x16x32_bf16 v[168:171], v[68:71], v[60:63], v[168:171]
    v_mfma_f32_16x16x32_bf16 v[164:167], v[68:71], v[64:67], v[164:167]
    v_mfma_f32_16x16x32_bf16 v[188:191], v[72:75], v[44:47], v[188:191]
    buffer_load_dword v252, v248, s[12:15], s39 offen
    s_add_u32 s39, s39, 16384
    v_mfma_f32_16x16x32_bf16 v[184:187], v[72:75], v[48:51], v[184:187]
    v_mfma_f32_16x16x32_bf16 v[180:183], v[72:75], v[52:55], v[180:183]
    v_mfma_f32_16x16x32_bf16 v[176:179], v[72:75], v[56:59], v[176:179]
    v_mfma_f32_16x16x32_bf16 v[172:175], v[72:75], v[60:63], v[172:175]
    v_mfma_f32_16x16x32_bf16 v[168:171], v[72:75], v[64:67], v[168:171]
    v_mfma_f32_16x16x32_bf16 v[188:191], v[76:79], v[48:51], v[188:191]
    buffer_load_dword v252, v248, s[12:15], s39 offen
    s_add_u32 s39, s39, 16384
    v_mfma_f32_16x16x32_bf16 v[184:187], v[76:79], v[52:55], v[184:187]
    v_mfma_f32_16x16x32_bf16 v[180:183], v[76:79], v[56:59], v[180:183]
    v_mfma_f32_16x16x32_bf16 v[176:179], v[76:79], v[60:63], v[176:179]
    v_mfma_f32_16x16x32_bf16 v[172:175], v[76:79], v[64:67], v[172:175]
    v_mfma_f32_16x16x32_bf16 v[188:191], v[80:83], v[52:55], v[188:191]
    v_mfma_f32_16x16x32_bf16 v[184:187], v[80:83], v[56:59], v[184:187]
    buffer_load_dword v252, v248, s[12:15], s39 offen
    s_add_u32 s39, s39, 16384
    v_mfma_f32_16x16x32_bf16 v[180:183], v[80:83], v[60:63], v[180:183]
    v_mfma_f32_16x16x32_bf16 v[176:179], v[80:83], v[64:67], v[176:179]
    s_waitcnt lgkmcnt(4)
    v_mfma_f32_16x16x32_bf16 v[188:191], v[84:87], v[56:59], v[188:191]
    v_mfma_f32_16x16x32_bf16 v[184:187], v[84:87], v[60:63], v[184:187]
    v_mfma_f32_16x16x32_bf16 v[180:183], v[84:87], v[64:67], v[180:183]
    s_waitcnt lgkmcnt(2)
    v_mfma_f32_16x16x32_bf16 v[188:191], v[88:91], v[60:63], v[188:191]
    buffer_load_dword v252, v248, s[12:15], s39 offen
    s_add_u32 s39, s39, 16384
    v_mfma_f32_16x16x32_bf16 v[184:187], v[88:91], v[64:67], v[184:187]
    s_waitcnt lgkmcnt(0)
    v_mfma_f32_16x16x32_bf16 v[188:191], v[92:95], v[64:67], v[188:191]
    s_nop 7
    v_subrev_u32 v220, s64, v220
    v_subrev_u32 v221, s65, v221
    v_subrev_u32 v223, s66, v223
    v_add_u32 v250, 0, v223
    v_cmp_eq_u32 vcc, 0, v250
    v_max_i32 v251, 0, v250
    v_lshl_add_u32 v228, v251, 2, s34
    v_cndmask_b32 v224, 0, v242, vcc
    v_add_u32 v250, 1, v223
    v_cmp_eq_u32 vcc, 0, v250
    v_max_i32 v251, 0, v250
    v_lshl_add_u32 v229, v251, 2, s34
    v_cndmask_b32 v225, 0, v242, vcc
    v_add_u32 v250, 2, v223
    v_cmp_eq_u32 vcc, 0, v250
    v_max_i32 v251, 0, v250
    v_lshl_add_u32 v230, v251, 2, s34
    v_cndmask_b32 v226, 0, v242, vcc
    v_add_u32 v250, 3, v223
    v_cmp_eq_u32 vcc, 0, v250
    v_max_i32 v251, 0, v250
    v_lshl_add_u32 v231, v251, 2, s34
    v_cndmask_b32 v227, 0, v242, vcc
    s_getpc_b64 s[66:67]
Lhere_27:
    s_sub_u32 s66, s66, Lhere_27-parallel_sum__ssm_conv_h3__dense_activation_mish__prompt_kernel
    s_subb_u32 s67, s67, 0
    s_lshr_b32 s56, s28, 3
    s_mul_i32 s56, s56, 10240
    s_mul_i32 s57, s30, 1280
    s_add_u32 s56, s56, s57
    v_min_u32 v249, 9, v241
    v_lshl_add_u32 v249, v249, 7, s56
    v_min_u32 v249, Lend_1-parallel_sum__ssm_conv_h3__dense_activation_mish__prompt_kernel, v249
    ds_read_b32 v32, v228
    ds_read_b32 v33, v229
    ds_read_b32 v34, v230
    ds_read_b32 v35, v231
    ds_read_b128 v[36:39], v221 offset:0
    ds_read_b128 v[40:43], v221 offset:512
    ds_read_b128 v[44:47], v221 offset:1024
    ds_read_b128 v[48:51], v221 offset:1536
    ds_read_b128 v[52:55], v221 offset:2048
    ds_read_b128 v[56:59], v221 offset:2560
    ds_read_b128 v[60:63], v221 offset:3072
    ds_read_b128 v[64:67], v221 offset:3584
    v_add_u32 v250, 0, v223
    v_cmp_le_i32 vcc, 0, v250
    s_nop 1
    s_waitcnt lgkmcnt(8)
    v_cndmask_b32 v32, 0, v32, vcc
    v_add_u32 v250, 1, v223
    v_cmp_le_i32 vcc, 0, v250
    s_nop 1
    v_cndmask_b32 v33, 0, v33, vcc
    v_add_u32 v250, 2, v223
    v_cmp_le_i32 vcc, 0, v250
    s_nop 1
    v_cndmask_b32 v34, 0, v34, vcc
    v_add_u32 v250, 3, v223
    v_cmp_le_i32 vcc, 0, v250
    s_nop 1
    v_cndmask_b32 v35, 0, v35, vcc
    s_waitcnt lgkmcnt(7)
    v_mfma_f32_16x16x32_bf16 v[28:31], v[224:227], v[36:39], 0
    ds_read_b64 v[68:69], v220 offset:448
    ds_read_b64 v[70:71], v220 offset:456
    s_waitcnt lgkmcnt(8)
    v_mfma_f32_16x16x32_bf16 v[24:27], v[224:227], v[40:43], 0
    ds_read_b64 v[72:73], v220 offset:960
    ds_read_b64 v[74:75], v220 offset:968
    s_waitcnt lgkmcnt(9)
    v_mfma_f32_16x16x32_bf16 v[20:23], v[224:227], v[44:47], 0
    ds_read_b64 v[76:77], v220 offset:1472
    ds_read_b64 v[78:79], v220 offset:1480
    s_waitcnt lgkmcnt(10)
    v_mfma_f32_16x16x32_bf16 v[16:19], v[224:227], v[48:51], 0
    ds_read_b64 v[80:81], v220 offset:1984
    ds_read_b64 v[82:83], v220 offset:1992
    s_waitcnt lgkmcnt(11)
    v_mfma_f32_16x16x32_bf16 v[12:15], v[224:227], v[52:55], 0
    ds_read_b64 v[84:85], v220 offset:2496
    ds_read_b64 v[86:87], v220 offset:2504
    s_waitcnt lgkmcnt(12)
    v_mfma_f32_16x16x32_bf16 v[8:11], v[224:227], v[56:59], 0
    s_waitcnt lgkmcnt(11)
    v_mfma_f32_16x16x32_bf16 v[4:7], v[224:227], v[60:63], 0
    ds_read_b64 v[88:89], v220 offset:3008
    ds_read_b64 v[90:91], v220 offset:3016
    s_waitcnt lgkmcnt(12)
    v_mfma_f32_16x16x32_bf16 v[0:3], v[224:227], v[64:67], 0
    v_mfma_f32_16x16x32_bf16 v[28:31], v[32:35], v[36:39], v[28:31]
    s_waitcnt lgkmcnt(4)
    ds_read_b64 v[92:93], v220 offset:3520
    ds_read_b64 v[94:95], v220 offset:3528
    v_mfma_f32_16x16x32_bf16 v[24:27], v[32:35], v[40:43], v[24:27]
    v_mfma_f32_16x16x32_bf16 v[20:23], v[32:35], v[44:47], v[20:23]
    ds_read_b64 v[96:97], v220 offset:0
    ds_read_b64 v[98:99], v220 offset:8
    v_mfma_f32_16x16x32_bf16 v[16:19], v[32:35], v[48:51], v[16:19]
    buffer_load_dword v252, v248, s[12:15], s39 offen
    s_add_u32 s39, s39, 16384
    v_mfma_f32_16x16x32_bf16 v[12:15], v[32:35], v[52:55], v[12:15]
    ds_read_b128 v[100:103], v221 offset:64
    v_mfma_f32_16x16x32_bf16 v[8:11], v[32:35], v[56:59], v[8:11]
    v_mfma_f32_16x16x32_bf16 v[4:7], v[32:35], v[60:63], v[4:7]
    ds_read_b128 v[104:107], v221 offset:576
    v_mfma_f32_16x16x32_bf16 v[0:3], v[32:35], v[64:67], v[0:3]
    v_mfma_f32_16x16x32_bf16 v[28:31], v[68:71], v[40:43], v[28:31]
    ds_read_b128 v[108:111], v221 offset:1088
    v_mfma_f32_16x16x32_bf16 v[24:27], v[68:71], v[44:47], v[24:27]
    buffer_load_dword v252, v248, s[12:15], s39 offen
    s_add_u32 s39, s39, 16384
    v_mfma_f32_16x16x32_bf16 v[20:23], v[68:71], v[48:51], v[20:23]
    ds_read_b128 v[112:115], v221 offset:1600
    v_mfma_f32_16x16x32_bf16 v[16:19], v[68:71], v[52:55], v[16:19]
    v_mfma_f32_16x16x32_bf16 v[12:15], v[68:71], v[56:59], v[12:15]
    s_waitcnt lgkmcnt(4)
    ds_read_b128 v[116:119], v221 offset:2112
    v_mfma_f32_16x16x32_bf16 v[8:11], v[68:71], v[60:63], v[8:11]
    v_mfma_f32_16x16x32_bf16 v[4:7], v[68:71], v[64:67], v[4:7]
    ds_read_b128 v[120:123], v221 offset:2624
    v_mfma_f32_16x16x32_bf16 v[28:31], v[72:75], v[44:47], v[28:31]
    buffer_load_dword v252, v248, s[12:15], s39 offen
    s_add_u32 s39, s39, 16384
    v_mfma_f32_16x16x32_bf16 v[24:27], v[72:75], v[48:51], v[24:27]
    ds_read_b128 v[124:127], v221 offset:3136
    v_mfma_f32_16x16x32_bf16 v[20:23], v[72:75], v[52:55], v[20:23]
    v_mfma_f32_16x16x32_bf16 v[16:19], v[72:75], v[56:59], v[16:19]
    ds_read_b128 v[128:131], v221 offset:3648
    v_mfma_f32_16x16x32_bf16 v[12:15], v[72:75], v[60:63], v[12:15]
    v_mfma_f32_16x16x32_bf16 v[8:11], v[72:75], v[64:67], v[8:11]
    ds_read_b64 v[132:133], v220 offset:512
    ds_read_b64 v[134:135], v220 offset:520
    v_mfma_f32_16x16x32_bf16 v[28:31], v[76:79], v[48:51], v[28:31]
    buffer_load_dword v252, v248, s[12:15], s39 offen
    s_add_u32 s39, s39, 2048
    v_mfma_f32_16x16x32_bf16 v[24:27], v[76:79], v[52:55], v[24:27]
    ds_read_b64 v[136:137], v220 offset:1024
    ds_read_b64 v[138:139], v220 offset:1032
    v_mfma_f32_16x16x32_bf16 v[20:23], v[76:79], v[56:59], v[20:23]
    v_mfma_f32_16x16x32_bf16 v[16:19], v[76:79], v[60:63], v[16:19]
    s_waitcnt lgkmcnt(4)
    ds_read_b64 v[140:141], v220 offset:1536
    ds_read_b64 v[142:143], v220 offset:1544
    v_mfma_f32_16x16x32_bf16 v[12:15], v[76:79], v[64:67], v[12:15]
    v_mfma_f32_16x16x32_bf16 v[28:31], v[80:83], v[52:55], v[28:31]
    ds_read_b64 v[144:145], v220 offset:2048
    ds_read_b64 v[146:147], v220 offset:2056
    v_mfma_f32_16x16x32_bf16 v[24:27], v[80:83], v[56:59], v[24:27]
    buffer_load_dword v252, v248, s[12:15], s39 offen
    s_add_u32 s39, s39, 2048
    v_mfma_f32_16x16x32_bf16 v[20:23], v[80:83], v[60:63], v[20:23]
    ds_read_b64 v[148:149], v220 offset:2560
    ds_read_b64 v[150:151], v220 offset:2568
    v_mfma_f32_16x16x32_bf16 v[16:19], v[80:83], v[64:67], v[16:19]
    v_mfma_f32_16x16x32_bf16 v[28:31], v[84:87], v[56:59], v[28:31]
    ds_read_b64 v[152:153], v220 offset:3072
    ds_read_b64 v[154:155], v220 offset:3080
    v_mfma_f32_16x16x32_bf16 v[24:27], v[84:87], v[60:63], v[24:27]
    v_mfma_f32_16x16x32_bf16 v[20:23], v[84:87], v[64:67], v[20:23]
    s_waitcnt lgkmcnt(4)
    ds_read_b64 v[156:157], v220 offset:3584
    ds_read_b64 v[158:159], v220 offset:3592
    v_mfma_f32_16x16x32_bf16 v[28:31], v[88:91], v[60:63], v[28:31]
    global_load_dword v252, v249, s[66:67]
    v_mfma_f32_16x16x32_bf16 v[24:27], v[88:91], v[64:67], v[24:27]
    v_mfma_f32_16x16x32_bf16 v[28:31], v[92:95], v[64:67], v[28:31]
    v_mfma_f32_16x16x32_bf16 v[28:31], v[96:99], v[100:103], v[28:31]
    ds_read_b64 v[36:37], v220 offset:64
    ds_read_b64 v[38:39], v220 offset:72
    v_mfma_f32_16x16x32_bf16 v[24:27], v[96:99], v[104:107], v[24:27]
    v_mfma_f32_16x16x32_bf16 v[20:23], v[96:99], v[108:111], v[20:23]
    ds_read_b128 v[32:35], v221 offset:128
    v_mfma_f32_16x16x32_bf16 v[16:19], v[96:99], v[112:115], v[16:19]
    v_mfma_f32_16x16x32_bf16 v[12:15], v[96:99], v[116:119], v[12:15]
    ds_read_b128 v[40:43], v221 offset:640
    v_mfma_f32_16x16x32_bf16 v[8:11], v[96:99], v[120:123], v[8:11]
    v_mfma_f32_16x16x32_bf16 v[4:7], v[96:99], v[124:127], v[4:7]
    ds_read_b128 v[68:71], v221 offset:1152
    v_mfma_f32_16x16x32_bf16 v[0:3], v[96:99], v[128:131], v[0:3]
    v_mfma_f32_16x16x32_bf16 v[28:31], v[132:135], v[104:107], v[28:31]
    ds_read_b128 v[44:47], v221 offset:1664
    v_mfma_f32_16x16x32_bf16 v[24:27], v[132:135], v[108:111], v[24:27]
    v_mfma_f32_16x16x32_bf16 v[20:23], v[132:135], v[112:115], v[20:23]
    s_waitcnt lgkmcnt(4)
    ds_read_b128 v[72:75], v221 offset:2176
    v_mfma_f32_16x16x32_bf16 v[16:19], v[132:135], v[116:119], v[16:19]
    v_mfma_f32_16x16x32_bf16 v[12:15], v[132:135], v[120:123], v[12:15]
    ds_read_b128 v[48:51], v221 offset:2688
    v_mfma_f32_16x16x32_bf16 v[8:11], v[132:135], v[124:127], v[8:11]
    v_mfma_f32_16x16x32_bf16 v[4:7], v[132:135], v[128:131], v[4:7]
    ds_read_b128 v[76:79], v221 offset:3200
    v_mfma_f32_16x16x32_bf16 v[28:31], v[136:139], v[108:111], v[28:31]
    v_mfma_f32_16x16x32_bf16 v[24:27], v[136:139], v[112:115], v[24:27]
    ds_read_b128 v[52:55], v221 offset:3712
    v_mfma_f32_16x16x32_bf16 v[20:23], v[136:139], v[116:119], v[20:23]
    v_mfma_f32_16x16x32_bf16 v[16:19], v[136:139], v[120:123], v[16:19]
    ds_read_b64 v[80:81], v220 offset:576
    ds_read_b64 v[82:83], v220 offset:584
    v_mfma_f32_16x16x32_bf16 v[12:15], v[136:139], v[124:127], v[12:15]
    v_mfma_f32_16x16x32_bf16 v[8:11], v[136:139], v[128:131], v[8:11]
    ds_read_b64 v[56:57], v220 offset:1088
    ds_read_b64 v[58:59], v220 offset:1096
    v_mfma_f32_16x16x32_bf16 v[28:31], v[140:143], v[112:115], v[28:31]
    v_mfma_f32_16x16x32_bf16 v[24:27], v[140:143], v[116:119], v[24:27]
    s_waitcnt lgkmcnt(4)
    ds_read_b64 v[84:85], v220 offset:1600
    ds_read_b64 v[86:87], v220 offset:1608
    v_mfma_f32_16x16x32_bf16 v[20:23], v[140:143], v[120:123], v[20:23]
    v_mfma_f32_16x16x32_bf16 v[16:19], v[140:143], v[124:127], v[16:19]
    ds_read_b64 v[60:61], v220 offset:2112
    ds_read_b64 v[62:63], v220 offset:2120
    v_mfma_f32_16x16x32_bf16 v[12:15], v[140:143], v[128:131], v[12:15]
    v_mfma_f32_16x16x32_bf16 v[28:31], v[144:147], v[116:119], v[28:31]
    ds_read_b64 v[88:89], v220 offset:2624
    ds_read_b64 v[90:91], v220 offset:2632
    v_mfma_f32_16x16x32_bf16 v[24:27], v[144:147], v[120:123], v[24:27]
    v_mfma_f32_16x16x32_bf16 v[20:23], v[144:147], v[124:127], v[20:23]
    ds_read_b64 v[92:93], v220 offset:3136
    ds_read_b64 v[94:95], v220 offset:3144
    v_mfma_f32_16x16x32_bf16 v[16:19], v[144:147], v[128:131], v[16:19]
    v_mfma_f32_16x16x32_bf16 v[28:31], v[148:151], v[120:123], v[28:31]
    s_waitcnt lgkmcnt(4)
    ds_read_b64 v[64:65], v220 offset:3648
    ds_read_b64 v[66:67], v220 offset:3656
    v_mfma_f32_16x16x32_bf16 v[24:27], v[148:151], v[124:127], v[24:27]
    v_mfma_f32_16x16x32_bf16 v[20:23], v[148:151], v[128:131], v[20:23]
    v_mfma_f32_16x16x32_bf16 v[28:31], v[152:155], v[124:127], v[28:31]
    v_mfma_f32_16x16x32_bf16 v[24:27], v[152:155], v[128:131], v[24:27]
    v_mfma_f32_16x16x32_bf16 v[28:31], v[156:159], v[128:131], v[28:31]
    v_mfma_f32_16x16x32_bf16 v[28:31], v[36:39], v[32:35], v[28:31]
    ds_read_b64 v[100:101], v220 offset:128
    ds_read_b64 v[102:103], v220 offset:136
    v_mfma_f32_16x16x32_bf16 v[24:27], v[36:39], v[40:43], v[24:27]
    v_mfma_f32_16x16x32_bf16 v[20:23], v[36:39], v[68:71], v[20:23]
    ds_read_b128 v[96:99], v221 offset:192
    v_mfma_f32_16x16x32_bf16 v[16:19], v[36:39], v[44:47], v[16:19]
    v_mfma_f32_16x16x32_bf16 v[12:15], v[36:39], v[72:75], v[12:15]
    ds_read_b128 v[104:107], v221 offset:704
    v_mfma_f32_16x16x32_bf16 v[8:11], v[36:39], v[48:51], v[8:11]
    v_mfma_f32_16x16x32_bf16 v[4:7], v[36:39], v[76:79], v[4:7]
    ds_read_b128 v[132:135], v221 offset:1216
    v_mfma_f32_16x16x32_bf16 v[0:3], v[36:39], v[52:55], v[0:3]
    v_mfma_f32_16x16x32_bf16 v[28:31], v[80:83], v[40:43], v[28:31]
    ds_read_b128 v[108:111], v221 offset:1728
    v_mfma_f32_16x16x32_bf16 v[24:27], v[80:83], v[68:71], v[24:27]
    v_mfma_f32_16x16x32_bf16 v[20:23], v[80:83], v[44:47], v[20:23]
    s_waitcnt lgkmcnt(4)
    ds_read_b128 v[136:139], v221 offset:2240
    v_mfma_f32_16x16x32_bf16 v[16:19], v[80:83], v[72:75], v[16:19]
    v_mfma_f32_16x16x32_bf16 v[12:15], v[80:83], v[48:51], v[12:15]
    ds_read_b128 v[112:115], v221 offset:2752
    v_mfma_f32_16x16x32_bf16 v[8:11], v[80:83], v[76:79], v[8:11]
    v_mfma_f32_16x16x32_bf16 v[4:7], v[80:83], v[52:55], v[4:7]
    ds_read_b128 v[140:143], v221 offset:3264
    v_mfma_f32_16x16x32_bf16 v[28:31], v[56:59], v[68:71], v[28:31]
    v_mfma_f32_16x16x32_bf16 v[24:27], v[56:59], v[44:47], v[24:27]
    ds_read_b128 v[116:119], v221 offset:3776
    v_mfma_f32_16x16x32_bf16 v[20:23], v[56:59], v[72:75], v[20:23]
    v_mfma_f32_16x16x32_bf16 v[16:19], v[56:59], v[48:51], v[16:19]
    ds_read_b64 v[144:145], v220 offset:640
    ds_read_b64 v[146:147], v220 offset:648
    v_mfma_f32_16x16x32_bf16 v[12:15], v[56:59], v[76:79], v[12:15]
    v_mfma_f32_16x16x32_bf16 v[8:11], v[56:59], v[52:55], v[8:11]
    ds_read_b64 v[120:121], v220 offset:1152
    ds_read_b64 v[122:123], v220 offset:1160
    v_mfma_f32_16x16x32_bf16 v[28:31], v[84:87], v[44:47], v[28:31]
    v_mfma_f32_16x16x32_bf16 v[24:27], v[84:87], v[72:75], v[24:27]
    s_waitcnt lgkmcnt(4)
    ds_read_b64 v[148:149], v220 offset:1664
    ds_read_b64 v[150:151], v220 offset:1672
    v_mfma_f32_16x16x32_bf16 v[20:23], v[84:87], v[48:51], v[20:23]
    v_mfma_f32_16x16x32_bf16 v[16:19], v[84:87], v[76:79], v[16:19]
    ds_read_b64 v[124:125], v220 offset:2176
    ds_read_b64 v[126:127], v220 offset:2184
    v_mfma_f32_16x16x32_bf16 v[12:15], v[84:87], v[52:55], v[12:15]
    v_mfma_f32_16x16x32_bf16 v[28:31], v[60:63], v[72:75], v[28:31]
    ds_read_b64 v[152:153], v220 offset:2688
    ds_read_b64 v[154:155], v220 offset:2696
    v_mfma_f32_16x16x32_bf16 v[24:27], v[60:63], v[48:51], v[24:27]
    v_mfma_f32_16x16x32_bf16 v[20:23], v[60:63], v[76:79], v[20:23]
    ds_read_b64 v[156:157], v220 offset:3200
    ds_read_b64 v[158:159], v220 offset:3208
    v_mfma_f32_16x16x32_bf16 v[16:19], v[60:63], v[52:55], v[16:19]
    v_mfma_f32_16x16x32_bf16 v[28:31], v[88:91], v[48:51], v[28:31]
    s_waitcnt lgkmcnt(4)
    ds_read_b64 v[128:129], v220 offset:3712
    ds_read_b64 v[130:131], v220 offset:3720
    v_mfma_f32_16x16x32_bf16 v[24:27], v[88:91], v[76:79], v[24:27]
    v_mfma_f32_16x16x32_bf16 v[20:23], v[88:91], v[52:55], v[20:23]
    v_mfma_f32_16x16x32_bf16 v[28:31], v[92:95], v[76:79], v[28:31]
    v_mfma_f32_16x16x32_bf16 v[24:27], v[92:95], v[52:55], v[24:27]
    v_mfma_f32_16x16x32_bf16 v[28:31], v[64:67], v[52:55], v[28:31]
    v_mfma_f32_16x16x32_bf16 v[28:31], v[100:103], v[96:99], v[28:31]
    ds_read_b64 v[32:33], v220 offset:192
    ds_read_b64 v[34:35], v220 offset:200
    v_mfma_f32_16x16x32_bf16 v[24:27], v[100:103], v[104:107], v[24:27]
    v_mfma_f32_16x16x32_bf16 v[20:23], v[100:103], v[132:135], v[20:23]
    ds_read_b128 v[36:39], v221 offset:256
    v_mfma_f32_16x16x32_bf16 v[16:19], v[100:103], v[108:111], v[16:19]
    v_mfma_f32_16x16x32_bf16 v[12:15], v[100:103], v[136:139], v[12:15]
    ds_read_b128 v[40:43], v221 offset:768
    v_mfma_f32_16x16x32_bf16 v[8:11], v[100:103], v[112:115], v[8:11]
    v_mfma_f32_16x16x32_bf16 v[4:7], v[100:103], v[140:143], v[4:7]
    ds_read_b128 v[80:83], v221 offset:1280
    v_mfma_f32_16x16x32_bf16 v[0:3], v[100:103], v[116:119], v[0:3]
    v_mfma_f32_16x16x32_bf16 v[28:31], v[144:147], v[104:107], v[28:31]
    ds_read_b128 v[68:71], v221 offset:1792
    v_mfma_f32_16x16x32_bf16 v[24:27], v[144:147], v[132:135], v[24:27]
    v_mfma_f32_16x16x32_bf16 v[20:23], v[144:147], v[108:111], v[20:23]
    s_waitcnt lgkmcnt(4)
    ds_read_b128 v[56:59], v221 offset:2304
    v_mfma_f32_16x16x32_bf16 v[16:19], v[144:147], v[136:139], v[16:19]
    v_mfma_f32_16x16x32_bf16 v[12:15], v[144:147], v[112:115], v[12:15]
    ds_read_b128 v[44:47], v221 offset:2816
    v_mfma_f32_16x16x32_bf16 v[8:11], v[144:147], v[140:143], v[8:11]
    v_mfma_f32_16x16x32_bf16 v[4:7], v[144:147], v[116:119], v[4:7]
    ds_read_b128 v[84:87], v221 offset:3328
    v_mfma_f32_16x16x32_bf16 v[28:31], v[120:123], v[132:135], v[28:31]
    v_mfma_f32_16x16x32_bf16 v[24:27], v[120:123], v[108:111], v[24:27]
    ds_read_b128 v[72:75], v221 offset:3840
    v_mfma_f32_16x16x32_bf16 v[20:23], v[120:123], v[136:139], v[20:23]
    v_mfma_f32_16x16x32_bf16 v[16:19], v[120:123], v[112:115], v[16:19]
    ds_read_b64 v[60:61], v220 offset:704
    ds_read_b64 v[62:63], v220 offset:712
    v_mfma_f32_16x16x32_bf16 v[12:15], v[120:123], v[140:143], v[12:15]
    v_mfma_f32_16x16x32_bf16 v[8:11], v[120:123], v[116:119], v[8:11]
    ds_read_b64 v[48:49], v220 offset:1216
    ds_read_b64 v[50:51], v220 offset:1224
    v_mfma_f32_16x16x32_bf16 v[28:31], v[148:151], v[108:111], v[28:31]
    v_mfma_f32_16x16x32_bf16 v[24:27], v[148:151], v[136:139], v[24:27]
    s_waitcnt lgkmcnt(4)
    ds_read_b64 v[88:89], v220 offset:1728
    ds_read_b64 v[90:91], v220 offset:1736
    v_mfma_f32_16x16x32_bf16 v[20:23], v[148:151], v[112:115], v[20:23]
    v_mfma_f32_16x16x32_bf16 v[16:19], v[148:151], v[140:143], v[16:19]
    ds_read_b64 v[76:77], v220 offset:2240
    ds_read_b64 v[78:79], v220 offset:2248
    v_mfma_f32_16x16x32_bf16 v[12:15], v[148:151], v[116:119], v[12:15]
    v_mfma_f32_16x16x32_bf16 v[28:31], v[124:127], v[136:139], v[28:31]
    ds_read_b64 v[92:93], v220 offset:2752
    ds_read_b64 v[94:95], v220 offset:2760
    v_mfma_f32_16x16x32_bf16 v[24:27], v[124:127], v[112:115], v[24:27]
    v_mfma_f32_16x16x32_bf16 v[20:23], v[124:127], v[140:143], v[20:23]
    ds_read_b64 v[64:65], v220 offset:3264
    ds_read_b64 v[66:67], v220 offset:3272
    v_mfma_f32_16x16x32_bf16 v[16:19], v[124:127], v[116:119], v[16:19]
    v_mfma_f32_16x16x32_bf16 v[28:31], v[152:155], v[112:115], v[28:31]
    s_waitcnt lgkmcnt(4)
    ds_read_b64 v[52:53], v220 offset:3776
    ds_read_b64 v[54:55], v220 offset:3784
    v_mfma_f32_16x16x32_bf16 v[24:27], v[152:155], v[140:143], v[24:27]
    v_mfma_f32_16x16x32_bf16 v[20:23], v[152:155], v[116:119], v[20:23]
    v_mfma_f32_16x16x32_bf16 v[28:31], v[156:159], v[140:143], v[28:31]
    v_mfma_f32_16x16x32_bf16 v[24:27], v[156:159], v[116:119], v[24:27]
    v_mfma_f32_16x16x32_bf16 v[28:31], v[128:131], v[116:119], v[28:31]
    v_mfma_f32_16x16x32_bf16 v[28:31], v[32:35], v[36:39], v[28:31]
    ds_read_b64 v[96:97], v220 offset:256
    ds_read_b64 v[98:99], v220 offset:264
    v_mfma_f32_16x16x32_bf16 v[24:27], v[32:35], v[40:43], v[24:27]
    v_mfma_f32_16x16x32_bf16 v[20:23], v[32:35], v[80:83], v[20:23]
    ds_read_b128 v[100:103], v221 offset:320
    v_mfma_f32_16x16x32_bf16 v[16:19], v[32:35], v[68:71], v[16:19]
    v_mfma_f32_16x16x32_bf16 v[12:15], v[32:35], v[56:59], v[12:15]
    ds_read_b128 v[104:107], v221 offset:832
    v_mfma_f32_16x16x32_bf16 v[8:11], v[32:35], v[44:47], v[8:11]
    v_mfma_f32_16x16x32_bf16 v[4:7], v[32:35], v[84:87], v[4:7]
    ds_read_b128 v[144:147], v221 offset:1344
    v_mfma_f32_16x16x32_bf16 v[0:3], v[32:35], v[72:75], v[0:3]
    v_mfma_f32_16x16x32_bf16 v[28:31], v[60:63], v[40:43], v[28:31]
    ds_read_b128 v[132:135], v221 offset:1856
    v_mfma_f32_16x16x32_bf16 v[24:27], v[60:63], v[80:83], v[24:27]
    v_mfma_f32_16x16x32_bf16 v[20:23], v[60:63], v[68:71], v[20:23]
    s_waitcnt lgkmcnt(4)
    ds_read_b128 v[120:123], v221 offset:2368
    v_mfma_f32_16x16x32_bf16 v[16:19], v[60:63], v[56:59], v[16:19]
    v_mfma_f32_16x16x32_bf16 v[12:15], v[60:63], v[44:47], v[12:15]
    ds_read_b128 v[108:111], v221 offset:2880
    v_mfma_f32_16x16x32_bf16 v[8:11], v[60:63], v[84:87], v[8:11]
    v_mfma_f32_16x16x32_bf16 v[4:7], v[60:63], v[72:75], v[4:7]
    ds_read_b128 v[148:151], v221 offset:3392
    v_mfma_f32_16x16x32_bf16 v[28:31], v[48:51], v[80:83], v[28:31]
    v_mfma_f32_16x16x32_bf16 v[24:27], v[48:51], v[68:71], v[24:27]
    ds_read_b128 v[136:139], v221 offset:3904
    v_mfma_f32_16x16x32_bf16 v[20:23], v[48:51], v[56:59], v[20:23]
    v_mfma_f32_16x16x32_bf16 v[16:19], v[48:51], v[44:47], v[16:19]
    ds_read_b64 v[124:125], v220 offset:768
    ds_read_b64 v[126:127], v220 offset:776
    v_mfma_f32_16x16x32_bf16 v[12:15], v[48:51], v[84:87], v[12:15]
    v_mfma_f32_16x16x32_bf16 v[8:11], v[48:51], v[72:75], v[8:11]
    ds_read_b64 v[112:113], v220 offset:1280
    ds_read_b64 v[114:115], v220 offset:1288
    v_mfma_f32_16x16x32_bf16 v[28:31], v[88:91], v[68:71], v[28:31]
    v_mfma_f32_16x16x32_bf16 v[24:27], v[88:91], v[56:59], v[24:27]
    s_waitcnt lgkmcnt(4)
    ds_read_b64 v[152:153], v220 offset:1792
    ds_read_b64 v[154:155], v220 offset:1800
    v_mfma_f32_16x16x32_bf16 v[20:23], v[88:91], v[44:47], v[20:23]
    v_mfma_f32_16x16x32_bf16 v[16:19], v[88:91], v[84:87], v[16:19]
    ds_read_b64 v[140:141], v220 offset:2304
    ds_read_b64 v[142:143], v220 offset:2312
    v_mfma_f32_16x16x32_bf16 v[12:15], v[88:91], v[72:75], v[12:15]
    v_mfma_f32_16x16x32_bf16 v[28:31], v[76:79], v[56:59], v[28:31]
    ds_read_b64 v[156:157], v220 offset:2816
    ds_read_b64 v[158:159], v220 offset:2824
    v_mfma_f32_16x16x32_bf16 v[24:27], v[76:79], v[44:47], v[24:27]
    v_mfma_f32_16x16x32_bf16 v[20:23], v[76:79], v[84:87], v[20:23]
    ds_read_b64 v[128:129], v220 offset:3328
    ds_read_b64 v[130:131], v220 offset:3336
    v_mfma_f32_16x16x32_bf16 v[16:19], v[76:79], v[72:75], v[16:19]
    v_mfma_f32_16x16x32_bf16 v[28:31], v[92:95], v[44:47], v[28:31]
    s_waitcnt lgkmcnt(4)
    ds_read_b64 v[116:117], v220 offset:3840
    ds_read_b64 v[118:119], v220 offset:3848
    v_mfma_f32_16x16x32_bf16 v[24:27], v[92:95], v[84:87], v[24:27]
    v_mfma_f32_16x16x32_bf16 v[20:23], v[92:95], v[72:75], v[20:23]
    v_mfma_f32_16x16x32_bf16 v[28:31], v[64:67], v[84:87], v[28:31]
    v_mfma_f32_16x16x32_bf16 v[24:27], v[64:67], v[72:75], v[24:27]
    v_mfma_f32_16x16x32_bf16 v[28:31], v[52:55], v[72:75], v[28:31]
    v_mfma_f32_16x16x32_bf16 v[28:31], v[96:99], v[100:103], v[28:31]
    ds_read_b64 v[36:37], v220 offset:320
    ds_read_b64 v[38:39], v220 offset:328
    v_mfma_f32_16x16x32_bf16 v[24:27], v[96:99], v[104:107], v[24:27]
    v_mfma_f32_16x16x32_bf16 v[20:23], v[96:99], v[144:147], v[20:23]
    ds_read_b128 v[32:35], v221 offset:384
    v_mfma_f32_16x16x32_bf16 v[16:19], v[96:99], v[132:135], v[16:19]
    v_mfma_f32_16x16x32_bf16 v[12:15], v[96:99], v[120:123], v[12:15]
    ds_read_b128 v[40:43], v221 offset:896
    v_mfma_f32_16x16x32_bf16 v[8:11], v[96:99], v[108:111], v[8:11]
    v_mfma_f32_16x16x32_bf16 v[4:7], v[96:99], v[148:151], v[4:7]
    ds_read_b128 v[60:63], v221 offset:1408
    v_mfma_f32_16x16x32_bf16 v[0:3], v[96:99], v[136:139], v[0:3]
    v_mfma_f32_16x16x32_bf16 v[28:31], v[124:127], v[104:107], v[28:31]
    ds_read_b128 v[80:83], v221 offset:1920
    v_mfma_f32_16x16x32_bf16 v[24:27], v[124:127], v[144:147], v[24:27]
    v_mfma_f32_16x16x32_bf16 v[20:23], v[124:127], v[132:135], v[20:23]
    s_waitcnt lgkmcnt(4)
    ds_read_b128 v[48:51], v221 offset:2432
    v_mfma_f32_16x16x32_bf16 v[16:19], v[124:127], v[120:123], v[16:19]
    v_mfma_f32_16x16x32_bf16 v[12:15], v[124:127], v[108:111], v[12:15]
    ds_read_b128 v[68:71], v221 offset:2944
    v_mfma_f32_16x16x32_bf16 v[8:11], v[124:127], v[148:151], v[8:11]
    v_mfma_f32_16x16x32_bf16 v[4:7], v[124:127], v[136:139], v[4:7]
    ds_read_b128 v[88:91], v221 offset:3456
    v_mfma_f32_16x16x32_bf16 v[28:31], v[112:115], v[144:147], v[28:31]
    v_mfma_f32_16x16x32_bf16 v[24:27], v[112:115], v[132:135], v[24:27]
    ds_read_b128 v[56:59], v221 offset:3968
    v_mfma_f32_16x16x32_bf16 v[20:23], v[112:115], v[120:123], v[20:23]
    v_mfma_f32_16x16x32_bf16 v[16:19], v[112:115], v[108:111], v[16:19]
    ds_read_b64 v[76:77], v220 offset:832
    ds_read_b64 v[78:79], v220 offset:840
    v_mfma_f32_16x16x32_bf16 v[12:15], v[112:115], v[148:151], v[12:15]
    v_mfma_f32_16x16x32_bf16 v[8:11], v[112:115], v[136:139], v[8:11]
    ds_read_b64 v[44:45], v220 offset:1344
    ds_read_b64 v[46:47], v220 offset:1352
    v_mfma_f32_16x16x32_bf16 v[28:31], v[152:155], v[132:135], v[28:31]
    v_mfma_f32_16x16x32_bf16 v[24:27], v[152:155], v[120:123], v[24:27]
    s_waitcnt lgkmcnt(4)
    ds_read_b64 v[92:93], v220 offset:1856
    ds_read_b64 v[94:95], v220 offset:1864
    v_mfma_f32_16x16x32_bf16 v[20:23], v[152:155], v[108:111], v[20:23]
    v_mfma_f32_16x16x32_bf16 v[16:19], v[152:155], v[148:151], v[16:19]
    ds_read_b64 v[84:85], v220 offset:2368
    ds_read_b64 v[86:87], v220 offset:2376
    v_mfma_f32_16x16x32_bf16 v[12:15], v[152:155], v[136:139], v[12:15]
    v_mfma_f32_16x16x32_bf16 v[28:31], v[140:143], v[120:123], v[28:31]
    ds_read_b64 v[64:65], v220 offset:2880
    ds_read_b64 v[66:67], v220 offset:2888
    v_mfma_f32_16x16x32_bf16 v[24:27], v[140:143], v[108:111], v[24:27]
    v_mfma_f32_16x16x32_bf16 v[20:23], v[140:143], v[148:151], v[20:23]
    ds_read_b64 v[52:53], v220 offset:3392
    ds_read_b64 v[54:55], v220 offset:3400
    v_mfma_f32_16x16x32_bf16 v[16:19], v[140:143], v[136:139], v[16:19]
    v_mfma_f32_16x16x32_bf16 v[28:31], v[156:159], v[108:111], v[28:31]
    s_waitcnt lgkmcnt(4)
    ds_read_b64 v[72:73], v220 offset:3904
    ds_read_b64 v[74:75], v220 offset:3912
    v_mfma_f32_16x16x32_bf16 v[24:27], v[156:159], v[148:151], v[24:27]
    v_mfma_f32_16x16x32_bf16 v[20:23], v[156:159], v[136:139], v[20:23]
    v_mfma_f32_16x16x32_bf16 v[28:31], v[128:131], v[148:151], v[28:31]
    v_mfma_f32_16x16x32_bf16 v[24:27], v[128:131], v[136:139], v[24:27]
    v_mfma_f32_16x16x32_bf16 v[28:31], v[116:119], v[136:139], v[28:31]
    v_mfma_f32_16x16x32_bf16 v[28:31], v[36:39], v[32:35], v[28:31]
    ds_read_b64 v[100:101], v220 offset:384
    ds_read_b64 v[102:103], v220 offset:392
    v_mfma_f32_16x16x32_bf16 v[24:27], v[36:39], v[40:43], v[24:27]
    v_mfma_f32_16x16x32_bf16 v[20:23], v[36:39], v[60:63], v[20:23]
    ds_read_b128 v[96:99], v221 offset:448
    v_mfma_f32_16x16x32_bf16 v[16:19], v[36:39], v[80:83], v[16:19]
    v_mfma_f32_16x16x32_bf16 v[12:15], v[36:39], v[48:51], v[12:15]
    ds_read_b128 v[104:107], v221 offset:960
    v_mfma_f32_16x16x32_bf16 v[8:11], v[36:39], v[68:71], v[8:11]
    v_mfma_f32_16x16x32_bf16 v[4:7], v[36:39], v[88:91], v[4:7]
    ds_read_b128 v[124:127], v221 offset:1472
    v_mfma_f32_16x16x32_bf16 v[0:3], v[36:39], v[56:59], v[0:3]
    v_mfma_f32_16x16x32_bf16 v[28:31], v[76:79], v[40:43], v[28:31]
    ds_read_b128 v[144:147], v221 offset:1984
    v_mfma_f32_16x16x32_bf16 v[24:27], v[76:79], v[60:63], v[24:27]
    v_mfma_f32_16x16x32_bf16 v[20:23], v[76:79], v[80:83], v[20:23]
    s_waitcnt lgkmcnt(4)
    ds_read_b128 v[112:115], v221 offset:2496
    v_mfma_f32_16x16x32_bf16 v[16:19], v[76:79], v[48:51], v[16:19]
    v_mfma_f32_16x16x32_bf16 v[12:15], v[76:79], v[68:71], v[12:15]
    ds_read_b128 v[132:135], v221 offset:3008
    v_mfma_f32_16x16x32_bf16 v[8:11], v[76:79], v[88:91], v[8:11]
    v_mfma_f32_16x16x32_bf16 v[4:7], v[76:79], v[56:59], v[4:7]
    ds_read_b128 v[152:155], v221 offset:3520
    v_mfma_f32_16x16x32_bf16 v[28:31], v[44:47], v[60:63], v[28:31]
    v_mfma_f32_16x16x32_bf16 v[24:27], v[44:47], v[80:83], v[24:27]
    ds_read_b128 v[120:123], v221 offset:4032
    v_mfma_f32_16x16x32_bf16 v[20:23], v[44:47], v[48:51], v[20:23]
    v_mfma_f32_16x16x32_bf16 v[16:19], v[44:47], v[68:71], v[16:19]
    ds_read_b64 v[140:141], v220 offset:896
    ds_read_b64 v[142:143], v220 offset:904
    v_mfma_f32_16x16x32_bf16 v[12:15], v[44:47], v[88:91], v[12:15]
    v_mfma_f32_16x16x32_bf16 v[8:11], v[44:47], v[56:59], v[8:11]
    ds_read_b64 v[108:109], v220 offset:1408
    ds_read_b64 v[110:111], v220 offset:1416
    v_mfma_f32_16x16x32_bf16 v[28:31], v[92:95], v[80:83], v[28:31]
    v_mfma_f32_16x16x32_bf16 v[24:27], v[92:95], v[48:51], v[24:27]
    s_waitcnt lgkmcnt(4)
    ds_read_b64 v[156:157], v220 offset:1920
    ds_read_b64 v[158:159], v220 offset:1928
    v_mfma_f32_16x16x32_bf16 v[20:23], v[92:95], v[68:71], v[20:23]
    v_mfma_f32_16x16x32_bf16 v[16:19], v[92:95], v[88:91], v[16:19]
    ds_read_b64 v[148:149], v220 offset:2432
    ds_read_b64 v[150:151], v220 offset:2440
    v_mfma_f32_16x16x32_bf16 v[12:15], v[92:95], v[56:59], v[12:15]
    v_mfma_f32_16x16x32_bf16 v[28:31], v[84:87], v[48:51], v[28:31]
    ds_read_b64 v[128:129], v220 offset:2944
    ds_read_b64 v[130:131], v220 offset:2952
    v_mfma_f32_16x16x32_bf16 v[24:27], v[84:87], v[68:71], v[24:27]
    v_mfma_f32_16x16x32_bf16 v[20:23], v[84:87], v[88:91], v[20:23]
    ds_read_b64 v[116:117], v220 offset:3456
    ds_read_b64 v[118:119], v220 offset:3464
    v_mfma_f32_16x16x32_bf16 v[16:19], v[84:87], v[56:59], v[16:19]
    v_mfma_f32_16x16x32_bf16 v[28:31], v[64:67], v[68:71], v[28:31]
    s_waitcnt lgkmcnt(4)
    ds_read_b64 v[136:137], v220 offset:3968
    ds_read_b64 v[138:139], v220 offset:3976
    v_mfma_f32_16x16x32_bf16 v[24:27], v[64:67], v[88:91], v[24:27]
    v_mfma_f32_16x16x32_bf16 v[20:23], v[64:67], v[56:59], v[20:23]
    v_mfma_f32_16x16x32_bf16 v[28:31], v[52:55], v[88:91], v[28:31]
    v_mfma_f32_16x16x32_bf16 v[24:27], v[52:55], v[56:59], v[24:27]
    v_mfma_f32_16x16x32_bf16 v[28:31], v[72:75], v[56:59], v[28:31]
    v_mfma_f32_16x16x32_bf16 v[28:31], v[100:103], v[96:99], v[28:31]
    v_mfma_f32_16x16x32_bf16 v[24:27], v[100:103], v[104:107], v[24:27]
    v_mfma_f32_16x16x32_bf16 v[20:23], v[100:103], v[124:127], v[20:23]
    v_mfma_f32_16x16x32_bf16 v[16:19], v[100:103], v[144:147], v[16:19]
    v_mfma_f32_16x16x32_bf16 v[12:15], v[100:103], v[112:115], v[12:15]
    v_mfma_f32_16x16x32_bf16 v[8:11], v[100:103], v[132:135], v[8:11]
    v_mfma_f32_16x16x32_bf16 v[4:7], v[100:103], v[152:155], v[4:7]
    v_mfma_f32_16x16x32_bf16 v[0:3], v[100:103], v[120:123], v[0:3]
    v_mfma_f32_16x16x32_bf16 v[28:31], v[140:143], v[104:107], v[28:31]
    v_mfma_f32_16x16x32_bf16 v[24:27], v[140:143], v[124:127], v[24:27]
    v_mfma_f32_16x16x32_bf16 v[20:23], v[140:143], v[144:147], v[20:23]
    v_mfma_f32_16x16x32_bf16 v[16:19], v[140:143], v[112:115], v[16:19]
    v_mfma_f32_16x16x32_bf16 v[12:15], v[140:143], v[132:135], v[12:15]
    v_mfma_f32_16x16x32_bf16 v[8:11], v[140:143], v[152:155], v[8:11]
    v_mfma_f32_16x16x32_bf16 v[4:7], v[140:143], v[120:123], v[4:7]
    v_mfma_f32_16x16x32_bf16 v[28:31], v[108:111], v[124:127], v[28:31]
    v_mfma_f32_16x16x32_bf16 v[24:27], v[108:111], v[144:147], v[24:27]
    v_mfma_f32_16x16x32_bf16 v[20:23], v[108:111], v[112:115], v[20:23]
    v_mfma_f32_16x16x32_bf16 v[16:19], v[108:111], v[132:135], v[16:19]
    v_mfma_f32_16x16x32_bf16 v[12:15], v[108:111], v[152:155], v[12:15]
    v_mfma_f32_16x16x32_bf16 v[8:11], v[108:111], v[120:123], v[8:11]
    v_mfma_f32_16x16x32_bf16 v[28:31], v[156:159], v[144:147], v[28:31]
    v_mfma_f32_16x16x32_bf16 v[24:27], v[156:159], v[112:115], v[24:27]
    v_mfma_f32_16x16x32_bf16 v[20:23], v[156:159], v[132:135], v[20:23]
    v_mfma_f32_16x16x32_bf16 v[16:19], v[156:159], v[152:155], v[16:19]
    v_mfma_f32_16x16x32_bf16 v[12:15], v[156:159], v[120:123], v[12:15]
    v_mfma_f32_16x16x32_bf16 v[28:31], v[148:151], v[112:115], v[28:31]
    v_mfma_f32_16x16x32_bf16 v[24:27], v[148:151], v[132:135], v[24:27]
    v_mfma_f32_16x16x32_bf16 v[20:23], v[148:151], v[152:155], v[20:23]
    v_mfma_f32_16x16x32_bf16 v[16:19], v[148:151], v[120:123], v[16:19]
    s_waitcnt lgkmcnt(4)
    v_mfma_f32_16x16x32_bf16 v[28:31], v[128:131], v[132:135], v[28:31]
    v_mfma_f32_16x16x32_bf16 v[24:27], v[128:131], v[152:155], v[24:27]
    v_mfma_f32_16x16x32_bf16 v[20:23], v[128:131], v[120:123], v[20:23]
    s_waitcnt lgkmcnt(2)
    v_mfma_f32_16x16x32_bf16 v[28:31], v[116:119], v[152:155], v[28:31]
    v_mfma_f32_16x16x32_bf16 v[24:27], v[116:119], v[120:123], v[24:27]
    s_waitcnt lgkmcnt(0)
    v_mfma_f32_16x16x32_bf16 v[28:31], v[136:139], v[120:123], v[28:31]
    s_nop 7
    v_cvt_pk_bf16_f32 v32, v0, v1
    v_cvt_pk_bf16_f32 v33, v2, v3
    ds_write_b64 v222, v[32:33] offset:0
    v_cvt_pk_bf16_f32 v34, v4, v5
    v_cvt_pk_bf16_f32 v35, v6, v7
    ds_write_b64 v222, v[34:35] offset:512
    v_cvt_pk_bf16_f32 v36, v8, v9
    v_cvt_pk_bf16_f32 v37, v10, v11
    ds_write_b64 v222, v[36:37] offset:1024
    v_cvt_pk_bf16_f32 v38, v12, v13
    v_cvt_pk_bf16_f32 v39, v14, v15
    ds_write_b64 v222, v[38:39] offset:1536
    v_cvt_pk_bf16_f32 v40, v16, v17
    v_cvt_pk_bf16_f32 v41, v18, v19
    ds_write_b64 v222, v[40:41] offset:2048
    v_cvt_pk_bf16_f32 v42, v20, v21
    v_cvt_pk_bf16_f32 v43, v22, v23
    ds_write_b64 v222, v[42:43] offset:2560
    v_cvt_pk_bf16_f32 v44, v24, v25
    v_cvt_pk_bf16_f32 v45, v26, v27
    ds_write_b64 v222, v[44:45] offset:3072
    v_cvt_pk_bf16_f32 v46, v28, v29
    v_cvt_pk_bf16_f32 v47, v30, v31
    ds_write_b64 v222, v[46:47] offset:3584
    s_mov_b32 s67, 76032
    v_add_u32 v250, s34, v239
    s_waitcnt lgkmcnt(4)
    ds_write_b128 v250, v[160:163] offset:0
    ds_write_b128 v250, v[164:167] offset:1024
    ds_write_b128 v250, v[168:171] offset:2048
    ds_write_b128 v250, v[172:175] offset:3072
    ds_write_b128 v250, v[176:179] offset:4096
    ds_write_b128 v250, v[180:183] offset:5120
    ds_write_b128 v250, v[184:187] offset:6144
    ds_write_b128 v250, v[188:191] offset:7168
    v_bfe_u32 v250, v238, 6, 3
    v_mul_u32_u24 v250, 9216, v250
    v_lshrrev_b32 v251, 9, v238
    v_lshl_add_u32 v250, v251, 6, v250
    v_and_b32 v249, 48, v238
    v_add3_u32 v250, v250, v249, s67
    v_mul_u32_u24 v251, 36864, v251
    v_and_b32 v249, 0x1f0, v238
    v_add_u32 v251, v251, v249
    s_waitcnt lgkmcnt(0)
    s_barrier
    ds_read_b128 v[84:87], v250 offset:0
    ds_read_b128 v[88:91], v250 offset:1024
    ds_read_b128 v[92:95], v250 offset:2048
    ds_read_b128 v[96:99], v250 offset:3072
    ds_read_b128 v[52:55], v238 offset:0
    ds_read_b128 v[56:59], v238 offset:8448
    ds_read_b128 v[60:63], v238 offset:16896
    ds_read_b128 v[64:67], v238 offset:25344
    ds_read_b128 v[68:71], v238 offset:33792
    ds_read_b128 v[72:75], v238 offset:42240
    ds_read_b128 v[76:79], v238 offset:50688
    ds_read_b128 v[80:83], v238 offset:59136
    s_lshl_b32 s35, s28, 9
    s_add_u32 s35, s35, 42483712
    s_waitcnt lgkmcnt(11)
    buffer_store_dwordx4 v[84:87], v251, s[20:23], s35 offen sc1
    s_add_u32 s35, s35, 589824
    s_waitcnt lgkmcnt(10)
    buffer_store_dwordx4 v[88:91], v251, s[20:23], s35 offen sc1
    s_add_u32 s35, s35, 589824
    s_waitcnt lgkmcnt(9)
    buffer_store_dwordx4 v[92:95], v251, s[20:23], s35 offen sc1
    s_add_u32 s35, s35, 589824
    s_waitcnt lgkmcnt(8)
    buffer_store_dwordx4 v[96:99], v251, s[20:23], s35 offen sc1
    s_add_u32 s35, s35, 589824
    s_lshl_b32 s35, s28, 6
    s_mul_i32 s56, s30, 294912
    s_add_u32 s35, s35, s56
    s_add_u32 s35, s35, 42516480
    s_waitcnt lgkmcnt(0)
    v_add_f32 v52, v52, v56
    v_add_f32 v53, v53, v57
    v_add_f32 v54, v54, v58
    v_add_f32 v55, v55, v59
    v_add_f32 v52, v52, v60
    v_add_f32 v53, v53, v61
    v_add_f32 v54, v54, v62
    v_add_f32 v55, v55, v63
    v_add_f32 v52, v52, v64
    v_add_f32 v53, v53, v65
    v_add_f32 v54, v54, v66
    v_add_f32 v55, v55, v67
    v_add_f32 v52, v52, v68
    v_add_f32 v53, v53, v69
    v_add_f32 v54, v54, v70
    v_add_f32 v55, v55, v71
    v_add_f32 v52, v52, v72
    v_add_f32 v53, v53, v73
    v_add_f32 v54, v54, v74
    v_add_f32 v55, v55, v75
    v_add_f32 v52, v52, v76
    v_add_f32 v53, v53, v77
    v_add_f32 v54, v54, v78
    v_add_f32 v55, v55, v79
    v_add_f32 v52, v52, v80
    v_add_f32 v53, v53, v81
    v_add_f32 v54, v54, v82
    v_add_f32 v55, v55, v83
    v_cvt_pk_bf16_f32 v48, v52, v53
    v_cvt_pk_bf16_f32 v49, v54, v55
    buffer_store_dwordx2 v[48:49], v253, s[20:23], s35 offen sc1
    ds_read_b64 v[150:151], v235
    v_lshrrev_b32 v250, 6, v238
    v_and_b32 v251, 48, v238
    v_mov_b32 v225, v238
    v_bfe_u32 v249, v238, 9, 2
    v_lshlrev_b32 v249, 4, v249
    v_xor_b32 v227, v249, v238
    s_cmp_eq_u32 s32, 0
    s_cselect_b32 s58, 0, 0x7ffffff0
    v_or_b32 v226, s58, v225
    v_bfe_u32 v250, v241, 3, 2
    v_lshrrev_b32 v249, 5, v241
    v_and_b32 v251, 0x70, v239
    v_lshl_add_u32 v251, v250, 9, v251
    v_mul_u32_u24 v220, 36864, v249
    v_add_u32 v220, v220, v251
    s_mul_i32 s56, s28, 479232
    s_lshl_b32 s57, s31, 7
    s_add_u32 s56, s56, s57
    s_lshl_b32 s57, s32, 11
    s_add_u32 s56, s56, s57
    v_add_u32 v220, s56, v220
    v_min_u32 v251, 11, v241
    s_lshl_b32 s56, s28, 7
    s_add_u32 s56, s56, 44847104
    v_lshl_add_u32 v221, v251, 3, s56
    v_xor_b32 v251, s31, v250
    v_lshlrev_b32 v251, 4, v251
    v_lshl_add_u32 v228, v250, 9, v251
    v_lshl_add_u32 v228, v249, 12, v228
    v_and_b32 v251, 1, v241
    v_lshl_add_u32 v228, v251, 3, v228
    v_and_b32 v251, 6, v241
    v_add_u32 v228, v228, v251
    v_add_u32 v228, s57, v228
    v_lshrrev_b32 v229, 1, v239
    v_add_u32 v229, 44846592, v229
    s_mov_b32 s63, 0x00003f80
    s_mov_b32 s64, 0x3f800000
    s_mov_b32 s65, 0x3f317218
    s_mov_b32 s36, 0
    v_mov_b32 v231, 160256
    s_waitcnt lgkmcnt(0)
    v_mul_f32 v152, 0x3ae38e39, v150
    v_mul_f32 v153, 0x3ae38e39, v151
    v_fma_f32 v153, -v152, v152, v153
    v_max_f32 v153, 0, v153
    v_cvt_pk_bf16_f32 v232, v152, v153
    v_and_b32 v153, 0xffff0000, v232
    v_lshlrev_b32 v232, 16, v232
    v_add_f32 v153, 0x3727c5ac, v153
    v_cvt_pk_bf16_f32 v153, v153, v153
    v_lshlrev_b32 v153, 16, v153
    v_sqrt_f32 v153, v153
    s_nop 0
    v_cvt_pk_bf16_f32 v153, v153, v153
    v_lshlrev_b32 v153, 16, v153
    v_rcp_f32 v233, v153
    s_nop 0
    v_lshlrev_b32 v160, 16, v200
    v_and_b32 v161, 0xffff0000, v200
    v_lshlrev_b32 v162, 16, v201
    v_and_b32 v163, 0xffff0000, v201
    v_lshlrev_b32 v164, 16, v202
    v_and_b32 v165, 0xffff0000, v202
    v_lshlrev_b32 v166, 16, v203
    v_and_b32 v167, 0xffff0000, v203
    v_lshlrev_b32 v168, 16, v204
    v_and_b32 v169, 0xffff0000, v204
    v_lshlrev_b32 v170, 16, v205
    v_and_b32 v171, 0xffff0000, v205
    v_lshlrev_b32 v172, 16, v206
    v_and_b32 v173, 0xffff0000, v206
    v_lshlrev_b32 v174, 16, v207
    v_and_b32 v175, 0xffff0000, v207
    v_lshlrev_b32 v176, 16, v208
    v_and_b32 v177, 0xffff0000, v208
    v_lshlrev_b32 v178, 16, v209
    v_and_b32 v179, 0xffff0000, v209
    v_lshlrev_b32 v180, 16, v210
    v_and_b32 v181, 0xffff0000, v210
    v_lshlrev_b32 v182, 16, v211
    v_and_b32 v183, 0xffff0000, v211
    v_lshlrev_b32 v184, 16, v212
    v_and_b32 v185, 0xffff0000, v212
    v_lshlrev_b32 v186, 16, v213
    v_and_b32 v187, 0xffff0000, v213
    v_lshlrev_b32 v188, 16, v214
    v_and_b32 v189, 0xffff0000, v214
    v_lshlrev_b32 v190, 16, v215
    v_and_b32 v191, 0xffff0000, v215
    v_lshlrev_b32 v192, 16, v216
    v_and_b32 v193, 0xffff0000, v216
    v_lshlrev_b32 v194, 16, v217
    v_and_b32 v195, 0xffff0000, v217
    v_lshlrev_b32 v196, 16, v218
    v_and_b32 v197, 0xffff0000, v218
    v_lshlrev_b32 v198, 16, v219
    v_and_b32 v199, 0xffff0000, v219
    v_mov_b32 v116, 0
    v_mov_b32 v117, 0
    v_mov_b32 v118, 0
    v_mov_b32 v119, 0
    v_mov_b32 v120, 0
    v_mov_b32 v121, 0
    v_mov_b32 v122, 0
    v_mov_b32 v123, 0
    v_mov_b32 v124, 0
    v_mov_b32 v125, 0
    v_mov_b32 v126, 0
    v_mov_b32 v127, 0
    v_mov_b32 v128, 0
    v_mov_b32 v129, 0
    v_mov_b32 v130, 0
    v_mov_b32 v131, 0
    v_mul_f32 v232, v232, v233
    v_lshrrev_b32 v230, 5, v241
    v_mul_u32_u24 v230, 32768, v230
    v_sub_u32 v230, v220, v230
    v_mov_b32 v234, 0x7ffffff0
    v_cmp_gt_u32 vcc, 32, v241
    s_nop 1
    v_cndmask_b32 v234, v234, v230, vcc
    s_cmp_lg_u32 s30, 7
    s_cbranch_scc1 Lq_29
Lpollp_30:
    buffer_load_dwordx2 v[222:223], v221, s[20:23], 0 offen sc1
    s_waitcnt vmcnt(0)
    v_subrev_u32 v222, s6, v222
    v_xor_b32 v223, s7, v223
    v_lshrrev_b32 v224, 4, v222
    v_or_b32 v223, v223, v224
    v_cmp_eq_u32 vcc, 0, v223
    s_nop 1
    v_cndmask_b32 v222, 0, v222, vcc
    s_nop 1
    v_min_u32_dpp v222, v222, v222 row_ror:8 row_mask:0xf bank_mask:0xf
    s_nop 1
    v_min_u32_dpp v222, v222, v222 row_ror:4 row_mask:0xf bank_mask:0xf
    s_nop 1
    v_min_u32_dpp v222, v222, v222 row_ror:2 row_mask:0xf bank_mask:0xf
    s_nop 1
    v_min_u32_dpp v222, v222, v222 row_ror:1 row_mask:0xf bank_mask:0xf
    s_nop 0
    v_readfirstlane_b32 s36, v222
    s_nop 0
    s_cmp_ge_u32 s36, 0
    s_cbranch_scc1 Lpdp_31
    s_sleep 6
    s_sub_u32 s5, s5, 1
    s_cbranch_scc0 Lpollp_30
    s_mov_b32 s5, 0
Lpdp_31:
    v_mov_b32 v222, s36
    ds_write_b32 v231, v222 offset:0
    s_waitcnt lgkmcnt(0)
Lq_29:
    s_waitcnt vmcnt(0)
    s_barrier
    ds_read_b32 v222, v231 offset:0
    s_waitcnt lgkmcnt(0)
    v_readfirstlane_b32 s36, v222
Lk_28:
    s_cmp_lg_u32 s30, 0
    s_cbranch_scc1 Lf_32
    s_lshl_b32 s56, s28, 3
    s_add_u32 s56, s56, 44846592
    v_mov_b32 v248, 0x7ffffff0
    s_add_u32 s59, s6, 1
    v_mov_b32 v250, s59
    v_mov_b32 v251, s7
    v_writelane_b32 v248, s56, 0
    buffer_store_dwordx2 v[250:251], v248, s[20:23], 0 offen sc1
Lf_32:
    s_cmp_ge_u32 s36, 1
    s_cbranch_scc1 Lk_33
    s_cmp_lg_u32 s30, 7
    s_cbranch_scc1 Lq_34
Lpollp_35:
    buffer_load_dwordx2 v[222:223], v221, s[20:23], 0 offen sc1
    s_waitcnt vmcnt(0)
    v_subrev_u32 v222, s6, v222
    v_xor_b32 v223, s7, v223
    v_lshrrev_b32 v224, 4, v222
    v_or_b32 v223, v223, v224
    v_cmp_eq_u32 vcc, 0, v223
    s_nop 1
    v_cndmask_b32 v222, 0, v222, vcc
    s_nop 1
    v_min_u32_dpp v222, v222, v222 row_ror:8 row_mask:0xf bank_mask:0xf
    s_nop 1
    v_min_u32_dpp v222, v222, v222 row_ror:4 row_mask:0xf bank_mask:0xf
    s_nop 1
    v_min_u32_dpp v222, v222, v222 row_ror:2 row_mask:0xf bank_mask:0xf
    s_nop 1
    v_min_u32_dpp v222, v222, v222 row_ror:1 row_mask:0xf bank_mask:0xf
    s_nop 0
    v_readfirstlane_b32 s36, v222
    s_nop 0
    s_cmp_ge_u32 s36, 1
    s_cbranch_scc1 Lpdp_36
    s_sleep 6
    s_sub_u32 s5, s5, 1
    s_cbranch_scc0 Lpollp_35
    s_mov_b32 s5, 0
Lpdp_36:
    v_mov_b32 v222, s36
    ds_write_b32 v231, v222 offset:4
    s_waitcnt lgkmcnt(0)
Lq_34:
    s_barrier
    ds_read_b32 v222, v231 offset:4
    s_waitcnt lgkmcnt(0)
    v_readfirstlane_b32 s36, v222
Lk_33:
    s_mov_b32 s62, 0
    buffer_load_dwordx4 v[0:3], v220, s[20:23], s62 offen sc1
    s_mov_b32 s62, 73728
    buffer_load_dwordx4 v[4:7], v220, s[20:23], s62 offen sc1
    s_mov_b32 s62, 147456
    buffer_load_dwordx4 v[8:11], v220, s[20:23], s62 offen sc1
    s_mov_b32 s62, 221184
    buffer_load_dwordx4 v[12:15], v220, s[20:23], s62 offen sc1
    s_mov_b32 s62, 294912
    buffer_load_dwordx4 v[16:19], v220, s[20:23], s62 offen sc1
    s_mov_b32 s62, 368640
    buffer_load_dwordx4 v[20:23], v220, s[20:23], s62 offen sc1
    s_cmp_lg_u32 s30, 6
    s_cbranch_scc1 Lk_37
Lpollz_38:
    buffer_load_dwordx2 v[222:223], v229, s[20:23], 0 offen sc1
    s_waitcnt vmcnt(0)
    s_add_u32 s59, s6, 1
    v_subrev_u32 v222, s59, v222
    v_xor_b32 v223, s7, v223
    v_lshrrev_b32 v222, 4, v222
    v_or_b32 v222, v222, v223
    v_cmp_ne_u32 vcc, 0, v222
    s_cmp_eq_u64 vcc, 0
    s_cbranch_scc1 Lpdz_39
    s_sleep 6
    s_sub_u32 s5, s5, 1
    s_cbranch_scc0 Lpollz_38
    s_mov_b32 s5, 0
Lpdz_39:
Lk_37:
    s_mov_b32 s36, 0
    s_cmp_ge_u32 s36, 2
    s_cbranch_scc1 Lk_40
    s_cmp_lg_u32 s30, 7
    s_cbranch_scc1 Lq_41
Lpollp_42:
    buffer_load_dwordx2 v[222:223], v221, s[20:23], 0 offen sc1
    s_waitcnt vmcnt(0)
    v_subrev_u32 v222, s6, v222
    v_xor_b32 v223, s7, v223
    v_lshrrev_b32 v224, 4, v222
    v_or_b32 v223, v223, v224
    v_cmp_eq_u32 vcc, 0, v223
    s_nop 1
    v_cndmask_b32 v222, 0, v222, vcc
    s_nop 1
    v_min_u32_dpp v222, v222, v222 row_ror:8 row_mask:0xf bank_mask:0xf
    s_nop 1
    v_min_u32_dpp v222, v222, v222 row_ror:4 row_mask:0xf bank_mask:0xf
    s_nop 1
    v_min_u32_dpp v222, v222, v222 row_ror:2 row_mask:0xf bank_mask:0xf
    s_nop 1
    v_min_u32_dpp v222, v222, v222 row_ror:1 row_mask:0xf bank_mask:0xf
    s_nop 0
    v_readfirstlane_b32 s36, v222
    s_nop 0
    s_cmp_ge_u32 s36, 2
    s_cbranch_scc1 Lpdp_43
    s_sleep 6
    s_sub_u32 s5, s5, 1
    s_cbranch_scc0 Lpollp_42
    s_mov_b32 s5, 0
Lpdp_43:
    v_mov_b32 v222, s36
    ds_write_b32 v231, v222 offset:8
    s_waitcnt lgkmcnt(0)
Lq_41:
    s_barrier
    ds_read_b32 v222, v231 offset:8
    s_waitcnt lgkmcnt(0)
    v_readfirstlane_b32 s36, v222
Lk_40:
    s_mul_i32 s56, s28, 36864
    s_add_u32 s56, s56, 42483712
    buffer_load_dwordx4 v[96:99], v225, s[20:23], s56 offen sc1
    s_add_u32 s56, s56, 8192
    buffer_load_dwordx4 v[100:103], v225, s[20:23], s56 offen sc1
    s_add_u32 s56, s56, 8192
    buffer_load_dwordx4 v[104:107], v225, s[20:23], s56 offen sc1
    s_add_u32 s56, s56, 8192
    buffer_load_dwordx4 v[108:111], v225, s[20:23], s56 offen sc1
    s_add_u32 s56, s56, 8192
    buffer_load_dwordx4 v[112:115], v226, s[20:23], s56 offen sc1
    s_mov_b32 s62, 4096
    buffer_load_dwordx4 v[24:27], v220, s[20:23], s62 offen sc1
    s_mov_b32 s62, 77824
    buffer_load_dwordx4 v[28:31], v220, s[20:23], s62 offen sc1
    s_mov_b32 s62, 151552
    buffer_load_dwordx4 v[32:35], v220, s[20:23], s62 offen sc1
    s_mov_b32 s62, 225280
    buffer_load_dwordx4 v[36:39], v220, s[20:23], s62 offen sc1
    s_mov_b32 s62, 299008
    buffer_load_dwordx4 v[40:43], v220, s[20:23], s62 offen sc1
    s_mov_b32 s62, 372736
    buffer_load_dwordx4 v[44:47], v220, s[20:23], s62 offen sc1
    s_cmp_ge_u32 s36, 3
    s_cbranch_scc0 Lr_44
    s_mov_b32 s62, 8192
    buffer_load_dwordx4 v[48:51], v220, s[20:23], s62 offen sc1
    s_mov_b32 s62, 81920
    buffer_load_dwordx4 v[52:55], v220, s[20:23], s62 offen sc1
    s_mov_b32 s62, 155648
    buffer_load_dwordx4 v[56:59], v220, s[20:23], s62 offen sc1
    s_mov_b32 s62, 229376
    buffer_load_dwordx4 v[60:63], v220, s[20:23], s62 offen sc1
    s_mov_b32 s62, 303104
    buffer_load_dwordx4 v[64:67], v220, s[20:23], s62 offen sc1
    s_mov_b32 s62, 376832
    buffer_load_dwordx4 v[68:71], v220, s[20:23], s62 offen sc1
    v_mov_b32 v144, 0
    v_mov_b32 v145, 0
    v_mov_b32 v146, 0
    v_mov_b32 v147, 0
    v_mov_b32 v148, 0
    v_mov_b32 v149, 0
    v_mov_b32 v150, 0
    v_mov_b32 v151, 0
    s_waitcnt vmcnt(22)
    v_dot2c_f32_bf16 v144, s63, v0
    v_dot2c_f32_bf16 v145, s64, v0
    v_dot2c_f32_bf16 v146, s63, v1
    v_dot2c_f32_bf16 v147, s64, v1
    v_dot2c_f32_bf16 v148, s63, v2
    v_dot2c_f32_bf16 v149, s64, v2
    v_dot2c_f32_bf16 v150, s63, v3
    v_dot2c_f32_bf16 v151, s64, v3
    s_waitcnt vmcnt(21)
    v_dot2c_f32_bf16 v144, s63, v4
    v_dot2c_f32_bf16 v145, s64, v4
    v_dot2c_f32_bf16 v146, s63, v5
    v_dot2c_f32_bf16 v147, s64, v5
    v_dot2c_f32_bf16 v148, s63, v6
    v_dot2c_f32_bf16 v149, s64, v6
    v_dot2c_f32_bf16 v150, s63, v7
    v_dot2c_f32_bf16 v151, s64, v7
    s_waitcnt vmcnt(20)
    v_dot2c_f32_bf16 v144, s63, v8
    v_dot2c_f32_bf16 v145, s64, v8
    v_dot2c_f32_bf16 v146, s63, v9
    v_dot2c_f32_bf16 v147, s64, v9
    v_dot2c_f32_bf16 v148, s63, v10
    v_dot2c_f32_bf16 v149, s64, v10
    v_dot2c_f32_bf16 v150, s63, v11
    v_dot2c_f32_bf16 v151, s64, v11
    s_waitcnt vmcnt(19)
    v_dot2c_f32_bf16 v144, s63, v12
    v_dot2c_f32_bf16 v145, s64, v12
    v_dot2c_f32_bf16 v146, s63, v13
    v_dot2c_f32_bf16 v147, s64, v13
    v_dot2c_f32_bf16 v148, s63, v14
    v_dot2c_f32_bf16 v149, s64, v14
    v_dot2c_f32_bf16 v150, s63, v15
    v_dot2c_f32_bf16 v151, s64, v15
    s_waitcnt vmcnt(18)
    v_dot2c_f32_bf16 v144, s63, v16
    v_dot2c_f32_bf16 v145, s64, v16
    v_dot2c_f32_bf16 v146, s63, v17
    v_dot2c_f32_bf16 v147, s64, v17
    v_dot2c_f32_bf16 v148, s63, v18
    v_dot2c_f32_bf16 v149, s64, v18
    v_dot2c_f32_bf16 v150, s63, v19
    v_dot2c_f32_bf16 v151, s64, v19
    s_waitcnt vmcnt(17)
    v_dot2c_f32_bf16 v144, s63, v20
    v_dot2c_f32_bf16 v145, s64, v20
    v_dot2c_f32_bf16 v146, s63, v21
    v_dot2c_f32_bf16 v147, s64, v21
    v_dot2c_f32_bf16 v148, s63, v22
    v_dot2c_f32_bf16 v149, s64, v22
    v_dot2c_f32_bf16 v150, s63, v23
    v_dot2c_f32_bf16 v151, s64, v23
    s_nop 2
    v_mov_b32 v152, v144
    v_mov_b32 v153, v145
    v_mov_b32 v154, v146
    v_mov_b32 v155, v147
    v_mov_b32 v156, v148
    v_mov_b32 v157, v149
    v_mov_b32 v158, v150
    v_mov_b32 v159, v151
    v_permlane32_swap_b32 v144, v152
    v_permlane32_swap_b32 v145, v153
    v_permlane32_swap_b32 v146, v154
    v_permlane32_swap_b32 v147, v155
    v_permlane32_swap_b32 v148, v156
    v_permlane32_swap_b32 v149, v157
    v_permlane32_swap_b32 v150, v158
    v_permlane32_swap_b32 v151, v159
    v_add_f32 v144, v144, v152
    v_add_f32 v145, v145, v153
    v_add_f32 v146, v146, v154
    v_add_f32 v147, v147, v155
    v_add_f32 v148, v148, v156
    v_add_f32 v149, v149, v157
    v_add_f32 v150, v150, v158
    v_add_f32 v151, v151, v159
    v_mul_f32 v240, s65, v144
    v_mul_f32 v241, s65, v145
    v_mul_f32 v242, s65, v146
    v_mul_f32 v243, s65, v147
    v_mul_f32 v244, s65, v148
    v_mul_f32 v245, s65, v149
    v_mul_f32 v246, s65, v150
    v_mul_f32 v247, s65, v151
    s_branch Lr_45
Lr_44:
    v_mov_b32 v144, 0
    v_mov_b32 v145, 0
    v_mov_b32 v146, 0
    v_mov_b32 v147, 0
    v_mov_b32 v148, 0
    v_mov_b32 v149, 0
    v_mov_b32 v150, 0
    v_mov_b32 v151, 0
    s_waitcnt vmcnt(16)
    v_dot2c_f32_bf16 v144, s63, v0
    v_dot2c_f32_bf16 v145, s64, v0
    v_dot2c_f32_bf16 v146, s63, v1
    v_dot2c_f32_bf16 v147, s64, v1
    v_dot2c_f32_bf16 v148, s63, v2
    v_dot2c_f32_bf16 v149, s64, v2
    v_dot2c_f32_bf16 v150, s63, v3
    v_dot2c_f32_bf16 v151, s64, v3
    s_waitcnt vmcnt(15)
    v_dot2c_f32_bf16 v144, s63, v4
    v_dot2c_f32_bf16 v145, s64, v4
    v_dot2c_f32_bf16 v146, s63, v5
    v_dot2c_f32_bf16 v147, s64, v5
    v_dot2c_f32_bf16 v148, s63, v6
    v_dot2c_f32_bf16 v149, s64, v6
    v_dot2c_f32_bf16 v150, s63, v7
    v_dot2c_f32_bf16 v151, s64, v7
    s_waitcnt vmcnt(14)
    v_dot2c_f32_bf16 v144, s63, v8
    v_dot2c_f32_bf16 v145, s64, v8
    v_dot2c_f32_bf16 v146, s63, v9
    v_dot2c_f32_bf16 v147, s64, v9
    v_dot2c_f32_bf16 v148, s63, v10
    v_dot2c_f32_bf16 v149, s64, v10
    v_dot2c_f32_bf16 v150, s63, v11
    v_dot2c_f32_bf16 v151, s64, v11
    s_waitcnt vmcnt(13)
    v_dot2c_f32_bf16 v144, s63, v12
    v_dot2c_f32_bf16 v145, s64, v12
    v_dot2c_f32_bf16 v146, s63, v13
    v_dot2c_f32_bf16 v147, s64, v13
    v_dot2c_f32_bf16 v148, s63, v14
    v_dot2c_f32_bf16 v149, s64, v14
    v_dot2c_f32_bf16 v150, s63, v15
    v_dot2c_f32_bf16 v151, s64, v15
    s_waitcnt vmcnt(12)
    v_dot2c_f32_bf16 v144, s63, v16
    v_dot2c_f32_bf16 v145, s64, v16
    v_dot2c_f32_bf16 v146, s63, v17
    v_dot2c_f32_bf16 v147, s64, v17
    v_dot2c_f32_bf16 v148, s63, v18
    v_dot2c_f32_bf16 v149, s64, v18
    v_dot2c_f32_bf16 v150, s63, v19
    v_dot2c_f32_bf16 v151, s64, v19
    s_waitcnt vmcnt(11)
    v_dot2c_f32_bf16 v144, s63, v20
    v_dot2c_f32_bf16 v145, s64, v20
    v_dot2c_f32_bf16 v146, s63, v21
    v_dot2c_f32_bf16 v147, s64, v21
    v_dot2c_f32_bf16 v148, s63, v22
    v_dot2c_f32_bf16 v149, s64, v22
    v_dot2c_f32_bf16 v150, s63, v23
    v_dot2c_f32_bf16 v151, s64, v23
    s_nop 2
    v_mov_b32 v152, v144
    v_mov_b32 v153, v145
    v_mov_b32 v154, v146
    v_mov_b32 v155, v147
    v_mov_b32 v156, v148
    v_mov_b32 v157, v149
    v_mov_b32 v158, v150
    v_mov_b32 v159, v151
    v_permlane32_swap_b32 v144, v152
    v_permlane32_swap_b32 v145, v153
    v_permlane32_swap_b32 v146, v154
    v_permlane32_swap_b32 v147, v155
    v_permlane32_swap_b32 v148, v156
    v_permlane32_swap_b32 v149, v157
    v_permlane32_swap_b32 v150, v158
    v_permlane32_swap_b32 v151, v159
    v_add_f32 v144, v144, v152
    v_add_f32 v145, v145, v153
    v_add_f32 v146, v146, v154
    v_add_f32 v147, v147, v155
    v_add_f32 v148, v148, v156
    v_add_f32 v149, v149, v157
    v_add_f32 v150, v150, v158
    v_add_f32 v151, v151, v159
    v_mul_f32 v240, s65, v144
    v_mul_f32 v241, s65, v145
    v_mul_f32 v242, s65, v146
    v_mul_f32 v243, s65, v147
    v_mul_f32 v244, s65, v148
    v_mul_f32 v245, s65, v149
    v_mul_f32 v246, s65, v150
    v_mul_f32 v247, s65, v151
    s_cmp_ge_u32 s36, 3
    s_cbranch_scc1 Lk_46
    s_cmp_lg_u32 s30, 7
    s_cbranch_scc1 Lq_47
Lpollp_48:
    buffer_load_dwordx2 v[222:223], v221, s[20:23], 0 offen sc1
    s_waitcnt vmcnt(0)
    v_subrev_u32 v222, s6, v222
    v_xor_b32 v223, s7, v223
    v_lshrrev_b32 v224, 4, v222
    v_or_b32 v223, v223, v224
    v_cmp_eq_u32 vcc, 0, v223
    s_nop 1
    v_cndmask_b32 v222, 0, v222, vcc
    s_nop 1
    v_min_u32_dpp v222, v222, v222 row_ror:8 row_mask:0xf bank_mask:0xf
    s_nop 1
    v_min_u32_dpp v222, v222, v222 row_ror:4 row_mask:0xf bank_mask:0xf
    s_nop 1
    v_min_u32_dpp v222, v222, v222 row_ror:2 row_mask:0xf bank_mask:0xf
    s_nop 1
    v_min_u32_dpp v222, v222, v222 row_ror:1 row_mask:0xf bank_mask:0xf
    s_nop 0
    v_readfirstlane_b32 s36, v222
    s_nop 0
    s_cmp_ge_u32 s36, 3
    s_cbranch_scc1 Lpdp_49
    s_sleep 6
    s_sub_u32 s5, s5, 1
    s_cbranch_scc0 Lpollp_48
    s_mov_b32 s5, 0
Lpdp_49:
    v_mov_b32 v222, s36
    ds_write_b32 v231, v222 offset:12
    s_waitcnt lgkmcnt(0)
Lq_47:
    s_barrier
    ds_read_b32 v222, v231 offset:12
    s_waitcnt lgkmcnt(0)
    v_readfirstlane_b32 s36, v222
Lk_46:
    s_mov_b32 s62, 8192
    buffer_load_dwordx4 v[48:51], v220, s[20:23], s62 offen sc1
    s_mov_b32 s62, 81920
    buffer_load_dwordx4 v[52:55], v220, s[20:23], s62 offen sc1
    s_mov_b32 s62, 155648
    buffer_load_dwordx4 v[56:59], v220, s[20:23], s62 offen sc1
    s_mov_b32 s62, 229376
    buffer_load_dwordx4 v[60:63], v220, s[20:23], s62 offen sc1
    s_mov_b32 s62, 303104
    buffer_load_dwordx4 v[64:67], v220, s[20:23], s62 offen sc1
    s_mov_b32 s62, 376832
    buffer_load_dwordx4 v[68:71], v220, s[20:23], s62 offen sc1
Lr_45:
    s_waitcnt vmcnt(12)
    ds_write_b128 v227, v[96:99] offset:0
    ds_write_b128 v227, v[100:103] offset:8192
    ds_write_b128 v227, v[104:107] offset:16384
    ds_write_b128 v227, v[108:111] offset:24576
    ds_write_b128 v227, v[112:115] offset:32768
    s_waitcnt lgkmcnt(0)
    s_barrier
    ds_read_u16_d16_hi v116, v228 offset:24576
    ds_read_u16_d16_hi v117, v228 offset:24640
    ds_read_u16_d16_hi v118, v228 offset:24704
    ds_read_u16_d16_hi v119, v228 offset:24768
    ds_read_u16_d16_hi v120, v228 offset:24832
    ds_read_u16_d16_hi v121, v228 offset:24896
    ds_read_u16_d16_hi v122, v228 offset:24960
    ds_read_u16_d16_hi v123, v228 offset:25024
    s_waitcnt lgkmcnt(4)
    ds_read_u16_d16_hi v124, v228 offset:32768
    ds_read_u16_d16_hi v125, v228 offset:32832
    ds_read_u16_d16_hi v126, v228 offset:32896
    ds_read_u16_d16_hi v127, v228 offset:32960
    ds_read_u16_d16_hi v128, v228 offset:33024
    ds_read_u16_d16_hi v129, v228 offset:33088
    ds_read_u16_d16_hi v130, v228 offset:33152
    ds_read_u16_d16_hi v131, v228 offset:33216
    v_fma_f32 v144, v184, v233, -v232
    v_fma_f32 v145, v185, v233, -v232
    v_fma_f32 v146, v186, v233, -v232
    v_fma_f32 v147, v187, v233, -v232
    v_fma_f32 v148, v188, v233, -v232
    v_fma_f32 v149, v189, v233, -v232
    v_fma_f32 v150, v190, v233, -v232
    v_fma_f32 v151, v191, v233, -v232
    s_waitcnt lgkmcnt(8)
    v_fmac_f32 v184, v144, v116
    v_fmac_f32 v185, v145, v117
    v_fmac_f32 v186, v146, v118
    v_fmac_f32 v187, v147, v119
    v_fmac_f32 v188, v148, v120
    v_fmac_f32 v189, v149, v121
    v_fmac_f32 v190, v150, v122
    v_fmac_f32 v191, v151, v123
    v_cvt_pk_bf16_f32 v212, v184, v185
    v_cvt_pk_bf16_f32 v213, v186, v187
    v_cvt_pk_bf16_f32 v214, v188, v189
    v_cvt_pk_bf16_f32 v215, v190, v191
    s_mov_b32 s62, 466944
    buffer_store_dwordx4 v[212:215], v230, s[20:23], s62 offen sc1
    s_waitcnt lgkmcnt(4)
    ds_read_u16_d16_hi v116, v228 offset:0
    ds_read_u16_d16_hi v117, v228 offset:64
    ds_read_u16_d16_hi v118, v228 offset:128
    ds_read_u16_d16_hi v119, v228 offset:192
    ds_read_u16_d16_hi v120, v228 offset:256
    ds_read_u16_d16_hi v121, v228 offset:320
    ds_read_u16_d16_hi v122, v228 offset:384
    ds_read_u16_d16_hi v123, v228 offset:448
    v_fma_f32 v144, v192, v233, -v232
    v_fma_f32 v145, v193, v233, -v232
    v_fma_f32 v146, v194, v233, -v232
    v_fma_f32 v147, v195, v233, -v232
    v_fma_f32 v148, v196, v233, -v232
    v_fma_f32 v149, v197, v233, -v232
    v_fma_f32 v150, v198, v233, -v232
    v_fma_f32 v151, v199, v233, -v232
    s_waitcnt lgkmcnt(8)
    v_fmac_f32 v192, v144, v124
    v_fmac_f32 v193, v145, v125
    v_fmac_f32 v194, v146, v126
    v_fmac_f32 v195, v147, v127
    v_fmac_f32 v196, v148, v128
    v_fmac_f32 v197, v149, v129
    v_fmac_f32 v198, v150, v130
    v_fmac_f32 v199, v151, v131
    v_cvt_pk_bf16_f32 v216, v192, v193
    v_cvt_pk_bf16_f32 v217, v194, v195
    v_cvt_pk_bf16_f32 v218, v196, v197
    v_cvt_pk_bf16_f32 v219, v198, v199
    s_mov_b32 s62, 475136
    buffer_store_dwordx4 v[216:219], v234, s[20:23], s62 offen sc1
    s_waitcnt lgkmcnt(4)
    ds_read_u16_d16_hi v124, v228 offset:8192
    ds_read_u16_d16_hi v125, v228 offset:8256
    ds_read_u16_d16_hi v126, v228 offset:8320
    ds_read_u16_d16_hi v127, v228 offset:8384
    ds_read_u16_d16_hi v128, v228 offset:8448
    ds_read_u16_d16_hi v129, v228 offset:8512
    ds_read_u16_d16_hi v130, v228 offset:8576
    ds_read_u16_d16_hi v131, v228 offset:8640
    v_fma_f32 v144, v160, v233, -v232
    v_fma_f32 v145, v161, v233, -v232
    v_fma_f32 v146, v162, v233, -v232
    v_fma_f32 v147, v163, v233, -v232
    v_fma_f32 v148, v164, v233, -v232
    v_fma_f32 v149, v165, v233, -v232
    v_fma_f32 v150, v166, v233, -v232
    v_fma_f32 v151, v167, v233, -v232
    s_waitcnt lgkmcnt(8)
    v_fmac_f32 v160, v144, v116
    v_fmac_f32 v161, v145, v117
    v_fmac_f32 v162, v146, v118
    v_fmac_f32 v163, v147, v119
    v_fmac_f32 v164, v148, v120
    v_fmac_f32 v165, v149, v121
    v_fmac_f32 v166, v150, v122
    v_fmac_f32 v167, v151, v123
    s_waitcnt lgkmcnt(4)
    ds_read_u16_d16_hi v116, v228 offset:16384
    ds_read_u16_d16_hi v117, v228 offset:16448
    ds_read_u16_d16_hi v118, v228 offset:16512
    ds_read_u16_d16_hi v119, v228 offset:16576
    ds_read_u16_d16_hi v120, v228 offset:16640
    ds_read_u16_d16_hi v121, v228 offset:16704
    ds_read_u16_d16_hi v122, v228 offset:16768
    ds_read_u16_d16_hi v123, v228 offset:16832
    v_fma_f32 v144, v168, v233, -v232
    v_fma_f32 v145, v169, v233, -v232
    v_fma_f32 v146, v170, v233, -v232
    v_fma_f32 v147, v171, v233, -v232
    v_fma_f32 v148, v172, v233, -v232
    v_fma_f32 v149, v173, v233, -v232
    v_fma_f32 v150, v174, v233, -v232
    v_fma_f32 v151, v175, v233, -v232
    s_waitcnt lgkmcnt(8)
    v_fmac_f32 v168, v144, v124
    v_fmac_f32 v169, v145, v125
    v_fmac_f32 v170, v146, v126
    v_fmac_f32 v171, v147, v127
    v_fmac_f32 v172, v148, v128
    v_fmac_f32 v173, v149, v129
    v_fmac_f32 v174, v150, v130
    v_fmac_f32 v175, v151, v131
    v_fma_f32 v144, v176, v233, -v232
    v_fma_f32 v145, v177, v233, -v232
    v_fma_f32 v146, v178, v233, -v232
    v_fma_f32 v147, v179, v233, -v232
    v_fma_f32 v148, v180, v233, -v232
    v_fma_f32 v149, v181, v233, -v232
    v_fma_f32 v150, v182, v233, -v232
    v_fma_f32 v151, v183, v233, -v232
    s_waitcnt lgkmcnt(0)
    v_fmac_f32 v176, v144, v116
    v_fmac_f32 v177, v145, v117
    v_fmac_f32 v178, v146, v118
    v_fmac_f32 v179, v147, v119
    v_fmac_f32 v180, v148, v120
    v_fmac_f32 v181, v149, v121
    v_fmac_f32 v182, v150, v122
    v_fmac_f32 v183, v151, v123
    v_add_f32 v144, v240, v160
    v_add_f32 v145, v241, v161
    v_add_f32 v146, v242, v162
    v_add_f32 v147, v243, v163
    v_add_f32 v148, v244, v164
    v_add_f32 v149, v245, v165
    v_add_f32 v150, v246, v166
    v_add_f32 v151, v247, v167
    v_cvt_pk_bf16_f32 v132, v144, v145
    v_cvt_pk_bf16_f32 v133, v146, v147
    v_cvt_pk_bf16_f32 v134, v148, v149
    v_cvt_pk_bf16_f32 v135, v150, v151
    buffer_store_dwordx4 v[132:135], v236, s[48:51], 0 offen offset:0
    s_cmp_ge_u32 s36, 4
    s_cbranch_scc0 Lr_50
    s_mov_b32 s62, 12288
    buffer_load_dwordx4 v[72:75], v220, s[20:23], s62 offen sc1
    s_mov_b32 s62, 86016
    buffer_load_dwordx4 v[76:79], v220, s[20:23], s62 offen sc1
    s_mov_b32 s62, 159744
    buffer_load_dwordx4 v[80:83], v220, s[20:23], s62 offen sc1
    s_mov_b32 s62, 233472
    buffer_load_dwordx4 v[84:87], v220, s[20:23], s62 offen sc1
    s_mov_b32 s62, 307200
    buffer_load_dwordx4 v[88:91], v220, s[20:23], s62 offen sc1
    s_mov_b32 s62, 380928
    buffer_load_dwordx4 v[92:95], v220, s[20:23], s62 offen sc1
    v_mov_b32 v144, 0
    v_mov_b32 v145, 0
    v_mov_b32 v146, 0
    v_mov_b32 v147, 0
    v_mov_b32 v148, 0
    v_mov_b32 v149, 0
    v_mov_b32 v150, 0
    v_mov_b32 v151, 0
    s_waitcnt vmcnt(20)
    v_dot2c_f32_bf16 v144, s63, v24
    v_dot2c_f32_bf16 v145, s64, v24
    v_dot2c_f32_bf16 v146, s63, v25
    v_dot2c_f32_bf16 v147, s64, v25
    v_dot2c_f32_bf16 v148, s63, v26
    v_dot2c_f32_bf16 v149, s64, v26
    v_dot2c_f32_bf16 v150, s63, v27
    v_dot2c_f32_bf16 v151, s64, v27
    s_waitcnt vmcnt(19)
    v_dot2c_f32_bf16 v144, s63, v28
    v_dot2c_f32_bf16 v145, s64, v28
    v_dot2c_f32_bf16 v146, s63, v29
    v_dot2c_f32_bf16 v147, s64, v29
    v_dot2c_f32_bf16 v148, s63, v30
    v_dot2c_f32_bf16 v149, s64, v30
    v_dot2c_f32_bf16 v150, s63, v31
    v_dot2c_f32_bf16 v151, s64, v31
    s_waitcnt vmcnt(18)
    v_dot2c_f32_bf16 v144, s63, v32
    v_dot2c_f32_bf16 v145, s64, v32
    v_dot2c_f32_bf16 v146, s63, v33
    v_dot2c_f32_bf16 v147, s64, v33
    v_dot2c_f32_bf16 v148, s63, v34
    v_dot2c_f32_bf16 v149, s64, v34
    v_dot2c_f32_bf16 v150, s63, v35
    v_dot2c_f32_bf16 v151, s64, v35
    s_waitcnt vmcnt(17)
    v_dot2c_f32_bf16 v144, s63, v36
    v_dot2c_f32_bf16 v145, s64, v36
    v_dot2c_f32_bf16 v146, s63, v37
    v_dot2c_f32_bf16 v147, s64, v37
    v_dot2c_f32_bf16 v148, s63, v38
    v_dot2c_f32_bf16 v149, s64, v38
    v_dot2c_f32_bf16 v150, s63, v39
    v_dot2c_f32_bf16 v151, s64, v39
    s_waitcnt vmcnt(16)
    v_dot2c_f32_bf16 v144, s63, v40
    v_dot2c_f32_bf16 v145, s64, v40
    v_dot2c_f32_bf16 v146, s63, v41
    v_dot2c_f32_bf16 v147, s64, v41
    v_dot2c_f32_bf16 v148, s63, v42
    v_dot2c_f32_bf16 v149, s64, v42
    v_dot2c_f32_bf16 v150, s63, v43
    v_dot2c_f32_bf16 v151, s64, v43
    s_waitcnt vmcnt(15)
    v_dot2c_f32_bf16 v144, s63, v44
    v_dot2c_f32_bf16 v145, s64, v44
    v_dot2c_f32_bf16 v146, s63, v45
    v_dot2c_f32_bf16 v147, s64, v45
    v_dot2c_f32_bf16 v148, s63, v46
    v_dot2c_f32_bf16 v149, s64, v46
    v_dot2c_f32_bf16 v150, s63, v47
    v_dot2c_f32_bf16 v151, s64, v47
    s_nop 2
    v_mov_b32 v152, v144
    v_mov_b32 v153, v145
    v_mov_b32 v154, v146
    v_mov_b32 v155, v147
    v_mov_b32 v156, v148
    v_mov_b32 v157, v149
    v_mov_b32 v158, v150
    v_mov_b32 v159, v151
    v_permlane32_swap_b32 v144, v152
    v_permlane32_swap_b32 v145, v153
    v_permlane32_swap_b32 v146, v154
    v_permlane32_swap_b32 v147, v155
    v_permlane32_swap_b32 v148, v156
    v_permlane32_swap_b32 v149, v157
    v_permlane32_swap_b32 v150, v158
    v_permlane32_swap_b32 v151, v159
    v_add_f32 v144, v144, v152
    v_add_f32 v145, v145, v153
    v_add_f32 v146, v146, v154
    v_add_f32 v147, v147, v155
    v_add_f32 v148, v148, v156
    v_add_f32 v149, v149, v157
    v_add_f32 v150, v150, v158
    v_add_f32 v151, v151, v159
    v_fma_f32 v144, s65, v144, v160
    v_fma_f32 v145, s65, v145, v161
    v_fma_f32 v146, s65, v146, v162
    v_fma_f32 v147, s65, v147, v163
    v_fma_f32 v148, s65, v148, v164
    v_fma_f32 v149, s65, v149, v165
    v_fma_f32 v150, s65, v150, v166
    v_fma_f32 v151, s65, v151, v167
    v_cvt_pk_bf16_f32 v136, v144, v145
    v_cvt_pk_bf16_f32 v137, v146, v147
    v_cvt_pk_bf16_f32 v138, v148, v149
    v_cvt_pk_bf16_f32 v139, v150, v151
    buffer_store_dwordx4 v[136:139], v237, s[48:51], 0 offen offset:0
    s_branch Lr_51
Lr_50:
    v_mov_b32 v144, 0
    v_mov_b32 v145, 0
    v_mov_b32 v146, 0
    v_mov_b32 v147, 0
    v_mov_b32 v148, 0
    v_mov_b32 v149, 0
    v_mov_b32 v150, 0
    v_mov_b32 v151, 0
    s_waitcnt vmcnt(14)
    v_dot2c_f32_bf16 v144, s63, v24
    v_dot2c_f32_bf16 v145, s64, v24
    v_dot2c_f32_bf16 v146, s63, v25
    v_dot2c_f32_bf16 v147, s64, v25
    v_dot2c_f32_bf16 v148, s63, v26
    v_dot2c_f32_bf16 v149, s64, v26
    v_dot2c_f32_bf16 v150, s63, v27
    v_dot2c_f32_bf16 v151, s64, v27
    s_waitcnt vmcnt(13)
    v_dot2c_f32_bf16 v144, s63, v28
    v_dot2c_f32_bf16 v145, s64, v28
    v_dot2c_f32_bf16 v146, s63, v29
    v_dot2c_f32_bf16 v147, s64, v29
    v_dot2c_f32_bf16 v148, s63, v30
    v_dot2c_f32_bf16 v149, s64, v30
    v_dot2c_f32_bf16 v150, s63, v31
    v_dot2c_f32_bf16 v151, s64, v31
    s_waitcnt vmcnt(12)
    v_dot2c_f32_bf16 v144, s63, v32
    v_dot2c_f32_bf16 v145, s64, v32
    v_dot2c_f32_bf16 v146, s63, v33
    v_dot2c_f32_bf16 v147, s64, v33
    v_dot2c_f32_bf16 v148, s63, v34
    v_dot2c_f32_bf16 v149, s64, v34
    v_dot2c_f32_bf16 v150, s63, v35
    v_dot2c_f32_bf16 v151, s64, v35
    s_waitcnt vmcnt(11)
    v_dot2c_f32_bf16 v144, s63, v36
    v_dot2c_f32_bf16 v145, s64, v36
    v_dot2c_f32_bf16 v146, s63, v37
    v_dot2c_f32_bf16 v147, s64, v37
    v_dot2c_f32_bf16 v148, s63, v38
    v_dot2c_f32_bf16 v149, s64, v38
    v_dot2c_f32_bf16 v150, s63, v39
    v_dot2c_f32_bf16 v151, s64, v39
    s_waitcnt vmcnt(10)
    v_dot2c_f32_bf16 v144, s63, v40
    v_dot2c_f32_bf16 v145, s64, v40
    v_dot2c_f32_bf16 v146, s63, v41
    v_dot2c_f32_bf16 v147, s64, v41
    v_dot2c_f32_bf16 v148, s63, v42
    v_dot2c_f32_bf16 v149, s64, v42
    v_dot2c_f32_bf16 v150, s63, v43
    v_dot2c_f32_bf16 v151, s64, v43
    s_waitcnt vmcnt(9)
    v_dot2c_f32_bf16 v144, s63, v44
    v_dot2c_f32_bf16 v145, s64, v44
    v_dot2c_f32_bf16 v146, s63, v45
    v_dot2c_f32_bf16 v147, s64, v45
    v_dot2c_f32_bf16 v148, s63, v46
    v_dot2c_f32_bf16 v149, s64, v46
    v_dot2c_f32_bf16 v150, s63, v47
    v_dot2c_f32_bf16 v151, s64, v47
    s_nop 2
    v_mov_b32 v152, v144
    v_mov_b32 v153, v145
    v_mov_b32 v154, v146
    v_mov_b32 v155, v147
    v_mov_b32 v156, v148
    v_mov_b32 v157, v149
    v_mov_b32 v158, v150
    v_mov_b32 v159, v151
    v_permlane32_swap_b32 v144, v152
    v_permlane32_swap_b32 v145, v153
    v_permlane32_swap_b32 v146, v154
    v_permlane32_swap_b32 v147, v155
    v_permlane32_swap_b32 v148, v156
    v_permlane32_swap_b32 v149, v157
    v_permlane32_swap_b32 v150, v158
    v_permlane32_swap_b32 v151, v159
    v_add_f32 v144, v144, v152
    v_add_f32 v145, v145, v153
    v_add_f32 v146, v146, v154
    v_add_f32 v147, v147, v155
    v_add_f32 v148, v148, v156
    v_add_f32 v149, v149, v157
    v_add_f32 v150, v150, v158
    v_add_f32 v151, v151, v159
    v_fma_f32 v144, s65, v144, v160
    v_fma_f32 v145, s65, v145, v161
    v_fma_f32 v146, s65, v146, v162
    v_fma_f32 v147, s65, v147, v163
    v_fma_f32 v148, s65, v148, v164
    v_fma_f32 v149, s65, v149, v165
    v_fma_f32 v150, s65, v150, v166
    v_fma_f32 v151, s65, v151, v167
    v_cvt_pk_bf16_f32 v136, v144, v145
    v_cvt_pk_bf16_f32 v137, v146, v147
    v_cvt_pk_bf16_f32 v138, v148, v149
    v_cvt_pk_bf16_f32 v139, v150, v151
    buffer_store_dwordx4 v[136:139], v237, s[48:51], 0 offen offset:0
    s_cmp_ge_u32 s36, 4
    s_cbranch_scc1 Lk_52
    s_cmp_lg_u32 s30, 7
    s_cbranch_scc1 Lq_53
Lpollp_54:
    buffer_load_dwordx2 v[222:223], v221, s[20:23], 0 offen sc1
    s_waitcnt vmcnt(0)
    v_subrev_u32 v222, s6, v222
    v_xor_b32 v223, s7, v223
    v_lshrrev_b32 v224, 4, v222
    v_or_b32 v223, v223, v224
    v_cmp_eq_u32 vcc, 0, v223
    s_nop 1
    v_cndmask_b32 v222, 0, v222, vcc
    s_nop 1
    v_min_u32_dpp v222, v222, v222 row_ror:8 row_mask:0xf bank_mask:0xf
    s_nop 1
    v_min_u32_dpp v222, v222, v222 row_ror:4 row_mask:0xf bank_mask:0xf
    s_nop 1
    v_min_u32_dpp v222, v222, v222 row_ror:2 row_mask:0xf bank_mask:0xf
    s_nop 1
    v_min_u32_dpp v222, v222, v222 row_ror:1 row_mask:0xf bank_mask:0xf
    s_nop 0
    v_readfirstlane_b32 s36, v222
    s_nop 0
    s_cmp_ge_u32 s36, 4
    s_cbranch_scc1 Lpdp_55
    s_sleep 6
    s_sub_u32 s5, s5, 1
    s_cbranch_scc0 Lpollp_54
    s_mov_b32 s5, 0
Lpdp_55:
    v_mov_b32 v222, s36
    ds_write_b32 v231, v222 offset:16
    s_waitcnt lgkmcnt(0)
Lq_53:
    s_barrier
    ds_read_b32 v222, v231 offset:16
    s_waitcnt lgkmcnt(0)
    v_readfirstlane_b32 s36, v222
Lk_52:
    s_mov_b32 s62, 12288
    buffer_load_dwordx4 v[72:75], v220, s[20:23], s62 offen sc1
    s_mov_b32 s62, 86016
    buffer_load_dwordx4 v[76:79], v220, s[20:23], s62 offen sc1
    s_mov_b32 s62, 159744
    buffer_load_dwordx4 v[80:83], v220, s[20:23], s62 offen sc1
    s_mov_b32 s62, 233472
    buffer_load_dwordx4 v[84:87], v220, s[20:23], s62 offen sc1
    s_mov_b32 s62, 307200
    buffer_load_dwordx4 v[88:91], v220, s[20:23], s62 offen sc1
    s_mov_b32 s62, 380928
    buffer_load_dwordx4 v[92:95], v220, s[20:23], s62 offen sc1
Lr_51:
    s_waitcnt vmcnt(6)
    s_barrier
    s_cmp_lg_u32 s30, 0
    s_cbranch_scc1 Lf_56
    s_lshr_b32 s56, s28, 2
    s_lshl_b32 s56, s56, 7
    s_and_b32 s57, s28, 3
    s_lshl_b32 s57, s57, 3
    s_add_u32 s56, s56, s57
    s_add_u32 s56, s56, 44843104
    s_add_u32 s57, s6, 15
    v_mov_b32 v248, 0x7ffffff0
    v_mov_b32 v250, s57
    v_mov_b32 v251, s7
    v_writelane_b32 v248, s56, 0
    buffer_store_dwordx2 v[250:251], v248, s[20:23], 0 offen sc1
Lf_56:
    s_cmp_ge_u32 s36, 5
    s_cbranch_scc0 Lr_57
    s_mov_b32 s62, 16384
    buffer_load_dwordx4 v[0:3], v220, s[20:23], s62 offen sc1
    s_mov_b32 s62, 90112
    buffer_load_dwordx4 v[4:7], v220, s[20:23], s62 offen sc1
    s_mov_b32 s62, 163840
    buffer_load_dwordx4 v[8:11], v220, s[20:23], s62 offen sc1
    s_mov_b32 s62, 237568
    buffer_load_dwordx4 v[12:15], v220, s[20:23], s62 offen sc1
    s_mov_b32 s62, 311296
    buffer_load_dwordx4 v[16:19], v220, s[20:23], s62 offen sc1
    s_mov_b32 s62, 385024
    buffer_load_dwordx4 v[20:23], v220, s[20:23], s62 offen sc1
    v_mov_b32 v144, 0
    v_mov_b32 v145, 0
    v_mov_b32 v146, 0
    v_mov_b32 v147, 0
    v_mov_b32 v148, 0
    v_mov_b32 v149, 0
    v_mov_b32 v150, 0
    v_mov_b32 v151, 0
    s_waitcnt vmcnt(17)
    v_dot2c_f32_bf16 v144, s63, v48
    v_dot2c_f32_bf16 v145, s64, v48
    v_dot2c_f32_bf16 v146, s63, v49
    v_dot2c_f32_bf16 v147, s64, v49
    v_dot2c_f32_bf16 v148, s63, v50
    v_dot2c_f32_bf16 v149, s64, v50
    v_dot2c_f32_bf16 v150, s63, v51
    v_dot2c_f32_bf16 v151, s64, v51
    s_waitcnt vmcnt(16)
    v_dot2c_f32_bf16 v144, s63, v52
    v_dot2c_f32_bf16 v145, s64, v52
    v_dot2c_f32_bf16 v146, s63, v53
    v_dot2c_f32_bf16 v147, s64, v53
    v_dot2c_f32_bf16 v148, s63, v54
    v_dot2c_f32_bf16 v149, s64, v54
    v_dot2c_f32_bf16 v150, s63, v55
    v_dot2c_f32_bf16 v151, s64, v55
    s_waitcnt vmcnt(15)
    v_dot2c_f32_bf16 v144, s63, v56
    v_dot2c_f32_bf16 v145, s64, v56
    v_dot2c_f32_bf16 v146, s63, v57
    v_dot2c_f32_bf16 v147, s64, v57
    v_dot2c_f32_bf16 v148, s63, v58
    v_dot2c_f32_bf16 v149, s64, v58
    v_dot2c_f32_bf16 v150, s63, v59
    v_dot2c_f32_bf16 v151, s64, v59
    s_waitcnt vmcnt(14)
    v_dot2c_f32_bf16 v144, s63, v60
    v_dot2c_f32_bf16 v145, s64, v60
    v_dot2c_f32_bf16 v146, s63, v61
    v_dot2c_f32_bf16 v147, s64, v61
    v_dot2c_f32_bf16 v148, s63, v62
    v_dot2c_f32_bf16 v149, s64, v62
    v_dot2c_f32_bf16 v150, s63, v63
    v_dot2c_f32_bf16 v151, s64, v63
    s_waitcnt vmcnt(13)
    v_dot2c_f32_bf16 v144, s63, v64
    v_dot2c_f32_bf16 v145, s64, v64
    v_dot2c_f32_bf16 v146, s63, v65
    v_dot2c_f32_bf16 v147, s64, v65
    v_dot2c_f32_bf16 v148, s63, v66
    v_dot2c_f32_bf16 v149, s64, v66
    v_dot2c_f32_bf16 v150, s63, v67
    v_dot2c_f32_bf16 v151, s64, v67
    s_waitcnt vmcnt(12)
    v_dot2c_f32_bf16 v144, s63, v68
    v_dot2c_f32_bf16 v145, s64, v68
    v_dot2c_f32_bf16 v146, s63, v69
    v_dot2c_f32_bf16 v147, s64, v69
    v_dot2c_f32_bf16 v148, s63, v70
    v_dot2c_f32_bf16 v149, s64, v70
    v_dot2c_f32_bf16 v150, s63, v71
    v_dot2c_f32_bf16 v151, s64, v71
    s_nop 2
    v_mov_b32 v152, v144
    v_mov_b32 v153, v145
    v_mov_b32 v154, v146
    v_mov_b32 v155, v147
    v_mov_b32 v156, v148
    v_mov_b32 v157, v149
    v_mov_b32 v158, v150
    v_mov_b32 v159, v151
    v_permlane32_swap_b32 v144, v152
    v_permlane32_swap_b32 v145, v153
    v_permlane32_swap_b32 v146, v154
    v_permlane32_swap_b32 v147, v155
    v_permlane32_swap_b32 v148, v156
    v_permlane32_swap_b32 v149, v157
    v_permlane32_swap_b32 v150, v158
    v_permlane32_swap_b32 v151, v159
    v_add_f32 v144, v144, v152
    v_add_f32 v145, v145, v153
    v_add_f32 v146, v146, v154
    v_add_f32 v147, v147, v155
    v_add_f32 v148, v148, v156
    v_add_f32 v149, v149, v157
    v_add_f32 v150, v150, v158
    v_add_f32 v151, v151, v159
    v_fma_f32 v144, s65, v144, v168
    v_fma_f32 v145, s65, v145, v169
    v_fma_f32 v146, s65, v146, v170
    v_fma_f32 v147, s65, v147, v171
    v_fma_f32 v148, s65, v148, v172
    v_fma_f32 v149, s65, v149, v173
    v_fma_f32 v150, s65, v150, v174
    v_fma_f32 v151, s65, v151, v175
    v_cvt_pk_bf16_f32 v140, v144, v145
    v_cvt_pk_bf16_f32 v141, v146, v147
    v_cvt_pk_bf16_f32 v142, v148, v149
    v_cvt_pk_bf16_f32 v143, v150, v151
    buffer_store_dwordx4 v[140:143], v236, s[48:51], 0 offen offset:256
    s_branch Lr_58
Lr_57:
    v_mov_b32 v144, 0
    v_mov_b32 v145, 0
    v_mov_b32 v146, 0
    v_mov_b32 v147, 0
    v_mov_b32 v148, 0
    v_mov_b32 v149, 0
    v_mov_b32 v150, 0
    v_mov_b32 v151, 0
    s_waitcnt vmcnt(11)
    v_dot2c_f32_bf16 v144, s63, v48
    v_dot2c_f32_bf16 v145, s64, v48
    v_dot2c_f32_bf16 v146, s63, v49
    v_dot2c_f32_bf16 v147, s64, v49
    v_dot2c_f32_bf16 v148, s63, v50
    v_dot2c_f32_bf16 v149, s64, v50
    v_dot2c_f32_bf16 v150, s63, v51
    v_dot2c_f32_bf16 v151, s64, v51
    s_waitcnt vmcnt(10)
    v_dot2c_f32_bf16 v144, s63, v52
    v_dot2c_f32_bf16 v145, s64, v52
    v_dot2c_f32_bf16 v146, s63, v53
    v_dot2c_f32_bf16 v147, s64, v53
    v_dot2c_f32_bf16 v148, s63, v54
    v_dot2c_f32_bf16 v149, s64, v54
    v_dot2c_f32_bf16 v150, s63, v55
    v_dot2c_f32_bf16 v151, s64, v55
    s_waitcnt vmcnt(9)
    v_dot2c_f32_bf16 v144, s63, v56
    v_dot2c_f32_bf16 v145, s64, v56
    v_dot2c_f32_bf16 v146, s63, v57
    v_dot2c_f32_bf16 v147, s64, v57
    v_dot2c_f32_bf16 v148, s63, v58
    v_dot2c_f32_bf16 v149, s64, v58
    v_dot2c_f32_bf16 v150, s63, v59
    v_dot2c_f32_bf16 v151, s64, v59
    s_waitcnt vmcnt(8)
    v_dot2c_f32_bf16 v144, s63, v60
    v_dot2c_f32_bf16 v145, s64, v60
    v_dot2c_f32_bf16 v146, s63, v61
    v_dot2c_f32_bf16 v147, s64, v61
    v_dot2c_f32_bf16 v148, s63, v62
    v_dot2c_f32_bf16 v149, s64, v62
    v_dot2c_f32_bf16 v150, s63, v63
    v_dot2c_f32_bf16 v151, s64, v63
    s_waitcnt vmcnt(7)
    v_dot2c_f32_bf16 v144, s63, v64
    v_dot2c_f32_bf16 v145, s64, v64
    v_dot2c_f32_bf16 v146, s63, v65
    v_dot2c_f32_bf16 v147, s64, v65
    v_dot2c_f32_bf16 v148, s63, v66
    v_dot2c_f32_bf16 v149, s64, v66
    v_dot2c_f32_bf16 v150, s63, v67
    v_dot2c_f32_bf16 v151, s64, v67
    s_waitcnt vmcnt(6)
    v_dot2c_f32_bf16 v144, s63, v68
    v_dot2c_f32_bf16 v145, s64, v68
    v_dot2c_f32_bf16 v146, s63, v69
    v_dot2c_f32_bf16 v147, s64, v69
    v_dot2c_f32_bf16 v148, s63, v70
    v_dot2c_f32_bf16 v149, s64, v70
    v_dot2c_f32_bf16 v150, s63, v71
    v_dot2c_f32_bf16 v151, s64, v71
    s_nop 2
    v_mov_b32 v152, v144
    v_mov_b32 v153, v145
    v_mov_b32 v154, v146
    v_mov_b32 v155, v147
    v_mov_b32 v156, v148
    v_mov_b32 v157, v149
    v_mov_b32 v158, v150
    v_mov_b32 v159, v151
    v_permlane32_swap_b32 v144, v152
    v_permlane32_swap_b32 v145, v153
    v_permlane32_swap_b32 v146, v154
    v_permlane32_swap_b32 v147, v155
    v_permlane32_swap_b32 v148, v156
    v_permlane32_swap_b32 v149, v157
    v_permlane32_swap_b32 v150, v158
    v_permlane32_swap_b32 v151, v159
    v_add_f32 v144, v144, v152
    v_add_f32 v145, v145, v153
    v_add_f32 v146, v146, v154
    v_add_f32 v147, v147, v155
    v_add_f32 v148, v148, v156
    v_add_f32 v149, v149, v157
    v_add_f32 v150, v150, v158
    v_add_f32 v151, v151, v159
    v_fma_f32 v144, s65, v144, v168
    v_fma_f32 v145, s65, v145, v169
    v_fma_f32 v146, s65, v146, v170
    v_fma_f32 v147, s65, v147, v171
    v_fma_f32 v148, s65, v148, v172
    v_fma_f32 v149, s65, v149, v173
    v_fma_f32 v150, s65, v150, v174
    v_fma_f32 v151, s65, v151, v175
    v_cvt_pk_bf16_f32 v140, v144, v145
    v_cvt_pk_bf16_f32 v141, v146, v147
    v_cvt_pk_bf16_f32 v142, v148, v149
    v_cvt_pk_bf16_f32 v143, v150, v151
    buffer_store_dwordx4 v[140:143], v236, s[48:51], 0 offen offset:256
    s_cmp_ge_u32 s36, 5
    s_cbranch_scc1 Lk_59
    s_cmp_lg_u32 s30, 7
    s_cbranch_scc1 Lq_60
Lpollp_61:
    buffer_load_dwordx2 v[222:223], v221, s[20:23], 0 offen sc1
    s_waitcnt vmcnt(0)
    v_subrev_u32 v222, s6, v222
    v_xor_b32 v223, s7, v223
    v_lshrrev_b32 v224, 4, v222
    v_or_b32 v223, v223, v224
    v_cmp_eq_u32 vcc, 0, v223
    s_nop 1
    v_cndmask_b32 v222, 0, v222, vcc
    s_nop 1
    v_min_u32_dpp v222, v222, v222 row_ror:8 row_mask:0xf bank_mask:0xf
    s_nop 1
    v_min_u32_dpp v222, v222, v222 row_ror:4 row_mask:0xf bank_mask:0xf
    s_nop 1
    v_min_u32_dpp v222, v222, v222 row_ror:2 row_mask:0xf bank_mask:0xf
    s_nop 1
    v_min_u32_dpp v222, v222, v222 row_ror:1 row_mask:0xf bank_mask:0xf
    s_nop 0
    v_readfirstlane_b32 s36, v222
    s_nop 0
    s_cmp_ge_u32 s36, 5
    s_cbranch_scc1 Lpdp_62
    s_sleep 6
    s_sub_u32 s5, s5, 1
    s_cbranch_scc0 Lpollp_61
    s_mov_b32 s5, 0
Lpdp_62:
    v_mov_b32 v222, s36
    ds_write_b32 v231, v222 offset:20
    s_waitcnt lgkmcnt(0)
Lq_60:
    s_barrier
    ds_read_b32 v222, v231 offset:20
    s_waitcnt lgkmcnt(0)
    v_readfirstlane_b32 s36, v222
Lk_59:
    s_mov_b32 s62, 16384
    buffer_load_dwordx4 v[0:3], v220, s[20:23], s62 offen sc1
    s_mov_b32 s62, 90112
    buffer_load_dwordx4 v[4:7], v220, s[20:23], s62 offen sc1
    s_mov_b32 s62, 163840
    buffer_load_dwordx4 v[8:11], v220, s[20:23], s62 offen sc1
    s_mov_b32 s62, 237568
    buffer_load_dwordx4 v[12:15], v220, s[20:23], s62 offen sc1
    s_mov_b32 s62, 311296
    buffer_load_dwordx4 v[16:19], v220, s[20:23], s62 offen sc1
    s_mov_b32 s62, 385024
    buffer_load_dwordx4 v[20:23], v220, s[20:23], s62 offen sc1
Lr_58:
    s_cmp_ge_u32 s36, 6
    s_cbranch_scc0 Lr_63
    s_mov_b32 s62, 20480
    buffer_load_dwordx4 v[24:27], v220, s[20:23], s62 offen sc1
    s_mov_b32 s62, 94208
    buffer_load_dwordx4 v[28:31], v220, s[20:23], s62 offen sc1
    s_mov_b32 s62, 167936
    buffer_load_dwordx4 v[32:35], v220, s[20:23], s62 offen sc1
    s_mov_b32 s62, 241664
    buffer_load_dwordx4 v[36:39], v220, s[20:23], s62 offen sc1
    s_mov_b32 s62, 315392
    buffer_load_dwordx4 v[40:43], v220, s[20:23], s62 offen sc1
    s_mov_b32 s62, 389120
    buffer_load_dwordx4 v[44:47], v220, s[20:23], s62 offen sc1
    v_mov_b32 v144, 0
    v_mov_b32 v145, 0
    v_mov_b32 v146, 0
    v_mov_b32 v147, 0
    v_mov_b32 v148, 0
    v_mov_b32 v149, 0
    v_mov_b32 v150, 0
    v_mov_b32 v151, 0
    s_waitcnt vmcnt(17)
    v_dot2c_f32_bf16 v144, s63, v72
    v_dot2c_f32_bf16 v145, s64, v72
    v_dot2c_f32_bf16 v146, s63, v73
    v_dot2c_f32_bf16 v147, s64, v73
    v_dot2c_f32_bf16 v148, s63, v74
    v_dot2c_f32_bf16 v149, s64, v74
    v_dot2c_f32_bf16 v150, s63, v75
    v_dot2c_f32_bf16 v151, s64, v75
    s_waitcnt vmcnt(16)
    v_dot2c_f32_bf16 v144, s63, v76
    v_dot2c_f32_bf16 v145, s64, v76
    v_dot2c_f32_bf16 v146, s63, v77
    v_dot2c_f32_bf16 v147, s64, v77
    v_dot2c_f32_bf16 v148, s63, v78
    v_dot2c_f32_bf16 v149, s64, v78
    v_dot2c_f32_bf16 v150, s63, v79
    v_dot2c_f32_bf16 v151, s64, v79
    s_waitcnt vmcnt(15)
    v_dot2c_f32_bf16 v144, s63, v80
    v_dot2c_f32_bf16 v145, s64, v80
    v_dot2c_f32_bf16 v146, s63, v81
    v_dot2c_f32_bf16 v147, s64, v81
    v_dot2c_f32_bf16 v148, s63, v82
    v_dot2c_f32_bf16 v149, s64, v82
    v_dot2c_f32_bf16 v150, s63, v83
    v_dot2c_f32_bf16 v151, s64, v83
    s_waitcnt vmcnt(14)
    v_dot2c_f32_bf16 v144, s63, v84
    v_dot2c_f32_bf16 v145, s64, v84
    v_dot2c_f32_bf16 v146, s63, v85
    v_dot2c_f32_bf16 v147, s64, v85
    v_dot2c_f32_bf16 v148, s63, v86
    v_dot2c_f32_bf16 v149, s64, v86
    v_dot2c_f32_bf16 v150, s63, v87
    v_dot2c_f32_bf16 v151, s64, v87
    s_waitcnt vmcnt(13)
    v_dot2c_f32_bf16 v144, s63, v88
    v_dot2c_f32_bf16 v145, s64, v88
    v_dot2c_f32_bf16 v146, s63, v89
    v_dot2c_f32_bf16 v147, s64, v89
    v_dot2c_f32_bf16 v148, s63, v90
    v_dot2c_f32_bf16 v149, s64, v90
    v_dot2c_f32_bf16 v150, s63, v91
    v_dot2c_f32_bf16 v151, s64, v91
    s_waitcnt vmcnt(12)
    v_dot2c_f32_bf16 v144, s63, v92
    v_dot2c_f32_bf16 v145, s64, v92
    v_dot2c_f32_bf16 v146, s63, v93
    v_dot2c_f32_bf16 v147, s64, v93
    v_dot2c_f32_bf16 v148, s63, v94
    v_dot2c_f32_bf16 v149, s64, v94
    v_dot2c_f32_bf16 v150, s63, v95
    v_dot2c_f32_bf16 v151, s64, v95
    s_nop 2
    v_mov_b32 v152, v144
    v_mov_b32 v153, v145
    v_mov_b32 v154, v146
    v_mov_b32 v155, v147
    v_mov_b32 v156, v148
    v_mov_b32 v157, v149
    v_mov_b32 v158, v150
    v_mov_b32 v159, v151
    v_permlane32_swap_b32 v144, v152
    v_permlane32_swap_b32 v145, v153
    v_permlane32_swap_b32 v146, v154
    v_permlane32_swap_b32 v147, v155
    v_permlane32_swap_b32 v148, v156
    v_permlane32_swap_b32 v149, v157
    v_permlane32_swap_b32 v150, v158
    v_permlane32_swap_b32 v151, v159
    v_add_f32 v144, v144, v152
    v_add_f32 v145, v145, v153
    v_add_f32 v146, v146, v154
    v_add_f32 v147, v147, v155
    v_add_f32 v148, v148, v156
    v_add_f32 v149, v149, v157
    v_add_f32 v150, v150, v158
    v_add_f32 v151, v151, v159
    v_fma_f32 v144, s65, v144, v168
    v_fma_f32 v145, s65, v145, v169
    v_fma_f32 v146, s65, v146, v170
    v_fma_f32 v147, s65, v147, v171
    v_fma_f32 v148, s65, v148, v172
    v_fma_f32 v149, s65, v149, v173
    v_fma_f32 v150, s65, v150, v174
    v_fma_f32 v151, s65, v151, v175
    v_cvt_pk_bf16_f32 v132, v144, v145
    v_cvt_pk_bf16_f32 v133, v146, v147
    v_cvt_pk_bf16_f32 v134, v148, v149
    v_cvt_pk_bf16_f32 v135, v150, v151
    buffer_store_dwordx4 v[132:135], v237, s[48:51], 0 offen offset:256
    s_branch Lr_64
Lr_63:
    v_mov_b32 v144, 0
    v_mov_b32 v145, 0
    v_mov_b32 v146, 0
    v_mov_b32 v147, 0
    v_mov_b32 v148, 0
    v_mov_b32 v149, 0
    v_mov_b32 v150, 0
    v_mov_b32 v151, 0
    s_waitcnt vmcnt(11)
    v_dot2c_f32_bf16 v144, s63, v72
    v_dot2c_f32_bf16 v145, s64, v72
    v_dot2c_f32_bf16 v146, s63, v73
    v_dot2c_f32_bf16 v147, s64, v73
    v_dot2c_f32_bf16 v148, s63, v74
    v_dot2c_f32_bf16 v149, s64, v74
    v_dot2c_f32_bf16 v150, s63, v75
    v_dot2c_f32_bf16 v151, s64, v75
    s_waitcnt vmcnt(10)
    v_dot2c_f32_bf16 v144, s63, v76
    v_dot2c_f32_bf16 v145, s64, v76
    v_dot2c_f32_bf16 v146, s63, v77
    v_dot2c_f32_bf16 v147, s64, v77
    v_dot2c_f32_bf16 v148, s63, v78
    v_dot2c_f32_bf16 v149, s64, v78
    v_dot2c_f32_bf16 v150, s63, v79
    v_dot2c_f32_bf16 v151, s64, v79
    s_waitcnt vmcnt(9)
    v_dot2c_f32_bf16 v144, s63, v80
    v_dot2c_f32_bf16 v145, s64, v80
    v_dot2c_f32_bf16 v146, s63, v81
    v_dot2c_f32_bf16 v147, s64, v81
    v_dot2c_f32_bf16 v148, s63, v82
    v_dot2c_f32_bf16 v149, s64, v82
    v_dot2c_f32_bf16 v150, s63, v83
    v_dot2c_f32_bf16 v151, s64, v83
    s_waitcnt vmcnt(8)
    v_dot2c_f32_bf16 v144, s63, v84
    v_dot2c_f32_bf16 v145, s64, v84
    v_dot2c_f32_bf16 v146, s63, v85
    v_dot2c_f32_bf16 v147, s64, v85
    v_dot2c_f32_bf16 v148, s63, v86
    v_dot2c_f32_bf16 v149, s64, v86
    v_dot2c_f32_bf16 v150, s63, v87
    v_dot2c_f32_bf16 v151, s64, v87
    s_waitcnt vmcnt(7)
    v_dot2c_f32_bf16 v144, s63, v88
    v_dot2c_f32_bf16 v145, s64, v88
    v_dot2c_f32_bf16 v146, s63, v89
    v_dot2c_f32_bf16 v147, s64, v89
    v_dot2c_f32_bf16 v148, s63, v90
    v_dot2c_f32_bf16 v149, s64, v90
    v_dot2c_f32_bf16 v150, s63, v91
    v_dot2c_f32_bf16 v151, s64, v91
    s_waitcnt vmcnt(6)
    v_dot2c_f32_bf16 v144, s63, v92
    v_dot2c_f32_bf16 v145, s64, v92
    v_dot2c_f32_bf16 v146, s63, v93
    v_dot2c_f32_bf16 v147, s64, v93
    v_dot2c_f32_bf16 v148, s63, v94
    v_dot2c_f32_bf16 v149, s64, v94
    v_dot2c_f32_bf16 v150, s63, v95
    v_dot2c_f32_bf16 v151, s64, v95
    s_nop 2
    v_mov_b32 v152, v144
    v_mov_b32 v153, v145
    v_mov_b32 v154, v146
    v_mov_b32 v155, v147
    v_mov_b32 v156, v148
    v_mov_b32 v157, v149
    v_mov_b32 v158, v150
    v_mov_b32 v159, v151
    v_permlane32_swap_b32 v144, v152
    v_permlane32_swap_b32 v145, v153
    v_permlane32_swap_b32 v146, v154
    v_permlane32_swap_b32 v147, v155
    v_permlane32_swap_b32 v148, v156
    v_permlane32_swap_b32 v149, v157
    v_permlane32_swap_b32 v150, v158
    v_permlane32_swap_b32 v151, v159
    v_add_f32 v144, v144, v152
    v_add_f32 v145, v145, v153
    v_add_f32 v146, v146, v154
    v_add_f32 v147, v147, v155
    v_add_f32 v148, v148, v156
    v_add_f32 v149, v149, v157
    v_add_f32 v150, v150, v158
    v_add_f32 v151, v151, v159
    v_fma_f32 v144, s65, v144, v168
    v_fma_f32 v145, s65, v145, v169
    v_fma_f32 v146, s65, v146, v170
    v_fma_f32 v147, s65, v147, v171
    v_fma_f32 v148, s65, v148, v172
    v_fma_f32 v149, s65, v149, v173
    v_fma_f32 v150, s65, v150, v174
    v_fma_f32 v151, s65, v151, v175
    v_cvt_pk_bf16_f32 v132, v144, v145
    v_cvt_pk_bf16_f32 v133, v146, v147
    v_cvt_pk_bf16_f32 v134, v148, v149
    v_cvt_pk_bf16_f32 v135, v150, v151
    buffer_store_dwordx4 v[132:135], v237, s[48:51], 0 offen offset:256
    s_cmp_ge_u32 s36, 6
    s_cbranch_scc1 Lk_65
    s_cmp_lg_u32 s30, 7
    s_cbranch_scc1 Lq_66
Lpollp_67:
    buffer_load_dwordx2 v[222:223], v221, s[20:23], 0 offen sc1
    s_waitcnt vmcnt(0)
    v_subrev_u32 v222, s6, v222
    v_xor_b32 v223, s7, v223
    v_lshrrev_b32 v224, 4, v222
    v_or_b32 v223, v223, v224
    v_cmp_eq_u32 vcc, 0, v223
    s_nop 1
    v_cndmask_b32 v222, 0, v222, vcc
    s_nop 1
    v_min_u32_dpp v222, v222, v222 row_ror:8 row_mask:0xf bank_mask:0xf
    s_nop 1
    v_min_u32_dpp v222, v222, v222 row_ror:4 row_mask:0xf bank_mask:0xf
    s_nop 1
    v_min_u32_dpp v222, v222, v222 row_ror:2 row_mask:0xf bank_mask:0xf
    s_nop 1
    v_min_u32_dpp v222, v222, v222 row_ror:1 row_mask:0xf bank_mask:0xf
    s_nop 0
    v_readfirstlane_b32 s36, v222
    s_nop 0
    s_cmp_ge_u32 s36, 6
    s_cbranch_scc1 Lpdp_68
    s_sleep 6
    s_sub_u32 s5, s5, 1
    s_cbranch_scc0 Lpollp_67
    s_mov_b32 s5, 0
Lpdp_68:
    v_mov_b32 v222, s36
    ds_write_b32 v231, v222 offset:24
    s_waitcnt lgkmcnt(0)
Lq_66:
    s_barrier
    ds_read_b32 v222, v231 offset:24
    s_waitcnt lgkmcnt(0)
    v_readfirstlane_b32 s36, v222
Lk_65:
    s_mov_b32 s62, 20480
    buffer_load_dwordx4 v[24:27], v220, s[20:23], s62 offen sc1
    s_mov_b32 s62, 94208
    buffer_load_dwordx4 v[28:31], v220, s[20:23], s62 offen sc1
    s_mov_b32 s62, 167936
    buffer_load_dwordx4 v[32:35], v220, s[20:23], s62 offen sc1
    s_mov_b32 s62, 241664
    buffer_load_dwordx4 v[36:39], v220, s[20:23], s62 offen sc1
    s_mov_b32 s62, 315392
    buffer_load_dwordx4 v[40:43], v220, s[20:23], s62 offen sc1
    s_mov_b32 s62, 389120
    buffer_load_dwordx4 v[44:47], v220, s[20:23], s62 offen sc1
Lr_64:
    v_mov_b32 v144, 0
    v_mov_b32 v145, 0
    v_mov_b32 v146, 0
    v_mov_b32 v147, 0
    v_mov_b32 v148, 0
    v_mov_b32 v149, 0
    v_mov_b32 v150, 0
    v_mov_b32 v151, 0
    s_waitcnt vmcnt(11)
    v_dot2c_f32_bf16 v144, s63, v0
    v_dot2c_f32_bf16 v145, s64, v0
    v_dot2c_f32_bf16 v146, s63, v1
    v_dot2c_f32_bf16 v147, s64, v1
    v_dot2c_f32_bf16 v148, s63, v2
    v_dot2c_f32_bf16 v149, s64, v2
    v_dot2c_f32_bf16 v150, s63, v3
    v_dot2c_f32_bf16 v151, s64, v3
    s_waitcnt vmcnt(10)
    v_dot2c_f32_bf16 v144, s63, v4
    v_dot2c_f32_bf16 v145, s64, v4
    v_dot2c_f32_bf16 v146, s63, v5
    v_dot2c_f32_bf16 v147, s64, v5
    v_dot2c_f32_bf16 v148, s63, v6
    v_dot2c_f32_bf16 v149, s64, v6
    v_dot2c_f32_bf16 v150, s63, v7
    v_dot2c_f32_bf16 v151, s64, v7
    s_waitcnt vmcnt(9)
    v_dot2c_f32_bf16 v144, s63, v8
    v_dot2c_f32_bf16 v145, s64, v8
    v_dot2c_f32_bf16 v146, s63, v9
    v_dot2c_f32_bf16 v147, s64, v9
    v_dot2c_f32_bf16 v148, s63, v10
    v_dot2c_f32_bf16 v149, s64, v10
    v_dot2c_f32_bf16 v150, s63, v11
    v_dot2c_f32_bf16 v151, s64, v11
    s_waitcnt vmcnt(8)
    v_dot2c_f32_bf16 v144, s63, v12
    v_dot2c_f32_bf16 v145, s64, v12
    v_dot2c_f32_bf16 v146, s63, v13
    v_dot2c_f32_bf16 v147, s64, v13
    v_dot2c_f32_bf16 v148, s63, v14
    v_dot2c_f32_bf16 v149, s64, v14
    v_dot2c_f32_bf16 v150, s63, v15
    v_dot2c_f32_bf16 v151, s64, v15
    s_waitcnt vmcnt(7)
    v_dot2c_f32_bf16 v144, s63, v16
    v_dot2c_f32_bf16 v145, s64, v16
    v_dot2c_f32_bf16 v146, s63, v17
    v_dot2c_f32_bf16 v147, s64, v17
    v_dot2c_f32_bf16 v148, s63, v18
    v_dot2c_f32_bf16 v149, s64, v18
    v_dot2c_f32_bf16 v150, s63, v19
    v_dot2c_f32_bf16 v151, s64, v19
    s_waitcnt vmcnt(6)
    v_dot2c_f32_bf16 v144, s63, v20
    v_dot2c_f32_bf16 v145, s64, v20
    v_dot2c_f32_bf16 v146, s63, v21
    v_dot2c_f32_bf16 v147, s64, v21
    v_dot2c_f32_bf16 v148, s63, v22
    v_dot2c_f32_bf16 v149, s64, v22
    v_dot2c_f32_bf16 v150, s63, v23
    v_dot2c_f32_bf16 v151, s64, v23
    s_nop 2
    v_mov_b32 v152, v144
    v_mov_b32 v153, v145
    v_mov_b32 v154, v146
    v_mov_b32 v155, v147
    v_mov_b32 v156, v148
    v_mov_b32 v157, v149
    v_mov_b32 v158, v150
    v_mov_b32 v159, v151
    v_permlane32_swap_b32 v144, v152
    v_permlane32_swap_b32 v145, v153
    v_permlane32_swap_b32 v146, v154
    v_permlane32_swap_b32 v147, v155
    v_permlane32_swap_b32 v148, v156
    v_permlane32_swap_b32 v149, v157
    v_permlane32_swap_b32 v150, v158
    v_permlane32_swap_b32 v151, v159
    v_add_f32 v144, v144, v152
    v_add_f32 v145, v145, v153
    v_add_f32 v146, v146, v154
    v_add_f32 v147, v147, v155
    v_add_f32 v148, v148, v156
    v_add_f32 v149, v149, v157
    v_add_f32 v150, v150, v158
    v_add_f32 v151, v151, v159
    v_fma_f32 v144, s65, v144, v176
    v_fma_f32 v145, s65, v145, v177
    v_fma_f32 v146, s65, v146, v178
    v_fma_f32 v147, s65, v147, v179
    v_fma_f32 v148, s65, v148, v180
    v_fma_f32 v149, s65, v149, v181
    v_fma_f32 v150, s65, v150, v182
    v_fma_f32 v151, s65, v151, v183
    v_cvt_pk_bf16_f32 v136, v144, v145
    v_cvt_pk_bf16_f32 v137, v146, v147
    v_cvt_pk_bf16_f32 v138, v148, v149
    v_cvt_pk_bf16_f32 v139, v150, v151
    buffer_store_dwordx4 v[136:139], v236, s[48:51], 0 offen offset:512
    v_mov_b32 v144, 0
    v_mov_b32 v145, 0
    v_mov_b32 v146, 0
    v_mov_b32 v147, 0
    v_mov_b32 v148, 0
    v_mov_b32 v149, 0
    v_mov_b32 v150, 0
    v_mov_b32 v151, 0
    s_waitcnt vmcnt(6)
    v_dot2c_f32_bf16 v144, s63, v24
    v_dot2c_f32_bf16 v145, s64, v24
    v_dot2c_f32_bf16 v146, s63, v25
    v_dot2c_f32_bf16 v147, s64, v25
    v_dot2c_f32_bf16 v148, s63, v26
    v_dot2c_f32_bf16 v149, s64, v26
    v_dot2c_f32_bf16 v150, s63, v27
    v_dot2c_f32_bf16 v151, s64, v27
    s_waitcnt vmcnt(5)
    v_dot2c_f32_bf16 v144, s63, v28
    v_dot2c_f32_bf16 v145, s64, v28
    v_dot2c_f32_bf16 v146, s63, v29
    v_dot2c_f32_bf16 v147, s64, v29
    v_dot2c_f32_bf16 v148, s63, v30
    v_dot2c_f32_bf16 v149, s64, v30
    v_dot2c_f32_bf16 v150, s63, v31
    v_dot2c_f32_bf16 v151, s64, v31
    s_waitcnt vmcnt(4)
    v_dot2c_f32_bf16 v144, s63, v32
    v_dot2c_f32_bf16 v145, s64, v32
    v_dot2c_f32_bf16 v146, s63, v33
    v_dot2c_f32_bf16 v147, s64, v33
    v_dot2c_f32_bf16 v148, s63, v34
    v_dot2c_f32_bf16 v149, s64, v34
    v_dot2c_f32_bf16 v150, s63, v35
    v_dot2c_f32_bf16 v151, s64, v35
    s_waitcnt vmcnt(3)
    v_dot2c_f32_bf16 v144, s63, v36
    v_dot2c_f32_bf16 v145, s64, v36
    v_dot2c_f32_bf16 v146, s63, v37
    v_dot2c_f32_bf16 v147, s64, v37
    v_dot2c_f32_bf16 v148, s63, v38
    v_dot2c_f32_bf16 v149, s64, v38
    v_dot2c_f32_bf16 v150, s63, v39
    v_dot2c_f32_bf16 v151, s64, v39
    s_waitcnt vmcnt(2)
    v_dot2c_f32_bf16 v144, s63, v40
    v_dot2c_f32_bf16 v145, s64, v40
    v_dot2c_f32_bf16 v146, s63, v41
    v_dot2c_f32_bf16 v147, s64, v41
    v_dot2c_f32_bf16 v148, s63, v42
    v_dot2c_f32_bf16 v149, s64, v42
    v_dot2c_f32_bf16 v150, s63, v43
    v_dot2c_f32_bf16 v151, s64, v43
    s_waitcnt vmcnt(1)
    v_dot2c_f32_bf16 v144, s63, v44
    v_dot2c_f32_bf16 v145, s64, v44
    v_dot2c_f32_bf16 v146, s63, v45
    v_dot2c_f32_bf16 v147, s64, v45
    v_dot2c_f32_bf16 v148, s63, v46
    v_dot2c_f32_bf16 v149, s64, v46
    v_dot2c_f32_bf16 v150, s63, v47
    v_dot2c_f32_bf16 v151, s64, v47
    s_nop 2
    v_mov_b32 v152, v144
    v_mov_b32 v153, v145
    v_mov_b32 v154, v146
    v_mov_b32 v155, v147
    v_mov_b32 v156, v148
    v_mov_b32 v157, v149
    v_mov_b32 v158, v150
    v_mov_b32 v159, v151
    v_permlane32_swap_b32 v144, v152
    v_permlane32_swap_b32 v145, v153
    v_permlane32_swap_b32 v146, v154
    v_permlane32_swap_b32 v147, v155
    v_permlane32_swap_b32 v148, v156
    v_permlane32_swap_b32 v149, v157
    v_permlane32_swap_b32 v150, v158
    v_permlane32_swap_b32 v151, v159
    v_add_f32 v144, v144, v152
    v_add_f32 v145, v145, v153
    v_add_f32 v146, v146, v154
    v_add_f32 v147, v147, v155
    v_add_f32 v148, v148, v156
    v_add_f32 v149, v149, v157
    v_add_f32 v150, v150, v158
    v_add_f32 v151, v151, v159
    v_fma_f32 v144, s65, v144, v176
    v_fma_f32 v145, s65, v145, v177
    v_fma_f32 v146, s65, v146, v178
    v_fma_f32 v147, s65, v147, v179
    v_fma_f32 v148, s65, v148, v180
    v_fma_f32 v149, s65, v149, v181
    v_fma_f32 v150, s65, v150, v182
    v_fma_f32 v151, s65, v151, v183
    v_cvt_pk_bf16_f32 v140, v144, v145
    v_cvt_pk_bf16_f32 v141, v146, v147
    v_cvt_pk_bf16_f32 v142, v148, v149
    v_cvt_pk_bf16_f32 v143, v150, v151
    buffer_store_dwordx4 v[140:143], v237, s[48:51], 0 offen offset:512
Lend_1:
    s_endpgm
.section .rodata,"a"
.p2align 6
.amdhsa_kernel parallel_sum__ssm_conv_h3__dense_activation_mish__prompt_kernel
  .amdhsa_next_free_vgpr 256
  .amdhsa_next_free_sgpr 102
  .amdhsa_accum_offset 256
  .amdhsa_group_segment_fixed_size 0
  .amdhsa_kernarg_size 104
  .amdhsa_user_sgpr_count 2
  .amdhsa_user_sgpr_kernarg_segment_ptr 1
  .amdhsa_system_sgpr_workgroup_id_x 1
.end_amdhsa_kernel
```
